```python
import torch

def _softmax(x, axis=-1):
    return torch.softmax(x, dim=axis)
def _gelu(x):
    return torch.nn.functional.gelu(x, approximate="tanh")
def _silu(x):
    return torch.nn.functional.silu(x)
def _sigmoid(x):
    return torch.sigmoid(x)
def _layernorm(x, axis=-1, eps=1e-5):
    m = x.mean(dim=axis, keepdim=True)
    v = x.var(dim=axis, keepdim=True, unbiased=False)
    return (x - m) / torch.sqrt(v + eps)
def _scatter_add(tgt, idx, src, axis=0):
    return tgt.clone().index_add_(axis, idx, src)
def _segment_sum(src, seg, n):
    out = torch.zeros((n,) + src.shape[1:], dtype=src.dtype)
    return out.index_add_(0, seg, src)
def _pad(x, pw):
    flat = tuple(v for pair in reversed(pw) for v in pair)
    return torch.nn.functional.pad(x, flat)

kernel_name = 'recurrent_scan__compressed_kv_cla__mixer_s_mlp__prompt'

def setup_inputs():

    _w = (lambda a: (lambda t: t.to(torch.bfloat16) if t.is_floating_point() else t)(torch.as_tensor(a)))
    def _A_setup():
        B, H, Sq, Sk, D, M = 1, 32, 2048, 2048, 128, 512
        Dc = 4 * D
        return {
            "x": _w((lambda *s: torch.randn(*s, dtype=torch.bfloat16) * 0.05)(B, Sq, M)),
            "c_kv": _w((lambda *s: torch.randn(*s, dtype=torch.bfloat16) * 0.2)(B, Sk, Dc)),
            "w_q": _w((lambda *s: torch.randn(*s, dtype=torch.bfloat16) * 3.2)(M, H, D) * (M ** -0.5)),
            "w_uk": _w((lambda *s: torch.randn(*s, dtype=torch.bfloat16) * 3.2)(Dc, H, D) * (Dc ** -0.5)),
            "w_uv": _w((lambda *s: torch.randn(*s, dtype=torch.bfloat16) * 0.2)(Dc, H, D) * (Dc ** -0.5)),
            "w_o": _w((lambda *s: torch.randn(*s, dtype=torch.bfloat16) * 0.2)(H, D, M) * ((H * D) ** -0.5)),
        }
    _A_in = _A_setup()

    def _B_setup():
        B, S, D, F = 1, 2048, 512, 1792
        return {
            "x":  _w((lambda *s: torch.randn(*s, dtype=torch.bfloat16) * 0.05)(B, S, D)),
            "w1": _w((lambda *s: torch.randn(*s, dtype=torch.bfloat16) * 1.6)(D, D) * (D ** -0.5)),
            "w2": _w((lambda *s: torch.randn(*s, dtype=torch.bfloat16) * 1.6)(D, D) * (D ** -0.5)),
            "w3": _w((lambda *s: torch.randn(*s, dtype=torch.bfloat16) * 1.6)(D, F) * (D ** -0.5)),
            "w4": _w((lambda *s: torch.randn(*s, dtype=torch.bfloat16) * 1.6)(F, D) * (F ** -0.5)),
        }
    _B_in = _B_setup()

    return {
        "A_x": _A_in["x"],
        "A_c_kv": _A_in["c_kv"],
        "A_w_q": _A_in["w_q"],
        "A_w_uk": _A_in["w_uk"],
        "A_w_uv": _A_in["w_uv"],
        "A_w_o": _A_in["w_o"],
        "B_x": _B_in["x"],
        "B_w1": _B_in["w1"],
        "B_w2": _B_in["w2"],
        "B_w3": _B_in["w3"],
        "B_w4": _B_in["w4"],
    }

def reference(A_x, A_c_kv, A_w_q, A_w_uk, A_w_uv, A_w_o, B_x, B_w1, B_w2, B_w3, B_w4):
    def _A_ref(x, c_kv, w_q, w_uk, w_uv, w_o):
        B, Sq, M = x.shape[0], x.shape[1], x.shape[2]
        Sk = c_kv.shape[1]
        H, D = w_q.shape[1], w_q.shape[2]
        q = torch.einsum("bqm,mhd->bhqd", x, w_q)
        k = torch.einsum("bkc,chd->bhkd", c_kv, w_uk)
        v = torch.einsum("bkc,chd->bhkd", c_kv, w_uv)
        scores = torch.einsum("bhqd,bhkd->bhqk", q, k) * (D ** -0.5)
        off = Sk - Sq
        qi = torch.arange(Sq)[:, None]
        kj = torch.arange(Sk)[None, :]
        cmask = kj <= (qi + off)
        scores = torch.where(cmask[None, None], scores, -1e9)
        p = _softmax(scores, axis=-1)
        ctx = torch.einsum("bhqk,bhkd->bhqd", p, v)
        return torch.einsum("bhqd,hdm->bqm", ctx, w_o)

    def _B_ref(x, w1, w2, w3, w4):
        B, S, D = x.shape
        h = _gelu(_layernorm(x, axis=-1) @ w1)
        c = D // 4
        g0 = _pad(h[:, :, 0*c:1*c], ((0, 0), (1, 0), (0, 0)))[:, :S, :]
        g1 = _pad(h[:, :, 1*c:2*c], ((0, 0), (0, 1), (0, 0)))[:, 1:, :]
        g2 = _pad(h[:, :, 2*c:3*c], ((0, 0), (2, 0), (0, 0)))[:, :S, :]
        g3 = _pad(h[:, :, 3*c:   ], ((0, 0), (0, 2), (0, 0)))[:, 2:, :]
        hs = torch.concatenate([g0, g1, g2, g3], axis=-1) @ w2
        x1 = x + hs
        h2 = _gelu(_layernorm(x1, axis=-1) @ w3) @ w4
        return x1 + h2

    x = A_x
    xn = _layernorm(x, axis=-1)
    s = _A_ref(xn, A_c_kv, A_w_q, A_w_uk, A_w_uv, A_w_o)
    g = _silu(_B_ref(xn, B_w1, B_w2, B_w3, B_w4))
    return x + s * g
```

```asm
; @launch kernel=main_kernel grid=(256,1,1) block=(256,1,1) lds=163840
; @launch kernel=fin_kernel grid=(256,1,1) block=(256,1,1) lds=131072
.amdgcn_target "amdgcn-amd-amdhsa--gfx950"
.text
.globl main_kernel
.p2align 8
.type main_kernel,@function
main_kernel:
    s_cmp_ge_u32 s2, 256
    s_cbranch_scc1 END_100001
    s_getpc_b64 s[62:63]
PC_100002:
    s_lshr_b32 s3, s2, 3
    s_and_b32 s3, s3, 7
    s_lshl_b32 s3, s3, 14
    v_lshlrev_b32 v255, 6, v0
    v_add_u32 v255, s3, v255
    v_min_u32 v255, END_100001-PC_100002, v255
    v_mov_b32 v253, s63
    v_add_co_u32 v252, vcc, s62, v255
    s_nop 1
    v_addc_co_u32 v253, vcc, 0, v253, vcc
    global_load_dword v254, v[252:253], off
    s_load_dwordx2 s[40:41], s[0:1], 8
    s_load_dwordx2 s[42:43], s[0:1], 24
    s_load_dwordx2 s[44:45], s[0:1], 32
    s_load_dwordx2 s[46:47], s[0:1], 104
    s_load_dwordx2 s[36:37], s[0:1], 0
    s_load_dwordx2 s[52:53], s[0:1], 56
    s_load_dwordx2 s[84:85], s[0:1], 96
    v_lshrrev_b32 v1, 6, v0
    v_and_b32 v2, 63, v0
    v_readfirstlane_b32 s16, v1
    v_lshrrev_b32 v33, 5, v0
    v_and_b32 v34, 31, v0
    s_lshl_b32 s19, s2, 3
    v_add_u32 v33, s19, v33
    v_lshlrev_b32 v35, 10, v33
    v_lshl_add_u32 v35, v34, 4, v35
    v_lshrrev_b32 v36, 4, v33
    v_lshlrev_b32 v36, 14, v36
    v_lshrrev_b32 v37, 2, v34
    v_lshl_add_u32 v36, v37, 10, v36
    v_and_b32 v37, 3, v34
    v_and_b32 v38, 15, v33
    v_lshl_add_u32 v37, v37, 4, v38
    v_lshl_add_u32 v36, v37, 4, v36
    v_add_u32 v37, 8192, v36
    s_and_b32 s17, s2, 7
    s_lshr_b32 s18, s2, 3
    s_and_b32 s18, s18, 3
    s_lshl_b32 s18, s18, 3
    s_add_u32 s17, s17, s18
    s_lshr_b32 s18, s2, 5
    s_waitcnt lgkmcnt(0)
    s_mov_b32 s38, 0x200000
    s_mov_b32 s39, 0x00020000
    buffer_load_dwordx4 a[160:163], v35, s[36:39], 0 offen
    buffer_load_dwordx4 a[164:167], v35, s[36:39], 0 offen offset:512
    v_mov_b32 v20, v36
    s_mov_b32 s92, 0xffff0000
    s_mov_b32 s93, 8192
    s_lshl_b32 s19, s18, 18
    s_add_u32 s4, s40, s19
    s_addc_u32 s5, s41, 0
    s_mov_b32 s6, 0x40000
    s_mov_b32 s7, 0x00020000
    s_cmp_lt_u32 s16, 2
    s_cselect_b32 s8, s42, s44
    s_cselect_b32 s9, s43, s45
    s_mov_b32 s10, 0x400000
    s_mov_b32 s11, 0x00020000
    s_lshl_b32 s19, s17, 20
    s_lshl_b32 s20, s18, 17
    s_add_u32 s19, s19, s20
    s_and_b32 s20, s16, 1
    s_lshl_b32 s20, s20, 16
    s_add_u32 s19, s19, s20
    s_add_u32 s12, s46, s19
    s_addc_u32 s13, s47, 0
    s_mov_b32 s14, 0x10000
    s_mov_b32 s15, 0x00020000
    s_mov_b32 s20, 0
    s_mov_b32 s21, 16384
    s_mov_b32 s22, 32768
    s_mov_b32 s23, 49152
    s_mov_b32 s24, 0
    s_mov_b32 s25, 32768
    s_mov_b32 s26, 131072
    s_mov_b32 s27, 163840
    s_mov_b32 s28, 262144
    s_mov_b32 s29, 294912
    s_mov_b32 s30, 393216
    s_mov_b32 s31, 425984
    s_lshl_b32 s32, s16, 13
    s_add_u32 s33, s32, 65536
    v_lshrrev_b32 v5, 3, v2
    v_and_b32 v6, 7, v2
    v_lshrrev_b32 v7, 4, v2
    s_lshl_b32 s34, s16, 16
    v_lshlrev_b32 v3, 10, v5
    v_add_u32 v3, s34, v3
    v_xor_b32 v8, v6, v7
    v_lshl_add_u32 v4, v8, 4, v3
    v_xor_b32 v8, 4, v8
    v_lshl_add_u32 v8, v8, 4, v3
    v_add_u32 v8, 8192, v8
    v_mov_b32 v3, v4
    v_mov_b32 v4, v8
    v_and_b32 v8, 3, v5
    v_lshrrev_b32 v9, 2, v5
    v_lshl_add_u32 v8, v9, 3, v8
    v_lshlrev_b32 v8, 13, v8
    v_lshrrev_b32 v9, 1, v5
    v_and_b32 v10, 1, v9
    v_lshrrev_b32 v11, 1, v9
    v_lshl_add_u32 v10, v11, 2, v10
    v_lshlrev_b32 v11, 1, v9
    s_cmp_lt_u32 s16, 2
    s_cselect_b64 vcc, -1, 0
    v_cndmask_b32 v10, v11, v10, vcc
    v_xor_b32 v10, v6, v10
    v_lshl_add_u32 v9, v10, 4, v8
    s_lshl_b32 s34, s17, 8
    s_and_b32 s35, s16, 1
    s_lshl_b32 s35, s35, 7
    s_add_u32 s34, s34, s35
    v_add_u32 v9, s34, v9
    s_add_u32 m0, s32, 0
    s_nop 0
    buffer_load_dwordx4 v3, s[4:7], s20 offen lds
    s_add_u32 m0, s33, 0
    s_nop 0
    buffer_load_dwordx4 v9, s[8:11], s24 offen lds
    s_add_u32 m0, s32, 1024
    s_nop 0
    buffer_load_dwordx4 v4, s[4:7], s20 offen lds
    s_add_u32 m0, s33, 1024
    s_nop 0
    buffer_load_dwordx4 v9, s[8:11], s25 offen lds
    s_add_u32 m0, s32, 2048
    s_nop 0
    buffer_load_dwordx4 v3, s[4:7], s21 offen lds
    s_add_u32 m0, s33, 2048
    s_nop 0
    buffer_load_dwordx4 v9, s[8:11], s26 offen lds
    s_add_u32 m0, s32, 3072
    s_nop 0
    buffer_load_dwordx4 v4, s[4:7], s21 offen lds
    s_add_u32 m0, s33, 3072
    s_nop 0
    buffer_load_dwordx4 v9, s[8:11], s27 offen lds
    s_add_u32 m0, s32, 4096
    s_nop 0
    buffer_load_dwordx4 v3, s[4:7], s22 offen lds
    s_add_u32 m0, s33, 4096
    s_nop 0
    buffer_load_dwordx4 v9, s[8:11], s28 offen lds
    s_add_u32 m0, s32, 5120
    s_nop 0
    buffer_load_dwordx4 v4, s[4:7], s22 offen lds
    s_add_u32 m0, s33, 5120
    s_nop 0
    buffer_load_dwordx4 v9, s[8:11], s29 offen lds
    s_add_u32 m0, s32, 6144
    s_nop 0
    buffer_load_dwordx4 v3, s[4:7], s23 offen lds
    s_add_u32 m0, s33, 6144
    s_nop 0
    buffer_load_dwordx4 v9, s[8:11], s30 offen lds
    s_add_u32 m0, s32, 7168
    s_nop 0
    buffer_load_dwordx4 v4, s[4:7], s23 offen lds
    s_add_u32 m0, s33, 7168
    s_nop 0
    buffer_load_dwordx4 v9, s[8:11], s31 offen lds
    s_add_u32 s4, s4, 128
    s_addc_u32 s5, s5, 0
    s_add_u32 s8, s8, 524288
    s_addc_u32 s9, s9, 0
    s_add_u32 m0, s32, 32768
    s_nop 0
    buffer_load_dwordx4 v3, s[4:7], s20 offen lds
    s_add_u32 m0, s33, 32768
    s_nop 0
    buffer_load_dwordx4 v9, s[8:11], s24 offen lds
    s_add_u32 m0, s32, 33792
    s_nop 0
    buffer_load_dwordx4 v4, s[4:7], s20 offen lds
    s_add_u32 m0, s33, 33792
    s_nop 0
    buffer_load_dwordx4 v9, s[8:11], s25 offen lds
    s_add_u32 m0, s32, 34816
    s_nop 0
    buffer_load_dwordx4 v3, s[4:7], s21 offen lds
    s_add_u32 m0, s33, 34816
    s_nop 0
    buffer_load_dwordx4 v9, s[8:11], s26 offen lds
    s_add_u32 m0, s32, 35840
    s_nop 0
    buffer_load_dwordx4 v4, s[4:7], s21 offen lds
    s_add_u32 m0, s33, 35840
    s_nop 0
    buffer_load_dwordx4 v9, s[8:11], s27 offen lds
    s_add_u32 m0, s32, 36864
    s_nop 0
    buffer_load_dwordx4 v3, s[4:7], s22 offen lds
    s_add_u32 m0, s33, 36864
    s_nop 0
    buffer_load_dwordx4 v9, s[8:11], s28 offen lds
    s_add_u32 m0, s32, 37888
    s_nop 0
    buffer_load_dwordx4 v4, s[4:7], s22 offen lds
    s_add_u32 m0, s33, 37888
    s_nop 0
    buffer_load_dwordx4 v9, s[8:11], s29 offen lds
    s_add_u32 m0, s32, 38912
    s_nop 0
    buffer_load_dwordx4 v3, s[4:7], s23 offen lds
    s_add_u32 m0, s33, 38912
    s_nop 0
    buffer_load_dwordx4 v9, s[8:11], s30 offen lds
    s_add_u32 m0, s32, 39936
    s_nop 0
    buffer_load_dwordx4 v4, s[4:7], s23 offen lds
    s_add_u32 m0, s33, 39936
    s_nop 0
    buffer_load_dwordx4 v9, s[8:11], s31 offen lds
    s_add_u32 s4, s4, 128
    s_addc_u32 s5, s5, 0
    s_add_u32 s8, s8, 524288
    s_addc_u32 s9, s9, 0
    v_lshlrev_b32 v23, 4, v0
    s_mov_b32 s48, s40
    s_mov_b32 s49, s41
    s_mov_b32 s50, 0x200000
    s_mov_b32 s51, 0x00020000
    s_lshl_b32 s34, s2, 13
    buffer_load_dwordx4 a[252:255], v23, s[48:51], s34 offen
    s_lshl_b32 s34, s2, 13
    s_add_u32 s34, s34, 4096
    buffer_load_dwordx4 a[252:255], v23, s[48:51], s34 offen
    s_mov_b32 s48, s42
    s_mov_b32 s49, s43
    s_mov_b32 s50, 0x400000
    s_mov_b32 s51, 0x00020000
    s_lshl_b32 s34, s2, 14
    buffer_load_dwordx4 a[252:255], v23, s[48:51], s34 offen
    s_lshl_b32 s34, s2, 14
    s_add_u32 s34, s34, 4096
    buffer_load_dwordx4 a[252:255], v23, s[48:51], s34 offen
    s_lshl_b32 s34, s2, 14
    s_add_u32 s34, s34, 8192
    buffer_load_dwordx4 a[252:255], v23, s[48:51], s34 offen
    s_lshl_b32 s34, s2, 14
    s_add_u32 s34, s34, 12288
    buffer_load_dwordx4 a[252:255], v23, s[48:51], s34 offen
    s_mov_b32 s48, s44
    s_mov_b32 s49, s45
    s_mov_b32 s50, 0x400000
    s_mov_b32 s51, 0x00020000
    s_lshl_b32 s34, s2, 14
    buffer_load_dwordx4 a[252:255], v23, s[48:51], s34 offen
    s_lshl_b32 s34, s2, 14
    s_add_u32 s34, s34, 4096
    buffer_load_dwordx4 a[252:255], v23, s[48:51], s34 offen
    s_lshl_b32 s34, s2, 14
    s_add_u32 s34, s34, 8192
    buffer_load_dwordx4 a[252:255], v23, s[48:51], s34 offen
    s_lshl_b32 s34, s2, 14
    s_add_u32 s34, s34, 12288
    buffer_load_dwordx4 a[252:255], v23, s[48:51], s34 offen
    v_and_b32 v12, 15, v2
    v_lshrrev_b32 v13, 1, v12
    v_xor_b32 v13, v7, v13
    v_lshlrev_b32 v10, 7, v12
    v_lshl_add_u32 v10, v13, 4, v10
    s_and_b32 s34, s16, 1
    s_lshl_b32 s34, s34, 14
    v_add_u32 v10, s34, v10
    v_xor_b32 v11, 64, v10
    v_lshrrev_b32 v13, 2, v12
    v_and_b32 v14, 1, v7
    v_lshl_add_u32 v13, v14, 2, v13
    v_lshrrev_b32 v14, 1, v7
    v_lshlrev_b32 v14, 11, v14
    v_lshl_add_u32 v14, v13, 7, v14
    v_and_b32 v15, 1, v12
    v_lshl_add_u32 v14, v15, 3, v14
    s_lshr_b32 s34, s16, 1
    s_lshl_b32 s34, s34, 14
    s_add_u32 s34, s34, 65536
    v_add_u32 v14, s34, v14
    v_lshrrev_b32 v13, 1, v13
    v_and_b32 v15, 1, v13
    v_lshrrev_b32 v16, 1, v13
    v_lshl_add_u32 v15, v16, 2, v15
    v_lshlrev_b32 v16, 1, v13
    v_bfe_u32 v17, v12, 1, 1
    v_lshlrev_b32 v18, 1, v17
    v_xor_b32 v15, v15, v18
    v_xor_b32 v16, v16, v17
    s_cmp_lt_u32 s16, 2
    s_cselect_b64 vcc, -1, 0
    v_cndmask_b32 v15, v16, v15, vcc
    s_cselect_b32 s34, 1, 2
    s_cselect_b32 s35, 5, 6
    v_lshl_add_u32 v5, v15, 4, v14
    v_xor_b32 v16, s34, v15
    v_lshl_add_u32 v6, v16, 4, v14
    v_xor_b32 v16, 4, v15
    v_lshl_add_u32 v7, v16, 4, v14
    v_xor_b32 v16, s35, v15
    v_lshl_add_u32 v8, v16, 4, v14
    s_and_b32 s34, s2, 7
    s_lshr_b32 s19, s2, 6
    s_and_b32 s19, s19, 3
    s_lshl_b32 s19, s19, 3
    s_add_u32 s34, s34, s19
    s_lshr_b32 s35, s2, 3
    s_and_b32 s35, s35, 7
    s_lshl_b32 s88, s34, 3
    s_add_u32 s88, s88, 4
    s_lshl_b32 s19, s34, 6
    s_lshr_b32 s61, s16, 1
    s_lshl_b32 s61, s61, 5
    s_add_u32 s19, s19, s61
    v_and_b32 v12, 31, v2
    v_add_u32 v12, s19, v12
    v_lshrrev_b32 v13, 5, v2
    v_lshlrev_b32 v13, 8, v13
    v_lshrrev_b32 v14, 4, v12
    v_lshlrev_b32 v14, 14, v14
    v_and_b32 v15, 15, v12
    v_lshl_add_u32 v14, v15, 4, v14
    v_add_u32 v1, v14, v13
    v_lshrrev_b32 v14, 3, v2
    v_lshlrev_b32 v14, 10, v14
    v_bfe_u32 v15, v2, 4, 1
    v_lshlrev_b32 v15, 2, v15
    v_and_b32 v16, 7, v2
    v_xor_b32 v15, v15, v16
    v_lshl_add_u32 v30, v15, 4, v14
    s_lshl_b32 s19, s16, 15
    v_add_u32 v30, s19, v30
    v_and_b32 v14, 15, v2
    v_lshrrev_b32 v15, 4, v2
    v_lshrrev_b32 v16, 1, v15
    v_lshlrev_b32 v16, 3, v16
    v_lshrrev_b32 v17, 2, v14
    v_add_u32 v16, v16, v17
    v_and_b32 v15, 1, v15
    v_lshlrev_b32 v15, 1, v15
    v_and_b32 v17, 1, v14
    v_add_u32 v15, v15, v17
    s_and_b32 s19, s16, 1
    s_lshl_b32 s19, s19, 2
    v_add_u32 v15, s19, v15
    v_bfe_u32 v17, v14, 3, 1
    v_lshlrev_b32 v17, 2, v17
    v_xor_b32 v15, v15, v17
    v_lshlrev_b32 v15, 4, v15
    v_lshl_add_u32 v28, v16, 7, v15
    v_bfe_u32 v17, v14, 1, 1
    v_lshl_add_u32 v28, v17, 3, v28
    v_add_u32 v29, 0x20000, v28
    s_lshl_b32 s19, s35, 7
    s_add_u32 s52, s52, s19
    s_addc_u32 s53, s53, 0
    s_sub_u32 s54, 0x80000, s19
    s_mov_b32 s55, 0x00020000
    s_add_u32 s56, s46, 0x3200000
    s_addc_u32 s57, s47, 0
    s_mov_b32 s58, 0x200000
    s_mov_b32 s59, 0x00020000
    s_add_u32 s80, s46, 0x3e00000
    s_addc_u32 s81, s47, 0
    s_mov_b32 s82, 0x200000
    s_mov_b32 s83, 0x00020000
    s_add_u32 s76, s46, 0x3000000
    s_addc_u32 s77, s47, 0
    s_mov_b32 s78, 0x200000
    s_mov_b32 s79, 0x00020000
    s_mov_b32 s86, 256
    s_mov_b32 s87, 0x00020000
    s_lshl_b32 s60, s16, 12
    s_lshl_b32 s90, s35, 1
    s_and_b32 s19, s16, 1
    s_add_u32 s90, s90, s19
    s_lshl_b32 s90, s90, 10
    s_lshr_b32 s19, s2, 3
    s_lshl_b32 s19, s19, 3
    s_add_u32 s19, s19, 4
    v_mov_b32 v22, s19
    v_bfrev_b32 v12, 1
    v_cmp_eq_u32 vcc, 0, v0
    s_nop 1
    v_cndmask_b32 v22, v12, v22, vcc
    v_mov_b32 v21, 1
    s_cmp_lt_u32 s16, 2
    s_cbranch_scc0 KVV_100003
    s_waitcnt vmcnt(26)
    s_barrier
    ds_read_b64_tr_b16 a[64:65], v5 offset:0
    ds_read_b64_tr_b16 a[66:67], v5 offset:1024
    ds_read_b128 a[32:35], v10 offset:0
    ds_read_b64_tr_b16 a[68:69], v6 offset:0
    ds_read_b64_tr_b16 a[70:71], v6 offset:1024
    ds_read_b128 a[36:39], v10 offset:2048
    ds_read_b64_tr_b16 a[72:73], v7 offset:0
    ds_read_b64_tr_b16 a[74:75], v7 offset:1024
    ds_read_b128 a[40:43], v10 offset:4096
    ds_read_b64_tr_b16 a[76:77], v8 offset:0
    ds_read_b64_tr_b16 a[78:79], v8 offset:1024
    ds_read_b128 a[44:47], v10 offset:6144
    ds_read_b64_tr_b16 a[80:81], v5 offset:8192
    ds_read_b64_tr_b16 a[82:83], v5 offset:9216
    ds_read_b128 a[48:51], v10 offset:8192
    ds_read_b64_tr_b16 a[84:85], v6 offset:8192
    ds_read_b64_tr_b16 a[86:87], v6 offset:9216
    ds_read_b128 a[52:55], v10 offset:10240
    ds_read_b64_tr_b16 a[88:89], v7 offset:8192
    ds_read_b64_tr_b16 a[90:91], v7 offset:9216
    ds_read_b128 a[56:59], v10 offset:12288
    ds_read_b64_tr_b16 a[92:93], v8 offset:8192
    ds_read_b64_tr_b16 a[94:95], v8 offset:9216
    ds_read_b128 a[60:63], v10 offset:14336
    s_waitcnt lgkmcnt(0)
    v_mfma_f32_16x16x32_bf16 v[32:35], a[64:67], a[32:35], 0
    ds_read_b64_tr_b16 a[128:129], v5 offset:4096
    v_accvgpr_read_b32 v12, a160
    v_mfma_f32_16x16x32_bf16 v[36:39], a[64:67], a[36:39], 0
    ds_read_b64_tr_b16 a[130:131], v5 offset:5120
    v_accvgpr_read_b32 v13, a161
    v_mfma_f32_16x16x32_bf16 v[40:43], a[64:67], a[40:43], 0
    ds_read_b128 a[96:99], v11 offset:0
    v_accvgpr_read_b32 v14, a162
    v_mfma_f32_16x16x32_bf16 v[44:47], a[64:67], a[44:47], 0
    ds_read_b64_tr_b16 a[132:133], v6 offset:4096
    v_accvgpr_read_b32 v15, a163
    v_mfma_f32_16x16x32_bf16 v[48:51], a[64:67], a[48:51], 0
    ds_read_b64_tr_b16 a[134:135], v6 offset:5120
    v_accvgpr_read_b32 v16, a164
    v_mfma_f32_16x16x32_bf16 v[52:55], a[64:67], a[52:55], 0
    ds_read_b128 a[100:103], v11 offset:2048
    v_accvgpr_read_b32 v17, a165
    v_mfma_f32_16x16x32_bf16 v[56:59], a[64:67], a[56:59], 0
    ds_read_b64_tr_b16 a[136:137], v7 offset:4096
    v_accvgpr_read_b32 v18, a166
    v_mfma_f32_16x16x32_bf16 v[60:63], a[64:67], a[60:63], 0
    ds_read_b64_tr_b16 a[138:139], v7 offset:5120
    v_accvgpr_read_b32 v19, a167
    v_mfma_f32_16x16x32_bf16 v[64:67], a[68:71], a[32:35], 0
    ds_read_b128 a[104:107], v11 offset:4096
    v_lshlrev_b32 v24, 16, v12
    v_mfma_f32_16x16x32_bf16 v[68:71], a[68:71], a[36:39], 0
    ds_read_b64_tr_b16 a[140:141], v8 offset:4096
    v_and_b32 v25, s92, v12
    v_mfma_f32_16x16x32_bf16 v[72:75], a[68:71], a[40:43], 0
    ds_read_b64_tr_b16 a[142:143], v8 offset:5120
    v_add_f32 v0, v24, v25
    v_mfma_f32_16x16x32_bf16 v[76:79], a[68:71], a[44:47], 0
    ds_read_b128 a[108:111], v11 offset:6144
    v_lshlrev_b32 v24, 16, v13
    v_mfma_f32_16x16x32_bf16 v[80:83], a[68:71], a[48:51], 0
    ds_read_b64_tr_b16 a[144:145], v5 offset:12288
    v_and_b32 v25, s92, v13
    v_mfma_f32_16x16x32_bf16 v[84:87], a[68:71], a[52:55], 0
    ds_read_b64_tr_b16 a[146:147], v5 offset:13312
    v_add_f32 v24, v24, v25
    v_mfma_f32_16x16x32_bf16 v[88:91], a[68:71], a[56:59], 0
    ds_read_b128 a[112:115], v11 offset:8192
    v_add_f32 v0, v0, v24
    v_mfma_f32_16x16x32_bf16 v[92:95], a[68:71], a[60:63], 0
    ds_read_b64_tr_b16 a[148:149], v6 offset:12288
    v_lshlrev_b32 v24, 16, v14
    v_mfma_f32_16x16x32_bf16 v[96:99], a[72:75], a[32:35], 0
    ds_read_b64_tr_b16 a[150:151], v6 offset:13312
    v_and_b32 v25, s92, v14
    v_mfma_f32_16x16x32_bf16 v[100:103], a[72:75], a[36:39], 0
    ds_read_b128 a[116:119], v11 offset:10240
    v_add_f32 v24, v24, v25
    v_mfma_f32_16x16x32_bf16 v[104:107], a[72:75], a[40:43], 0
    ds_read_b64_tr_b16 a[152:153], v7 offset:12288
    v_add_f32 v0, v0, v24
    v_mfma_f32_16x16x32_bf16 v[108:111], a[72:75], a[44:47], 0
    ds_read_b64_tr_b16 a[154:155], v7 offset:13312
    v_lshlrev_b32 v24, 16, v15
    v_mfma_f32_16x16x32_bf16 v[112:115], a[72:75], a[48:51], 0
    ds_read_b128 a[120:123], v11 offset:12288
    v_and_b32 v25, s92, v15
    v_mfma_f32_16x16x32_bf16 v[116:119], a[72:75], a[52:55], 0
    ds_read_b64_tr_b16 a[156:157], v8 offset:12288
    v_add_f32 v24, v24, v25
    v_mfma_f32_16x16x32_bf16 v[120:123], a[72:75], a[56:59], 0
    ds_read_b64_tr_b16 a[158:159], v8 offset:13312
    v_add_f32 v0, v0, v24
    v_mfma_f32_16x16x32_bf16 v[124:127], a[72:75], a[60:63], 0
    ds_read_b128 a[124:127], v11 offset:14336
    v_lshlrev_b32 v24, 16, v16
    v_mfma_f32_16x16x32_bf16 v[128:131], a[76:79], a[32:35], 0
    v_and_b32 v25, s92, v16
    v_add_f32 v24, v24, v25
    v_mfma_f32_16x16x32_bf16 v[132:135], a[76:79], a[36:39], 0
    v_add_f32 v0, v0, v24
    v_lshlrev_b32 v24, 16, v17
    v_mfma_f32_16x16x32_bf16 v[136:139], a[76:79], a[40:43], 0
    v_and_b32 v25, s92, v17
    v_add_f32 v24, v24, v25
    v_mfma_f32_16x16x32_bf16 v[140:143], a[76:79], a[44:47], 0
    v_add_f32 v0, v0, v24
    v_lshlrev_b32 v24, 16, v18
    v_mfma_f32_16x16x32_bf16 v[144:147], a[76:79], a[48:51], 0
    v_and_b32 v25, s92, v18
    v_add_f32 v24, v24, v25
    v_mfma_f32_16x16x32_bf16 v[148:151], a[76:79], a[52:55], 0
    v_add_f32 v0, v0, v24
    v_lshlrev_b32 v24, 16, v19
    v_mfma_f32_16x16x32_bf16 v[152:155], a[76:79], a[56:59], 0
    v_and_b32 v25, s92, v19
    v_add_f32 v24, v24, v25
    v_mfma_f32_16x16x32_bf16 v[156:159], a[76:79], a[60:63], 0
    v_add_f32 v0, v0, v24
    s_nop 1
    v_add_f32_dpp v0, v0, v0 quad_perm:[1,0,3,2] row_mask:0xf bank_mask:0xf
    v_mfma_f32_16x16x32_bf16 v[160:163], a[80:83], a[32:35], 0
    s_nop 1
    v_add_f32_dpp v0, v0, v0 quad_perm:[2,3,0,1] row_mask:0xf bank_mask:0xf
    s_nop 1
    v_add_f32_dpp v0, v0, v0 row_half_mirror row_mask:0xf bank_mask:0xf
    v_mfma_f32_16x16x32_bf16 v[164:167], a[80:83], a[36:39], 0
    s_nop 1
    v_add_f32_dpp v0, v0, v0 row_mirror row_mask:0xf bank_mask:0xf
    v_mov_b32 v24, v0
    v_mfma_f32_16x16x32_bf16 v[168:171], a[80:83], a[40:43], 0
    s_nop 1
    v_permlane16_swap_b32 v0, v24
    s_nop 1
    v_add_f32 v0, v0, v24
    v_mfma_f32_16x16x32_bf16 v[172:175], a[80:83], a[44:47], 0
    v_mul_f32 v0, 0x3b000000, v0
    v_lshlrev_b32 v24, 16, v12
    v_mfma_f32_16x16x32_bf16 v[176:179], a[80:83], a[48:51], 0
    v_and_b32 v25, s92, v12
    v_sub_f32 v24, v24, v0
    v_mfma_f32_16x16x32_bf16 v[180:183], a[80:83], a[52:55], 0
    v_sub_f32 v25, v25, v0
    v_mul_f32 v27, v24, v24
    v_mfma_f32_16x16x32_bf16 v[184:187], a[80:83], a[56:59], 0
    v_fma_f32 v27, v25, v25, v27
    v_lshlrev_b32 v24, 16, v13
    v_mfma_f32_16x16x32_bf16 v[188:191], a[80:83], a[60:63], 0
    v_and_b32 v25, s92, v13
    v_sub_f32 v24, v24, v0
    v_mfma_f32_16x16x32_bf16 v[192:195], a[84:87], a[32:35], 0
    v_sub_f32 v25, v25, v0
    v_fma_f32 v27, v24, v24, v27
    v_mfma_f32_16x16x32_bf16 v[196:199], a[84:87], a[36:39], 0
    v_fma_f32 v27, v25, v25, v27
    v_lshlrev_b32 v24, 16, v14
    v_mfma_f32_16x16x32_bf16 v[200:203], a[84:87], a[40:43], 0
    v_and_b32 v25, s92, v14
    v_sub_f32 v24, v24, v0
    v_mfma_f32_16x16x32_bf16 v[204:207], a[84:87], a[44:47], 0
    v_sub_f32 v25, v25, v0
    v_fma_f32 v27, v24, v24, v27
    v_mfma_f32_16x16x32_bf16 v[208:211], a[84:87], a[48:51], 0
    v_fma_f32 v27, v25, v25, v27
    v_lshlrev_b32 v24, 16, v15
    v_mfma_f32_16x16x32_bf16 v[212:215], a[84:87], a[52:55], 0
    v_and_b32 v25, s92, v15
    v_sub_f32 v24, v24, v0
    v_mfma_f32_16x16x32_bf16 v[216:219], a[84:87], a[56:59], 0
    v_sub_f32 v25, v25, v0
    v_fma_f32 v27, v24, v24, v27
    v_mfma_f32_16x16x32_bf16 v[220:223], a[84:87], a[60:63], 0
    v_fma_f32 v27, v25, v25, v27
    v_lshlrev_b32 v24, 16, v16
    v_mfma_f32_16x16x32_bf16 v[224:227], a[88:91], a[32:35], 0
    v_and_b32 v25, s92, v16
    v_sub_f32 v24, v24, v0
    v_mfma_f32_16x16x32_bf16 v[228:231], a[88:91], a[36:39], 0
    v_sub_f32 v25, v25, v0
    v_fma_f32 v27, v24, v24, v27
    v_mfma_f32_16x16x32_bf16 v[232:235], a[88:91], a[40:43], 0
    v_fma_f32 v27, v25, v25, v27
    v_lshlrev_b32 v24, 16, v17
    v_mfma_f32_16x16x32_bf16 v[236:239], a[88:91], a[44:47], 0
    v_and_b32 v25, s92, v17
    v_sub_f32 v24, v24, v0
    v_mfma_f32_16x16x32_bf16 v[240:243], a[88:91], a[48:51], 0
    v_sub_f32 v25, v25, v0
    v_fma_f32 v27, v24, v24, v27
    v_mfma_f32_16x16x32_bf16 v[244:247], a[88:91], a[52:55], 0
    v_fma_f32 v27, v25, v25, v27
    v_lshlrev_b32 v24, 16, v18
    v_mfma_f32_16x16x32_bf16 v[248:251], a[88:91], a[56:59], 0
    v_and_b32 v25, s92, v18
    v_sub_f32 v24, v24, v0
    v_mfma_f32_16x16x32_bf16 v[252:255], a[88:91], a[60:63], 0
    v_sub_f32 v25, v25, v0
    v_fma_f32 v27, v24, v24, v27
    v_mfma_f32_16x16x32_bf16 a[0:3], a[92:95], a[32:35], 0
    v_fma_f32 v27, v25, v25, v27
    v_lshlrev_b32 v24, 16, v19
    v_mfma_f32_16x16x32_bf16 a[4:7], a[92:95], a[36:39], 0
    v_and_b32 v25, s92, v19
    v_sub_f32 v24, v24, v0
    v_mfma_f32_16x16x32_bf16 a[8:11], a[92:95], a[40:43], 0
    v_sub_f32 v25, v25, v0
    v_fma_f32 v27, v24, v24, v27
    v_mfma_f32_16x16x32_bf16 a[12:15], a[92:95], a[44:47], 0
    v_fma_f32 v27, v25, v25, v27
    s_nop 1
    v_add_f32_dpp v27, v27, v27 quad_perm:[1,0,3,2] row_mask:0xf bank_mask:0xf
    v_mfma_f32_16x16x32_bf16 a[16:19], a[92:95], a[48:51], 0
    s_nop 1
    v_add_f32_dpp v27, v27, v27 quad_perm:[2,3,0,1] row_mask:0xf bank_mask:0xf
    s_nop 1
    v_add_f32_dpp v27, v27, v27 row_half_mirror row_mask:0xf bank_mask:0xf
    v_mfma_f32_16x16x32_bf16 a[20:23], a[92:95], a[52:55], 0
    s_nop 1
    v_add_f32_dpp v27, v27, v27 row_mirror row_mask:0xf bank_mask:0xf
    v_mov_b32 v24, v27
    v_mfma_f32_16x16x32_bf16 a[24:27], a[92:95], a[56:59], 0
    s_nop 1
    v_permlane16_swap_b32 v27, v24
    s_nop 1
    v_add_f32 v27, v27, v24
    v_mfma_f32_16x16x32_bf16 a[28:31], a[92:95], a[60:63], 0
    v_mov_b32 v25, 0x3727c5ac
    v_fmac_f32 v25, 0x3b000000, v27
    s_waitcnt vmcnt(10) lgkmcnt(0)
    s_barrier
    v_mfma_f32_16x16x32_bf16 v[32:35], a[128:131], a[96:99], v[32:35]
    ds_read_b64_tr_b16 a[64:65], v5 offset:32768
    v_rsq_f32 v27, v25
    v_mfma_f32_16x16x32_bf16 v[36:39], a[128:131], a[100:103], v[36:39]
    ds_read_b64_tr_b16 a[66:67], v5 offset:33792
    s_add_u32 m0, s32, 0
    s_nop 0
    v_lshlrev_b32 v24, 16, v12
    v_mfma_f32_16x16x32_bf16 v[40:43], a[128:131], a[104:107], v[40:43]
    ds_read_b128 a[32:35], v10 offset:32768
    buffer_load_dwordx4 v3, s[4:7], s20 offen lds
    v_mfma_f32_16x16x32_bf16 v[44:47], a[128:131], a[108:111], v[44:47]
    ds_read_b64_tr_b16 a[68:69], v6 offset:32768
    v_and_b32 v25, s92, v12
    v_mfma_f32_16x16x32_bf16 v[48:51], a[128:131], a[112:115], v[48:51]
    ds_read_b64_tr_b16 a[70:71], v6 offset:33792
    v_sub_f32 v24, v24, v0
    v_mfma_f32_16x16x32_bf16 v[52:55], a[128:131], a[116:119], v[52:55]
    ds_read_b128 a[36:39], v10 offset:34816
    s_add_u32 m0, s33, 0
    v_sub_f32 v25, v25, v0
    v_mfma_f32_16x16x32_bf16 v[56:59], a[128:131], a[120:123], v[56:59]
    ds_read_b64_tr_b16 a[72:73], v7 offset:32768
    buffer_load_dwordx4 v9, s[8:11], s24 offen lds
    v_mfma_f32_16x16x32_bf16 v[60:63], a[128:131], a[124:127], v[60:63]
    ds_read_b64_tr_b16 a[74:75], v7 offset:33792
    v_mul_f32 v24, v24, v27
    v_mfma_f32_16x16x32_bf16 v[64:67], a[132:135], a[96:99], v[64:67]
    ds_read_b128 a[40:43], v10 offset:36864
    v_mul_f32 v25, v25, v27
    v_mfma_f32_16x16x32_bf16 v[68:71], a[132:135], a[100:103], v[68:71]
    ds_read_b64_tr_b16 a[76:77], v8 offset:32768
    s_add_u32 m0, s32, 1024
    v_cvt_pk_bf16_f32 v12, v24, v25
    v_mfma_f32_16x16x32_bf16 v[72:75], a[132:135], a[104:107], v[72:75]
    ds_read_b64_tr_b16 a[78:79], v8 offset:33792
    buffer_load_dwordx4 v4, s[4:7], s20 offen lds
    v_mfma_f32_16x16x32_bf16 v[76:79], a[132:135], a[108:111], v[76:79]
    ds_read_b128 a[44:47], v10 offset:38912
    v_lshlrev_b32 v24, 16, v13
    v_mfma_f32_16x16x32_bf16 v[80:83], a[132:135], a[112:115], v[80:83]
    ds_read_b64_tr_b16 a[80:81], v5 offset:40960
    v_and_b32 v25, s92, v13
    v_mfma_f32_16x16x32_bf16 v[84:87], a[132:135], a[116:119], v[84:87]
    ds_read_b64_tr_b16 a[82:83], v5 offset:41984
    s_add_u32 m0, s33, 1024
    v_sub_f32 v24, v24, v0
    v_mfma_f32_16x16x32_bf16 v[88:91], a[132:135], a[120:123], v[88:91]
    ds_read_b128 a[48:51], v10 offset:40960
    buffer_load_dwordx4 v9, s[8:11], s25 offen lds
    v_mfma_f32_16x16x32_bf16 v[92:95], a[132:135], a[124:127], v[92:95]
    ds_read_b64_tr_b16 a[84:85], v6 offset:40960
    v_sub_f32 v25, v25, v0
    v_mfma_f32_16x16x32_bf16 v[96:99], a[136:139], a[96:99], v[96:99]
    ds_read_b64_tr_b16 a[86:87], v6 offset:41984
    v_mul_f32 v24, v24, v27
    v_mfma_f32_16x16x32_bf16 v[100:103], a[136:139], a[100:103], v[100:103]
    ds_read_b128 a[52:55], v10 offset:43008
    s_add_u32 m0, s32, 2048
    v_mul_f32 v25, v25, v27
    v_mfma_f32_16x16x32_bf16 v[104:107], a[136:139], a[104:107], v[104:107]
    ds_read_b64_tr_b16 a[88:89], v7 offset:40960
    buffer_load_dwordx4 v3, s[4:7], s21 offen lds
    v_mfma_f32_16x16x32_bf16 v[108:111], a[136:139], a[108:111], v[108:111]
    ds_read_b64_tr_b16 a[90:91], v7 offset:41984
    v_cvt_pk_bf16_f32 v13, v24, v25
    v_mfma_f32_16x16x32_bf16 v[112:115], a[136:139], a[112:115], v[112:115]
    ds_read_b128 a[56:59], v10 offset:45056
    v_lshlrev_b32 v24, 16, v14
    v_mfma_f32_16x16x32_bf16 v[116:119], a[136:139], a[116:119], v[116:119]
    ds_read_b64_tr_b16 a[92:93], v8 offset:40960
    s_add_u32 m0, s33, 2048
    v_and_b32 v25, s92, v14
    v_mfma_f32_16x16x32_bf16 v[120:123], a[136:139], a[120:123], v[120:123]
    ds_read_b64_tr_b16 a[94:95], v8 offset:41984
    buffer_load_dwordx4 v9, s[8:11], s26 offen lds
    v_mfma_f32_16x16x32_bf16 v[124:127], a[136:139], a[124:127], v[124:127]
    ds_read_b128 a[60:63], v10 offset:47104
    v_sub_f32 v24, v24, v0
    v_mfma_f32_16x16x32_bf16 v[128:131], a[140:143], a[96:99], v[128:131]
    v_sub_f32 v25, v25, v0
    v_mul_f32 v24, v24, v27
    v_mfma_f32_16x16x32_bf16 v[132:135], a[140:143], a[100:103], v[132:135]
    s_add_u32 m0, s32, 3072
    v_mul_f32 v25, v25, v27
    v_cvt_pk_bf16_f32 v14, v24, v25
    v_mfma_f32_16x16x32_bf16 v[136:139], a[140:143], a[104:107], v[136:139]
    buffer_load_dwordx4 v4, s[4:7], s21 offen lds
    v_lshlrev_b32 v24, 16, v15
    v_mfma_f32_16x16x32_bf16 v[140:143], a[140:143], a[108:111], v[140:143]
    v_and_b32 v25, s92, v15
    v_sub_f32 v24, v24, v0
    v_mfma_f32_16x16x32_bf16 v[144:147], a[140:143], a[112:115], v[144:147]
    v_sub_f32 v25, v25, v0
    v_mul_f32 v24, v24, v27
    v_mfma_f32_16x16x32_bf16 v[148:151], a[140:143], a[116:119], v[148:151]
    s_add_u32 m0, s33, 3072
    v_mul_f32 v25, v25, v27
    v_cvt_pk_bf16_f32 v15, v24, v25
    v_mfma_f32_16x16x32_bf16 v[152:155], a[140:143], a[120:123], v[152:155]
    s_load_dwordx2 s[36:37], s[0:1], 56
    buffer_load_dwordx4 v9, s[8:11], s27 offen lds
    v_lshlrev_b32 v24, 16, v16
    v_mfma_f32_16x16x32_bf16 v[156:159], a[140:143], a[124:127], v[156:159]
    s_load_dwordx2 s[48:49], s[0:1], 64
    v_and_b32 v25, s92, v16
    v_sub_f32 v24, v24, v0
    v_mfma_f32_16x16x32_bf16 v[160:163], a[144:147], a[96:99], v[160:163]
    v_sub_f32 v25, v25, v0
    v_mul_f32 v24, v24, v27
    v_mfma_f32_16x16x32_bf16 v[164:167], a[144:147], a[100:103], v[164:167]
    s_add_u32 m0, s32, 4096
    v_mul_f32 v25, v25, v27
    v_cvt_pk_bf16_f32 v16, v24, v25
    v_mfma_f32_16x16x32_bf16 v[168:171], a[144:147], a[104:107], v[168:171]
    buffer_load_dwordx4 v3, s[4:7], s22 offen lds
    v_lshlrev_b32 v24, 16, v17
    v_mfma_f32_16x16x32_bf16 v[172:175], a[144:147], a[108:111], v[172:175]
    v_and_b32 v25, s92, v17
    v_sub_f32 v24, v24, v0
    v_mfma_f32_16x16x32_bf16 v[176:179], a[144:147], a[112:115], v[176:179]
    v_sub_f32 v25, v25, v0
    v_mul_f32 v24, v24, v27
    v_mfma_f32_16x16x32_bf16 v[180:183], a[144:147], a[116:119], v[180:183]
    s_add_u32 m0, s32, 5120
    v_mul_f32 v25, v25, v27
    v_cvt_pk_bf16_f32 v17, v24, v25
    v_mfma_f32_16x16x32_bf16 v[184:187], a[144:147], a[120:123], v[184:187]
    buffer_load_dwordx4 v4, s[4:7], s22 offen lds
    v_lshlrev_b32 v24, 16, v18
    v_mfma_f32_16x16x32_bf16 v[188:191], a[144:147], a[124:127], v[188:191]
    v_and_b32 v25, s92, v18
    v_sub_f32 v24, v24, v0
    v_mfma_f32_16x16x32_bf16 v[192:195], a[148:151], a[96:99], v[192:195]
    v_sub_f32 v25, v25, v0
    v_mul_f32 v24, v24, v27
    v_mfma_f32_16x16x32_bf16 v[196:199], a[148:151], a[100:103], v[196:199]
    s_add_u32 m0, s32, 6144
    v_mul_f32 v25, v25, v27
    v_cvt_pk_bf16_f32 v18, v24, v25
    v_mfma_f32_16x16x32_bf16 v[200:203], a[148:151], a[104:107], v[200:203]
    buffer_load_dwordx4 v3, s[4:7], s23 offen lds
    v_lshlrev_b32 v24, 16, v19
    v_mfma_f32_16x16x32_bf16 v[204:207], a[148:151], a[108:111], v[204:207]
    v_and_b32 v25, s92, v19
    v_sub_f32 v24, v24, v0
    v_mfma_f32_16x16x32_bf16 v[208:211], a[148:151], a[112:115], v[208:211]
    v_sub_f32 v25, v25, v0
    v_mul_f32 v24, v24, v27
    v_mfma_f32_16x16x32_bf16 v[212:215], a[148:151], a[116:119], v[212:215]
    s_add_u32 m0, s32, 7168
    v_mul_f32 v25, v25, v27
    v_cvt_pk_bf16_f32 v19, v24, v25
    v_mfma_f32_16x16x32_bf16 v[216:219], a[148:151], a[120:123], v[216:219]
    buffer_load_dwordx4 v4, s[4:7], s23 offen lds
    v_mfma_f32_16x16x32_bf16 v[220:223], a[148:151], a[124:127], v[220:223]
    v_mfma_f32_16x16x32_bf16 v[224:227], a[152:155], a[96:99], v[224:227]
    v_mfma_f32_16x16x32_bf16 v[228:231], a[152:155], a[100:103], v[228:231]
    v_mfma_f32_16x16x32_bf16 v[232:235], a[152:155], a[104:107], v[232:235]
    v_mfma_f32_16x16x32_bf16 v[236:239], a[152:155], a[108:111], v[236:239]
    v_mfma_f32_16x16x32_bf16 v[240:243], a[152:155], a[112:115], v[240:243]
    v_mfma_f32_16x16x32_bf16 v[244:247], a[152:155], a[116:119], v[244:247]
    v_mfma_f32_16x16x32_bf16 v[248:251], a[152:155], a[120:123], v[248:251]
    v_mfma_f32_16x16x32_bf16 v[252:255], a[152:155], a[124:127], v[252:255]
    v_mfma_f32_16x16x32_bf16 a[0:3], a[156:159], a[96:99], a[0:3]
    v_mfma_f32_16x16x32_bf16 a[4:7], a[156:159], a[100:103], a[4:7]
    v_mfma_f32_16x16x32_bf16 a[8:11], a[156:159], a[104:107], a[8:11]
    buffer_store_dwordx4 v[12:15], v20, s[76:79], 0 offen sc1
    buffer_store_dwordx4 v[16:19], v20, s[76:79], s93 offen sc1
    v_mfma_f32_16x16x32_bf16 a[12:15], a[156:159], a[108:111], a[12:15]
    v_lshlrev_b32 v24, 16, v12
    v_and_b32 v25, s92, v12
    v_mfma_f32_16x16x32_bf16 a[16:19], a[156:159], a[112:115], a[16:19]
    v_add_f32 v0, v24, v25
    v_lshlrev_b32 v24, 16, v13
    v_mfma_f32_16x16x32_bf16 a[20:23], a[156:159], a[116:119], a[20:23]
    v_and_b32 v25, s92, v13
    v_add_f32 v24, v24, v25
    v_mfma_f32_16x16x32_bf16 a[24:27], a[156:159], a[120:123], a[24:27]
    s_add_u32 s4, s4, 128
    s_addc_u32 s5, s5, 0
    v_add_f32 v0, v0, v24
    v_lshlrev_b32 v24, 16, v14
    v_mfma_f32_16x16x32_bf16 a[28:31], a[156:159], a[124:127], a[28:31]
    v_and_b32 v25, s92, v14
    v_add_f32 v24, v24, v25
    s_waitcnt lgkmcnt(0)
    v_mfma_f32_16x16x32_bf16 v[32:35], a[64:67], a[32:35], v[32:35]
    ds_read_b64_tr_b16 a[128:129], v5 offset:36864
    v_add_f32 v0, v0, v24
    v_mfma_f32_16x16x32_bf16 v[36:39], a[64:67], a[36:39], v[36:39]
    ds_read_b64_tr_b16 a[130:131], v5 offset:37888
    s_add_u32 m0, s33, 4096
    v_lshlrev_b32 v24, 16, v15
    v_mfma_f32_16x16x32_bf16 v[40:43], a[64:67], a[40:43], v[40:43]
    ds_read_b128 a[96:99], v11 offset:32768
    buffer_load_dwordx4 v9, s[8:11], s28 offen lds
    v_mfma_f32_16x16x32_bf16 v[44:47], a[64:67], a[44:47], v[44:47]
    ds_read_b64_tr_b16 a[132:133], v6 offset:36864
    v_and_b32 v25, s92, v15
    v_mfma_f32_16x16x32_bf16 v[48:51], a[64:67], a[48:51], v[48:51]
    ds_read_b64_tr_b16 a[134:135], v6 offset:37888
    v_add_f32 v24, v24, v25
    v_mfma_f32_16x16x32_bf16 v[52:55], a[64:67], a[52:55], v[52:55]
    ds_read_b128 a[100:103], v11 offset:34816
    v_add_f32 v0, v0, v24
    v_mfma_f32_16x16x32_bf16 v[56:59], a[64:67], a[56:59], v[56:59]
    ds_read_b64_tr_b16 a[136:137], v7 offset:36864
    v_lshlrev_b32 v24, 16, v16
    v_mfma_f32_16x16x32_bf16 v[60:63], a[64:67], a[60:63], v[60:63]
    ds_read_b64_tr_b16 a[138:139], v7 offset:37888
    v_and_b32 v25, s92, v16
    v_mfma_f32_16x16x32_bf16 v[64:67], a[68:71], a[32:35], v[64:67]
    ds_read_b128 a[104:107], v11 offset:36864
    v_add_f32 v24, v24, v25
    v_mfma_f32_16x16x32_bf16 v[68:71], a[68:71], a[36:39], v[68:71]
    ds_read_b64_tr_b16 a[140:141], v8 offset:36864
    s_add_u32 m0, s33, 5120
    v_add_f32 v0, v0, v24
    v_mfma_f32_16x16x32_bf16 v[72:75], a[68:71], a[40:43], v[72:75]
    ds_read_b64_tr_b16 a[142:143], v8 offset:37888
    buffer_load_dwordx4 v9, s[8:11], s29 offen lds
    v_mfma_f32_16x16x32_bf16 v[76:79], a[68:71], a[44:47], v[76:79]
    ds_read_b128 a[108:111], v11 offset:38912
    v_lshlrev_b32 v24, 16, v17
    v_mfma_f32_16x16x32_bf16 v[80:83], a[68:71], a[48:51], v[80:83]
    ds_read_b64_tr_b16 a[144:145], v5 offset:45056
    v_and_b32 v25, s92, v17
    v_mfma_f32_16x16x32_bf16 v[84:87], a[68:71], a[52:55], v[84:87]
    ds_read_b64_tr_b16 a[146:147], v5 offset:46080
    v_add_f32 v24, v24, v25
    v_mfma_f32_16x16x32_bf16 v[88:91], a[68:71], a[56:59], v[88:91]
    ds_read_b128 a[112:115], v11 offset:40960
    v_add_f32 v0, v0, v24
    v_mfma_f32_16x16x32_bf16 v[92:95], a[68:71], a[60:63], v[92:95]
    ds_read_b64_tr_b16 a[148:149], v6 offset:45056
    v_lshlrev_b32 v24, 16, v18
    v_mfma_f32_16x16x32_bf16 v[96:99], a[72:75], a[32:35], v[96:99]
    ds_read_b64_tr_b16 a[150:151], v6 offset:46080
    v_and_b32 v25, s92, v18
    v_mfma_f32_16x16x32_bf16 v[100:103], a[72:75], a[36:39], v[100:103]
    ds_read_b128 a[116:119], v11 offset:43008
    s_add_u32 m0, s33, 6144
    v_add_f32 v24, v24, v25
    v_mfma_f32_16x16x32_bf16 v[104:107], a[72:75], a[40:43], v[104:107]
    ds_read_b64_tr_b16 a[152:153], v7 offset:45056
    buffer_load_dwordx4 v9, s[8:11], s30 offen lds
    v_mfma_f32_16x16x32_bf16 v[108:111], a[72:75], a[44:47], v[108:111]
    ds_read_b64_tr_b16 a[154:155], v7 offset:46080
    v_add_f32 v0, v0, v24
    v_mfma_f32_16x16x32_bf16 v[112:115], a[72:75], a[48:51], v[112:115]
    ds_read_b128 a[120:123], v11 offset:45056
    v_lshlrev_b32 v24, 16, v19
    v_mfma_f32_16x16x32_bf16 v[116:119], a[72:75], a[52:55], v[116:119]
    ds_read_b64_tr_b16 a[156:157], v8 offset:45056
    v_and_b32 v25, s92, v19
    v_mfma_f32_16x16x32_bf16 v[120:123], a[72:75], a[56:59], v[120:123]
    ds_read_b64_tr_b16 a[158:159], v8 offset:46080
    v_add_f32 v24, v24, v25
    v_mfma_f32_16x16x32_bf16 v[124:127], a[72:75], a[60:63], v[124:127]
    ds_read_b128 a[124:127], v11 offset:47104
    v_add_f32 v0, v0, v24
    v_mfma_f32_16x16x32_bf16 v[128:131], a[76:79], a[32:35], v[128:131]
    s_nop 1
    v_add_f32_dpp v0, v0, v0 quad_perm:[1,0,3,2] row_mask:0xf bank_mask:0xf
    s_nop 1
    v_add_f32_dpp v0, v0, v0 quad_perm:[2,3,0,1] row_mask:0xf bank_mask:0xf
    v_mfma_f32_16x16x32_bf16 v[132:135], a[76:79], a[36:39], v[132:135]
    s_add_u32 m0, s33, 7168
    s_nop 1
    v_add_f32_dpp v0, v0, v0 row_half_mirror row_mask:0xf bank_mask:0xf
    s_nop 1
    v_add_f32_dpp v0, v0, v0 row_mirror row_mask:0xf bank_mask:0xf
    v_mfma_f32_16x16x32_bf16 v[136:139], a[76:79], a[40:43], v[136:139]
    buffer_load_dwordx4 v9, s[8:11], s31 offen lds
    v_mov_b32 v24, v0
    v_mfma_f32_16x16x32_bf16 v[140:143], a[76:79], a[44:47], v[140:143]
    s_nop 1
    v_permlane16_swap_b32 v0, v24
    s_nop 1
    v_add_f32 v0, v0, v24
    v_mfma_f32_16x16x32_bf16 v[144:147], a[76:79], a[48:51], v[144:147]
    v_mul_f32 v0, 0x3b000000, v0
    v_lshlrev_b32 v24, 16, v12
    v_mfma_f32_16x16x32_bf16 v[148:151], a[76:79], a[52:55], v[148:151]
    v_and_b32 v25, s92, v12
    v_sub_f32 v24, v24, v0
    v_mfma_f32_16x16x32_bf16 v[152:155], a[76:79], a[56:59], v[152:155]
    s_add_u32 s8, s8, 524288
    s_addc_u32 s9, s9, 0
    v_sub_f32 v25, v25, v0
    v_mul_f32 v27, v24, v24
    v_mfma_f32_16x16x32_bf16 v[156:159], a[76:79], a[60:63], v[156:159]
    v_fma_f32 v27, v25, v25, v27
    v_lshlrev_b32 v24, 16, v13
    v_mfma_f32_16x16x32_bf16 v[160:163], a[80:83], a[32:35], v[160:163]
    v_and_b32 v25, s92, v13
    v_sub_f32 v24, v24, v0
    v_mfma_f32_16x16x32_bf16 v[164:167], a[80:83], a[36:39], v[164:167]
    v_sub_f32 v25, v25, v0
    v_fma_f32 v27, v24, v24, v27
    v_mfma_f32_16x16x32_bf16 v[168:171], a[80:83], a[40:43], v[168:171]
    s_mov_b32 s38, 0x80000
    s_mov_b32 s39, 0x00020000
    s_lshl_b32 s34, s2, 12
    v_fma_f32 v27, v25, v25, v27
    v_lshlrev_b32 v24, 16, v14
    v_mfma_f32_16x16x32_bf16 v[172:175], a[80:83], a[44:47], v[172:175]
    buffer_load_dwordx4 a[252:255], v23, s[36:39], s34 offen
    v_and_b32 v25, s92, v14
    v_mfma_f32_16x16x32_bf16 v[176:179], a[80:83], a[48:51], v[176:179]
    v_sub_f32 v24, v24, v0
    v_sub_f32 v25, v25, v0
    v_mfma_f32_16x16x32_bf16 v[180:183], a[80:83], a[52:55], v[180:183]
    v_fma_f32 v27, v24, v24, v27
    v_fma_f32 v27, v25, v25, v27
    v_mfma_f32_16x16x32_bf16 v[184:187], a[80:83], a[56:59], v[184:187]
    v_lshlrev_b32 v24, 16, v15
    v_and_b32 v25, s92, v15
    v_mfma_f32_16x16x32_bf16 v[188:191], a[80:83], a[60:63], v[188:191]
    v_sub_f32 v24, v24, v0
    v_sub_f32 v25, v25, v0
    v_mfma_f32_16x16x32_bf16 v[192:195], a[84:87], a[32:35], v[192:195]
    v_fma_f32 v27, v24, v24, v27
    v_fma_f32 v27, v25, v25, v27
    v_mfma_f32_16x16x32_bf16 v[196:199], a[84:87], a[36:39], v[196:199]
    v_lshlrev_b32 v24, 16, v16
    v_and_b32 v25, s92, v16
    v_mfma_f32_16x16x32_bf16 v[200:203], a[84:87], a[40:43], v[200:203]
    s_mov_b32 s50, 0x80000
    s_mov_b32 s51, 0x00020000
    s_lshl_b32 s34, s2, 12
    v_sub_f32 v24, v24, v0
    v_sub_f32 v25, v25, v0
    v_mfma_f32_16x16x32_bf16 v[204:207], a[84:87], a[44:47], v[204:207]
    buffer_load_dwordx4 a[252:255], v23, s[48:51], s34 offen
    v_fma_f32 v27, v24, v24, v27
    v_mfma_f32_16x16x32_bf16 v[208:211], a[84:87], a[48:51], v[208:211]
    v_fma_f32 v27, v25, v25, v27
    v_lshlrev_b32 v24, 16, v17
    v_mfma_f32_16x16x32_bf16 v[212:215], a[84:87], a[52:55], v[212:215]
    v_and_b32 v25, s92, v17
    v_sub_f32 v24, v24, v0
    v_mfma_f32_16x16x32_bf16 v[216:219], a[84:87], a[56:59], v[216:219]
    v_sub_f32 v25, v25, v0
    v_fma_f32 v27, v24, v24, v27
    v_mfma_f32_16x16x32_bf16 v[220:223], a[84:87], a[60:63], v[220:223]
    v_fma_f32 v27, v25, v25, v27
    v_lshlrev_b32 v24, 16, v18
    v_mfma_f32_16x16x32_bf16 v[224:227], a[88:91], a[32:35], v[224:227]
    v_and_b32 v25, s92, v18
    v_sub_f32 v24, v24, v0
    v_mfma_f32_16x16x32_bf16 v[228:231], a[88:91], a[36:39], v[228:231]
    v_sub_f32 v25, v25, v0
    v_fma_f32 v27, v24, v24, v27
    v_mfma_f32_16x16x32_bf16 v[232:235], a[88:91], a[40:43], v[232:235]
    v_fma_f32 v27, v25, v25, v27
    v_lshlrev_b32 v24, 16, v19
    v_mfma_f32_16x16x32_bf16 v[236:239], a[88:91], a[44:47], v[236:239]
    v_and_b32 v25, s92, v19
    v_sub_f32 v24, v24, v0
    v_mfma_f32_16x16x32_bf16 v[240:243], a[88:91], a[48:51], v[240:243]
    v_sub_f32 v25, v25, v0
    v_fma_f32 v27, v24, v24, v27
    v_mfma_f32_16x16x32_bf16 v[244:247], a[88:91], a[52:55], v[244:247]
    v_fma_f32 v27, v25, v25, v27
    s_nop 1
    v_add_f32_dpp v27, v27, v27 quad_perm:[1,0,3,2] row_mask:0xf bank_mask:0xf
    v_mfma_f32_16x16x32_bf16 v[248:251], a[88:91], a[56:59], v[248:251]
    s_nop 1
    v_add_f32_dpp v27, v27, v27 quad_perm:[2,3,0,1] row_mask:0xf bank_mask:0xf
    s_nop 1
    v_add_f32_dpp v27, v27, v27 row_half_mirror row_mask:0xf bank_mask:0xf
    v_mfma_f32_16x16x32_bf16 v[252:255], a[88:91], a[60:63], v[252:255]
    s_nop 1
    v_add_f32_dpp v27, v27, v27 row_mirror row_mask:0xf bank_mask:0xf
    v_mov_b32 v24, v27
    v_mfma_f32_16x16x32_bf16 a[0:3], a[92:95], a[32:35], a[0:3]
    s_nop 1
    v_permlane16_swap_b32 v27, v24
    s_nop 1
    v_add_f32 v27, v27, v24
    v_mfma_f32_16x16x32_bf16 a[4:7], a[92:95], a[36:39], a[4:7]
    v_mov_b32 v25, 0x3727c5ac
    v_fmac_f32 v25, 0x3b000000, v27
    v_mfma_f32_16x16x32_bf16 a[8:11], a[92:95], a[40:43], a[8:11]
    v_rsq_f32 v27, v25
    s_nop 0
    v_lshlrev_b32 v24, 16, v12
    v_mfma_f32_16x16x32_bf16 a[12:15], a[92:95], a[44:47], a[12:15]
    v_and_b32 v25, s92, v12
    v_sub_f32 v24, v24, v0
    v_mfma_f32_16x16x32_bf16 a[16:19], a[92:95], a[48:51], a[16:19]
    v_sub_f32 v25, v25, v0
    v_mul_f32 v24, v24, v27
    v_mfma_f32_16x16x32_bf16 a[20:23], a[92:95], a[52:55], a[20:23]
    v_mul_f32 v25, v25, v27
    v_cvt_pk_bf16_f32 v12, v24, v25
    v_mfma_f32_16x16x32_bf16 a[24:27], a[92:95], a[56:59], a[24:27]
    v_lshlrev_b32 v24, 16, v13
    v_and_b32 v25, s92, v13
    v_mfma_f32_16x16x32_bf16 a[28:31], a[92:95], a[60:63], a[28:31]
    v_sub_f32 v24, v24, v0
    v_sub_f32 v25, v25, v0
    s_waitcnt vmcnt(8) lgkmcnt(0)
    s_barrier
    v_mfma_f32_16x16x32_bf16 v[32:35], a[128:131], a[96:99], v[32:35]
    ds_read_b64_tr_b16 a[64:65], v5 offset:0
    v_mul_f32 v24, v24, v27
    v_mfma_f32_16x16x32_bf16 v[36:39], a[128:131], a[100:103], v[36:39]
    ds_read_b64_tr_b16 a[66:67], v5 offset:1024
    s_add_u32 m0, s32, 32768
    v_mul_f32 v25, v25, v27
    v_mfma_f32_16x16x32_bf16 v[40:43], a[128:131], a[104:107], v[40:43]
    ds_read_b128 a[32:35], v10 offset:0
    buffer_load_dwordx4 v3, s[4:7], s20 offen lds
    v_mfma_f32_16x16x32_bf16 v[44:47], a[128:131], a[108:111], v[44:47]
    ds_read_b64_tr_b16 a[68:69], v6 offset:0
    v_cvt_pk_bf16_f32 v13, v24, v25
    v_mfma_f32_16x16x32_bf16 v[48:51], a[128:131], a[112:115], v[48:51]
    ds_read_b64_tr_b16 a[70:71], v6 offset:1024
    v_lshlrev_b32 v24, 16, v14
    v_mfma_f32_16x16x32_bf16 v[52:55], a[128:131], a[116:119], v[52:55]
    ds_read_b128 a[36:39], v10 offset:2048
    s_add_u32 m0, s33, 32768
    v_and_b32 v25, s92, v14
    v_mfma_f32_16x16x32_bf16 v[56:59], a[128:131], a[120:123], v[56:59]
    ds_read_b64_tr_b16 a[72:73], v7 offset:0
    buffer_load_dwordx4 v9, s[8:11], s24 offen lds
    v_mfma_f32_16x16x32_bf16 v[60:63], a[128:131], a[124:127], v[60:63]
    ds_read_b64_tr_b16 a[74:75], v7 offset:1024
    v_sub_f32 v24, v24, v0
    v_mfma_f32_16x16x32_bf16 v[64:67], a[132:135], a[96:99], v[64:67]
    ds_read_b128 a[40:43], v10 offset:4096
    v_sub_f32 v25, v25, v0
    v_mfma_f32_16x16x32_bf16 v[68:71], a[132:135], a[100:103], v[68:71]
    ds_read_b64_tr_b16 a[76:77], v8 offset:0
    s_add_u32 m0, s32, 33792
    v_mul_f32 v24, v24, v27
    v_mfma_f32_16x16x32_bf16 v[72:75], a[132:135], a[104:107], v[72:75]
    ds_read_b64_tr_b16 a[78:79], v8 offset:1024
    buffer_load_dwordx4 v4, s[4:7], s20 offen lds
    v_mfma_f32_16x16x32_bf16 v[76:79], a[132:135], a[108:111], v[76:79]
    ds_read_b128 a[44:47], v10 offset:6144
    v_mul_f32 v25, v25, v27
    v_mfma_f32_16x16x32_bf16 v[80:83], a[132:135], a[112:115], v[80:83]
    ds_read_b64_tr_b16 a[80:81], v5 offset:8192
    v_cvt_pk_bf16_f32 v14, v24, v25
    v_mfma_f32_16x16x32_bf16 v[84:87], a[132:135], a[116:119], v[84:87]
    ds_read_b64_tr_b16 a[82:83], v5 offset:9216
    s_add_u32 m0, s33, 33792
    v_lshlrev_b32 v24, 16, v15
    v_mfma_f32_16x16x32_bf16 v[88:91], a[132:135], a[120:123], v[88:91]
    ds_read_b128 a[48:51], v10 offset:8192
    buffer_load_dwordx4 v9, s[8:11], s25 offen lds
    v_mfma_f32_16x16x32_bf16 v[92:95], a[132:135], a[124:127], v[92:95]
    ds_read_b64_tr_b16 a[84:85], v6 offset:8192
    v_and_b32 v25, s92, v15
    v_mfma_f32_16x16x32_bf16 v[96:99], a[136:139], a[96:99], v[96:99]
    ds_read_b64_tr_b16 a[86:87], v6 offset:9216
    v_sub_f32 v24, v24, v0
    v_mfma_f32_16x16x32_bf16 v[100:103], a[136:139], a[100:103], v[100:103]
    ds_read_b128 a[52:55], v10 offset:10240
    s_add_u32 m0, s32, 34816
    v_sub_f32 v25, v25, v0
    v_mfma_f32_16x16x32_bf16 v[104:107], a[136:139], a[104:107], v[104:107]
    ds_read_b64_tr_b16 a[88:89], v7 offset:8192
    buffer_load_dwordx4 v3, s[4:7], s21 offen lds
    v_mfma_f32_16x16x32_bf16 v[108:111], a[136:139], a[108:111], v[108:111]
    ds_read_b64_tr_b16 a[90:91], v7 offset:9216
    v_mul_f32 v24, v24, v27
    v_mfma_f32_16x16x32_bf16 v[112:115], a[136:139], a[112:115], v[112:115]
    ds_read_b128 a[56:59], v10 offset:12288
    v_mul_f32 v25, v25, v27
    v_mfma_f32_16x16x32_bf16 v[116:119], a[136:139], a[116:119], v[116:119]
    ds_read_b64_tr_b16 a[92:93], v8 offset:8192
    s_add_u32 m0, s33, 34816
    v_cvt_pk_bf16_f32 v15, v24, v25
    v_mfma_f32_16x16x32_bf16 v[120:123], a[136:139], a[120:123], v[120:123]
    ds_read_b64_tr_b16 a[94:95], v8 offset:9216
    buffer_load_dwordx4 v9, s[8:11], s26 offen lds
    v_mfma_f32_16x16x32_bf16 v[124:127], a[136:139], a[124:127], v[124:127]
    ds_read_b128 a[60:63], v10 offset:14336
    v_lshlrev_b32 v24, 16, v16
    v_mfma_f32_16x16x32_bf16 v[128:131], a[140:143], a[96:99], v[128:131]
    v_and_b32 v25, s92, v16
    v_sub_f32 v24, v24, v0
    v_mfma_f32_16x16x32_bf16 v[132:135], a[140:143], a[100:103], v[132:135]
    s_add_u32 m0, s32, 35840
    v_sub_f32 v25, v25, v0
    v_mul_f32 v24, v24, v27
    v_mfma_f32_16x16x32_bf16 v[136:139], a[140:143], a[104:107], v[136:139]
    buffer_load_dwordx4 v4, s[4:7], s21 offen lds
    v_mul_f32 v25, v25, v27
    v_mfma_f32_16x16x32_bf16 v[140:143], a[140:143], a[108:111], v[140:143]
    v_cvt_pk_bf16_f32 v16, v24, v25
    v_lshlrev_b32 v24, 16, v17
    v_mfma_f32_16x16x32_bf16 v[144:147], a[140:143], a[112:115], v[144:147]
    v_and_b32 v25, s92, v17
    v_sub_f32 v24, v24, v0
    v_mfma_f32_16x16x32_bf16 v[148:151], a[140:143], a[116:119], v[148:151]
    s_add_u32 m0, s33, 35840
    v_sub_f32 v25, v25, v0
    v_mul_f32 v24, v24, v27
    v_mfma_f32_16x16x32_bf16 v[152:155], a[140:143], a[120:123], v[152:155]
    s_load_dwordx2 s[36:37], s[0:1], 16
    buffer_load_dwordx4 v9, s[8:11], s27 offen lds
    v_mul_f32 v25, v25, v27
    v_mfma_f32_16x16x32_bf16 v[156:159], a[140:143], a[124:127], v[156:159]
    v_cvt_pk_bf16_f32 v17, v24, v25
    v_lshlrev_b32 v24, 16, v18
    v_mfma_f32_16x16x32_bf16 v[160:163], a[144:147], a[96:99], v[160:163]
    v_and_b32 v25, s92, v18
    v_sub_f32 v24, v24, v0
    v_mfma_f32_16x16x32_bf16 v[164:167], a[144:147], a[100:103], v[164:167]
    s_add_u32 m0, s32, 36864
    v_sub_f32 v25, v25, v0
    v_mul_f32 v24, v24, v27
    v_mfma_f32_16x16x32_bf16 v[168:171], a[144:147], a[104:107], v[168:171]
    buffer_load_dwordx4 v3, s[4:7], s22 offen lds
    v_mul_f32 v25, v25, v27
    v_mfma_f32_16x16x32_bf16 v[172:175], a[144:147], a[108:111], v[172:175]
    v_cvt_pk_bf16_f32 v18, v24, v25
    v_lshlrev_b32 v24, 16, v19
    v_mfma_f32_16x16x32_bf16 v[176:179], a[144:147], a[112:115], v[176:179]
    v_and_b32 v25, s92, v19
    v_sub_f32 v24, v24, v0
    v_mfma_f32_16x16x32_bf16 v[180:183], a[144:147], a[116:119], v[180:183]
    s_add_u32 m0, s32, 37888
    v_sub_f32 v25, v25, v0
    v_mul_f32 v24, v24, v27
    v_mfma_f32_16x16x32_bf16 v[184:187], a[144:147], a[120:123], v[184:187]
    buffer_load_dwordx4 v4, s[4:7], s22 offen lds
    v_mul_f32 v25, v25, v27
    v_mfma_f32_16x16x32_bf16 v[188:191], a[144:147], a[124:127], v[188:191]
    v_cvt_pk_bf16_f32 v19, v24, v25
    v_mfma_f32_16x16x32_bf16 v[192:195], a[148:151], a[96:99], v[192:195]
    v_mfma_f32_16x16x32_bf16 v[196:199], a[148:151], a[100:103], v[196:199]
    s_add_u32 m0, s32, 38912
    v_mfma_f32_16x16x32_bf16 v[200:203], a[148:151], a[104:107], v[200:203]
    buffer_load_dwordx4 v3, s[4:7], s23 offen lds
    v_mfma_f32_16x16x32_bf16 v[204:207], a[148:151], a[108:111], v[204:207]
    v_mfma_f32_16x16x32_bf16 v[208:211], a[148:151], a[112:115], v[208:211]
    v_mfma_f32_16x16x32_bf16 v[212:215], a[148:151], a[116:119], v[212:215]
    s_add_u32 m0, s32, 39936
    v_mfma_f32_16x16x32_bf16 v[216:219], a[148:151], a[120:123], v[216:219]
    buffer_load_dwordx4 v4, s[4:7], s23 offen lds
    v_mfma_f32_16x16x32_bf16 v[220:223], a[148:151], a[124:127], v[220:223]
    v_mfma_f32_16x16x32_bf16 v[224:227], a[152:155], a[96:99], v[224:227]
    v_mfma_f32_16x16x32_bf16 v[228:231], a[152:155], a[100:103], v[228:231]
    v_mfma_f32_16x16x32_bf16 v[232:235], a[152:155], a[104:107], v[232:235]
    v_mfma_f32_16x16x32_bf16 v[236:239], a[152:155], a[108:111], v[236:239]
    v_mfma_f32_16x16x32_bf16 v[240:243], a[152:155], a[112:115], v[240:243]
    v_mfma_f32_16x16x32_bf16 v[244:247], a[152:155], a[116:119], v[244:247]
    v_mfma_f32_16x16x32_bf16 v[248:251], a[152:155], a[120:123], v[248:251]
    v_mfma_f32_16x16x32_bf16 v[252:255], a[152:155], a[124:127], v[252:255]
    v_mfma_f32_16x16x32_bf16 a[0:3], a[156:159], a[96:99], a[0:3]
    v_mfma_f32_16x16x32_bf16 a[4:7], a[156:159], a[100:103], a[4:7]
    v_mfma_f32_16x16x32_bf16 a[8:11], a[156:159], a[104:107], a[8:11]
    buffer_store_dwordx4 v[12:15], v20, s[80:83], 0 offen sc1
    buffer_store_dwordx4 v[16:19], v20, s[80:83], s93 offen sc1
    v_mfma_f32_16x16x32_bf16 a[12:15], a[156:159], a[108:111], a[12:15]
    v_mfma_f32_16x16x32_bf16 a[16:19], a[156:159], a[112:115], a[16:19]
    v_mfma_f32_16x16x32_bf16 a[20:23], a[156:159], a[116:119], a[20:23]
    v_mfma_f32_16x16x32_bf16 a[24:27], a[156:159], a[120:123], a[24:27]
    s_add_u32 s4, s4, 128
    s_addc_u32 s5, s5, 0
    v_mfma_f32_16x16x32_bf16 a[28:31], a[156:159], a[124:127], a[28:31]
    s_waitcnt vmcnt(16) lgkmcnt(0)
    s_barrier
    v_mfma_f32_16x16x32_bf16 v[32:35], a[64:67], a[32:35], v[32:35]
    ds_read_b64_tr_b16 a[128:129], v5 offset:4096
    v_mfma_f32_16x16x32_bf16 v[36:39], a[64:67], a[36:39], v[36:39]
    ds_read_b64_tr_b16 a[130:131], v5 offset:5120
    s_add_u32 m0, s33, 36864
    v_mfma_f32_16x16x32_bf16 v[40:43], a[64:67], a[40:43], v[40:43]
    ds_read_b128 a[96:99], v11 offset:0
    buffer_load_dwordx4 v9, s[8:11], s28 offen lds
    v_mfma_f32_16x16x32_bf16 v[44:47], a[64:67], a[44:47], v[44:47]
    ds_read_b64_tr_b16 a[132:133], v6 offset:4096
    v_mfma_f32_16x16x32_bf16 v[48:51], a[64:67], a[48:51], v[48:51]
    ds_read_b64_tr_b16 a[134:135], v6 offset:5120
    v_mfma_f32_16x16x32_bf16 v[52:55], a[64:67], a[52:55], v[52:55]
    ds_read_b128 a[100:103], v11 offset:2048
    v_mfma_f32_16x16x32_bf16 v[56:59], a[64:67], a[56:59], v[56:59]
    ds_read_b64_tr_b16 a[136:137], v7 offset:4096
    v_mfma_f32_16x16x32_bf16 v[60:63], a[64:67], a[60:63], v[60:63]
    ds_read_b64_tr_b16 a[138:139], v7 offset:5120
    v_mfma_f32_16x16x32_bf16 v[64:67], a[68:71], a[32:35], v[64:67]
    ds_read_b128 a[104:107], v11 offset:4096
    v_mfma_f32_16x16x32_bf16 v[68:71], a[68:71], a[36:39], v[68:71]
    ds_read_b64_tr_b16 a[140:141], v8 offset:4096
    s_add_u32 m0, s33, 37888
    v_mfma_f32_16x16x32_bf16 v[72:75], a[68:71], a[40:43], v[72:75]
    ds_read_b64_tr_b16 a[142:143], v8 offset:5120
    buffer_load_dwordx4 v9, s[8:11], s29 offen lds
    v_mfma_f32_16x16x32_bf16 v[76:79], a[68:71], a[44:47], v[76:79]
    ds_read_b128 a[108:111], v11 offset:6144
    v_mfma_f32_16x16x32_bf16 v[80:83], a[68:71], a[48:51], v[80:83]
    ds_read_b64_tr_b16 a[144:145], v5 offset:12288
    v_mfma_f32_16x16x32_bf16 v[84:87], a[68:71], a[52:55], v[84:87]
    ds_read_b64_tr_b16 a[146:147], v5 offset:13312
    v_mfma_f32_16x16x32_bf16 v[88:91], a[68:71], a[56:59], v[88:91]
    ds_read_b128 a[112:115], v11 offset:8192
    v_mfma_f32_16x16x32_bf16 v[92:95], a[68:71], a[60:63], v[92:95]
    ds_read_b64_tr_b16 a[148:149], v6 offset:12288
    v_mfma_f32_16x16x32_bf16 v[96:99], a[72:75], a[32:35], v[96:99]
    ds_read_b64_tr_b16 a[150:151], v6 offset:13312
    v_mfma_f32_16x16x32_bf16 v[100:103], a[72:75], a[36:39], v[100:103]
    ds_read_b128 a[116:119], v11 offset:10240
    s_add_u32 m0, s33, 38912
    v_mfma_f32_16x16x32_bf16 v[104:107], a[72:75], a[40:43], v[104:107]
    ds_read_b64_tr_b16 a[152:153], v7 offset:12288
    buffer_load_dwordx4 v9, s[8:11], s30 offen lds
    v_mfma_f32_16x16x32_bf16 v[108:111], a[72:75], a[44:47], v[108:111]
    ds_read_b64_tr_b16 a[154:155], v7 offset:13312
    v_mfma_f32_16x16x32_bf16 v[112:115], a[72:75], a[48:51], v[112:115]
    ds_read_b128 a[120:123], v11 offset:12288
    v_mfma_f32_16x16x32_bf16 v[116:119], a[72:75], a[52:55], v[116:119]
    ds_read_b64_tr_b16 a[156:157], v8 offset:12288
    v_mfma_f32_16x16x32_bf16 v[120:123], a[72:75], a[56:59], v[120:123]
    ds_read_b64_tr_b16 a[158:159], v8 offset:13312
    v_mfma_f32_16x16x32_bf16 v[124:127], a[72:75], a[60:63], v[124:127]
    ds_read_b128 a[124:127], v11 offset:14336
    v_mfma_f32_16x16x32_bf16 v[128:131], a[76:79], a[32:35], v[128:131]
    v_mfma_f32_16x16x32_bf16 v[132:135], a[76:79], a[36:39], v[132:135]
    s_add_u32 m0, s33, 39936
    v_mfma_f32_16x16x32_bf16 v[136:139], a[76:79], a[40:43], v[136:139]
    buffer_load_dwordx4 v9, s[8:11], s31 offen lds
    v_mfma_f32_16x16x32_bf16 v[140:143], a[76:79], a[44:47], v[140:143]
    v_mfma_f32_16x16x32_bf16 v[144:147], a[76:79], a[48:51], v[144:147]
    v_mfma_f32_16x16x32_bf16 v[148:151], a[76:79], a[52:55], v[148:151]
    v_mfma_f32_16x16x32_bf16 v[152:155], a[76:79], a[56:59], v[152:155]
    s_add_u32 s8, s8, 524288
    s_addc_u32 s9, s9, 0
    v_mfma_f32_16x16x32_bf16 v[156:159], a[76:79], a[60:63], v[156:159]
    v_mfma_f32_16x16x32_bf16 v[160:163], a[80:83], a[32:35], v[160:163]
    v_mfma_f32_16x16x32_bf16 v[164:167], a[80:83], a[36:39], v[164:167]
    v_mfma_f32_16x16x32_bf16 v[168:171], a[80:83], a[40:43], v[168:171]
    s_mov_b32 s38, 0x400000
    s_mov_b32 s39, 0x00020000
    s_lshl_b32 s34, s2, 14
    v_mfma_f32_16x16x32_bf16 v[172:175], a[80:83], a[44:47], v[172:175]
    buffer_load_dwordx4 a[252:255], v23, s[36:39], s34 offen
    v_mfma_f32_16x16x32_bf16 v[176:179], a[80:83], a[48:51], v[176:179]
    v_mfma_f32_16x16x32_bf16 v[180:183], a[80:83], a[52:55], v[180:183]
    v_mfma_f32_16x16x32_bf16 v[184:187], a[80:83], a[56:59], v[184:187]
    v_mfma_f32_16x16x32_bf16 v[188:191], a[80:83], a[60:63], v[188:191]
    v_mfma_f32_16x16x32_bf16 v[192:195], a[84:87], a[32:35], v[192:195]
    v_mfma_f32_16x16x32_bf16 v[196:199], a[84:87], a[36:39], v[196:199]
    v_mfma_f32_16x16x32_bf16 v[200:203], a[84:87], a[40:43], v[200:203]
    s_lshl_b32 s34, s2, 14
    s_add_u32 s34, s34, 4096
    v_mfma_f32_16x16x32_bf16 v[204:207], a[84:87], a[44:47], v[204:207]
    buffer_load_dwordx4 a[252:255], v23, s[36:39], s34 offen
    v_mfma_f32_16x16x32_bf16 v[208:211], a[84:87], a[48:51], v[208:211]
    v_mfma_f32_16x16x32_bf16 v[212:215], a[84:87], a[52:55], v[212:215]
    v_mfma_f32_16x16x32_bf16 v[216:219], a[84:87], a[56:59], v[216:219]
    v_mfma_f32_16x16x32_bf16 v[220:223], a[84:87], a[60:63], v[220:223]
    v_mfma_f32_16x16x32_bf16 v[224:227], a[88:91], a[32:35], v[224:227]
    v_mfma_f32_16x16x32_bf16 v[228:231], a[88:91], a[36:39], v[228:231]
    v_mfma_f32_16x16x32_bf16 v[232:235], a[88:91], a[40:43], v[232:235]
    v_mfma_f32_16x16x32_bf16 v[236:239], a[88:91], a[44:47], v[236:239]
    v_mfma_f32_16x16x32_bf16 v[240:243], a[88:91], a[48:51], v[240:243]
    v_mfma_f32_16x16x32_bf16 v[244:247], a[88:91], a[52:55], v[244:247]
    v_mfma_f32_16x16x32_bf16 v[248:251], a[88:91], a[56:59], v[248:251]
    v_mfma_f32_16x16x32_bf16 v[252:255], a[88:91], a[60:63], v[252:255]
    v_mfma_f32_16x16x32_bf16 a[0:3], a[92:95], a[32:35], a[0:3]
    v_mfma_f32_16x16x32_bf16 a[4:7], a[92:95], a[36:39], a[4:7]
    v_mfma_f32_16x16x32_bf16 a[8:11], a[92:95], a[40:43], a[8:11]
    v_mfma_f32_16x16x32_bf16 a[12:15], a[92:95], a[44:47], a[12:15]
    v_mfma_f32_16x16x32_bf16 a[16:19], a[92:95], a[48:51], a[16:19]
    v_mfma_f32_16x16x32_bf16 a[20:23], a[92:95], a[52:55], a[20:23]
    v_mfma_f32_16x16x32_bf16 a[24:27], a[92:95], a[56:59], a[24:27]
    v_mfma_f32_16x16x32_bf16 a[28:31], a[92:95], a[60:63], a[28:31]
    s_waitcnt vmcnt(8) lgkmcnt(0)
    s_barrier
    v_mfma_f32_16x16x32_bf16 v[32:35], a[128:131], a[96:99], v[32:35]
    ds_read_b64_tr_b16 a[64:65], v5 offset:32768
    v_mfma_f32_16x16x32_bf16 v[36:39], a[128:131], a[100:103], v[36:39]
    ds_read_b64_tr_b16 a[66:67], v5 offset:33792
    s_add_u32 m0, s32, 0
    v_mfma_f32_16x16x32_bf16 v[40:43], a[128:131], a[104:107], v[40:43]
    ds_read_b128 a[32:35], v10 offset:32768
    buffer_load_dwordx4 v3, s[4:7], s20 offen lds
    v_mfma_f32_16x16x32_bf16 v[44:47], a[128:131], a[108:111], v[44:47]
    ds_read_b64_tr_b16 a[68:69], v6 offset:32768
    v_mfma_f32_16x16x32_bf16 v[48:51], a[128:131], a[112:115], v[48:51]
    ds_read_b64_tr_b16 a[70:71], v6 offset:33792
    v_mfma_f32_16x16x32_bf16 v[52:55], a[128:131], a[116:119], v[52:55]
    ds_read_b128 a[36:39], v10 offset:34816
    s_add_u32 m0, s33, 0
    v_mfma_f32_16x16x32_bf16 v[56:59], a[128:131], a[120:123], v[56:59]
    ds_read_b64_tr_b16 a[72:73], v7 offset:32768
    buffer_load_dwordx4 v9, s[8:11], s24 offen lds
    v_mfma_f32_16x16x32_bf16 v[60:63], a[128:131], a[124:127], v[60:63]
    ds_read_b64_tr_b16 a[74:75], v7 offset:33792
    v_mfma_f32_16x16x32_bf16 v[64:67], a[132:135], a[96:99], v[64:67]
    ds_read_b128 a[40:43], v10 offset:36864
    v_mfma_f32_16x16x32_bf16 v[68:71], a[132:135], a[100:103], v[68:71]
    ds_read_b64_tr_b16 a[76:77], v8 offset:32768
    s_add_u32 m0, s32, 1024
    v_mfma_f32_16x16x32_bf16 v[72:75], a[132:135], a[104:107], v[72:75]
    ds_read_b64_tr_b16 a[78:79], v8 offset:33792
    buffer_load_dwordx4 v4, s[4:7], s20 offen lds
    v_mfma_f32_16x16x32_bf16 v[76:79], a[132:135], a[108:111], v[76:79]
    ds_read_b128 a[44:47], v10 offset:38912
    v_mfma_f32_16x16x32_bf16 v[80:83], a[132:135], a[112:115], v[80:83]
    ds_read_b64_tr_b16 a[80:81], v5 offset:40960
    v_mfma_f32_16x16x32_bf16 v[84:87], a[132:135], a[116:119], v[84:87]
    ds_read_b64_tr_b16 a[82:83], v5 offset:41984
    s_add_u32 m0, s33, 1024
    v_mfma_f32_16x16x32_bf16 v[88:91], a[132:135], a[120:123], v[88:91]
    ds_read_b128 a[48:51], v10 offset:40960
    buffer_load_dwordx4 v9, s[8:11], s25 offen lds
    v_mfma_f32_16x16x32_bf16 v[92:95], a[132:135], a[124:127], v[92:95]
    ds_read_b64_tr_b16 a[84:85], v6 offset:40960
    v_mfma_f32_16x16x32_bf16 v[96:99], a[136:139], a[96:99], v[96:99]
    ds_read_b64_tr_b16 a[86:87], v6 offset:41984
    v_mfma_f32_16x16x32_bf16 v[100:103], a[136:139], a[100:103], v[100:103]
    ds_read_b128 a[52:55], v10 offset:43008
    s_add_u32 m0, s32, 2048
    v_mfma_f32_16x16x32_bf16 v[104:107], a[136:139], a[104:107], v[104:107]
    ds_read_b64_tr_b16 a[88:89], v7 offset:40960
    buffer_load_dwordx4 v3, s[4:7], s21 offen lds
    v_mfma_f32_16x16x32_bf16 v[108:111], a[136:139], a[108:111], v[108:111]
    ds_read_b64_tr_b16 a[90:91], v7 offset:41984
    v_mfma_f32_16x16x32_bf16 v[112:115], a[136:139], a[112:115], v[112:115]
    ds_read_b128 a[56:59], v10 offset:45056
    v_mfma_f32_16x16x32_bf16 v[116:119], a[136:139], a[116:119], v[116:119]
    ds_read_b64_tr_b16 a[92:93], v8 offset:40960
    s_add_u32 m0, s33, 2048
    v_mfma_f32_16x16x32_bf16 v[120:123], a[136:139], a[120:123], v[120:123]
    ds_read_b64_tr_b16 a[94:95], v8 offset:41984
    buffer_load_dwordx4 v9, s[8:11], s26 offen lds
    v_mfma_f32_16x16x32_bf16 v[124:127], a[136:139], a[124:127], v[124:127]
    ds_read_b128 a[60:63], v10 offset:47104
    v_mfma_f32_16x16x32_bf16 v[128:131], a[140:143], a[96:99], v[128:131]
    v_mfma_f32_16x16x32_bf16 v[132:135], a[140:143], a[100:103], v[132:135]
    s_add_u32 m0, s32, 3072
    v_mfma_f32_16x16x32_bf16 v[136:139], a[140:143], a[104:107], v[136:139]
    buffer_load_dwordx4 v4, s[4:7], s21 offen lds
    v_mfma_f32_16x16x32_bf16 v[140:143], a[140:143], a[108:111], v[140:143]
    v_mfma_f32_16x16x32_bf16 v[144:147], a[140:143], a[112:115], v[144:147]
    v_mfma_f32_16x16x32_bf16 v[148:151], a[140:143], a[116:119], v[148:151]
    s_add_u32 m0, s33, 3072
    v_mfma_f32_16x16x32_bf16 v[152:155], a[140:143], a[120:123], v[152:155]
    s_load_dwordx2 s[36:37], s[0:1], 16
    buffer_load_dwordx4 v9, s[8:11], s27 offen lds
    v_mfma_f32_16x16x32_bf16 v[156:159], a[140:143], a[124:127], v[156:159]
    s_load_dwordx2 s[48:49], s[0:1], 72
    v_mfma_f32_16x16x32_bf16 v[160:163], a[144:147], a[96:99], v[160:163]
    v_mfma_f32_16x16x32_bf16 v[164:167], a[144:147], a[100:103], v[164:167]
    s_add_u32 m0, s32, 4096
    v_mfma_f32_16x16x32_bf16 v[168:171], a[144:147], a[104:107], v[168:171]
    buffer_load_dwordx4 v3, s[4:7], s22 offen lds
    v_mfma_f32_16x16x32_bf16 v[172:175], a[144:147], a[108:111], v[172:175]
    v_mfma_f32_16x16x32_bf16 v[176:179], a[144:147], a[112:115], v[176:179]
    v_mfma_f32_16x16x32_bf16 v[180:183], a[144:147], a[116:119], v[180:183]
    s_add_u32 m0, s32, 5120
    v_mfma_f32_16x16x32_bf16 v[184:187], a[144:147], a[120:123], v[184:187]
    buffer_load_dwordx4 v4, s[4:7], s22 offen lds
    v_mfma_f32_16x16x32_bf16 v[188:191], a[144:147], a[124:127], v[188:191]
    v_mfma_f32_16x16x32_bf16 v[192:195], a[148:151], a[96:99], v[192:195]
    v_mfma_f32_16x16x32_bf16 v[196:199], a[148:151], a[100:103], v[196:199]
    s_add_u32 m0, s32, 6144
    v_mfma_f32_16x16x32_bf16 v[200:203], a[148:151], a[104:107], v[200:203]
    buffer_load_dwordx4 v3, s[4:7], s23 offen lds
    v_mfma_f32_16x16x32_bf16 v[204:207], a[148:151], a[108:111], v[204:207]
    v_mfma_f32_16x16x32_bf16 v[208:211], a[148:151], a[112:115], v[208:211]
    v_mfma_f32_16x16x32_bf16 v[212:215], a[148:151], a[116:119], v[212:215]
    s_add_u32 m0, s32, 7168
    v_mfma_f32_16x16x32_bf16 v[216:219], a[148:151], a[120:123], v[216:219]
    buffer_load_dwordx4 v4, s[4:7], s23 offen lds
    v_mfma_f32_16x16x32_bf16 v[220:223], a[148:151], a[124:127], v[220:223]
    v_mfma_f32_16x16x32_bf16 v[224:227], a[152:155], a[96:99], v[224:227]
    v_mfma_f32_16x16x32_bf16 v[228:231], a[152:155], a[100:103], v[228:231]
    v_mfma_f32_16x16x32_bf16 v[232:235], a[152:155], a[104:107], v[232:235]
    v_mfma_f32_16x16x32_bf16 v[236:239], a[152:155], a[108:111], v[236:239]
    v_mfma_f32_16x16x32_bf16 v[240:243], a[152:155], a[112:115], v[240:243]
    v_mfma_f32_16x16x32_bf16 v[244:247], a[152:155], a[116:119], v[244:247]
    v_mfma_f32_16x16x32_bf16 v[248:251], a[152:155], a[120:123], v[248:251]
    v_mfma_f32_16x16x32_bf16 v[252:255], a[152:155], a[124:127], v[252:255]
    v_mfma_f32_16x16x32_bf16 a[0:3], a[156:159], a[96:99], a[0:3]
    v_mfma_f32_16x16x32_bf16 a[4:7], a[156:159], a[100:103], a[4:7]
    v_mfma_f32_16x16x32_bf16 a[8:11], a[156:159], a[104:107], a[8:11]
    v_mfma_f32_16x16x32_bf16 a[12:15], a[156:159], a[108:111], a[12:15]
    v_mfma_f32_16x16x32_bf16 a[16:19], a[156:159], a[112:115], a[16:19]
    v_mfma_f32_16x16x32_bf16 a[20:23], a[156:159], a[116:119], a[20:23]
    v_mfma_f32_16x16x32_bf16 a[24:27], a[156:159], a[120:123], a[24:27]
    s_add_u32 s4, s4, 128
    s_addc_u32 s5, s5, 0
    v_mfma_f32_16x16x32_bf16 a[28:31], a[156:159], a[124:127], a[28:31]
    s_waitcnt vmcnt(14) lgkmcnt(0)
    s_barrier
    v_mfma_f32_16x16x32_bf16 v[32:35], a[64:67], a[32:35], v[32:35]
    ds_read_b64_tr_b16 a[128:129], v5 offset:36864
    v_mfma_f32_16x16x32_bf16 v[36:39], a[64:67], a[36:39], v[36:39]
    ds_read_b64_tr_b16 a[130:131], v5 offset:37888
    s_add_u32 m0, s33, 4096
    v_mfma_f32_16x16x32_bf16 v[40:43], a[64:67], a[40:43], v[40:43]
    ds_read_b128 a[96:99], v11 offset:32768
    buffer_load_dwordx4 v9, s[8:11], s28 offen lds
    v_mfma_f32_16x16x32_bf16 v[44:47], a[64:67], a[44:47], v[44:47]
    ds_read_b64_tr_b16 a[132:133], v6 offset:36864
    v_mfma_f32_16x16x32_bf16 v[48:51], a[64:67], a[48:51], v[48:51]
    ds_read_b64_tr_b16 a[134:135], v6 offset:37888
    v_mfma_f32_16x16x32_bf16 v[52:55], a[64:67], a[52:55], v[52:55]
    ds_read_b128 a[100:103], v11 offset:34816
    v_mfma_f32_16x16x32_bf16 v[56:59], a[64:67], a[56:59], v[56:59]
    ds_read_b64_tr_b16 a[136:137], v7 offset:36864
    v_mfma_f32_16x16x32_bf16 v[60:63], a[64:67], a[60:63], v[60:63]
    ds_read_b64_tr_b16 a[138:139], v7 offset:37888
    v_mfma_f32_16x16x32_bf16 v[64:67], a[68:71], a[32:35], v[64:67]
    ds_read_b128 a[104:107], v11 offset:36864
    v_mfma_f32_16x16x32_bf16 v[68:71], a[68:71], a[36:39], v[68:71]
    ds_read_b64_tr_b16 a[140:141], v8 offset:36864
    s_add_u32 m0, s33, 5120
    v_mfma_f32_16x16x32_bf16 v[72:75], a[68:71], a[40:43], v[72:75]
    ds_read_b64_tr_b16 a[142:143], v8 offset:37888
    buffer_load_dwordx4 v9, s[8:11], s29 offen lds
    v_mfma_f32_16x16x32_bf16 v[76:79], a[68:71], a[44:47], v[76:79]
    ds_read_b128 a[108:111], v11 offset:38912
    v_mfma_f32_16x16x32_bf16 v[80:83], a[68:71], a[48:51], v[80:83]
    ds_read_b64_tr_b16 a[144:145], v5 offset:45056
    v_mfma_f32_16x16x32_bf16 v[84:87], a[68:71], a[52:55], v[84:87]
    ds_read_b64_tr_b16 a[146:147], v5 offset:46080
    v_mfma_f32_16x16x32_bf16 v[88:91], a[68:71], a[56:59], v[88:91]
    ds_read_b128 a[112:115], v11 offset:40960
    v_mfma_f32_16x16x32_bf16 v[92:95], a[68:71], a[60:63], v[92:95]
    ds_read_b64_tr_b16 a[148:149], v6 offset:45056
    v_mfma_f32_16x16x32_bf16 v[96:99], a[72:75], a[32:35], v[96:99]
    ds_read_b64_tr_b16 a[150:151], v6 offset:46080
    v_mfma_f32_16x16x32_bf16 v[100:103], a[72:75], a[36:39], v[100:103]
    ds_read_b128 a[116:119], v11 offset:43008
    s_add_u32 m0, s33, 6144
    v_mfma_f32_16x16x32_bf16 v[104:107], a[72:75], a[40:43], v[104:107]
    ds_read_b64_tr_b16 a[152:153], v7 offset:45056
    buffer_load_dwordx4 v9, s[8:11], s30 offen lds
    v_mfma_f32_16x16x32_bf16 v[108:111], a[72:75], a[44:47], v[108:111]
    ds_read_b64_tr_b16 a[154:155], v7 offset:46080
    v_mfma_f32_16x16x32_bf16 v[112:115], a[72:75], a[48:51], v[112:115]
    ds_read_b128 a[120:123], v11 offset:45056
    v_mfma_f32_16x16x32_bf16 v[116:119], a[72:75], a[52:55], v[116:119]
    ds_read_b64_tr_b16 a[156:157], v8 offset:45056
    v_mfma_f32_16x16x32_bf16 v[120:123], a[72:75], a[56:59], v[120:123]
    ds_read_b64_tr_b16 a[158:159], v8 offset:46080
    v_mfma_f32_16x16x32_bf16 v[124:127], a[72:75], a[60:63], v[124:127]
    ds_read_b128 a[124:127], v11 offset:47104
    v_mfma_f32_16x16x32_bf16 v[128:131], a[76:79], a[32:35], v[128:131]
    v_mfma_f32_16x16x32_bf16 v[132:135], a[76:79], a[36:39], v[132:135]
    s_add_u32 m0, s33, 7168
    v_mfma_f32_16x16x32_bf16 v[136:139], a[76:79], a[40:43], v[136:139]
    buffer_load_dwordx4 v9, s[8:11], s31 offen lds
    v_mfma_f32_16x16x32_bf16 v[140:143], a[76:79], a[44:47], v[140:143]
    v_mfma_f32_16x16x32_bf16 v[144:147], a[76:79], a[48:51], v[144:147]
    v_mfma_f32_16x16x32_bf16 v[148:151], a[76:79], a[52:55], v[148:151]
    v_mfma_f32_16x16x32_bf16 v[152:155], a[76:79], a[56:59], v[152:155]
    s_add_u32 s8, s8, 524288
    s_addc_u32 s9, s9, 0
    v_mfma_f32_16x16x32_bf16 v[156:159], a[76:79], a[60:63], v[156:159]
    v_mfma_f32_16x16x32_bf16 v[160:163], a[80:83], a[32:35], v[160:163]
    v_mfma_f32_16x16x32_bf16 v[164:167], a[80:83], a[36:39], v[164:167]
    v_mfma_f32_16x16x32_bf16 v[168:171], a[80:83], a[40:43], v[168:171]
    s_mov_b32 s38, 0x400000
    s_mov_b32 s39, 0x00020000
    s_lshl_b32 s34, s2, 14
    s_add_u32 s34, s34, 8192
    v_mfma_f32_16x16x32_bf16 v[172:175], a[80:83], a[44:47], v[172:175]
    buffer_load_dwordx4 a[252:255], v23, s[36:39], s34 offen
    v_mfma_f32_16x16x32_bf16 v[176:179], a[80:83], a[48:51], v[176:179]
    v_mfma_f32_16x16x32_bf16 v[180:183], a[80:83], a[52:55], v[180:183]
    v_mfma_f32_16x16x32_bf16 v[184:187], a[80:83], a[56:59], v[184:187]
    v_mfma_f32_16x16x32_bf16 v[188:191], a[80:83], a[60:63], v[188:191]
    v_mfma_f32_16x16x32_bf16 v[192:195], a[84:87], a[32:35], v[192:195]
    v_mfma_f32_16x16x32_bf16 v[196:199], a[84:87], a[36:39], v[196:199]
    v_mfma_f32_16x16x32_bf16 v[200:203], a[84:87], a[40:43], v[200:203]
    s_lshl_b32 s34, s2, 14
    s_add_u32 s34, s34, 12288
    v_mfma_f32_16x16x32_bf16 v[204:207], a[84:87], a[44:47], v[204:207]
    buffer_load_dwordx4 a[252:255], v23, s[36:39], s34 offen
    v_mfma_f32_16x16x32_bf16 v[208:211], a[84:87], a[48:51], v[208:211]
    v_mfma_f32_16x16x32_bf16 v[212:215], a[84:87], a[52:55], v[212:215]
    v_mfma_f32_16x16x32_bf16 v[216:219], a[84:87], a[56:59], v[216:219]
    v_mfma_f32_16x16x32_bf16 v[220:223], a[84:87], a[60:63], v[220:223]
    v_mfma_f32_16x16x32_bf16 v[224:227], a[88:91], a[32:35], v[224:227]
    v_mfma_f32_16x16x32_bf16 v[228:231], a[88:91], a[36:39], v[228:231]
    v_mfma_f32_16x16x32_bf16 v[232:235], a[88:91], a[40:43], v[232:235]
    s_mov_b32 s50, 0x1c0000
    s_mov_b32 s51, 0x00020000
    s_lshl_b32 s34, s2, 13
    v_mfma_f32_16x16x32_bf16 v[236:239], a[88:91], a[44:47], v[236:239]
    buffer_load_dwordx4 a[252:255], v23, s[48:51], s34 offen
    v_mfma_f32_16x16x32_bf16 v[240:243], a[88:91], a[48:51], v[240:243]
    v_mfma_f32_16x16x32_bf16 v[244:247], a[88:91], a[52:55], v[244:247]
    v_mfma_f32_16x16x32_bf16 v[248:251], a[88:91], a[56:59], v[248:251]
    v_mfma_f32_16x16x32_bf16 v[252:255], a[88:91], a[60:63], v[252:255]
    v_mfma_f32_16x16x32_bf16 a[0:3], a[92:95], a[32:35], a[0:3]
    v_mfma_f32_16x16x32_bf16 a[4:7], a[92:95], a[36:39], a[4:7]
    v_mfma_f32_16x16x32_bf16 a[8:11], a[92:95], a[40:43], a[8:11]
    v_mfma_f32_16x16x32_bf16 a[12:15], a[92:95], a[44:47], a[12:15]
    v_mfma_f32_16x16x32_bf16 a[16:19], a[92:95], a[48:51], a[16:19]
    v_mfma_f32_16x16x32_bf16 a[20:23], a[92:95], a[52:55], a[20:23]
    v_mfma_f32_16x16x32_bf16 a[24:27], a[92:95], a[56:59], a[24:27]
    v_mfma_f32_16x16x32_bf16 a[28:31], a[92:95], a[60:63], a[28:31]
    buffer_atomic_add v21, v22, s[84:87], 0 offen sc1
    s_waitcnt vmcnt(8) lgkmcnt(0)
    s_barrier
    v_mfma_f32_16x16x32_bf16 v[32:35], a[128:131], a[96:99], v[32:35]
    ds_read_b64_tr_b16 a[64:65], v5 offset:0
    v_mfma_f32_16x16x32_bf16 v[36:39], a[128:131], a[100:103], v[36:39]
    ds_read_b64_tr_b16 a[66:67], v5 offset:1024
    s_add_u32 m0, s32, 32768
    v_mfma_f32_16x16x32_bf16 v[40:43], a[128:131], a[104:107], v[40:43]
    ds_read_b128 a[32:35], v10 offset:0
    buffer_load_dwordx4 v3, s[4:7], s20 offen lds
    v_mfma_f32_16x16x32_bf16 v[44:47], a[128:131], a[108:111], v[44:47]
    ds_read_b64_tr_b16 a[68:69], v6 offset:0
    v_mfma_f32_16x16x32_bf16 v[48:51], a[128:131], a[112:115], v[48:51]
    ds_read_b64_tr_b16 a[70:71], v6 offset:1024
    v_mfma_f32_16x16x32_bf16 v[52:55], a[128:131], a[116:119], v[52:55]
    ds_read_b128 a[36:39], v10 offset:2048
    s_add_u32 m0, s33, 32768
    v_mfma_f32_16x16x32_bf16 v[56:59], a[128:131], a[120:123], v[56:59]
    ds_read_b64_tr_b16 a[72:73], v7 offset:0
    buffer_load_dwordx4 v9, s[8:11], s24 offen lds
    v_mfma_f32_16x16x32_bf16 v[60:63], a[128:131], a[124:127], v[60:63]
    ds_read_b64_tr_b16 a[74:75], v7 offset:1024
    v_mfma_f32_16x16x32_bf16 v[64:67], a[132:135], a[96:99], v[64:67]
    ds_read_b128 a[40:43], v10 offset:4096
    v_mfma_f32_16x16x32_bf16 v[68:71], a[132:135], a[100:103], v[68:71]
    ds_read_b64_tr_b16 a[76:77], v8 offset:0
    s_add_u32 m0, s32, 33792
    v_mfma_f32_16x16x32_bf16 v[72:75], a[132:135], a[104:107], v[72:75]
    ds_read_b64_tr_b16 a[78:79], v8 offset:1024
    buffer_load_dwordx4 v4, s[4:7], s20 offen lds
    v_mfma_f32_16x16x32_bf16 v[76:79], a[132:135], a[108:111], v[76:79]
    ds_read_b128 a[44:47], v10 offset:6144
    v_mfma_f32_16x16x32_bf16 v[80:83], a[132:135], a[112:115], v[80:83]
    ds_read_b64_tr_b16 a[80:81], v5 offset:8192
    v_mfma_f32_16x16x32_bf16 v[84:87], a[132:135], a[116:119], v[84:87]
    ds_read_b64_tr_b16 a[82:83], v5 offset:9216
    s_add_u32 m0, s33, 33792
    v_mfma_f32_16x16x32_bf16 v[88:91], a[132:135], a[120:123], v[88:91]
    ds_read_b128 a[48:51], v10 offset:8192
    buffer_load_dwordx4 v9, s[8:11], s25 offen lds
    v_mfma_f32_16x16x32_bf16 v[92:95], a[132:135], a[124:127], v[92:95]
    ds_read_b64_tr_b16 a[84:85], v6 offset:8192
    v_mfma_f32_16x16x32_bf16 v[96:99], a[136:139], a[96:99], v[96:99]
    ds_read_b64_tr_b16 a[86:87], v6 offset:9216
    v_mfma_f32_16x16x32_bf16 v[100:103], a[136:139], a[100:103], v[100:103]
    ds_read_b128 a[52:55], v10 offset:10240
    s_add_u32 m0, s32, 34816
    v_mfma_f32_16x16x32_bf16 v[104:107], a[136:139], a[104:107], v[104:107]
    ds_read_b64_tr_b16 a[88:89], v7 offset:8192
    buffer_load_dwordx4 v3, s[4:7], s21 offen lds
    v_mfma_f32_16x16x32_bf16 v[108:111], a[136:139], a[108:111], v[108:111]
    ds_read_b64_tr_b16 a[90:91], v7 offset:9216
    v_mfma_f32_16x16x32_bf16 v[112:115], a[136:139], a[112:115], v[112:115]
    ds_read_b128 a[56:59], v10 offset:12288
    v_mfma_f32_16x16x32_bf16 v[116:119], a[136:139], a[116:119], v[116:119]
    ds_read_b64_tr_b16 a[92:93], v8 offset:8192
    s_add_u32 m0, s33, 34816
    v_mfma_f32_16x16x32_bf16 v[120:123], a[136:139], a[120:123], v[120:123]
    ds_read_b64_tr_b16 a[94:95], v8 offset:9216
    buffer_load_dwordx4 v9, s[8:11], s26 offen lds
    v_mfma_f32_16x16x32_bf16 v[124:127], a[136:139], a[124:127], v[124:127]
    ds_read_b128 a[60:63], v10 offset:14336
    v_mfma_f32_16x16x32_bf16 v[128:131], a[140:143], a[96:99], v[128:131]
    v_mfma_f32_16x16x32_bf16 v[132:135], a[140:143], a[100:103], v[132:135]
    s_add_u32 m0, s32, 35840
    v_mfma_f32_16x16x32_bf16 v[136:139], a[140:143], a[104:107], v[136:139]
    buffer_load_dwordx4 v4, s[4:7], s21 offen lds
    v_mfma_f32_16x16x32_bf16 v[140:143], a[140:143], a[108:111], v[140:143]
    v_mfma_f32_16x16x32_bf16 v[144:147], a[140:143], a[112:115], v[144:147]
    v_mfma_f32_16x16x32_bf16 v[148:151], a[140:143], a[116:119], v[148:151]
    s_add_u32 m0, s33, 35840
    v_mfma_f32_16x16x32_bf16 v[152:155], a[140:143], a[120:123], v[152:155]
    s_load_dwordx2 s[36:37], s[0:1], 72
    buffer_load_dwordx4 v9, s[8:11], s27 offen lds
    v_mfma_f32_16x16x32_bf16 v[156:159], a[140:143], a[124:127], v[156:159]
    s_load_dwordx2 s[48:49], s[0:1], 80
    v_mfma_f32_16x16x32_bf16 v[160:163], a[144:147], a[96:99], v[160:163]
    v_mfma_f32_16x16x32_bf16 v[164:167], a[144:147], a[100:103], v[164:167]
    s_add_u32 m0, s32, 36864
    v_mfma_f32_16x16x32_bf16 v[168:171], a[144:147], a[104:107], v[168:171]
    buffer_load_dwordx4 v3, s[4:7], s22 offen lds
    v_mfma_f32_16x16x32_bf16 v[172:175], a[144:147], a[108:111], v[172:175]
    v_mfma_f32_16x16x32_bf16 v[176:179], a[144:147], a[112:115], v[176:179]
    v_mfma_f32_16x16x32_bf16 v[180:183], a[144:147], a[116:119], v[180:183]
    s_add_u32 m0, s32, 37888
    v_mfma_f32_16x16x32_bf16 v[184:187], a[144:147], a[120:123], v[184:187]
    buffer_load_dwordx4 v4, s[4:7], s22 offen lds
    v_mfma_f32_16x16x32_bf16 v[188:191], a[144:147], a[124:127], v[188:191]
    v_mfma_f32_16x16x32_bf16 v[192:195], a[148:151], a[96:99], v[192:195]
    v_mfma_f32_16x16x32_bf16 v[196:199], a[148:151], a[100:103], v[196:199]
    s_add_u32 m0, s32, 38912
    v_mfma_f32_16x16x32_bf16 v[200:203], a[148:151], a[104:107], v[200:203]
    buffer_load_dwordx4 v3, s[4:7], s23 offen lds
    v_mfma_f32_16x16x32_bf16 v[204:207], a[148:151], a[108:111], v[204:207]
    v_mfma_f32_16x16x32_bf16 v[208:211], a[148:151], a[112:115], v[208:211]
    v_mfma_f32_16x16x32_bf16 v[212:215], a[148:151], a[116:119], v[212:215]
    s_add_u32 m0, s32, 39936
    v_mfma_f32_16x16x32_bf16 v[216:219], a[148:151], a[120:123], v[216:219]
    buffer_load_dwordx4 v4, s[4:7], s23 offen lds
    v_mfma_f32_16x16x32_bf16 v[220:223], a[148:151], a[124:127], v[220:223]
    v_mfma_f32_16x16x32_bf16 v[224:227], a[152:155], a[96:99], v[224:227]
    v_mfma_f32_16x16x32_bf16 v[228:231], a[152:155], a[100:103], v[228:231]
    v_mfma_f32_16x16x32_bf16 v[232:235], a[152:155], a[104:107], v[232:235]
    v_mfma_f32_16x16x32_bf16 v[236:239], a[152:155], a[108:111], v[236:239]
    v_mfma_f32_16x16x32_bf16 v[240:243], a[152:155], a[112:115], v[240:243]
    v_mfma_f32_16x16x32_bf16 v[244:247], a[152:155], a[116:119], v[244:247]
    v_mfma_f32_16x16x32_bf16 v[248:251], a[152:155], a[120:123], v[248:251]
    v_mfma_f32_16x16x32_bf16 v[252:255], a[152:155], a[124:127], v[252:255]
    v_mfma_f32_16x16x32_bf16 a[0:3], a[156:159], a[96:99], a[0:3]
    v_mfma_f32_16x16x32_bf16 a[4:7], a[156:159], a[100:103], a[4:7]
    v_mfma_f32_16x16x32_bf16 a[8:11], a[156:159], a[104:107], a[8:11]
    v_mfma_f32_16x16x32_bf16 a[12:15], a[156:159], a[108:111], a[12:15]
    v_mfma_f32_16x16x32_bf16 a[16:19], a[156:159], a[112:115], a[16:19]
    v_mfma_f32_16x16x32_bf16 a[20:23], a[156:159], a[116:119], a[20:23]
    v_mfma_f32_16x16x32_bf16 a[24:27], a[156:159], a[120:123], a[24:27]
    s_add_u32 s4, s4, 128
    s_addc_u32 s5, s5, 0
    v_mfma_f32_16x16x32_bf16 a[28:31], a[156:159], a[124:127], a[28:31]
    s_waitcnt vmcnt(16) lgkmcnt(0)
    s_barrier
    v_mfma_f32_16x16x32_bf16 v[32:35], a[64:67], a[32:35], v[32:35]
    ds_read_b64_tr_b16 a[128:129], v5 offset:4096
    v_mfma_f32_16x16x32_bf16 v[36:39], a[64:67], a[36:39], v[36:39]
    ds_read_b64_tr_b16 a[130:131], v5 offset:5120
    s_add_u32 m0, s33, 36864
    v_mfma_f32_16x16x32_bf16 v[40:43], a[64:67], a[40:43], v[40:43]
    ds_read_b128 a[96:99], v11 offset:0
    buffer_load_dwordx4 v9, s[8:11], s28 offen lds
    v_mfma_f32_16x16x32_bf16 v[44:47], a[64:67], a[44:47], v[44:47]
    ds_read_b64_tr_b16 a[132:133], v6 offset:4096
    v_mfma_f32_16x16x32_bf16 v[48:51], a[64:67], a[48:51], v[48:51]
    ds_read_b64_tr_b16 a[134:135], v6 offset:5120
    v_mfma_f32_16x16x32_bf16 v[52:55], a[64:67], a[52:55], v[52:55]
    ds_read_b128 a[100:103], v11 offset:2048
    v_mfma_f32_16x16x32_bf16 v[56:59], a[64:67], a[56:59], v[56:59]
    ds_read_b64_tr_b16 a[136:137], v7 offset:4096
    v_mfma_f32_16x16x32_bf16 v[60:63], a[64:67], a[60:63], v[60:63]
    ds_read_b64_tr_b16 a[138:139], v7 offset:5120
    v_mfma_f32_16x16x32_bf16 v[64:67], a[68:71], a[32:35], v[64:67]
    ds_read_b128 a[104:107], v11 offset:4096
    v_mfma_f32_16x16x32_bf16 v[68:71], a[68:71], a[36:39], v[68:71]
    ds_read_b64_tr_b16 a[140:141], v8 offset:4096
    s_add_u32 m0, s33, 37888
    v_mfma_f32_16x16x32_bf16 v[72:75], a[68:71], a[40:43], v[72:75]
    ds_read_b64_tr_b16 a[142:143], v8 offset:5120
    buffer_load_dwordx4 v9, s[8:11], s29 offen lds
    v_mfma_f32_16x16x32_bf16 v[76:79], a[68:71], a[44:47], v[76:79]
    ds_read_b128 a[108:111], v11 offset:6144
    v_mfma_f32_16x16x32_bf16 v[80:83], a[68:71], a[48:51], v[80:83]
    ds_read_b64_tr_b16 a[144:145], v5 offset:12288
    v_mfma_f32_16x16x32_bf16 v[84:87], a[68:71], a[52:55], v[84:87]
    ds_read_b64_tr_b16 a[146:147], v5 offset:13312
    v_mfma_f32_16x16x32_bf16 v[88:91], a[68:71], a[56:59], v[88:91]
    ds_read_b128 a[112:115], v11 offset:8192
    v_mfma_f32_16x16x32_bf16 v[92:95], a[68:71], a[60:63], v[92:95]
    ds_read_b64_tr_b16 a[148:149], v6 offset:12288
    v_mfma_f32_16x16x32_bf16 v[96:99], a[72:75], a[32:35], v[96:99]
    ds_read_b64_tr_b16 a[150:151], v6 offset:13312
    v_mfma_f32_16x16x32_bf16 v[100:103], a[72:75], a[36:39], v[100:103]
    ds_read_b128 a[116:119], v11 offset:10240
    s_add_u32 m0, s33, 38912
    v_mfma_f32_16x16x32_bf16 v[104:107], a[72:75], a[40:43], v[104:107]
    ds_read_b64_tr_b16 a[152:153], v7 offset:12288
    buffer_load_dwordx4 v9, s[8:11], s30 offen lds
    v_mfma_f32_16x16x32_bf16 v[108:111], a[72:75], a[44:47], v[108:111]
    ds_read_b64_tr_b16 a[154:155], v7 offset:13312
    v_mfma_f32_16x16x32_bf16 v[112:115], a[72:75], a[48:51], v[112:115]
    ds_read_b128 a[120:123], v11 offset:12288
    v_mfma_f32_16x16x32_bf16 v[116:119], a[72:75], a[52:55], v[116:119]
    ds_read_b64_tr_b16 a[156:157], v8 offset:12288
    v_mfma_f32_16x16x32_bf16 v[120:123], a[72:75], a[56:59], v[120:123]
    ds_read_b64_tr_b16 a[158:159], v8 offset:13312
    v_mfma_f32_16x16x32_bf16 v[124:127], a[72:75], a[60:63], v[124:127]
    ds_read_b128 a[124:127], v11 offset:14336
    v_mfma_f32_16x16x32_bf16 v[128:131], a[76:79], a[32:35], v[128:131]
    v_mfma_f32_16x16x32_bf16 v[132:135], a[76:79], a[36:39], v[132:135]
    s_add_u32 m0, s33, 39936
    v_mfma_f32_16x16x32_bf16 v[136:139], a[76:79], a[40:43], v[136:139]
    buffer_load_dwordx4 v9, s[8:11], s31 offen lds
    v_mfma_f32_16x16x32_bf16 v[140:143], a[76:79], a[44:47], v[140:143]
    v_mfma_f32_16x16x32_bf16 v[144:147], a[76:79], a[48:51], v[144:147]
    v_mfma_f32_16x16x32_bf16 v[148:151], a[76:79], a[52:55], v[148:151]
    v_mfma_f32_16x16x32_bf16 v[152:155], a[76:79], a[56:59], v[152:155]
    s_add_u32 s8, s8, 524288
    s_addc_u32 s9, s9, 0
    v_mfma_f32_16x16x32_bf16 v[156:159], a[76:79], a[60:63], v[156:159]
    v_mfma_f32_16x16x32_bf16 v[160:163], a[80:83], a[32:35], v[160:163]
    s_add_u32 m0, s60, 131072
    s_mov_b32 s61, 0
    v_mfma_f32_16x16x32_bf16 v[164:167], a[80:83], a[36:39], v[164:167]
    buffer_load_dwordx4 v30, s[52:55], s61 offen lds
    v_mfma_f32_16x16x32_bf16 v[168:171], a[80:83], a[40:43], v[168:171]
    s_mov_b32 s38, 0x1c0000
    s_mov_b32 s39, 0x00020000
    s_lshl_b32 s34, s2, 13
    s_add_u32 s34, s34, 4096
    v_mfma_f32_16x16x32_bf16 v[172:175], a[80:83], a[44:47], v[172:175]
    buffer_load_dwordx4 a[252:255], v23, s[36:39], s34 offen
    v_mfma_f32_16x16x32_bf16 v[176:179], a[80:83], a[48:51], v[176:179]
    v_mfma_f32_16x16x32_bf16 v[180:183], a[80:83], a[52:55], v[180:183]
    v_mfma_f32_16x16x32_bf16 v[184:187], a[80:83], a[56:59], v[184:187]
    v_mfma_f32_16x16x32_bf16 v[188:191], a[80:83], a[60:63], v[188:191]
    v_mfma_f32_16x16x32_bf16 v[192:195], a[84:87], a[32:35], v[192:195]
    s_add_u32 m0, s60, 132096
    s_mov_b32 s61, 8192
    v_mfma_f32_16x16x32_bf16 v[196:199], a[84:87], a[36:39], v[196:199]
    buffer_load_dwordx4 v30, s[52:55], s61 offen lds
    v_mfma_f32_16x16x32_bf16 v[200:203], a[84:87], a[40:43], v[200:203]
    s_mov_b32 s50, 0x1c0000
    s_mov_b32 s51, 0x00020000
    s_lshl_b32 s34, s2, 13
    v_mfma_f32_16x16x32_bf16 v[204:207], a[84:87], a[44:47], v[204:207]
    buffer_load_dwordx4 a[252:255], v23, s[48:51], s34 offen
    v_mfma_f32_16x16x32_bf16 v[208:211], a[84:87], a[48:51], v[208:211]
    v_mfma_f32_16x16x32_bf16 v[212:215], a[84:87], a[52:55], v[212:215]
    v_mfma_f32_16x16x32_bf16 v[216:219], a[84:87], a[56:59], v[216:219]
    v_mfma_f32_16x16x32_bf16 v[220:223], a[84:87], a[60:63], v[220:223]
    v_mfma_f32_16x16x32_bf16 v[224:227], a[88:91], a[32:35], v[224:227]
    s_add_u32 m0, s60, 133120
    s_mov_b32 s61, 16384
    v_mfma_f32_16x16x32_bf16 v[228:231], a[88:91], a[36:39], v[228:231]
    buffer_load_dwordx4 v30, s[52:55], s61 offen lds
    v_mfma_f32_16x16x32_bf16 v[232:235], a[88:91], a[40:43], v[232:235]
    s_lshl_b32 s34, s2, 13
    s_add_u32 s34, s34, 4096
    v_mfma_f32_16x16x32_bf16 v[236:239], a[88:91], a[44:47], v[236:239]
    buffer_load_dwordx4 a[252:255], v23, s[48:51], s34 offen
    v_mfma_f32_16x16x32_bf16 v[240:243], a[88:91], a[48:51], v[240:243]
    v_mfma_f32_16x16x32_bf16 v[244:247], a[88:91], a[52:55], v[244:247]
    v_mfma_f32_16x16x32_bf16 v[248:251], a[88:91], a[56:59], v[248:251]
    v_mfma_f32_16x16x32_bf16 v[252:255], a[88:91], a[60:63], v[252:255]
    v_mfma_f32_16x16x32_bf16 a[0:3], a[92:95], a[32:35], a[0:3]
    s_add_u32 m0, s60, 134144
    s_mov_b32 s61, 24576
    v_mfma_f32_16x16x32_bf16 a[4:7], a[92:95], a[36:39], a[4:7]
    buffer_load_dwordx4 v30, s[52:55], s61 offen lds
    v_mfma_f32_16x16x32_bf16 a[8:11], a[92:95], a[40:43], a[8:11]
    v_mfma_f32_16x16x32_bf16 a[12:15], a[92:95], a[44:47], a[12:15]
    v_mfma_f32_16x16x32_bf16 a[16:19], a[92:95], a[48:51], a[16:19]
    v_mfma_f32_16x16x32_bf16 a[20:23], a[92:95], a[52:55], a[20:23]
    v_mfma_f32_16x16x32_bf16 a[24:27], a[92:95], a[56:59], a[24:27]
    v_mfma_f32_16x16x32_bf16 a[28:31], a[92:95], a[60:63], a[28:31]
    s_waitcnt vmcnt(11) lgkmcnt(0)
    s_barrier
    v_mfma_f32_16x16x32_bf16 v[32:35], a[128:131], a[96:99], v[32:35]
    ds_read_b64_tr_b16 a[64:65], v5 offset:32768
    v_mfma_f32_16x16x32_bf16 v[36:39], a[128:131], a[100:103], v[36:39]
    ds_read_b64_tr_b16 a[66:67], v5 offset:33792
    s_add_u32 m0, s32, 0
    v_mfma_f32_16x16x32_bf16 v[40:43], a[128:131], a[104:107], v[40:43]
    ds_read_b128 a[32:35], v10 offset:32768
    buffer_load_dwordx4 v3, s[4:7], s20 offen lds
    v_mfma_f32_16x16x32_bf16 v[44:47], a[128:131], a[108:111], v[44:47]
    ds_read_b64_tr_b16 a[68:69], v6 offset:32768
    v_mfma_f32_16x16x32_bf16 v[48:51], a[128:131], a[112:115], v[48:51]
    ds_read_b64_tr_b16 a[70:71], v6 offset:33792
    v_mfma_f32_16x16x32_bf16 v[52:55], a[128:131], a[116:119], v[52:55]
    ds_read_b128 a[36:39], v10 offset:34816
    s_add_u32 m0, s33, 0
    v_mfma_f32_16x16x32_bf16 v[56:59], a[128:131], a[120:123], v[56:59]
    ds_read_b64_tr_b16 a[72:73], v7 offset:32768
    buffer_load_dwordx4 v9, s[8:11], s24 offen lds
    v_mfma_f32_16x16x32_bf16 v[60:63], a[128:131], a[124:127], v[60:63]
    ds_read_b64_tr_b16 a[74:75], v7 offset:33792
    v_mfma_f32_16x16x32_bf16 v[64:67], a[132:135], a[96:99], v[64:67]
    ds_read_b128 a[40:43], v10 offset:36864
    v_mfma_f32_16x16x32_bf16 v[68:71], a[132:135], a[100:103], v[68:71]
    ds_read_b64_tr_b16 a[76:77], v8 offset:32768
    s_add_u32 m0, s32, 1024
    v_mfma_f32_16x16x32_bf16 v[72:75], a[132:135], a[104:107], v[72:75]
    ds_read_b64_tr_b16 a[78:79], v8 offset:33792
    buffer_load_dwordx4 v4, s[4:7], s20 offen lds
    v_mfma_f32_16x16x32_bf16 v[76:79], a[132:135], a[108:111], v[76:79]
    ds_read_b128 a[44:47], v10 offset:38912
    v_mfma_f32_16x16x32_bf16 v[80:83], a[132:135], a[112:115], v[80:83]
    ds_read_b64_tr_b16 a[80:81], v5 offset:40960
    v_mfma_f32_16x16x32_bf16 v[84:87], a[132:135], a[116:119], v[84:87]
    ds_read_b64_tr_b16 a[82:83], v5 offset:41984
    s_add_u32 m0, s33, 1024
    v_mfma_f32_16x16x32_bf16 v[88:91], a[132:135], a[120:123], v[88:91]
    ds_read_b128 a[48:51], v10 offset:40960
    buffer_load_dwordx4 v9, s[8:11], s25 offen lds
    v_mfma_f32_16x16x32_bf16 v[92:95], a[132:135], a[124:127], v[92:95]
    ds_read_b64_tr_b16 a[84:85], v6 offset:40960
    v_mfma_f32_16x16x32_bf16 v[96:99], a[136:139], a[96:99], v[96:99]
    ds_read_b64_tr_b16 a[86:87], v6 offset:41984
    v_mfma_f32_16x16x32_bf16 v[100:103], a[136:139], a[100:103], v[100:103]
    ds_read_b128 a[52:55], v10 offset:43008
    s_add_u32 m0, s32, 2048
    v_mfma_f32_16x16x32_bf16 v[104:107], a[136:139], a[104:107], v[104:107]
    ds_read_b64_tr_b16 a[88:89], v7 offset:40960
    buffer_load_dwordx4 v3, s[4:7], s21 offen lds
    v_mfma_f32_16x16x32_bf16 v[108:111], a[136:139], a[108:111], v[108:111]
    ds_read_b64_tr_b16 a[90:91], v7 offset:41984
    v_mfma_f32_16x16x32_bf16 v[112:115], a[136:139], a[112:115], v[112:115]
    ds_read_b128 a[56:59], v10 offset:45056
    v_mfma_f32_16x16x32_bf16 v[116:119], a[136:139], a[116:119], v[116:119]
    ds_read_b64_tr_b16 a[92:93], v8 offset:40960
    s_add_u32 m0, s33, 2048
    v_mfma_f32_16x16x32_bf16 v[120:123], a[136:139], a[120:123], v[120:123]
    ds_read_b64_tr_b16 a[94:95], v8 offset:41984
    buffer_load_dwordx4 v9, s[8:11], s26 offen lds
    v_mfma_f32_16x16x32_bf16 v[124:127], a[136:139], a[124:127], v[124:127]
    ds_read_b128 a[60:63], v10 offset:47104
    v_mfma_f32_16x16x32_bf16 v[128:131], a[140:143], a[96:99], v[128:131]
    v_mfma_f32_16x16x32_bf16 v[132:135], a[140:143], a[100:103], v[132:135]
    s_add_u32 m0, s32, 3072
    v_mfma_f32_16x16x32_bf16 v[136:139], a[140:143], a[104:107], v[136:139]
    buffer_load_dwordx4 v4, s[4:7], s21 offen lds
    v_mfma_f32_16x16x32_bf16 v[140:143], a[140:143], a[108:111], v[140:143]
    v_mfma_f32_16x16x32_bf16 v[144:147], a[140:143], a[112:115], v[144:147]
    v_mfma_f32_16x16x32_bf16 v[148:151], a[140:143], a[116:119], v[148:151]
    s_add_u32 m0, s33, 3072
    v_mfma_f32_16x16x32_bf16 v[152:155], a[140:143], a[120:123], v[152:155]
    s_load_dwordx2 s[36:37], s[0:1], 40
    buffer_load_dwordx4 v9, s[8:11], s27 offen lds
    v_mfma_f32_16x16x32_bf16 v[156:159], a[140:143], a[124:127], v[156:159]
    v_mfma_f32_16x16x32_bf16 v[160:163], a[144:147], a[96:99], v[160:163]
    v_mfma_f32_16x16x32_bf16 v[164:167], a[144:147], a[100:103], v[164:167]
    s_add_u32 m0, s32, 4096
    v_mfma_f32_16x16x32_bf16 v[168:171], a[144:147], a[104:107], v[168:171]
    buffer_load_dwordx4 v3, s[4:7], s22 offen lds
    v_mfma_f32_16x16x32_bf16 v[172:175], a[144:147], a[108:111], v[172:175]
    v_mfma_f32_16x16x32_bf16 v[176:179], a[144:147], a[112:115], v[176:179]
    v_mfma_f32_16x16x32_bf16 v[180:183], a[144:147], a[116:119], v[180:183]
    s_add_u32 m0, s32, 5120
    v_mfma_f32_16x16x32_bf16 v[184:187], a[144:147], a[120:123], v[184:187]
    buffer_load_dwordx4 v4, s[4:7], s22 offen lds
    v_mfma_f32_16x16x32_bf16 v[188:191], a[144:147], a[124:127], v[188:191]
    v_mfma_f32_16x16x32_bf16 v[192:195], a[148:151], a[96:99], v[192:195]
    v_mfma_f32_16x16x32_bf16 v[196:199], a[148:151], a[100:103], v[196:199]
    s_add_u32 m0, s32, 6144
    v_mfma_f32_16x16x32_bf16 v[200:203], a[148:151], a[104:107], v[200:203]
    buffer_load_dwordx4 v3, s[4:7], s23 offen lds
    v_mfma_f32_16x16x32_bf16 v[204:207], a[148:151], a[108:111], v[204:207]
    v_mfma_f32_16x16x32_bf16 v[208:211], a[148:151], a[112:115], v[208:211]
    v_mfma_f32_16x16x32_bf16 v[212:215], a[148:151], a[116:119], v[212:215]
    s_add_u32 m0, s32, 7168
    v_mfma_f32_16x16x32_bf16 v[216:219], a[148:151], a[120:123], v[216:219]
    buffer_load_dwordx4 v4, s[4:7], s23 offen lds
    v_mfma_f32_16x16x32_bf16 v[220:223], a[148:151], a[124:127], v[220:223]
    v_mfma_f32_16x16x32_bf16 v[224:227], a[152:155], a[96:99], v[224:227]
    v_mfma_f32_16x16x32_bf16 v[228:231], a[152:155], a[100:103], v[228:231]
    v_mfma_f32_16x16x32_bf16 v[232:235], a[152:155], a[104:107], v[232:235]
    v_mfma_f32_16x16x32_bf16 v[236:239], a[152:155], a[108:111], v[236:239]
    v_mfma_f32_16x16x32_bf16 v[240:243], a[152:155], a[112:115], v[240:243]
    v_mfma_f32_16x16x32_bf16 v[244:247], a[152:155], a[116:119], v[244:247]
    v_mfma_f32_16x16x32_bf16 v[248:251], a[152:155], a[120:123], v[248:251]
    v_mfma_f32_16x16x32_bf16 v[252:255], a[152:155], a[124:127], v[252:255]
    v_mfma_f32_16x16x32_bf16 a[0:3], a[156:159], a[96:99], a[0:3]
    v_mfma_f32_16x16x32_bf16 a[4:7], a[156:159], a[100:103], a[4:7]
    v_mfma_f32_16x16x32_bf16 a[8:11], a[156:159], a[104:107], a[8:11]
    v_mfma_f32_16x16x32_bf16 a[12:15], a[156:159], a[108:111], a[12:15]
    v_mfma_f32_16x16x32_bf16 a[16:19], a[156:159], a[112:115], a[16:19]
    v_mfma_f32_16x16x32_bf16 a[20:23], a[156:159], a[116:119], a[20:23]
    v_mfma_f32_16x16x32_bf16 a[24:27], a[156:159], a[120:123], a[24:27]
    s_add_u32 s4, s4, 128
    s_addc_u32 s5, s5, 0
    v_mfma_f32_16x16x32_bf16 a[28:31], a[156:159], a[124:127], a[28:31]
    s_waitcnt vmcnt(19) lgkmcnt(0)
    s_barrier
    v_mfma_f32_16x16x32_bf16 v[32:35], a[64:67], a[32:35], v[32:35]
    ds_read_b64_tr_b16 a[128:129], v5 offset:36864
    v_mfma_f32_16x16x32_bf16 v[36:39], a[64:67], a[36:39], v[36:39]
    ds_read_b64_tr_b16 a[130:131], v5 offset:37888
    s_add_u32 m0, s33, 4096
    v_mfma_f32_16x16x32_bf16 v[40:43], a[64:67], a[40:43], v[40:43]
    ds_read_b128 a[96:99], v11 offset:32768
    buffer_load_dwordx4 v9, s[8:11], s28 offen lds
    v_mfma_f32_16x16x32_bf16 v[44:47], a[64:67], a[44:47], v[44:47]
    ds_read_b64_tr_b16 a[132:133], v6 offset:36864
    v_mfma_f32_16x16x32_bf16 v[48:51], a[64:67], a[48:51], v[48:51]
    ds_read_b64_tr_b16 a[134:135], v6 offset:37888
    v_mfma_f32_16x16x32_bf16 v[52:55], a[64:67], a[52:55], v[52:55]
    ds_read_b128 a[100:103], v11 offset:34816
    v_mfma_f32_16x16x32_bf16 v[56:59], a[64:67], a[56:59], v[56:59]
    ds_read_b64_tr_b16 a[136:137], v7 offset:36864
    v_mfma_f32_16x16x32_bf16 v[60:63], a[64:67], a[60:63], v[60:63]
    ds_read_b64_tr_b16 a[138:139], v7 offset:37888
    v_mfma_f32_16x16x32_bf16 v[64:67], a[68:71], a[32:35], v[64:67]
    ds_read_b128 a[104:107], v11 offset:36864
    v_mfma_f32_16x16x32_bf16 v[68:71], a[68:71], a[36:39], v[68:71]
    ds_read_b64_tr_b16 a[140:141], v8 offset:36864
    s_add_u32 m0, s33, 5120
    v_mfma_f32_16x16x32_bf16 v[72:75], a[68:71], a[40:43], v[72:75]
    ds_read_b64_tr_b16 a[142:143], v8 offset:37888
    buffer_load_dwordx4 v9, s[8:11], s29 offen lds
    v_mfma_f32_16x16x32_bf16 v[76:79], a[68:71], a[44:47], v[76:79]
    ds_read_b128 a[108:111], v11 offset:38912
    v_mfma_f32_16x16x32_bf16 v[80:83], a[68:71], a[48:51], v[80:83]
    ds_read_b64_tr_b16 a[144:145], v5 offset:45056
    v_mfma_f32_16x16x32_bf16 v[84:87], a[68:71], a[52:55], v[84:87]
    ds_read_b64_tr_b16 a[146:147], v5 offset:46080
    v_mfma_f32_16x16x32_bf16 v[88:91], a[68:71], a[56:59], v[88:91]
    ds_read_b128 a[112:115], v11 offset:40960
    v_mfma_f32_16x16x32_bf16 v[92:95], a[68:71], a[60:63], v[92:95]
    ds_read_b64_tr_b16 a[148:149], v6 offset:45056
    v_mfma_f32_16x16x32_bf16 v[96:99], a[72:75], a[32:35], v[96:99]
    ds_read_b64_tr_b16 a[150:151], v6 offset:46080
    v_mfma_f32_16x16x32_bf16 v[100:103], a[72:75], a[36:39], v[100:103]
    ds_read_b128 a[116:119], v11 offset:43008
    s_add_u32 m0, s33, 6144
    v_mfma_f32_16x16x32_bf16 v[104:107], a[72:75], a[40:43], v[104:107]
    ds_read_b64_tr_b16 a[152:153], v7 offset:45056
    buffer_load_dwordx4 v9, s[8:11], s30 offen lds
    v_mfma_f32_16x16x32_bf16 v[108:111], a[72:75], a[44:47], v[108:111]
    ds_read_b64_tr_b16 a[154:155], v7 offset:46080
    v_mfma_f32_16x16x32_bf16 v[112:115], a[72:75], a[48:51], v[112:115]
    ds_read_b128 a[120:123], v11 offset:45056
    v_mfma_f32_16x16x32_bf16 v[116:119], a[72:75], a[52:55], v[116:119]
    ds_read_b64_tr_b16 a[156:157], v8 offset:45056
    v_mfma_f32_16x16x32_bf16 v[120:123], a[72:75], a[56:59], v[120:123]
    ds_read_b64_tr_b16 a[158:159], v8 offset:46080
    v_mfma_f32_16x16x32_bf16 v[124:127], a[72:75], a[60:63], v[124:127]
    ds_read_b128 a[124:127], v11 offset:47104
    v_mfma_f32_16x16x32_bf16 v[128:131], a[76:79], a[32:35], v[128:131]
    v_mfma_f32_16x16x32_bf16 v[132:135], a[76:79], a[36:39], v[132:135]
    s_add_u32 m0, s33, 7168
    v_mfma_f32_16x16x32_bf16 v[136:139], a[76:79], a[40:43], v[136:139]
    buffer_load_dwordx4 v9, s[8:11], s31 offen lds
    v_mfma_f32_16x16x32_bf16 v[140:143], a[76:79], a[44:47], v[140:143]
    v_mfma_f32_16x16x32_bf16 v[144:147], a[76:79], a[48:51], v[144:147]
    v_mfma_f32_16x16x32_bf16 v[148:151], a[76:79], a[52:55], v[148:151]
    v_mfma_f32_16x16x32_bf16 v[152:155], a[76:79], a[56:59], v[152:155]
    s_add_u32 s8, s8, 524288
    s_addc_u32 s9, s9, 0
    v_mfma_f32_16x16x32_bf16 v[156:159], a[76:79], a[60:63], v[156:159]
    v_mfma_f32_16x16x32_bf16 v[160:163], a[80:83], a[32:35], v[160:163]
    s_add_u32 m0, s60, 147456
    s_mov_b32 s61, 131072
    v_mfma_f32_16x16x32_bf16 v[164:167], a[80:83], a[36:39], v[164:167]
    buffer_load_dwordx4 v30, s[52:55], s61 offen lds
    v_mfma_f32_16x16x32_bf16 v[168:171], a[80:83], a[40:43], v[168:171]
    s_mov_b32 s38, 0x400000
    s_mov_b32 s39, 0x00020000
    s_lshl_b32 s34, s2, 14
    v_mfma_f32_16x16x32_bf16 v[172:175], a[80:83], a[44:47], v[172:175]
    buffer_load_dwordx4 a[252:255], v23, s[36:39], s34 offen
    v_mfma_f32_16x16x32_bf16 v[176:179], a[80:83], a[48:51], v[176:179]
    v_mfma_f32_16x16x32_bf16 v[180:183], a[80:83], a[52:55], v[180:183]
    v_mfma_f32_16x16x32_bf16 v[184:187], a[80:83], a[56:59], v[184:187]
    v_mfma_f32_16x16x32_bf16 v[188:191], a[80:83], a[60:63], v[188:191]
    v_mfma_f32_16x16x32_bf16 v[192:195], a[84:87], a[32:35], v[192:195]
    s_add_u32 m0, s60, 148480
    s_mov_b32 s61, 139264
    v_mfma_f32_16x16x32_bf16 v[196:199], a[84:87], a[36:39], v[196:199]
    buffer_load_dwordx4 v30, s[52:55], s61 offen lds
    v_mfma_f32_16x16x32_bf16 v[200:203], a[84:87], a[40:43], v[200:203]
    s_lshl_b32 s34, s2, 14
    s_add_u32 s34, s34, 4096
    v_mfma_f32_16x16x32_bf16 v[204:207], a[84:87], a[44:47], v[204:207]
    buffer_load_dwordx4 a[252:255], v23, s[36:39], s34 offen
    v_mfma_f32_16x16x32_bf16 v[208:211], a[84:87], a[48:51], v[208:211]
    v_mfma_f32_16x16x32_bf16 v[212:215], a[84:87], a[52:55], v[212:215]
    v_mfma_f32_16x16x32_bf16 v[216:219], a[84:87], a[56:59], v[216:219]
    v_mfma_f32_16x16x32_bf16 v[220:223], a[84:87], a[60:63], v[220:223]
    v_mfma_f32_16x16x32_bf16 v[224:227], a[88:91], a[32:35], v[224:227]
    s_add_u32 m0, s60, 149504
    s_mov_b32 s61, 147456
    v_mfma_f32_16x16x32_bf16 v[228:231], a[88:91], a[36:39], v[228:231]
    buffer_load_dwordx4 v30, s[52:55], s61 offen lds
    v_mfma_f32_16x16x32_bf16 v[232:235], a[88:91], a[40:43], v[232:235]
    v_mfma_f32_16x16x32_bf16 v[236:239], a[88:91], a[44:47], v[236:239]
    v_mfma_f32_16x16x32_bf16 v[240:243], a[88:91], a[48:51], v[240:243]
    v_mfma_f32_16x16x32_bf16 v[244:247], a[88:91], a[52:55], v[244:247]
    v_mfma_f32_16x16x32_bf16 v[248:251], a[88:91], a[56:59], v[248:251]
    v_mfma_f32_16x16x32_bf16 v[252:255], a[88:91], a[60:63], v[252:255]
    v_mfma_f32_16x16x32_bf16 a[0:3], a[92:95], a[32:35], a[0:3]
    s_add_u32 m0, s60, 150528
    s_mov_b32 s61, 155648
    v_mfma_f32_16x16x32_bf16 a[4:7], a[92:95], a[36:39], a[4:7]
    buffer_load_dwordx4 v30, s[52:55], s61 offen lds
    v_mfma_f32_16x16x32_bf16 a[8:11], a[92:95], a[40:43], a[8:11]
    v_mfma_f32_16x16x32_bf16 a[12:15], a[92:95], a[44:47], a[12:15]
    v_mfma_f32_16x16x32_bf16 a[16:19], a[92:95], a[48:51], a[16:19]
    v_mfma_f32_16x16x32_bf16 a[20:23], a[92:95], a[52:55], a[20:23]
    v_mfma_f32_16x16x32_bf16 a[24:27], a[92:95], a[56:59], a[24:27]
    v_mfma_f32_16x16x32_bf16 a[28:31], a[92:95], a[60:63], a[28:31]
    s_waitcnt vmcnt(10) lgkmcnt(0)
    s_barrier
    v_mov_b32 v31, 0
    v_mfma_f32_16x16x32_bf16 v[32:35], a[128:131], a[96:99], v[32:35]
    ds_read_b64_tr_b16 a[64:65], v5 offset:0
    buffer_load_dword v31, v31, s[84:87], s88 offen sc1
    v_mfma_f32_16x16x32_bf16 v[36:39], a[128:131], a[100:103], v[36:39]
    ds_read_b64_tr_b16 a[66:67], v5 offset:1024
    s_add_u32 m0, s32, 32768
    v_mfma_f32_16x16x32_bf16 v[40:43], a[128:131], a[104:107], v[40:43]
    ds_read_b128 a[32:35], v10 offset:0
    buffer_load_dwordx4 v3, s[4:7], s20 offen lds
    v_mfma_f32_16x16x32_bf16 v[44:47], a[128:131], a[108:111], v[44:47]
    ds_read_b64_tr_b16 a[68:69], v6 offset:0
    v_mfma_f32_16x16x32_bf16 v[48:51], a[128:131], a[112:115], v[48:51]
    ds_read_b64_tr_b16 a[70:71], v6 offset:1024
    v_mfma_f32_16x16x32_bf16 v[52:55], a[128:131], a[116:119], v[52:55]
    ds_read_b128 a[36:39], v10 offset:2048
    s_add_u32 m0, s33, 32768
    v_mfma_f32_16x16x32_bf16 v[56:59], a[128:131], a[120:123], v[56:59]
    ds_read_b64_tr_b16 a[72:73], v7 offset:0
    buffer_load_dwordx4 v9, s[8:11], s24 offen lds
    v_mfma_f32_16x16x32_bf16 v[60:63], a[128:131], a[124:127], v[60:63]
    ds_read_b64_tr_b16 a[74:75], v7 offset:1024
    v_mfma_f32_16x16x32_bf16 v[64:67], a[132:135], a[96:99], v[64:67]
    ds_read_b128 a[40:43], v10 offset:4096
    v_mfma_f32_16x16x32_bf16 v[68:71], a[132:135], a[100:103], v[68:71]
    ds_read_b64_tr_b16 a[76:77], v8 offset:0
    s_add_u32 m0, s32, 33792
    v_mfma_f32_16x16x32_bf16 v[72:75], a[132:135], a[104:107], v[72:75]
    ds_read_b64_tr_b16 a[78:79], v8 offset:1024
    buffer_load_dwordx4 v4, s[4:7], s20 offen lds
    v_mfma_f32_16x16x32_bf16 v[76:79], a[132:135], a[108:111], v[76:79]
    ds_read_b128 a[44:47], v10 offset:6144
    v_mfma_f32_16x16x32_bf16 v[80:83], a[132:135], a[112:115], v[80:83]
    ds_read_b64_tr_b16 a[80:81], v5 offset:8192
    v_mfma_f32_16x16x32_bf16 v[84:87], a[132:135], a[116:119], v[84:87]
    ds_read_b64_tr_b16 a[82:83], v5 offset:9216
    s_add_u32 m0, s33, 33792
    v_mfma_f32_16x16x32_bf16 v[88:91], a[132:135], a[120:123], v[88:91]
    ds_read_b128 a[48:51], v10 offset:8192
    buffer_load_dwordx4 v9, s[8:11], s25 offen lds
    v_mfma_f32_16x16x32_bf16 v[92:95], a[132:135], a[124:127], v[92:95]
    ds_read_b64_tr_b16 a[84:85], v6 offset:8192
    v_mfma_f32_16x16x32_bf16 v[96:99], a[136:139], a[96:99], v[96:99]
    ds_read_b64_tr_b16 a[86:87], v6 offset:9216
    v_mfma_f32_16x16x32_bf16 v[100:103], a[136:139], a[100:103], v[100:103]
    ds_read_b128 a[52:55], v10 offset:10240
    s_add_u32 m0, s32, 34816
    v_mfma_f32_16x16x32_bf16 v[104:107], a[136:139], a[104:107], v[104:107]
    ds_read_b64_tr_b16 a[88:89], v7 offset:8192
    buffer_load_dwordx4 v3, s[4:7], s21 offen lds
    v_mfma_f32_16x16x32_bf16 v[108:111], a[136:139], a[108:111], v[108:111]
    ds_read_b64_tr_b16 a[90:91], v7 offset:9216
    v_mfma_f32_16x16x32_bf16 v[112:115], a[136:139], a[112:115], v[112:115]
    ds_read_b128 a[56:59], v10 offset:12288
    v_mfma_f32_16x16x32_bf16 v[116:119], a[136:139], a[116:119], v[116:119]
    ds_read_b64_tr_b16 a[92:93], v8 offset:8192
    s_add_u32 m0, s33, 34816
    v_mfma_f32_16x16x32_bf16 v[120:123], a[136:139], a[120:123], v[120:123]
    ds_read_b64_tr_b16 a[94:95], v8 offset:9216
    buffer_load_dwordx4 v9, s[8:11], s26 offen lds
    v_mfma_f32_16x16x32_bf16 v[124:127], a[136:139], a[124:127], v[124:127]
    ds_read_b128 a[60:63], v10 offset:14336
    v_mfma_f32_16x16x32_bf16 v[128:131], a[140:143], a[96:99], v[128:131]
    v_mfma_f32_16x16x32_bf16 v[132:135], a[140:143], a[100:103], v[132:135]
    s_add_u32 m0, s32, 35840
    v_mfma_f32_16x16x32_bf16 v[136:139], a[140:143], a[104:107], v[136:139]
    buffer_load_dwordx4 v4, s[4:7], s21 offen lds
    v_mfma_f32_16x16x32_bf16 v[140:143], a[140:143], a[108:111], v[140:143]
    v_mfma_f32_16x16x32_bf16 v[144:147], a[140:143], a[112:115], v[144:147]
    v_mfma_f32_16x16x32_bf16 v[148:151], a[140:143], a[116:119], v[148:151]
    s_add_u32 m0, s33, 35840
    v_mfma_f32_16x16x32_bf16 v[152:155], a[140:143], a[120:123], v[152:155]
    s_load_dwordx2 s[36:37], s[0:1], 40
    buffer_load_dwordx4 v9, s[8:11], s27 offen lds
    v_mfma_f32_16x16x32_bf16 v[156:159], a[140:143], a[124:127], v[156:159]
    v_mfma_f32_16x16x32_bf16 v[160:163], a[144:147], a[96:99], v[160:163]
    v_mfma_f32_16x16x32_bf16 v[164:167], a[144:147], a[100:103], v[164:167]
    s_add_u32 m0, s32, 36864
    v_mfma_f32_16x16x32_bf16 v[168:171], a[144:147], a[104:107], v[168:171]
    buffer_load_dwordx4 v3, s[4:7], s22 offen lds
    v_mfma_f32_16x16x32_bf16 v[172:175], a[144:147], a[108:111], v[172:175]
    v_mfma_f32_16x16x32_bf16 v[176:179], a[144:147], a[112:115], v[176:179]
    v_mfma_f32_16x16x32_bf16 v[180:183], a[144:147], a[116:119], v[180:183]
    s_add_u32 m0, s32, 37888
    v_mfma_f32_16x16x32_bf16 v[184:187], a[144:147], a[120:123], v[184:187]
    buffer_load_dwordx4 v4, s[4:7], s22 offen lds
    v_mfma_f32_16x16x32_bf16 v[188:191], a[144:147], a[124:127], v[188:191]
    v_mfma_f32_16x16x32_bf16 v[192:195], a[148:151], a[96:99], v[192:195]
    v_mfma_f32_16x16x32_bf16 v[196:199], a[148:151], a[100:103], v[196:199]
    s_add_u32 m0, s32, 38912
    v_mfma_f32_16x16x32_bf16 v[200:203], a[148:151], a[104:107], v[200:203]
    buffer_load_dwordx4 v3, s[4:7], s23 offen lds
    v_mfma_f32_16x16x32_bf16 v[204:207], a[148:151], a[108:111], v[204:207]
    v_mfma_f32_16x16x32_bf16 v[208:211], a[148:151], a[112:115], v[208:211]
    v_mfma_f32_16x16x32_bf16 v[212:215], a[148:151], a[116:119], v[212:215]
    s_add_u32 m0, s32, 39936
    v_mfma_f32_16x16x32_bf16 v[216:219], a[148:151], a[120:123], v[216:219]
    buffer_load_dwordx4 v4, s[4:7], s23 offen lds
    v_mfma_f32_16x16x32_bf16 v[220:223], a[148:151], a[124:127], v[220:223]
    v_mfma_f32_16x16x32_bf16 v[224:227], a[152:155], a[96:99], v[224:227]
    v_mfma_f32_16x16x32_bf16 v[228:231], a[152:155], a[100:103], v[228:231]
    v_mfma_f32_16x16x32_bf16 v[232:235], a[152:155], a[104:107], v[232:235]
    v_mfma_f32_16x16x32_bf16 v[236:239], a[152:155], a[108:111], v[236:239]
    v_mfma_f32_16x16x32_bf16 v[240:243], a[152:155], a[112:115], v[240:243]
    v_mfma_f32_16x16x32_bf16 v[244:247], a[152:155], a[116:119], v[244:247]
    v_mfma_f32_16x16x32_bf16 v[248:251], a[152:155], a[120:123], v[248:251]
    v_mfma_f32_16x16x32_bf16 v[252:255], a[152:155], a[124:127], v[252:255]
    v_mfma_f32_16x16x32_bf16 a[0:3], a[156:159], a[96:99], a[0:3]
    v_mfma_f32_16x16x32_bf16 a[4:7], a[156:159], a[100:103], a[4:7]
    v_mfma_f32_16x16x32_bf16 a[8:11], a[156:159], a[104:107], a[8:11]
    v_mfma_f32_16x16x32_bf16 a[12:15], a[156:159], a[108:111], a[12:15]
    v_mfma_f32_16x16x32_bf16 a[16:19], a[156:159], a[112:115], a[16:19]
    v_mfma_f32_16x16x32_bf16 a[20:23], a[156:159], a[116:119], a[20:23]
    v_mfma_f32_16x16x32_bf16 a[24:27], a[156:159], a[120:123], a[24:27]
    s_add_u32 s4, s4, 128
    s_addc_u32 s5, s5, 0
    v_mfma_f32_16x16x32_bf16 a[28:31], a[156:159], a[124:127], a[28:31]
    s_waitcnt vmcnt(12) lgkmcnt(0)
    s_barrier
    v_readfirstlane_b32 s61, v31
    s_and_b32 s61, s61, 0xff
    s_cmp_ge_u32 s61, 8
    s_cbranch_scc0 SPIN_100005
OK_100006:
    v_mfma_f32_16x16x32_bf16 v[32:35], a[64:67], a[32:35], v[32:35]
    ds_read_b64_tr_b16 a[128:129], v5 offset:4096
    v_mfma_f32_16x16x32_bf16 v[36:39], a[64:67], a[36:39], v[36:39]
    ds_read_b64_tr_b16 a[130:131], v5 offset:5120
    s_add_u32 m0, s33, 36864
    v_mfma_f32_16x16x32_bf16 v[40:43], a[64:67], a[40:43], v[40:43]
    ds_read_b128 a[96:99], v11 offset:0
    buffer_load_dwordx4 v9, s[8:11], s28 offen lds
    v_mfma_f32_16x16x32_bf16 v[44:47], a[64:67], a[44:47], v[44:47]
    ds_read_b64_tr_b16 a[132:133], v6 offset:4096
    v_mfma_f32_16x16x32_bf16 v[48:51], a[64:67], a[48:51], v[48:51]
    ds_read_b64_tr_b16 a[134:135], v6 offset:5120
    v_mfma_f32_16x16x32_bf16 v[52:55], a[64:67], a[52:55], v[52:55]
    ds_read_b128 a[100:103], v11 offset:2048
    v_mfma_f32_16x16x32_bf16 v[56:59], a[64:67], a[56:59], v[56:59]
    ds_read_b64_tr_b16 a[136:137], v7 offset:4096
    v_mfma_f32_16x16x32_bf16 v[60:63], a[64:67], a[60:63], v[60:63]
    ds_read_b64_tr_b16 a[138:139], v7 offset:5120
    v_mfma_f32_16x16x32_bf16 v[64:67], a[68:71], a[32:35], v[64:67]
    ds_read_b128 a[104:107], v11 offset:4096
    v_mfma_f32_16x16x32_bf16 v[68:71], a[68:71], a[36:39], v[68:71]
    ds_read_b64_tr_b16 a[140:141], v8 offset:4096
    s_add_u32 m0, s33, 37888
    v_mfma_f32_16x16x32_bf16 v[72:75], a[68:71], a[40:43], v[72:75]
    ds_read_b64_tr_b16 a[142:143], v8 offset:5120
    buffer_load_dwordx4 v9, s[8:11], s29 offen lds
    v_mfma_f32_16x16x32_bf16 v[76:79], a[68:71], a[44:47], v[76:79]
    ds_read_b128 a[108:111], v11 offset:6144
    v_mfma_f32_16x16x32_bf16 v[80:83], a[68:71], a[48:51], v[80:83]
    ds_read_b64_tr_b16 a[144:145], v5 offset:12288
    v_mfma_f32_16x16x32_bf16 v[84:87], a[68:71], a[52:55], v[84:87]
    ds_read_b64_tr_b16 a[146:147], v5 offset:13312
    v_mfma_f32_16x16x32_bf16 v[88:91], a[68:71], a[56:59], v[88:91]
    ds_read_b128 a[112:115], v11 offset:8192
    v_mfma_f32_16x16x32_bf16 v[92:95], a[68:71], a[60:63], v[92:95]
    ds_read_b64_tr_b16 a[148:149], v6 offset:12288
    v_mfma_f32_16x16x32_bf16 v[96:99], a[72:75], a[32:35], v[96:99]
    ds_read_b64_tr_b16 a[150:151], v6 offset:13312
    v_mfma_f32_16x16x32_bf16 v[100:103], a[72:75], a[36:39], v[100:103]
    ds_read_b128 a[116:119], v11 offset:10240
    s_add_u32 m0, s33, 38912
    v_mfma_f32_16x16x32_bf16 v[104:107], a[72:75], a[40:43], v[104:107]
    ds_read_b64_tr_b16 a[152:153], v7 offset:12288
    buffer_load_dwordx4 v9, s[8:11], s30 offen lds
    v_mfma_f32_16x16x32_bf16 v[108:111], a[72:75], a[44:47], v[108:111]
    ds_read_b64_tr_b16 a[154:155], v7 offset:13312
    v_mfma_f32_16x16x32_bf16 v[112:115], a[72:75], a[48:51], v[112:115]
    ds_read_b128 a[120:123], v11 offset:12288
    v_mfma_f32_16x16x32_bf16 v[116:119], a[72:75], a[52:55], v[116:119]
    ds_read_b64_tr_b16 a[156:157], v8 offset:12288
    v_mfma_f32_16x16x32_bf16 v[120:123], a[72:75], a[56:59], v[120:123]
    ds_read_b64_tr_b16 a[158:159], v8 offset:13312
    v_mfma_f32_16x16x32_bf16 v[124:127], a[72:75], a[60:63], v[124:127]
    ds_read_b128 a[124:127], v11 offset:14336
    v_mfma_f32_16x16x32_bf16 v[128:131], a[76:79], a[32:35], v[128:131]
    v_mfma_f32_16x16x32_bf16 v[132:135], a[76:79], a[36:39], v[132:135]
    s_add_u32 m0, s33, 39936
    v_mfma_f32_16x16x32_bf16 v[136:139], a[76:79], a[40:43], v[136:139]
    buffer_load_dwordx4 v9, s[8:11], s31 offen lds
    v_mfma_f32_16x16x32_bf16 v[140:143], a[76:79], a[44:47], v[140:143]
    v_mfma_f32_16x16x32_bf16 v[144:147], a[76:79], a[48:51], v[144:147]
    v_mfma_f32_16x16x32_bf16 v[148:151], a[76:79], a[52:55], v[148:151]
    v_mfma_f32_16x16x32_bf16 v[152:155], a[76:79], a[56:59], v[152:155]
    s_add_u32 s8, s8, 524288
    s_addc_u32 s9, s9, 0
    v_mfma_f32_16x16x32_bf16 v[156:159], a[76:79], a[60:63], v[156:159]
    v_mfma_f32_16x16x32_bf16 v[160:163], a[80:83], a[32:35], v[160:163]
    v_mfma_f32_16x16x32_bf16 v[164:167], a[80:83], a[36:39], v[164:167]
    s_mov_b32 s89, 0
    v_mfma_f32_16x16x32_bf16 v[168:171], a[80:83], a[40:43], v[168:171]
    s_mov_b32 s38, 0x400000
    s_mov_b32 s39, 0x00020000
    s_lshl_b32 s34, s2, 14
    s_add_u32 s34, s34, 8192
    buffer_load_dwordx4 a[160:163], v1, s[80:83], s89 offen offset:0 sc1
    v_mfma_f32_16x16x32_bf16 v[172:175], a[80:83], a[44:47], v[172:175]
    buffer_load_dwordx4 a[252:255], v23, s[36:39], s34 offen
    v_mfma_f32_16x16x32_bf16 v[176:179], a[80:83], a[48:51], v[176:179]
    v_mfma_f32_16x16x32_bf16 v[180:183], a[80:83], a[52:55], v[180:183]
    v_mfma_f32_16x16x32_bf16 v[184:187], a[80:83], a[56:59], v[184:187]
    v_mfma_f32_16x16x32_bf16 v[188:191], a[80:83], a[60:63], v[188:191]
    v_mfma_f32_16x16x32_bf16 v[192:195], a[84:87], a[32:35], v[192:195]
    v_mfma_f32_16x16x32_bf16 v[196:199], a[84:87], a[36:39], v[196:199]
    buffer_load_dwordx4 a[164:167], v1, s[80:83], s89 offen offset:512 sc1
    v_mfma_f32_16x16x32_bf16 v[200:203], a[84:87], a[40:43], v[200:203]
    s_lshl_b32 s34, s2, 14
    s_add_u32 s34, s34, 12288
    v_mfma_f32_16x16x32_bf16 v[204:207], a[84:87], a[44:47], v[204:207]
    buffer_load_dwordx4 a[252:255], v23, s[36:39], s34 offen
    v_mfma_f32_16x16x32_bf16 v[208:211], a[84:87], a[48:51], v[208:211]
    v_mfma_f32_16x16x32_bf16 v[212:215], a[84:87], a[52:55], v[212:215]
    v_mfma_f32_16x16x32_bf16 v[216:219], a[84:87], a[56:59], v[216:219]
    v_mfma_f32_16x16x32_bf16 v[220:223], a[84:87], a[60:63], v[220:223]
    v_mfma_f32_16x16x32_bf16 v[224:227], a[88:91], a[32:35], v[224:227]
    buffer_load_dwordx4 a[168:171], v1, s[80:83], s89 offen offset:1024 sc1
    v_mfma_f32_16x16x32_bf16 v[228:231], a[88:91], a[36:39], v[228:231]
    v_mfma_f32_16x16x32_bf16 v[232:235], a[88:91], a[40:43], v[232:235]
    v_mfma_f32_16x16x32_bf16 v[236:239], a[88:91], a[44:47], v[236:239]
    v_mfma_f32_16x16x32_bf16 v[240:243], a[88:91], a[48:51], v[240:243]
    v_mfma_f32_16x16x32_bf16 v[244:247], a[88:91], a[52:55], v[244:247]
    v_mfma_f32_16x16x32_bf16 v[248:251], a[88:91], a[56:59], v[248:251]
    v_mfma_f32_16x16x32_bf16 v[252:255], a[88:91], a[60:63], v[252:255]
    buffer_load_dwordx4 a[172:175], v1, s[80:83], s89 offen offset:1536 sc1
    v_mfma_f32_16x16x32_bf16 a[0:3], a[92:95], a[32:35], a[0:3]
    v_mfma_f32_16x16x32_bf16 a[4:7], a[92:95], a[36:39], a[4:7]
    v_mfma_f32_16x16x32_bf16 a[8:11], a[92:95], a[40:43], a[8:11]
    v_mfma_f32_16x16x32_bf16 a[12:15], a[92:95], a[44:47], a[12:15]
    v_mfma_f32_16x16x32_bf16 a[16:19], a[92:95], a[48:51], a[16:19]
    v_mfma_f32_16x16x32_bf16 a[20:23], a[92:95], a[52:55], a[20:23]
    v_mfma_f32_16x16x32_bf16 a[24:27], a[92:95], a[56:59], a[24:27]
    v_mfma_f32_16x16x32_bf16 a[28:31], a[92:95], a[60:63], a[28:31]
    s_waitcnt vmcnt(10) lgkmcnt(0)
    s_barrier
    v_mfma_f32_16x16x32_bf16 v[32:35], a[128:131], a[96:99], v[32:35]
    ds_read_b64_tr_b16 a[64:65], v5 offset:32768
    v_mfma_f32_16x16x32_bf16 v[36:39], a[128:131], a[100:103], v[36:39]
    ds_read_b64_tr_b16 a[66:67], v5 offset:33792
    s_add_u32 m0, s60, 0
    s_mov_b32 s61, 262144
    v_mfma_f32_16x16x32_bf16 v[40:43], a[128:131], a[104:107], v[40:43]
    ds_read_b128 a[32:35], v10 offset:32768
    buffer_load_dwordx4 v30, s[52:55], s61 offen lds
    v_mfma_f32_16x16x32_bf16 v[44:47], a[128:131], a[108:111], v[44:47]
    ds_read_b64_tr_b16 a[68:69], v6 offset:32768
    v_mfma_f32_16x16x32_bf16 v[48:51], a[128:131], a[112:115], v[48:51]
    ds_read_b64_tr_b16 a[70:71], v6 offset:33792
    v_mfma_f32_16x16x32_bf16 v[52:55], a[128:131], a[116:119], v[52:55]
    ds_read_b128 a[36:39], v10 offset:34816
    v_mfma_f32_16x16x32_bf16 v[56:59], a[128:131], a[120:123], v[56:59]
    ds_read_b64_tr_b16 a[72:73], v7 offset:32768
    v_mfma_f32_16x16x32_bf16 v[60:63], a[128:131], a[124:127], v[60:63]
    ds_read_b64_tr_b16 a[74:75], v7 offset:33792
    s_add_u32 m0, s60, 1024
    s_mov_b32 s61, 270336
    v_mfma_f32_16x16x32_bf16 v[64:67], a[132:135], a[96:99], v[64:67]
    ds_read_b128 a[40:43], v10 offset:36864
    buffer_load_dwordx4 v30, s[52:55], s61 offen lds
    v_mfma_f32_16x16x32_bf16 v[68:71], a[132:135], a[100:103], v[68:71]
    ds_read_b64_tr_b16 a[76:77], v8 offset:32768
    v_mfma_f32_16x16x32_bf16 v[72:75], a[132:135], a[104:107], v[72:75]
    ds_read_b64_tr_b16 a[78:79], v8 offset:33792
    v_mfma_f32_16x16x32_bf16 v[76:79], a[132:135], a[108:111], v[76:79]
    ds_read_b128 a[44:47], v10 offset:38912
    v_mfma_f32_16x16x32_bf16 v[80:83], a[132:135], a[112:115], v[80:83]
    ds_read_b64_tr_b16 a[80:81], v5 offset:40960
    v_mfma_f32_16x16x32_bf16 v[84:87], a[132:135], a[116:119], v[84:87]
    ds_read_b64_tr_b16 a[82:83], v5 offset:41984
    s_add_u32 m0, s60, 2048
    s_mov_b32 s61, 278528
    v_mfma_f32_16x16x32_bf16 v[88:91], a[132:135], a[120:123], v[88:91]
    ds_read_b128 a[48:51], v10 offset:40960
    buffer_load_dwordx4 v30, s[52:55], s61 offen lds
    v_mfma_f32_16x16x32_bf16 v[92:95], a[132:135], a[124:127], v[92:95]
    ds_read_b64_tr_b16 a[84:85], v6 offset:40960
    v_mfma_f32_16x16x32_bf16 v[96:99], a[136:139], a[96:99], v[96:99]
    ds_read_b64_tr_b16 a[86:87], v6 offset:41984
    v_mfma_f32_16x16x32_bf16 v[100:103], a[136:139], a[100:103], v[100:103]
    ds_read_b128 a[52:55], v10 offset:43008
    v_mfma_f32_16x16x32_bf16 v[104:107], a[136:139], a[104:107], v[104:107]
    ds_read_b64_tr_b16 a[88:89], v7 offset:40960
    v_mfma_f32_16x16x32_bf16 v[108:111], a[136:139], a[108:111], v[108:111]
    ds_read_b64_tr_b16 a[90:91], v7 offset:41984
    s_add_u32 m0, s60, 3072
    s_mov_b32 s61, 286720
    v_mfma_f32_16x16x32_bf16 v[112:115], a[136:139], a[112:115], v[112:115]
    ds_read_b128 a[56:59], v10 offset:45056
    buffer_load_dwordx4 v30, s[52:55], s61 offen lds
    v_mfma_f32_16x16x32_bf16 v[116:119], a[136:139], a[116:119], v[116:119]
    ds_read_b64_tr_b16 a[92:93], v8 offset:40960
    v_mfma_f32_16x16x32_bf16 v[120:123], a[136:139], a[120:123], v[120:123]
    ds_read_b64_tr_b16 a[94:95], v8 offset:41984
    v_mfma_f32_16x16x32_bf16 v[124:127], a[136:139], a[124:127], v[124:127]
    ds_read_b128 a[60:63], v10 offset:47104
    v_mfma_f32_16x16x32_bf16 v[128:131], a[140:143], a[96:99], v[128:131]
    v_mfma_f32_16x16x32_bf16 v[132:135], a[140:143], a[100:103], v[132:135]
    s_add_u32 m0, s60, 16384
    s_mov_b32 s61, 393216
    v_mfma_f32_16x16x32_bf16 v[136:139], a[140:143], a[104:107], v[136:139]
    buffer_load_dwordx4 v30, s[52:55], s61 offen lds
    v_mfma_f32_16x16x32_bf16 v[140:143], a[140:143], a[108:111], v[140:143]
    v_mfma_f32_16x16x32_bf16 v[144:147], a[140:143], a[112:115], v[144:147]
    v_mfma_f32_16x16x32_bf16 v[148:151], a[140:143], a[116:119], v[148:151]
    v_mfma_f32_16x16x32_bf16 v[152:155], a[140:143], a[120:123], v[152:155]
    v_mfma_f32_16x16x32_bf16 v[156:159], a[140:143], a[124:127], v[156:159]
    s_add_u32 m0, s60, 17408
    s_mov_b32 s61, 401408
    v_mfma_f32_16x16x32_bf16 v[160:163], a[144:147], a[96:99], v[160:163]
    buffer_load_dwordx4 v30, s[52:55], s61 offen lds
    v_mfma_f32_16x16x32_bf16 v[164:167], a[144:147], a[100:103], v[164:167]
    v_mfma_f32_16x16x32_bf16 v[168:171], a[144:147], a[104:107], v[168:171]
    v_mfma_f32_16x16x32_bf16 v[172:175], a[144:147], a[108:111], v[172:175]
    v_mfma_f32_16x16x32_bf16 v[176:179], a[144:147], a[112:115], v[176:179]
    v_mfma_f32_16x16x32_bf16 v[180:183], a[144:147], a[116:119], v[180:183]
    s_add_u32 m0, s60, 18432
    s_mov_b32 s61, 409600
    v_mfma_f32_16x16x32_bf16 v[184:187], a[144:147], a[120:123], v[184:187]
    buffer_load_dwordx4 v30, s[52:55], s61 offen lds
    v_mfma_f32_16x16x32_bf16 v[188:191], a[144:147], a[124:127], v[188:191]
    v_mfma_f32_16x16x32_bf16 v[192:195], a[148:151], a[96:99], v[192:195]
    v_mfma_f32_16x16x32_bf16 v[196:199], a[148:151], a[100:103], v[196:199]
    v_mfma_f32_16x16x32_bf16 v[200:203], a[148:151], a[104:107], v[200:203]
    v_mfma_f32_16x16x32_bf16 v[204:207], a[148:151], a[108:111], v[204:207]
    s_add_u32 m0, s60, 19456
    s_mov_b32 s61, 417792
    v_mfma_f32_16x16x32_bf16 v[208:211], a[148:151], a[112:115], v[208:211]
    buffer_load_dwordx4 v30, s[52:55], s61 offen lds
    v_mfma_f32_16x16x32_bf16 v[212:215], a[148:151], a[116:119], v[212:215]
    v_mfma_f32_16x16x32_bf16 v[216:219], a[148:151], a[120:123], v[216:219]
    v_mfma_f32_16x16x32_bf16 v[220:223], a[148:151], a[124:127], v[220:223]
    v_mfma_f32_16x16x32_bf16 v[224:227], a[152:155], a[96:99], v[224:227]
    v_mfma_f32_16x16x32_bf16 v[228:231], a[152:155], a[100:103], v[228:231]
    v_mfma_f32_16x16x32_bf16 v[232:235], a[152:155], a[104:107], v[232:235]
    s_mov_b32 s89, 0
    v_mfma_f32_16x16x32_bf16 v[236:239], a[152:155], a[108:111], v[236:239]
    buffer_load_dwordx4 a[176:179], v1, s[80:83], s89 offen offset:2048 sc1
    v_mfma_f32_16x16x32_bf16 v[240:243], a[152:155], a[112:115], v[240:243]
    v_mfma_f32_16x16x32_bf16 v[244:247], a[152:155], a[116:119], v[244:247]
    v_mfma_f32_16x16x32_bf16 v[248:251], a[152:155], a[120:123], v[248:251]
    buffer_load_dwordx4 a[180:183], v1, s[80:83], s89 offen offset:2560 sc1
    v_mfma_f32_16x16x32_bf16 v[252:255], a[152:155], a[124:127], v[252:255]
    v_mfma_f32_16x16x32_bf16 a[0:3], a[156:159], a[96:99], a[0:3]
    v_mfma_f32_16x16x32_bf16 a[4:7], a[156:159], a[100:103], a[4:7]
    buffer_load_dwordx4 a[184:187], v1, s[80:83], s89 offen offset:3072 sc1
    v_mfma_f32_16x16x32_bf16 a[8:11], a[156:159], a[104:107], a[8:11]
    v_mfma_f32_16x16x32_bf16 a[12:15], a[156:159], a[108:111], a[12:15]
    v_mfma_f32_16x16x32_bf16 a[16:19], a[156:159], a[112:115], a[16:19]
    buffer_load_dwordx4 a[188:191], v1, s[80:83], s89 offen offset:3584 sc1
    v_mfma_f32_16x16x32_bf16 a[20:23], a[156:159], a[116:119], a[20:23]
    v_mfma_f32_16x16x32_bf16 a[24:27], a[156:159], a[120:123], a[24:27]
    v_mfma_f32_16x16x32_bf16 a[28:31], a[156:159], a[124:127], a[28:31]
    s_waitcnt vmcnt(18) lgkmcnt(0)
    s_barrier
    v_mfma_f32_16x16x32_bf16 v[32:35], a[64:67], a[32:35], v[32:35]
    ds_read_b64_tr_b16 a[128:129], v5 offset:36864
    v_mfma_f32_16x16x32_bf16 v[36:39], a[64:67], a[36:39], v[36:39]
    ds_read_b64_tr_b16 a[130:131], v5 offset:37888
    s_mov_b32 s89, 4096
    v_mfma_f32_16x16x32_bf16 v[40:43], a[64:67], a[40:43], v[40:43]
    ds_read_b128 a[96:99], v11 offset:32768
    buffer_load_dwordx4 a[192:195], v1, s[80:83], s89 offen offset:0 sc1
    v_mfma_f32_16x16x32_bf16 v[44:47], a[64:67], a[44:47], v[44:47]
    ds_read_b64_tr_b16 a[132:133], v6 offset:36864
    v_mfma_f32_16x16x32_bf16 v[48:51], a[64:67], a[48:51], v[48:51]
    ds_read_b64_tr_b16 a[134:135], v6 offset:37888
    v_mfma_f32_16x16x32_bf16 v[52:55], a[64:67], a[52:55], v[52:55]
    ds_read_b128 a[100:103], v11 offset:34816
    v_mfma_f32_16x16x32_bf16 v[56:59], a[64:67], a[56:59], v[56:59]
    ds_read_b64_tr_b16 a[136:137], v7 offset:36864
    buffer_load_dwordx4 a[196:199], v1, s[80:83], s89 offen offset:512 sc1
    v_mfma_f32_16x16x32_bf16 v[60:63], a[64:67], a[60:63], v[60:63]
    ds_read_b64_tr_b16 a[138:139], v7 offset:37888
    v_mfma_f32_16x16x32_bf16 v[64:67], a[68:71], a[32:35], v[64:67]
    ds_read_b128 a[104:107], v11 offset:36864
    v_mfma_f32_16x16x32_bf16 v[68:71], a[68:71], a[36:39], v[68:71]
    ds_read_b64_tr_b16 a[140:141], v8 offset:36864
    v_mfma_f32_16x16x32_bf16 v[72:75], a[68:71], a[40:43], v[72:75]
    ds_read_b64_tr_b16 a[142:143], v8 offset:37888
    buffer_load_dwordx4 a[200:203], v1, s[80:83], s89 offen offset:1024 sc1
    v_mfma_f32_16x16x32_bf16 v[76:79], a[68:71], a[44:47], v[76:79]
    ds_read_b128 a[108:111], v11 offset:38912
    v_mfma_f32_16x16x32_bf16 v[80:83], a[68:71], a[48:51], v[80:83]
    ds_read_b64_tr_b16 a[144:145], v5 offset:45056
    v_mfma_f32_16x16x32_bf16 v[84:87], a[68:71], a[52:55], v[84:87]
    ds_read_b64_tr_b16 a[146:147], v5 offset:46080
    v_mfma_f32_16x16x32_bf16 v[88:91], a[68:71], a[56:59], v[88:91]
    ds_read_b128 a[112:115], v11 offset:40960
    buffer_load_dwordx4 a[204:207], v1, s[80:83], s89 offen offset:1536 sc1
    v_mfma_f32_16x16x32_bf16 v[92:95], a[68:71], a[60:63], v[92:95]
    ds_read_b64_tr_b16 a[148:149], v6 offset:45056
    v_mfma_f32_16x16x32_bf16 v[96:99], a[72:75], a[32:35], v[96:99]
    ds_read_b64_tr_b16 a[150:151], v6 offset:46080
    v_mfma_f32_16x16x32_bf16 v[100:103], a[72:75], a[36:39], v[100:103]
    ds_read_b128 a[116:119], v11 offset:43008
    v_mfma_f32_16x16x32_bf16 v[104:107], a[72:75], a[40:43], v[104:107]
    ds_read_b64_tr_b16 a[152:153], v7 offset:45056
    buffer_load_dwordx4 a[208:211], v1, s[80:83], s89 offen offset:2048 sc1
    v_mfma_f32_16x16x32_bf16 v[108:111], a[72:75], a[44:47], v[108:111]
    ds_read_b64_tr_b16 a[154:155], v7 offset:46080
    v_mfma_f32_16x16x32_bf16 v[112:115], a[72:75], a[48:51], v[112:115]
    ds_read_b128 a[120:123], v11 offset:45056
    v_mfma_f32_16x16x32_bf16 v[116:119], a[72:75], a[52:55], v[116:119]
    ds_read_b64_tr_b16 a[156:157], v8 offset:45056
    v_mfma_f32_16x16x32_bf16 v[120:123], a[72:75], a[56:59], v[120:123]
    ds_read_b64_tr_b16 a[158:159], v8 offset:46080
    buffer_load_dwordx4 a[212:215], v1, s[80:83], s89 offen offset:2560 sc1
    v_mfma_f32_16x16x32_bf16 v[124:127], a[72:75], a[60:63], v[124:127]
    ds_read_b128 a[124:127], v11 offset:47104
    v_mfma_f32_16x16x32_bf16 v[128:131], a[76:79], a[32:35], v[128:131]
    v_mfma_f32_16x16x32_bf16 v[132:135], a[76:79], a[36:39], v[132:135]
    v_mfma_f32_16x16x32_bf16 v[136:139], a[76:79], a[40:43], v[136:139]
    buffer_load_dwordx4 a[216:219], v1, s[80:83], s89 offen offset:3072 sc1
    v_mfma_f32_16x16x32_bf16 v[140:143], a[76:79], a[44:47], v[140:143]
    v_mfma_f32_16x16x32_bf16 v[144:147], a[76:79], a[48:51], v[144:147]
    v_mfma_f32_16x16x32_bf16 v[148:151], a[76:79], a[52:55], v[148:151]
    v_mfma_f32_16x16x32_bf16 v[152:155], a[76:79], a[56:59], v[152:155]
    buffer_load_dwordx4 a[220:223], v1, s[80:83], s89 offen offset:3584 sc1
    v_mfma_f32_16x16x32_bf16 v[156:159], a[76:79], a[60:63], v[156:159]
    v_mfma_f32_16x16x32_bf16 v[160:163], a[80:83], a[32:35], v[160:163]
    v_mfma_f32_16x16x32_bf16 v[164:167], a[80:83], a[36:39], v[164:167]
    s_mov_b32 s89, 8192
    v_mfma_f32_16x16x32_bf16 v[168:171], a[80:83], a[40:43], v[168:171]
    buffer_load_dwordx4 a[224:227], v1, s[80:83], s89 offen offset:0 sc1
    v_mfma_f32_16x16x32_bf16 v[172:175], a[80:83], a[44:47], v[172:175]
    v_mfma_f32_16x16x32_bf16 v[176:179], a[80:83], a[48:51], v[176:179]
    v_mfma_f32_16x16x32_bf16 v[180:183], a[80:83], a[52:55], v[180:183]
    v_mfma_f32_16x16x32_bf16 v[184:187], a[80:83], a[56:59], v[184:187]
    buffer_load_dwordx4 a[228:231], v1, s[80:83], s89 offen offset:512 sc1
    v_mfma_f32_16x16x32_bf16 v[188:191], a[80:83], a[60:63], v[188:191]
    v_mfma_f32_16x16x32_bf16 v[192:195], a[84:87], a[32:35], v[192:195]
    v_mfma_f32_16x16x32_bf16 v[196:199], a[84:87], a[36:39], v[196:199]
    v_mfma_f32_16x16x32_bf16 v[200:203], a[84:87], a[40:43], v[200:203]
    buffer_load_dwordx4 a[232:235], v1, s[80:83], s89 offen offset:1024 sc1
    v_mfma_f32_16x16x32_bf16 v[204:207], a[84:87], a[44:47], v[204:207]
    v_mfma_f32_16x16x32_bf16 v[208:211], a[84:87], a[48:51], v[208:211]
    v_mfma_f32_16x16x32_bf16 v[212:215], a[84:87], a[52:55], v[212:215]
    v_mfma_f32_16x16x32_bf16 v[216:219], a[84:87], a[56:59], v[216:219]
    buffer_load_dwordx4 a[236:239], v1, s[80:83], s89 offen offset:1536 sc1
    v_mfma_f32_16x16x32_bf16 v[220:223], a[84:87], a[60:63], v[220:223]
    v_mfma_f32_16x16x32_bf16 v[224:227], a[88:91], a[32:35], v[224:227]
    v_mfma_f32_16x16x32_bf16 v[228:231], a[88:91], a[36:39], v[228:231]
    v_mfma_f32_16x16x32_bf16 v[232:235], a[88:91], a[40:43], v[232:235]
    buffer_load_dwordx4 a[240:243], v1, s[80:83], s89 offen offset:2048 sc1
    v_mfma_f32_16x16x32_bf16 v[236:239], a[88:91], a[44:47], v[236:239]
    v_mfma_f32_16x16x32_bf16 v[240:243], a[88:91], a[48:51], v[240:243]
    v_mfma_f32_16x16x32_bf16 v[244:247], a[88:91], a[52:55], v[244:247]
    v_mfma_f32_16x16x32_bf16 v[248:251], a[88:91], a[56:59], v[248:251]
    buffer_load_dwordx4 a[244:247], v1, s[80:83], s89 offen offset:2560 sc1
    v_mfma_f32_16x16x32_bf16 v[252:255], a[88:91], a[60:63], v[252:255]
    v_mfma_f32_16x16x32_bf16 a[0:3], a[92:95], a[32:35], a[0:3]
    v_mfma_f32_16x16x32_bf16 a[4:7], a[92:95], a[36:39], a[4:7]
    v_mfma_f32_16x16x32_bf16 a[8:11], a[92:95], a[40:43], a[8:11]
    buffer_load_dwordx4 a[248:251], v1, s[80:83], s89 offen offset:3072 sc1
    v_mfma_f32_16x16x32_bf16 a[12:15], a[92:95], a[44:47], a[12:15]
    v_mfma_f32_16x16x32_bf16 a[16:19], a[92:95], a[48:51], a[16:19]
    v_mfma_f32_16x16x32_bf16 a[20:23], a[92:95], a[52:55], a[20:23]
    v_mfma_f32_16x16x32_bf16 a[24:27], a[92:95], a[56:59], a[24:27]
    buffer_load_dwordx4 a[252:255], v1, s[80:83], s89 offen offset:3584 sc1
    v_mfma_f32_16x16x32_bf16 a[28:31], a[92:95], a[60:63], a[28:31]
    s_waitcnt lgkmcnt(0)
    v_mfma_f32_16x16x32_bf16 v[32:35], a[128:131], a[96:99], v[32:35]
    v_mfma_f32_16x16x32_bf16 v[36:39], a[128:131], a[100:103], v[36:39]
    s_mov_b32 s89, 12288
    v_mfma_f32_16x16x32_bf16 v[40:43], a[128:131], a[104:107], v[40:43]
    buffer_load_dwordx4 a[32:35], v1, s[80:83], s89 offen offset:0 sc1
    v_mfma_f32_16x16x32_bf16 v[44:47], a[128:131], a[108:111], v[44:47]
    v_mfma_f32_16x16x32_bf16 v[48:51], a[128:131], a[112:115], v[48:51]
    v_mfma_f32_16x16x32_bf16 v[52:55], a[128:131], a[116:119], v[52:55]
    v_mfma_f32_16x16x32_bf16 v[56:59], a[128:131], a[120:123], v[56:59]
    v_mfma_f32_16x16x32_bf16 v[60:63], a[128:131], a[124:127], v[60:63]
    v_mfma_f32_16x16x32_bf16 v[64:67], a[132:135], a[96:99], v[64:67]
    buffer_load_dwordx4 a[36:39], v1, s[80:83], s89 offen offset:512 sc1
    v_mfma_f32_16x16x32_bf16 v[68:71], a[132:135], a[100:103], v[68:71]
    v_mfma_f32_16x16x32_bf16 v[72:75], a[132:135], a[104:107], v[72:75]
    v_mfma_f32_16x16x32_bf16 v[76:79], a[132:135], a[108:111], v[76:79]
    v_mfma_f32_16x16x32_bf16 v[80:83], a[132:135], a[112:115], v[80:83]
    v_mfma_f32_16x16x32_bf16 v[84:87], a[132:135], a[116:119], v[84:87]
    v_mfma_f32_16x16x32_bf16 v[88:91], a[132:135], a[120:123], v[88:91]
    buffer_load_dwordx4 a[40:43], v1, s[80:83], s89 offen offset:1024 sc1
    v_mfma_f32_16x16x32_bf16 v[92:95], a[132:135], a[124:127], v[92:95]
    v_mfma_f32_16x16x32_bf16 v[96:99], a[136:139], a[96:99], v[96:99]
    v_mfma_f32_16x16x32_bf16 v[100:103], a[136:139], a[100:103], v[100:103]
    v_mfma_f32_16x16x32_bf16 v[104:107], a[136:139], a[104:107], v[104:107]
    v_mfma_f32_16x16x32_bf16 v[108:111], a[136:139], a[108:111], v[108:111]
    v_mfma_f32_16x16x32_bf16 v[112:115], a[136:139], a[112:115], v[112:115]
    buffer_load_dwordx4 a[44:47], v1, s[80:83], s89 offen offset:1536 sc1
    v_mfma_f32_16x16x32_bf16 v[116:119], a[136:139], a[116:119], v[116:119]
    v_mfma_f32_16x16x32_bf16 v[120:123], a[136:139], a[120:123], v[120:123]
    v_mfma_f32_16x16x32_bf16 v[124:127], a[136:139], a[124:127], v[124:127]
    v_mfma_f32_16x16x32_bf16 v[128:131], a[140:143], a[96:99], v[128:131]
    v_mfma_f32_16x16x32_bf16 v[132:135], a[140:143], a[100:103], v[132:135]
    v_mfma_f32_16x16x32_bf16 v[136:139], a[140:143], a[104:107], v[136:139]
    buffer_load_dwordx4 a[48:51], v1, s[80:83], s89 offen offset:2048 sc1
    v_mfma_f32_16x16x32_bf16 v[140:143], a[140:143], a[108:111], v[140:143]
    v_mfma_f32_16x16x32_bf16 v[144:147], a[140:143], a[112:115], v[144:147]
    v_mfma_f32_16x16x32_bf16 v[148:151], a[140:143], a[116:119], v[148:151]
    v_mfma_f32_16x16x32_bf16 v[152:155], a[140:143], a[120:123], v[152:155]
    v_mfma_f32_16x16x32_bf16 v[156:159], a[140:143], a[124:127], v[156:159]
    v_mfma_f32_16x16x32_bf16 v[160:163], a[144:147], a[96:99], v[160:163]
    buffer_load_dwordx4 a[52:55], v1, s[80:83], s89 offen offset:2560 sc1
    v_mfma_f32_16x16x32_bf16 v[164:167], a[144:147], a[100:103], v[164:167]
    v_mfma_f32_16x16x32_bf16 v[168:171], a[144:147], a[104:107], v[168:171]
    v_mfma_f32_16x16x32_bf16 v[172:175], a[144:147], a[108:111], v[172:175]
    v_mfma_f32_16x16x32_bf16 v[176:179], a[144:147], a[112:115], v[176:179]
    v_mfma_f32_16x16x32_bf16 v[180:183], a[144:147], a[116:119], v[180:183]
    v_mfma_f32_16x16x32_bf16 v[184:187], a[144:147], a[120:123], v[184:187]
    buffer_load_dwordx4 a[56:59], v1, s[80:83], s89 offen offset:3072 sc1
    v_mfma_f32_16x16x32_bf16 v[188:191], a[144:147], a[124:127], v[188:191]
    v_mfma_f32_16x16x32_bf16 v[192:195], a[148:151], a[96:99], v[192:195]
    v_mfma_f32_16x16x32_bf16 v[196:199], a[148:151], a[100:103], v[196:199]
    v_mfma_f32_16x16x32_bf16 v[200:203], a[148:151], a[104:107], v[200:203]
    v_mfma_f32_16x16x32_bf16 v[204:207], a[148:151], a[108:111], v[204:207]
    v_mfma_f32_16x16x32_bf16 v[208:211], a[148:151], a[112:115], v[208:211]
    buffer_load_dwordx4 a[60:63], v1, s[80:83], s89 offen offset:3584 sc1
    v_mfma_f32_16x16x32_bf16 v[212:215], a[148:151], a[116:119], v[212:215]
    v_mfma_f32_16x16x32_bf16 v[216:219], a[148:151], a[120:123], v[216:219]
    v_mfma_f32_16x16x32_bf16 v[220:223], a[148:151], a[124:127], v[220:223]
    v_mfma_f32_16x16x32_bf16 v[224:227], a[152:155], a[96:99], v[224:227]
    v_mfma_f32_16x16x32_bf16 v[228:231], a[152:155], a[100:103], v[228:231]
    v_mfma_f32_16x16x32_bf16 v[232:235], a[152:155], a[104:107], v[232:235]
    v_mfma_f32_16x16x32_bf16 v[236:239], a[152:155], a[108:111], v[236:239]
    v_mfma_f32_16x16x32_bf16 v[240:243], a[152:155], a[112:115], v[240:243]
    v_mfma_f32_16x16x32_bf16 v[244:247], a[152:155], a[116:119], v[244:247]
    v_mfma_f32_16x16x32_bf16 v[248:251], a[152:155], a[120:123], v[248:251]
    v_mfma_f32_16x16x32_bf16 v[252:255], a[152:155], a[124:127], v[252:255]
    v_mfma_f32_16x16x32_bf16 a[0:3], a[156:159], a[96:99], a[0:3]
    v_mfma_f32_16x16x32_bf16 a[4:7], a[156:159], a[100:103], a[4:7]
    v_mfma_f32_16x16x32_bf16 a[8:11], a[156:159], a[104:107], a[8:11]
    v_mfma_f32_16x16x32_bf16 a[12:15], a[156:159], a[108:111], a[12:15]
    v_mfma_f32_16x16x32_bf16 a[16:19], a[156:159], a[112:115], a[16:19]
    v_mfma_f32_16x16x32_bf16 a[20:23], a[156:159], a[116:119], a[20:23]
    v_mfma_f32_16x16x32_bf16 a[24:27], a[156:159], a[120:123], a[24:27]
    v_mfma_f32_16x16x32_bf16 a[28:31], a[156:159], a[124:127], a[28:31]
    s_nop 7
    s_nop 7
    v_lshrrev_b32 v13, 4, v2
    v_lshrrev_b32 v14, 1, v13
    v_and_b32 v15, 1, v13
    v_bfe_u32 v16, v2, 3, 1
    v_and_b32 v17, 7, v2
    v_lshl_add_u32 v17, v16, 4, v17
    v_lshl_add_u32 v17, v15, 5, v17
    v_lshlrev_b32 v17, 4, v17
    v_lshl_add_u32 v12, v14, 10, v17
    s_mov_b32 s35, 0x3e0293ee
    v_mul_f32 v32, s35, v32
    v_mul_f32 v33, s35, v33
    v_mul_f32 v34, s35, v34
    v_mul_f32 v35, s35, v35
    v_mul_f32 v64, s35, v64
    v_mul_f32 v65, s35, v65
    v_mul_f32 v66, s35, v66
    v_mul_f32 v67, s35, v67
    v_cvt_pk_bf16_f32 v16, v32, v33
    v_cvt_pk_bf16_f32 v17, v34, v35
    v_cvt_pk_bf16_f32 v18, v64, v65
    v_cvt_pk_bf16_f32 v19, v66, v67
    s_mov_b32 s34, 0
    buffer_store_dwordx4 v[16:19], v12, s[12:15], s34 offen offset:0 sc1
    v_mul_f32 v96, s35, v96
    v_mul_f32 v97, s35, v97
    v_mul_f32 v98, s35, v98
    v_mul_f32 v99, s35, v99
    v_mul_f32 v128, s35, v128
    v_mul_f32 v129, s35, v129
    v_mul_f32 v130, s35, v130
    v_mul_f32 v131, s35, v131
    v_cvt_pk_bf16_f32 v20, v96, v97
    v_cvt_pk_bf16_f32 v21, v98, v99
    v_cvt_pk_bf16_f32 v22, v128, v129
    v_cvt_pk_bf16_f32 v23, v130, v131
    s_mov_b32 s34, 0
    buffer_store_dwordx4 v[20:23], v12, s[12:15], s34 offen offset:2048 sc1
    v_mul_f32 v160, s35, v160
    v_mul_f32 v161, s35, v161
    v_mul_f32 v162, s35, v162
    v_mul_f32 v163, s35, v163
    v_mul_f32 v192, s35, v192
    v_mul_f32 v193, s35, v193
    v_mul_f32 v194, s35, v194
    v_mul_f32 v195, s35, v195
    v_cvt_pk_bf16_f32 v24, v160, v161
    v_cvt_pk_bf16_f32 v25, v162, v163
    v_cvt_pk_bf16_f32 v26, v192, v193
    v_cvt_pk_bf16_f32 v27, v194, v195
    s_mov_b32 s34, 4096
    buffer_store_dwordx4 v[24:27], v12, s[12:15], s34 offen offset:0 sc1
    v_accvgpr_read_b32 v9, a0
    v_accvgpr_read_b32 v10, a1
    v_accvgpr_read_b32 v11, a2
    v_accvgpr_read_b32 v13, a3
    v_mul_f32 v224, s35, v224
    v_mul_f32 v225, s35, v225
    v_mul_f32 v226, s35, v226
    v_mul_f32 v227, s35, v227
    v_mul_f32 v9, s35, v9
    v_mul_f32 v10, s35, v10
    v_mul_f32 v11, s35, v11
    v_mul_f32 v13, s35, v13
    v_cvt_pk_bf16_f32 v16, v224, v225
    v_cvt_pk_bf16_f32 v17, v226, v227
    v_cvt_pk_bf16_f32 v18, v9, v10
    v_cvt_pk_bf16_f32 v19, v11, v13
    s_mov_b32 s34, 4096
    buffer_store_dwordx4 v[16:19], v12, s[12:15], s34 offen offset:2048 sc1
    v_mul_f32 v36, s35, v36
    v_mul_f32 v37, s35, v37
    v_mul_f32 v38, s35, v38
    v_mul_f32 v39, s35, v39
    v_mul_f32 v68, s35, v68
    v_mul_f32 v69, s35, v69
    v_mul_f32 v70, s35, v70
    v_mul_f32 v71, s35, v71
    v_cvt_pk_bf16_f32 v20, v36, v37
    v_cvt_pk_bf16_f32 v21, v38, v39
    v_cvt_pk_bf16_f32 v22, v68, v69
    v_cvt_pk_bf16_f32 v23, v70, v71
    s_mov_b32 s34, 0
    buffer_store_dwordx4 v[20:23], v12, s[12:15], s34 offen offset:128 sc1
    v_mul_f32 v100, s35, v100
    v_mul_f32 v101, s35, v101
    v_mul_f32 v102, s35, v102
    v_mul_f32 v103, s35, v103
    v_mul_f32 v132, s35, v132
    v_mul_f32 v133, s35, v133
    v_mul_f32 v134, s35, v134
    v_mul_f32 v135, s35, v135
    v_cvt_pk_bf16_f32 v24, v100, v101
    v_cvt_pk_bf16_f32 v25, v102, v103
    v_cvt_pk_bf16_f32 v26, v132, v133
    v_cvt_pk_bf16_f32 v27, v134, v135
    s_mov_b32 s34, 0
    buffer_store_dwordx4 v[24:27], v12, s[12:15], s34 offen offset:2176 sc1
    v_mul_f32 v164, s35, v164
    v_mul_f32 v165, s35, v165
    v_mul_f32 v166, s35, v166
    v_mul_f32 v167, s35, v167
    v_mul_f32 v196, s35, v196
    v_mul_f32 v197, s35, v197
    v_mul_f32 v198, s35, v198
    v_mul_f32 v199, s35, v199
    v_cvt_pk_bf16_f32 v16, v164, v165
    v_cvt_pk_bf16_f32 v17, v166, v167
    v_cvt_pk_bf16_f32 v18, v196, v197
    v_cvt_pk_bf16_f32 v19, v198, v199
    s_mov_b32 s34, 4096
    buffer_store_dwordx4 v[16:19], v12, s[12:15], s34 offen offset:128 sc1
    v_accvgpr_read_b32 v9, a4
    v_accvgpr_read_b32 v10, a5
    v_accvgpr_read_b32 v11, a6
    v_accvgpr_read_b32 v13, a7
    v_mul_f32 v228, s35, v228
    v_mul_f32 v229, s35, v229
    v_mul_f32 v230, s35, v230
    v_mul_f32 v231, s35, v231
    v_mul_f32 v9, s35, v9
    v_mul_f32 v10, s35, v10
    v_mul_f32 v11, s35, v11
    v_mul_f32 v13, s35, v13
    v_cvt_pk_bf16_f32 v20, v228, v229
    v_cvt_pk_bf16_f32 v21, v230, v231
    v_cvt_pk_bf16_f32 v22, v9, v10
    v_cvt_pk_bf16_f32 v23, v11, v13
    s_mov_b32 s34, 4096
    buffer_store_dwordx4 v[20:23], v12, s[12:15], s34 offen offset:2176 sc1
    v_mul_f32 v40, s35, v40
    v_mul_f32 v41, s35, v41
    v_mul_f32 v42, s35, v42
    v_mul_f32 v43, s35, v43
    v_mul_f32 v72, s35, v72
    v_mul_f32 v73, s35, v73
    v_mul_f32 v74, s35, v74
    v_mul_f32 v75, s35, v75
    v_cvt_pk_bf16_f32 v24, v40, v41
    v_cvt_pk_bf16_f32 v25, v42, v43
    v_cvt_pk_bf16_f32 v26, v72, v73
    v_cvt_pk_bf16_f32 v27, v74, v75
    s_mov_b32 s34, 8192
    buffer_store_dwordx4 v[24:27], v12, s[12:15], s34 offen offset:0 sc1
    v_mul_f32 v104, s35, v104
    v_mul_f32 v105, s35, v105
    v_mul_f32 v106, s35, v106
    v_mul_f32 v107, s35, v107
    v_mul_f32 v136, s35, v136
    v_mul_f32 v137, s35, v137
    v_mul_f32 v138, s35, v138
    v_mul_f32 v139, s35, v139
    v_cvt_pk_bf16_f32 v16, v104, v105
    v_cvt_pk_bf16_f32 v17, v106, v107
    v_cvt_pk_bf16_f32 v18, v136, v137
    v_cvt_pk_bf16_f32 v19, v138, v139
    s_mov_b32 s34, 8192
    buffer_store_dwordx4 v[16:19], v12, s[12:15], s34 offen offset:2048 sc1
    v_mul_f32 v168, s35, v168
    v_mul_f32 v169, s35, v169
    v_mul_f32 v170, s35, v170
    v_mul_f32 v171, s35, v171
    v_mul_f32 v200, s35, v200
    v_mul_f32 v201, s35, v201
    v_mul_f32 v202, s35, v202
    v_mul_f32 v203, s35, v203
    v_cvt_pk_bf16_f32 v20, v168, v169
    v_cvt_pk_bf16_f32 v21, v170, v171
    v_cvt_pk_bf16_f32 v22, v200, v201
    v_cvt_pk_bf16_f32 v23, v202, v203
    s_mov_b32 s34, 12288
    buffer_store_dwordx4 v[20:23], v12, s[12:15], s34 offen offset:0 sc1
    v_accvgpr_read_b32 v9, a8
    v_accvgpr_read_b32 v10, a9
    v_accvgpr_read_b32 v11, a10
    v_accvgpr_read_b32 v13, a11
    v_mul_f32 v232, s35, v232
    v_mul_f32 v233, s35, v233
    v_mul_f32 v234, s35, v234
    v_mul_f32 v235, s35, v235
    v_mul_f32 v9, s35, v9
    v_mul_f32 v10, s35, v10
    v_mul_f32 v11, s35, v11
    v_mul_f32 v13, s35, v13
    v_cvt_pk_bf16_f32 v24, v232, v233
    v_cvt_pk_bf16_f32 v25, v234, v235
    v_cvt_pk_bf16_f32 v26, v9, v10
    v_cvt_pk_bf16_f32 v27, v11, v13
    s_mov_b32 s34, 12288
    buffer_store_dwordx4 v[24:27], v12, s[12:15], s34 offen offset:2048 sc1
    v_mul_f32 v44, s35, v44
    v_mul_f32 v45, s35, v45
    v_mul_f32 v46, s35, v46
    v_mul_f32 v47, s35, v47
    v_mul_f32 v76, s35, v76
    v_mul_f32 v77, s35, v77
    v_mul_f32 v78, s35, v78
    v_mul_f32 v79, s35, v79
    v_cvt_pk_bf16_f32 v16, v44, v45
    v_cvt_pk_bf16_f32 v17, v46, v47
    v_cvt_pk_bf16_f32 v18, v76, v77
    v_cvt_pk_bf16_f32 v19, v78, v79
    s_mov_b32 s34, 8192
    buffer_store_dwordx4 v[16:19], v12, s[12:15], s34 offen offset:128 sc1
    v_mul_f32 v108, s35, v108
    v_mul_f32 v109, s35, v109
    v_mul_f32 v110, s35, v110
    v_mul_f32 v111, s35, v111
    v_mul_f32 v140, s35, v140
    v_mul_f32 v141, s35, v141
    v_mul_f32 v142, s35, v142
    v_mul_f32 v143, s35, v143
    v_cvt_pk_bf16_f32 v20, v108, v109
    v_cvt_pk_bf16_f32 v21, v110, v111
    v_cvt_pk_bf16_f32 v22, v140, v141
    v_cvt_pk_bf16_f32 v23, v142, v143
    s_mov_b32 s34, 8192
    buffer_store_dwordx4 v[20:23], v12, s[12:15], s34 offen offset:2176 sc1
    v_mul_f32 v172, s35, v172
    v_mul_f32 v173, s35, v173
    v_mul_f32 v174, s35, v174
    v_mul_f32 v175, s35, v175
    v_mul_f32 v204, s35, v204
    v_mul_f32 v205, s35, v205
    v_mul_f32 v206, s35, v206
    v_mul_f32 v207, s35, v207
    v_cvt_pk_bf16_f32 v24, v172, v173
    v_cvt_pk_bf16_f32 v25, v174, v175
    v_cvt_pk_bf16_f32 v26, v204, v205
    v_cvt_pk_bf16_f32 v27, v206, v207
    s_mov_b32 s34, 12288
    buffer_store_dwordx4 v[24:27], v12, s[12:15], s34 offen offset:128 sc1
    v_accvgpr_read_b32 v9, a12
    v_accvgpr_read_b32 v10, a13
    v_accvgpr_read_b32 v11, a14
    v_accvgpr_read_b32 v13, a15
    v_mul_f32 v236, s35, v236
    v_mul_f32 v237, s35, v237
    v_mul_f32 v238, s35, v238
    v_mul_f32 v239, s35, v239
    v_mul_f32 v9, s35, v9
    v_mul_f32 v10, s35, v10
    v_mul_f32 v11, s35, v11
    v_mul_f32 v13, s35, v13
    v_cvt_pk_bf16_f32 v16, v236, v237
    v_cvt_pk_bf16_f32 v17, v238, v239
    v_cvt_pk_bf16_f32 v18, v9, v10
    v_cvt_pk_bf16_f32 v19, v11, v13
    s_mov_b32 s34, 12288
    buffer_store_dwordx4 v[16:19], v12, s[12:15], s34 offen offset:2176 sc1
    v_mul_f32 v48, s35, v48
    v_mul_f32 v49, s35, v49
    v_mul_f32 v50, s35, v50
    v_mul_f32 v51, s35, v51
    v_mul_f32 v80, s35, v80
    v_mul_f32 v81, s35, v81
    v_mul_f32 v82, s35, v82
    v_mul_f32 v83, s35, v83
    v_cvt_pk_bf16_f32 v20, v48, v49
    v_cvt_pk_bf16_f32 v21, v50, v51
    v_cvt_pk_bf16_f32 v22, v80, v81
    v_cvt_pk_bf16_f32 v23, v82, v83
    s_mov_b32 s34, 32768
    buffer_store_dwordx4 v[20:23], v12, s[12:15], s34 offen offset:0 sc1
    v_mul_f32 v112, s35, v112
    v_mul_f32 v113, s35, v113
    v_mul_f32 v114, s35, v114
    v_mul_f32 v115, s35, v115
    v_mul_f32 v144, s35, v144
    v_mul_f32 v145, s35, v145
    v_mul_f32 v146, s35, v146
    v_mul_f32 v147, s35, v147
    v_cvt_pk_bf16_f32 v24, v112, v113
    v_cvt_pk_bf16_f32 v25, v114, v115
    v_cvt_pk_bf16_f32 v26, v144, v145
    v_cvt_pk_bf16_f32 v27, v146, v147
    s_mov_b32 s34, 32768
    buffer_store_dwordx4 v[24:27], v12, s[12:15], s34 offen offset:2048 sc1
    v_mul_f32 v176, s35, v176
    v_mul_f32 v177, s35, v177
    v_mul_f32 v178, s35, v178
    v_mul_f32 v179, s35, v179
    v_mul_f32 v208, s35, v208
    v_mul_f32 v209, s35, v209
    v_mul_f32 v210, s35, v210
    v_mul_f32 v211, s35, v211
    v_cvt_pk_bf16_f32 v16, v176, v177
    v_cvt_pk_bf16_f32 v17, v178, v179
    v_cvt_pk_bf16_f32 v18, v208, v209
    v_cvt_pk_bf16_f32 v19, v210, v211
    s_mov_b32 s34, 36864
    buffer_store_dwordx4 v[16:19], v12, s[12:15], s34 offen offset:0 sc1
    v_accvgpr_read_b32 v9, a16
    v_accvgpr_read_b32 v10, a17
    v_accvgpr_read_b32 v11, a18
    v_accvgpr_read_b32 v13, a19
    v_mul_f32 v240, s35, v240
    v_mul_f32 v241, s35, v241
    v_mul_f32 v242, s35, v242
    v_mul_f32 v243, s35, v243
    v_mul_f32 v9, s35, v9
    v_mul_f32 v10, s35, v10
    v_mul_f32 v11, s35, v11
    v_mul_f32 v13, s35, v13
    v_cvt_pk_bf16_f32 v20, v240, v241
    v_cvt_pk_bf16_f32 v21, v242, v243
    v_cvt_pk_bf16_f32 v22, v9, v10
    v_cvt_pk_bf16_f32 v23, v11, v13
    s_mov_b32 s34, 36864
    buffer_store_dwordx4 v[20:23], v12, s[12:15], s34 offen offset:2048 sc1
    v_mul_f32 v52, s35, v52
    v_mul_f32 v53, s35, v53
    v_mul_f32 v54, s35, v54
    v_mul_f32 v55, s35, v55
    v_mul_f32 v84, s35, v84
    v_mul_f32 v85, s35, v85
    v_mul_f32 v86, s35, v86
    v_mul_f32 v87, s35, v87
    v_cvt_pk_bf16_f32 v24, v52, v53
    v_cvt_pk_bf16_f32 v25, v54, v55
    v_cvt_pk_bf16_f32 v26, v84, v85
    v_cvt_pk_bf16_f32 v27, v86, v87
    s_mov_b32 s34, 32768
    buffer_store_dwordx4 v[24:27], v12, s[12:15], s34 offen offset:128 sc1
    v_mul_f32 v116, s35, v116
    v_mul_f32 v117, s35, v117
    v_mul_f32 v118, s35, v118
    v_mul_f32 v119, s35, v119
    v_mul_f32 v148, s35, v148
    v_mul_f32 v149, s35, v149
    v_mul_f32 v150, s35, v150
    v_mul_f32 v151, s35, v151
    v_cvt_pk_bf16_f32 v16, v116, v117
    v_cvt_pk_bf16_f32 v17, v118, v119
    v_cvt_pk_bf16_f32 v18, v148, v149
    v_cvt_pk_bf16_f32 v19, v150, v151
    s_mov_b32 s34, 32768
    buffer_store_dwordx4 v[16:19], v12, s[12:15], s34 offen offset:2176 sc1
    v_mul_f32 v180, s35, v180
    v_mul_f32 v181, s35, v181
    v_mul_f32 v182, s35, v182
    v_mul_f32 v183, s35, v183
    v_mul_f32 v212, s35, v212
    v_mul_f32 v213, s35, v213
    v_mul_f32 v214, s35, v214
    v_mul_f32 v215, s35, v215
    v_cvt_pk_bf16_f32 v20, v180, v181
    v_cvt_pk_bf16_f32 v21, v182, v183
    v_cvt_pk_bf16_f32 v22, v212, v213
    v_cvt_pk_bf16_f32 v23, v214, v215
    s_mov_b32 s34, 36864
    buffer_store_dwordx4 v[20:23], v12, s[12:15], s34 offen offset:128 sc1
    v_accvgpr_read_b32 v9, a20
    v_accvgpr_read_b32 v10, a21
    v_accvgpr_read_b32 v11, a22
    v_accvgpr_read_b32 v13, a23
    v_mul_f32 v244, s35, v244
    v_mul_f32 v245, s35, v245
    v_mul_f32 v246, s35, v246
    v_mul_f32 v247, s35, v247
    v_mul_f32 v9, s35, v9
    v_mul_f32 v10, s35, v10
    v_mul_f32 v11, s35, v11
    v_mul_f32 v13, s35, v13
    v_cvt_pk_bf16_f32 v24, v244, v245
    v_cvt_pk_bf16_f32 v25, v246, v247
    v_cvt_pk_bf16_f32 v26, v9, v10
    v_cvt_pk_bf16_f32 v27, v11, v13
    s_mov_b32 s34, 36864
    buffer_store_dwordx4 v[24:27], v12, s[12:15], s34 offen offset:2176 sc1
    v_mul_f32 v56, s35, v56
    v_mul_f32 v57, s35, v57
    v_mul_f32 v58, s35, v58
    v_mul_f32 v59, s35, v59
    v_mul_f32 v88, s35, v88
    v_mul_f32 v89, s35, v89
    v_mul_f32 v90, s35, v90
    v_mul_f32 v91, s35, v91
    v_cvt_pk_bf16_f32 v16, v56, v57
    v_cvt_pk_bf16_f32 v17, v58, v59
    v_cvt_pk_bf16_f32 v18, v88, v89
    v_cvt_pk_bf16_f32 v19, v90, v91
    s_mov_b32 s34, 40960
    buffer_store_dwordx4 v[16:19], v12, s[12:15], s34 offen offset:0 sc1
    v_mul_f32 v120, s35, v120
    v_mul_f32 v121, s35, v121
    v_mul_f32 v122, s35, v122
    v_mul_f32 v123, s35, v123
    v_mul_f32 v152, s35, v152
    v_mul_f32 v153, s35, v153
    v_mul_f32 v154, s35, v154
    v_mul_f32 v155, s35, v155
    v_cvt_pk_bf16_f32 v20, v120, v121
    v_cvt_pk_bf16_f32 v21, v122, v123
    v_cvt_pk_bf16_f32 v22, v152, v153
    v_cvt_pk_bf16_f32 v23, v154, v155
    s_mov_b32 s34, 40960
    buffer_store_dwordx4 v[20:23], v12, s[12:15], s34 offen offset:2048 sc1
    v_mul_f32 v184, s35, v184
    v_mul_f32 v185, s35, v185
    v_mul_f32 v186, s35, v186
    v_mul_f32 v187, s35, v187
    v_mul_f32 v216, s35, v216
    v_mul_f32 v217, s35, v217
    v_mul_f32 v218, s35, v218
    v_mul_f32 v219, s35, v219
    v_cvt_pk_bf16_f32 v24, v184, v185
    v_cvt_pk_bf16_f32 v25, v186, v187
    v_cvt_pk_bf16_f32 v26, v216, v217
    v_cvt_pk_bf16_f32 v27, v218, v219
    s_mov_b32 s34, 45056
    buffer_store_dwordx4 v[24:27], v12, s[12:15], s34 offen offset:0 sc1
    v_accvgpr_read_b32 v9, a24
    v_accvgpr_read_b32 v10, a25
    v_accvgpr_read_b32 v11, a26
    v_accvgpr_read_b32 v13, a27
    v_mul_f32 v248, s35, v248
    v_mul_f32 v249, s35, v249
    v_mul_f32 v250, s35, v250
    v_mul_f32 v251, s35, v251
    v_mul_f32 v9, s35, v9
    v_mul_f32 v10, s35, v10
    v_mul_f32 v11, s35, v11
    v_mul_f32 v13, s35, v13
    v_cvt_pk_bf16_f32 v16, v248, v249
    v_cvt_pk_bf16_f32 v17, v250, v251
    v_cvt_pk_bf16_f32 v18, v9, v10
    v_cvt_pk_bf16_f32 v19, v11, v13
    s_mov_b32 s34, 45056
    buffer_store_dwordx4 v[16:19], v12, s[12:15], s34 offen offset:2048 sc1
    v_mul_f32 v60, s35, v60
    v_mul_f32 v61, s35, v61
    v_mul_f32 v62, s35, v62
    v_mul_f32 v63, s35, v63
    v_mul_f32 v92, s35, v92
    v_mul_f32 v93, s35, v93
    v_mul_f32 v94, s35, v94
    v_mul_f32 v95, s35, v95
    v_cvt_pk_bf16_f32 v20, v60, v61
    v_cvt_pk_bf16_f32 v21, v62, v63
    v_cvt_pk_bf16_f32 v22, v92, v93
    v_cvt_pk_bf16_f32 v23, v94, v95
    s_mov_b32 s34, 40960
    buffer_store_dwordx4 v[20:23], v12, s[12:15], s34 offen offset:128 sc1
    v_mul_f32 v124, s35, v124
    v_mul_f32 v125, s35, v125
    v_mul_f32 v126, s35, v126
    v_mul_f32 v127, s35, v127
    v_mul_f32 v156, s35, v156
    v_mul_f32 v157, s35, v157
    v_mul_f32 v158, s35, v158
    v_mul_f32 v159, s35, v159
    v_cvt_pk_bf16_f32 v24, v124, v125
    v_cvt_pk_bf16_f32 v25, v126, v127
    v_cvt_pk_bf16_f32 v26, v156, v157
    v_cvt_pk_bf16_f32 v27, v158, v159
    s_mov_b32 s34, 40960
    buffer_store_dwordx4 v[24:27], v12, s[12:15], s34 offen offset:2176 sc1
    v_mul_f32 v188, s35, v188
    v_mul_f32 v189, s35, v189
    v_mul_f32 v190, s35, v190
    v_mul_f32 v191, s35, v191
    v_mul_f32 v220, s35, v220
    v_mul_f32 v221, s35, v221
    v_mul_f32 v222, s35, v222
    v_mul_f32 v223, s35, v223
    v_cvt_pk_bf16_f32 v16, v188, v189
    v_cvt_pk_bf16_f32 v17, v190, v191
    v_cvt_pk_bf16_f32 v18, v220, v221
    v_cvt_pk_bf16_f32 v19, v222, v223
    s_mov_b32 s34, 45056
    buffer_store_dwordx4 v[16:19], v12, s[12:15], s34 offen offset:128 sc1
    v_accvgpr_read_b32 v9, a28
    v_accvgpr_read_b32 v10, a29
    v_accvgpr_read_b32 v11, a30
    v_accvgpr_read_b32 v13, a31
    v_mul_f32 v252, s35, v252
    v_mul_f32 v253, s35, v253
    v_mul_f32 v254, s35, v254
    v_mul_f32 v255, s35, v255
    v_mul_f32 v9, s35, v9
    v_mul_f32 v10, s35, v10
    v_mul_f32 v11, s35, v11
    v_mul_f32 v13, s35, v13
    v_cvt_pk_bf16_f32 v20, v252, v253
    v_cvt_pk_bf16_f32 v21, v254, v255
    v_cvt_pk_bf16_f32 v22, v9, v10
    v_cvt_pk_bf16_f32 v23, v11, v13
    s_mov_b32 s34, 45056
    buffer_store_dwordx4 v[20:23], v12, s[12:15], s34 offen offset:2176 sc1
    s_branch KVE_100004
KVV_100003:
    s_waitcnt vmcnt(26)
    s_barrier
    ds_read_b64_tr_b16 a[64:65], v5 offset:0
    ds_read_b64_tr_b16 a[66:67], v5 offset:1024
    ds_read_b128 a[32:35], v10 offset:0
    ds_read_b64_tr_b16 a[68:69], v6 offset:0
    ds_read_b64_tr_b16 a[70:71], v6 offset:1024
    ds_read_b128 a[36:39], v10 offset:2048
    ds_read_b64_tr_b16 a[72:73], v7 offset:0
    ds_read_b64_tr_b16 a[74:75], v7 offset:1024
    ds_read_b128 a[40:43], v10 offset:4096
    ds_read_b64_tr_b16 a[76:77], v8 offset:0
    ds_read_b64_tr_b16 a[78:79], v8 offset:1024
    ds_read_b128 a[44:47], v10 offset:6144
    ds_read_b64_tr_b16 a[80:81], v5 offset:8192
    ds_read_b64_tr_b16 a[82:83], v5 offset:9216
    ds_read_b128 a[48:51], v10 offset:8192
    ds_read_b64_tr_b16 a[84:85], v6 offset:8192
    ds_read_b64_tr_b16 a[86:87], v6 offset:9216
    ds_read_b128 a[52:55], v10 offset:10240
    ds_read_b64_tr_b16 a[88:89], v7 offset:8192
    ds_read_b64_tr_b16 a[90:91], v7 offset:9216
    ds_read_b128 a[56:59], v10 offset:12288
    ds_read_b64_tr_b16 a[92:93], v8 offset:8192
    ds_read_b64_tr_b16 a[94:95], v8 offset:9216
    ds_read_b128 a[60:63], v10 offset:14336
    s_waitcnt lgkmcnt(0)
    v_mfma_f32_16x16x32_bf16 v[32:35], a[32:35], a[64:67], 0
    ds_read_b64_tr_b16 a[128:129], v5 offset:4096
    v_accvgpr_read_b32 v12, a160
    v_mfma_f32_16x16x32_bf16 v[36:39], a[32:35], a[68:71], 0
    ds_read_b64_tr_b16 a[130:131], v5 offset:5120
    v_accvgpr_read_b32 v13, a161
    v_mfma_f32_16x16x32_bf16 v[40:43], a[32:35], a[72:75], 0
    ds_read_b128 a[96:99], v11 offset:0
    v_accvgpr_read_b32 v14, a162
    v_mfma_f32_16x16x32_bf16 v[44:47], a[32:35], a[76:79], 0
    ds_read_b64_tr_b16 a[132:133], v6 offset:4096
    v_accvgpr_read_b32 v15, a163
    v_mfma_f32_16x16x32_bf16 v[48:51], a[32:35], a[80:83], 0
    ds_read_b64_tr_b16 a[134:135], v6 offset:5120
    v_accvgpr_read_b32 v16, a164
    v_mfma_f32_16x16x32_bf16 v[52:55], a[32:35], a[84:87], 0
    ds_read_b128 a[100:103], v11 offset:2048
    v_accvgpr_read_b32 v17, a165
    v_mfma_f32_16x16x32_bf16 v[56:59], a[32:35], a[88:91], 0
    ds_read_b64_tr_b16 a[136:137], v7 offset:4096
    v_accvgpr_read_b32 v18, a166
    v_mfma_f32_16x16x32_bf16 v[60:63], a[32:35], a[92:95], 0
    ds_read_b64_tr_b16 a[138:139], v7 offset:5120
    v_accvgpr_read_b32 v19, a167
    v_mfma_f32_16x16x32_bf16 v[64:67], a[36:39], a[64:67], 0
    ds_read_b128 a[104:107], v11 offset:4096
    v_lshlrev_b32 v24, 16, v12
    v_mfma_f32_16x16x32_bf16 v[68:71], a[36:39], a[68:71], 0
    ds_read_b64_tr_b16 a[140:141], v8 offset:4096
    v_and_b32 v25, s92, v12
    v_mfma_f32_16x16x32_bf16 v[72:75], a[36:39], a[72:75], 0
    ds_read_b64_tr_b16 a[142:143], v8 offset:5120
    v_add_f32 v0, v24, v25
    v_mfma_f32_16x16x32_bf16 v[76:79], a[36:39], a[76:79], 0
    ds_read_b128 a[108:111], v11 offset:6144
    v_lshlrev_b32 v24, 16, v13
    v_mfma_f32_16x16x32_bf16 v[80:83], a[36:39], a[80:83], 0
    ds_read_b64_tr_b16 a[144:145], v5 offset:12288
    v_and_b32 v25, s92, v13
    v_mfma_f32_16x16x32_bf16 v[84:87], a[36:39], a[84:87], 0
    ds_read_b64_tr_b16 a[146:147], v5 offset:13312
    v_add_f32 v24, v24, v25
    v_mfma_f32_16x16x32_bf16 v[88:91], a[36:39], a[88:91], 0
    ds_read_b128 a[112:115], v11 offset:8192
    v_add_f32 v0, v0, v24
    v_mfma_f32_16x16x32_bf16 v[92:95], a[36:39], a[92:95], 0
    ds_read_b64_tr_b16 a[148:149], v6 offset:12288
    v_lshlrev_b32 v24, 16, v14
    v_mfma_f32_16x16x32_bf16 v[96:99], a[40:43], a[64:67], 0
    ds_read_b64_tr_b16 a[150:151], v6 offset:13312
    v_and_b32 v25, s92, v14
    v_mfma_f32_16x16x32_bf16 v[100:103], a[40:43], a[68:71], 0
    ds_read_b128 a[116:119], v11 offset:10240
    v_add_f32 v24, v24, v25
    v_mfma_f32_16x16x32_bf16 v[104:107], a[40:43], a[72:75], 0
    ds_read_b64_tr_b16 a[152:153], v7 offset:12288
    v_add_f32 v0, v0, v24
    v_mfma_f32_16x16x32_bf16 v[108:111], a[40:43], a[76:79], 0
    ds_read_b64_tr_b16 a[154:155], v7 offset:13312
    v_lshlrev_b32 v24, 16, v15
    v_mfma_f32_16x16x32_bf16 v[112:115], a[40:43], a[80:83], 0
    ds_read_b128 a[120:123], v11 offset:12288
    v_and_b32 v25, s92, v15
    v_mfma_f32_16x16x32_bf16 v[116:119], a[40:43], a[84:87], 0
    ds_read_b64_tr_b16 a[156:157], v8 offset:12288
    v_add_f32 v24, v24, v25
    v_mfma_f32_16x16x32_bf16 v[120:123], a[40:43], a[88:91], 0
    ds_read_b64_tr_b16 a[158:159], v8 offset:13312
    v_add_f32 v0, v0, v24
    v_mfma_f32_16x16x32_bf16 v[124:127], a[40:43], a[92:95], 0
    ds_read_b128 a[124:127], v11 offset:14336
    v_lshlrev_b32 v24, 16, v16
    v_mfma_f32_16x16x32_bf16 v[128:131], a[44:47], a[64:67], 0
    v_and_b32 v25, s92, v16
    v_add_f32 v24, v24, v25
    v_mfma_f32_16x16x32_bf16 v[132:135], a[44:47], a[68:71], 0
    v_add_f32 v0, v0, v24
    v_lshlrev_b32 v24, 16, v17
    v_mfma_f32_16x16x32_bf16 v[136:139], a[44:47], a[72:75], 0
    v_and_b32 v25, s92, v17
    v_add_f32 v24, v24, v25
    v_mfma_f32_16x16x32_bf16 v[140:143], a[44:47], a[76:79], 0
    v_add_f32 v0, v0, v24
    v_lshlrev_b32 v24, 16, v18
    v_mfma_f32_16x16x32_bf16 v[144:147], a[44:47], a[80:83], 0
    v_and_b32 v25, s92, v18
    v_add_f32 v24, v24, v25
    v_mfma_f32_16x16x32_bf16 v[148:151], a[44:47], a[84:87], 0
    v_add_f32 v0, v0, v24
    v_lshlrev_b32 v24, 16, v19
    v_mfma_f32_16x16x32_bf16 v[152:155], a[44:47], a[88:91], 0
    v_and_b32 v25, s92, v19
    v_add_f32 v24, v24, v25
    v_mfma_f32_16x16x32_bf16 v[156:159], a[44:47], a[92:95], 0
    v_add_f32 v0, v0, v24
    s_nop 1
    v_add_f32_dpp v0, v0, v0 quad_perm:[1,0,3,2] row_mask:0xf bank_mask:0xf
    v_mfma_f32_16x16x32_bf16 v[160:163], a[48:51], a[64:67], 0
    s_nop 1
    v_add_f32_dpp v0, v0, v0 quad_perm:[2,3,0,1] row_mask:0xf bank_mask:0xf
    s_nop 1
    v_add_f32_dpp v0, v0, v0 row_half_mirror row_mask:0xf bank_mask:0xf
    v_mfma_f32_16x16x32_bf16 v[164:167], a[48:51], a[68:71], 0
    s_nop 1
    v_add_f32_dpp v0, v0, v0 row_mirror row_mask:0xf bank_mask:0xf
    v_mov_b32 v24, v0
    v_mfma_f32_16x16x32_bf16 v[168:171], a[48:51], a[72:75], 0
    s_nop 1
    v_permlane16_swap_b32 v0, v24
    s_nop 1
    v_add_f32 v0, v0, v24
    v_mfma_f32_16x16x32_bf16 v[172:175], a[48:51], a[76:79], 0
    v_mul_f32 v0, 0x3b000000, v0
    v_lshlrev_b32 v24, 16, v12
    v_mfma_f32_16x16x32_bf16 v[176:179], a[48:51], a[80:83], 0
    v_and_b32 v25, s92, v12
    v_sub_f32 v24, v24, v0
    v_mfma_f32_16x16x32_bf16 v[180:183], a[48:51], a[84:87], 0
    v_sub_f32 v25, v25, v0
    v_mul_f32 v27, v24, v24
    v_mfma_f32_16x16x32_bf16 v[184:187], a[48:51], a[88:91], 0
    v_fma_f32 v27, v25, v25, v27
    v_lshlrev_b32 v24, 16, v13
    v_mfma_f32_16x16x32_bf16 v[188:191], a[48:51], a[92:95], 0
    v_and_b32 v25, s92, v13
    v_sub_f32 v24, v24, v0
    v_mfma_f32_16x16x32_bf16 v[192:195], a[52:55], a[64:67], 0
    v_sub_f32 v25, v25, v0
    v_fma_f32 v27, v24, v24, v27
    v_mfma_f32_16x16x32_bf16 v[196:199], a[52:55], a[68:71], 0
    v_fma_f32 v27, v25, v25, v27
    v_lshlrev_b32 v24, 16, v14
    v_mfma_f32_16x16x32_bf16 v[200:203], a[52:55], a[72:75], 0
    v_and_b32 v25, s92, v14
    v_sub_f32 v24, v24, v0
    v_mfma_f32_16x16x32_bf16 v[204:207], a[52:55], a[76:79], 0
    v_sub_f32 v25, v25, v0
    v_fma_f32 v27, v24, v24, v27
    v_mfma_f32_16x16x32_bf16 v[208:211], a[52:55], a[80:83], 0
    v_fma_f32 v27, v25, v25, v27
    v_lshlrev_b32 v24, 16, v15
    v_mfma_f32_16x16x32_bf16 v[212:215], a[52:55], a[84:87], 0
    v_and_b32 v25, s92, v15
    v_sub_f32 v24, v24, v0
    v_mfma_f32_16x16x32_bf16 v[216:219], a[52:55], a[88:91], 0
    v_sub_f32 v25, v25, v0
    v_fma_f32 v27, v24, v24, v27
    v_mfma_f32_16x16x32_bf16 v[220:223], a[52:55], a[92:95], 0
    v_fma_f32 v27, v25, v25, v27
    v_lshlrev_b32 v24, 16, v16
    v_mfma_f32_16x16x32_bf16 v[224:227], a[56:59], a[64:67], 0
    v_and_b32 v25, s92, v16
    v_sub_f32 v24, v24, v0
    v_mfma_f32_16x16x32_bf16 v[228:231], a[56:59], a[68:71], 0
    v_sub_f32 v25, v25, v0
    v_fma_f32 v27, v24, v24, v27
    v_mfma_f32_16x16x32_bf16 v[232:235], a[56:59], a[72:75], 0
    v_fma_f32 v27, v25, v25, v27
    v_lshlrev_b32 v24, 16, v17
    v_mfma_f32_16x16x32_bf16 v[236:239], a[56:59], a[76:79], 0
    v_and_b32 v25, s92, v17
    v_sub_f32 v24, v24, v0
    v_mfma_f32_16x16x32_bf16 v[240:243], a[56:59], a[80:83], 0
    v_sub_f32 v25, v25, v0
    v_fma_f32 v27, v24, v24, v27
    v_mfma_f32_16x16x32_bf16 v[244:247], a[56:59], a[84:87], 0
    v_fma_f32 v27, v25, v25, v27
    v_lshlrev_b32 v24, 16, v18
    v_mfma_f32_16x16x32_bf16 v[248:251], a[56:59], a[88:91], 0
    v_and_b32 v25, s92, v18
    v_sub_f32 v24, v24, v0
    v_mfma_f32_16x16x32_bf16 v[252:255], a[56:59], a[92:95], 0
    v_sub_f32 v25, v25, v0
    v_fma_f32 v27, v24, v24, v27
    v_mfma_f32_16x16x32_bf16 a[0:3], a[60:63], a[64:67], 0
    v_fma_f32 v27, v25, v25, v27
    v_lshlrev_b32 v24, 16, v19
    v_mfma_f32_16x16x32_bf16 a[4:7], a[60:63], a[68:71], 0
    v_and_b32 v25, s92, v19
    v_sub_f32 v24, v24, v0
    v_mfma_f32_16x16x32_bf16 a[8:11], a[60:63], a[72:75], 0
    v_sub_f32 v25, v25, v0
    v_fma_f32 v27, v24, v24, v27
    v_mfma_f32_16x16x32_bf16 a[12:15], a[60:63], a[76:79], 0
    v_fma_f32 v27, v25, v25, v27
    s_nop 1
    v_add_f32_dpp v27, v27, v27 quad_perm:[1,0,3,2] row_mask:0xf bank_mask:0xf
    v_mfma_f32_16x16x32_bf16 a[16:19], a[60:63], a[80:83], 0
    s_nop 1
    v_add_f32_dpp v27, v27, v27 quad_perm:[2,3,0,1] row_mask:0xf bank_mask:0xf
    s_nop 1
    v_add_f32_dpp v27, v27, v27 row_half_mirror row_mask:0xf bank_mask:0xf
    v_mfma_f32_16x16x32_bf16 a[20:23], a[60:63], a[84:87], 0
    s_nop 1
    v_add_f32_dpp v27, v27, v27 row_mirror row_mask:0xf bank_mask:0xf
    v_mov_b32 v24, v27
    v_mfma_f32_16x16x32_bf16 a[24:27], a[60:63], a[88:91], 0
    s_nop 1
    v_permlane16_swap_b32 v27, v24
    s_nop 1
    v_add_f32 v27, v27, v24
    v_mfma_f32_16x16x32_bf16 a[28:31], a[60:63], a[92:95], 0
    v_mov_b32 v25, 0x3727c5ac
    v_fmac_f32 v25, 0x3b000000, v27
    s_waitcnt vmcnt(10) lgkmcnt(0)
    s_barrier
    v_mfma_f32_16x16x32_bf16 v[32:35], a[96:99], a[128:131], v[32:35]
    ds_read_b64_tr_b16 a[64:65], v5 offset:32768
    v_rsq_f32 v27, v25
    v_mfma_f32_16x16x32_bf16 v[36:39], a[96:99], a[132:135], v[36:39]
    ds_read_b64_tr_b16 a[66:67], v5 offset:33792
    s_add_u32 m0, s32, 0
    s_nop 0
    v_lshlrev_b32 v24, 16, v12
    v_mfma_f32_16x16x32_bf16 v[40:43], a[96:99], a[136:139], v[40:43]
    ds_read_b128 a[32:35], v10 offset:32768
    buffer_load_dwordx4 v3, s[4:7], s20 offen lds
    v_mfma_f32_16x16x32_bf16 v[44:47], a[96:99], a[140:143], v[44:47]
    ds_read_b64_tr_b16 a[68:69], v6 offset:32768
    v_and_b32 v25, s92, v12
    v_mfma_f32_16x16x32_bf16 v[48:51], a[96:99], a[144:147], v[48:51]
    ds_read_b64_tr_b16 a[70:71], v6 offset:33792
    v_sub_f32 v24, v24, v0
    v_mfma_f32_16x16x32_bf16 v[52:55], a[96:99], a[148:151], v[52:55]
    ds_read_b128 a[36:39], v10 offset:34816
    s_add_u32 m0, s33, 0
    v_sub_f32 v25, v25, v0
    v_mfma_f32_16x16x32_bf16 v[56:59], a[96:99], a[152:155], v[56:59]
    ds_read_b64_tr_b16 a[72:73], v7 offset:32768
    buffer_load_dwordx4 v9, s[8:11], s24 offen lds
    v_mfma_f32_16x16x32_bf16 v[60:63], a[96:99], a[156:159], v[60:63]
    ds_read_b64_tr_b16 a[74:75], v7 offset:33792
    v_mul_f32 v24, v24, v27
    v_mfma_f32_16x16x32_bf16 v[64:67], a[100:103], a[128:131], v[64:67]
    ds_read_b128 a[40:43], v10 offset:36864
    v_mul_f32 v25, v25, v27
    v_mfma_f32_16x16x32_bf16 v[68:71], a[100:103], a[132:135], v[68:71]
    ds_read_b64_tr_b16 a[76:77], v8 offset:32768
    s_add_u32 m0, s32, 1024
    v_cvt_pk_bf16_f32 v12, v24, v25
    v_mfma_f32_16x16x32_bf16 v[72:75], a[100:103], a[136:139], v[72:75]
    ds_read_b64_tr_b16 a[78:79], v8 offset:33792
    buffer_load_dwordx4 v4, s[4:7], s20 offen lds
    v_mfma_f32_16x16x32_bf16 v[76:79], a[100:103], a[140:143], v[76:79]
    ds_read_b128 a[44:47], v10 offset:38912
    v_lshlrev_b32 v24, 16, v13
    v_mfma_f32_16x16x32_bf16 v[80:83], a[100:103], a[144:147], v[80:83]
    ds_read_b64_tr_b16 a[80:81], v5 offset:40960
    v_and_b32 v25, s92, v13
    v_mfma_f32_16x16x32_bf16 v[84:87], a[100:103], a[148:151], v[84:87]
    ds_read_b64_tr_b16 a[82:83], v5 offset:41984
    s_add_u32 m0, s33, 1024
    v_sub_f32 v24, v24, v0
    v_mfma_f32_16x16x32_bf16 v[88:91], a[100:103], a[152:155], v[88:91]
    ds_read_b128 a[48:51], v10 offset:40960
    buffer_load_dwordx4 v9, s[8:11], s25 offen lds
    v_mfma_f32_16x16x32_bf16 v[92:95], a[100:103], a[156:159], v[92:95]
    ds_read_b64_tr_b16 a[84:85], v6 offset:40960
    v_sub_f32 v25, v25, v0
    v_mfma_f32_16x16x32_bf16 v[96:99], a[104:107], a[128:131], v[96:99]
    ds_read_b64_tr_b16 a[86:87], v6 offset:41984
    v_mul_f32 v24, v24, v27
    v_mfma_f32_16x16x32_bf16 v[100:103], a[104:107], a[132:135], v[100:103]
    ds_read_b128 a[52:55], v10 offset:43008
    s_add_u32 m0, s32, 2048
    v_mul_f32 v25, v25, v27
    v_mfma_f32_16x16x32_bf16 v[104:107], a[104:107], a[136:139], v[104:107]
    ds_read_b64_tr_b16 a[88:89], v7 offset:40960
    buffer_load_dwordx4 v3, s[4:7], s21 offen lds
    v_mfma_f32_16x16x32_bf16 v[108:111], a[104:107], a[140:143], v[108:111]
    ds_read_b64_tr_b16 a[90:91], v7 offset:41984
    v_cvt_pk_bf16_f32 v13, v24, v25
    v_mfma_f32_16x16x32_bf16 v[112:115], a[104:107], a[144:147], v[112:115]
    ds_read_b128 a[56:59], v10 offset:45056
    v_lshlrev_b32 v24, 16, v14
    v_mfma_f32_16x16x32_bf16 v[116:119], a[104:107], a[148:151], v[116:119]
    ds_read_b64_tr_b16 a[92:93], v8 offset:40960
    s_add_u32 m0, s33, 2048
    v_and_b32 v25, s92, v14
    v_mfma_f32_16x16x32_bf16 v[120:123], a[104:107], a[152:155], v[120:123]
    ds_read_b64_tr_b16 a[94:95], v8 offset:41984
    buffer_load_dwordx4 v9, s[8:11], s26 offen lds
    v_mfma_f32_16x16x32_bf16 v[124:127], a[104:107], a[156:159], v[124:127]
    ds_read_b128 a[60:63], v10 offset:47104
    v_sub_f32 v24, v24, v0
    v_mfma_f32_16x16x32_bf16 v[128:131], a[108:111], a[128:131], v[128:131]
    v_sub_f32 v25, v25, v0
    v_mul_f32 v24, v24, v27
    v_mfma_f32_16x16x32_bf16 v[132:135], a[108:111], a[132:135], v[132:135]
    s_add_u32 m0, s32, 3072
    v_mul_f32 v25, v25, v27
    v_cvt_pk_bf16_f32 v14, v24, v25
    v_mfma_f32_16x16x32_bf16 v[136:139], a[108:111], a[136:139], v[136:139]
    buffer_load_dwordx4 v4, s[4:7], s21 offen lds
    v_lshlrev_b32 v24, 16, v15
    v_mfma_f32_16x16x32_bf16 v[140:143], a[108:111], a[140:143], v[140:143]
    v_and_b32 v25, s92, v15
    v_sub_f32 v24, v24, v0
    v_mfma_f32_16x16x32_bf16 v[144:147], a[108:111], a[144:147], v[144:147]
    v_sub_f32 v25, v25, v0
    v_mul_f32 v24, v24, v27
    v_mfma_f32_16x16x32_bf16 v[148:151], a[108:111], a[148:151], v[148:151]
    s_add_u32 m0, s33, 3072
    v_mul_f32 v25, v25, v27
    v_cvt_pk_bf16_f32 v15, v24, v25
    v_mfma_f32_16x16x32_bf16 v[152:155], a[108:111], a[152:155], v[152:155]
    s_load_dwordx2 s[36:37], s[0:1], 56
    buffer_load_dwordx4 v9, s[8:11], s27 offen lds
    v_lshlrev_b32 v24, 16, v16
    v_mfma_f32_16x16x32_bf16 v[156:159], a[108:111], a[156:159], v[156:159]
    s_load_dwordx2 s[48:49], s[0:1], 64
    v_and_b32 v25, s92, v16
    v_sub_f32 v24, v24, v0
    v_mfma_f32_16x16x32_bf16 v[160:163], a[112:115], a[128:131], v[160:163]
    v_sub_f32 v25, v25, v0
    v_mul_f32 v24, v24, v27
    v_mfma_f32_16x16x32_bf16 v[164:167], a[112:115], a[132:135], v[164:167]
    s_add_u32 m0, s32, 4096
    v_mul_f32 v25, v25, v27
    v_cvt_pk_bf16_f32 v16, v24, v25
    v_mfma_f32_16x16x32_bf16 v[168:171], a[112:115], a[136:139], v[168:171]
    buffer_load_dwordx4 v3, s[4:7], s22 offen lds
    v_lshlrev_b32 v24, 16, v17
    v_mfma_f32_16x16x32_bf16 v[172:175], a[112:115], a[140:143], v[172:175]
    v_and_b32 v25, s92, v17
    v_sub_f32 v24, v24, v0
    v_mfma_f32_16x16x32_bf16 v[176:179], a[112:115], a[144:147], v[176:179]
    v_sub_f32 v25, v25, v0
    v_mul_f32 v24, v24, v27
    v_mfma_f32_16x16x32_bf16 v[180:183], a[112:115], a[148:151], v[180:183]
    s_add_u32 m0, s32, 5120
    v_mul_f32 v25, v25, v27
    v_cvt_pk_bf16_f32 v17, v24, v25
    v_mfma_f32_16x16x32_bf16 v[184:187], a[112:115], a[152:155], v[184:187]
    buffer_load_dwordx4 v4, s[4:7], s22 offen lds
    v_lshlrev_b32 v24, 16, v18
    v_mfma_f32_16x16x32_bf16 v[188:191], a[112:115], a[156:159], v[188:191]
    v_and_b32 v25, s92, v18
    v_sub_f32 v24, v24, v0
    v_mfma_f32_16x16x32_bf16 v[192:195], a[116:119], a[128:131], v[192:195]
    v_sub_f32 v25, v25, v0
    v_mul_f32 v24, v24, v27
    v_mfma_f32_16x16x32_bf16 v[196:199], a[116:119], a[132:135], v[196:199]
    s_add_u32 m0, s32, 6144
    v_mul_f32 v25, v25, v27
    v_cvt_pk_bf16_f32 v18, v24, v25
    v_mfma_f32_16x16x32_bf16 v[200:203], a[116:119], a[136:139], v[200:203]
    buffer_load_dwordx4 v3, s[4:7], s23 offen lds
    v_lshlrev_b32 v24, 16, v19
    v_mfma_f32_16x16x32_bf16 v[204:207], a[116:119], a[140:143], v[204:207]
    v_and_b32 v25, s92, v19
    v_sub_f32 v24, v24, v0
    v_mfma_f32_16x16x32_bf16 v[208:211], a[116:119], a[144:147], v[208:211]
    v_sub_f32 v25, v25, v0
    v_mul_f32 v24, v24, v27
    v_mfma_f32_16x16x32_bf16 v[212:215], a[116:119], a[148:151], v[212:215]
    s_add_u32 m0, s32, 7168
    v_mul_f32 v25, v25, v27
    v_cvt_pk_bf16_f32 v19, v24, v25
    v_mfma_f32_16x16x32_bf16 v[216:219], a[116:119], a[152:155], v[216:219]
    buffer_load_dwordx4 v4, s[4:7], s23 offen lds
    v_mfma_f32_16x16x32_bf16 v[220:223], a[116:119], a[156:159], v[220:223]
    v_mfma_f32_16x16x32_bf16 v[224:227], a[120:123], a[128:131], v[224:227]
    v_mfma_f32_16x16x32_bf16 v[228:231], a[120:123], a[132:135], v[228:231]
    v_mfma_f32_16x16x32_bf16 v[232:235], a[120:123], a[136:139], v[232:235]
    v_mfma_f32_16x16x32_bf16 v[236:239], a[120:123], a[140:143], v[236:239]
    v_mfma_f32_16x16x32_bf16 v[240:243], a[120:123], a[144:147], v[240:243]
    v_mfma_f32_16x16x32_bf16 v[244:247], a[120:123], a[148:151], v[244:247]
    v_mfma_f32_16x16x32_bf16 v[248:251], a[120:123], a[152:155], v[248:251]
    v_mfma_f32_16x16x32_bf16 v[252:255], a[120:123], a[156:159], v[252:255]
    v_mfma_f32_16x16x32_bf16 a[0:3], a[124:127], a[128:131], a[0:3]
    v_mfma_f32_16x16x32_bf16 a[4:7], a[124:127], a[132:135], a[4:7]
    v_mfma_f32_16x16x32_bf16 a[8:11], a[124:127], a[136:139], a[8:11]
    buffer_store_dwordx4 v[12:15], v20, s[76:79], 0 offen sc1
    buffer_store_dwordx4 v[16:19], v20, s[76:79], s93 offen sc1
    v_mfma_f32_16x16x32_bf16 a[12:15], a[124:127], a[140:143], a[12:15]
    v_lshlrev_b32 v24, 16, v12
    v_and_b32 v25, s92, v12
    v_mfma_f32_16x16x32_bf16 a[16:19], a[124:127], a[144:147], a[16:19]
    v_add_f32 v0, v24, v25
    v_lshlrev_b32 v24, 16, v13
    v_mfma_f32_16x16x32_bf16 a[20:23], a[124:127], a[148:151], a[20:23]
    v_and_b32 v25, s92, v13
    v_add_f32 v24, v24, v25
    v_mfma_f32_16x16x32_bf16 a[24:27], a[124:127], a[152:155], a[24:27]
    s_add_u32 s4, s4, 128
    s_addc_u32 s5, s5, 0
    v_add_f32 v0, v0, v24
    v_lshlrev_b32 v24, 16, v14
    v_mfma_f32_16x16x32_bf16 a[28:31], a[124:127], a[156:159], a[28:31]
    v_and_b32 v25, s92, v14
    v_add_f32 v24, v24, v25
    s_waitcnt lgkmcnt(0)
    v_mfma_f32_16x16x32_bf16 v[32:35], a[32:35], a[64:67], v[32:35]
    ds_read_b64_tr_b16 a[128:129], v5 offset:36864
    v_add_f32 v0, v0, v24
    v_mfma_f32_16x16x32_bf16 v[36:39], a[32:35], a[68:71], v[36:39]
    ds_read_b64_tr_b16 a[130:131], v5 offset:37888
    s_add_u32 m0, s33, 4096
    v_lshlrev_b32 v24, 16, v15
    v_mfma_f32_16x16x32_bf16 v[40:43], a[32:35], a[72:75], v[40:43]
    ds_read_b128 a[96:99], v11 offset:32768
    buffer_load_dwordx4 v9, s[8:11], s28 offen lds
    v_mfma_f32_16x16x32_bf16 v[44:47], a[32:35], a[76:79], v[44:47]
    ds_read_b64_tr_b16 a[132:133], v6 offset:36864
    v_and_b32 v25, s92, v15
    v_mfma_f32_16x16x32_bf16 v[48:51], a[32:35], a[80:83], v[48:51]
    ds_read_b64_tr_b16 a[134:135], v6 offset:37888
    v_add_f32 v24, v24, v25
    v_mfma_f32_16x16x32_bf16 v[52:55], a[32:35], a[84:87], v[52:55]
    ds_read_b128 a[100:103], v11 offset:34816
    v_add_f32 v0, v0, v24
    v_mfma_f32_16x16x32_bf16 v[56:59], a[32:35], a[88:91], v[56:59]
    ds_read_b64_tr_b16 a[136:137], v7 offset:36864
    v_lshlrev_b32 v24, 16, v16
    v_mfma_f32_16x16x32_bf16 v[60:63], a[32:35], a[92:95], v[60:63]
    ds_read_b64_tr_b16 a[138:139], v7 offset:37888
    v_and_b32 v25, s92, v16
    v_mfma_f32_16x16x32_bf16 v[64:67], a[36:39], a[64:67], v[64:67]
    ds_read_b128 a[104:107], v11 offset:36864
    v_add_f32 v24, v24, v25
    v_mfma_f32_16x16x32_bf16 v[68:71], a[36:39], a[68:71], v[68:71]
    ds_read_b64_tr_b16 a[140:141], v8 offset:36864
    s_add_u32 m0, s33, 5120
    v_add_f32 v0, v0, v24
    v_mfma_f32_16x16x32_bf16 v[72:75], a[36:39], a[72:75], v[72:75]
    ds_read_b64_tr_b16 a[142:143], v8 offset:37888
    buffer_load_dwordx4 v9, s[8:11], s29 offen lds
    v_mfma_f32_16x16x32_bf16 v[76:79], a[36:39], a[76:79], v[76:79]
    ds_read_b128 a[108:111], v11 offset:38912
    v_lshlrev_b32 v24, 16, v17
    v_mfma_f32_16x16x32_bf16 v[80:83], a[36:39], a[80:83], v[80:83]
    ds_read_b64_tr_b16 a[144:145], v5 offset:45056
    v_and_b32 v25, s92, v17
    v_mfma_f32_16x16x32_bf16 v[84:87], a[36:39], a[84:87], v[84:87]
    ds_read_b64_tr_b16 a[146:147], v5 offset:46080
    v_add_f32 v24, v24, v25
    v_mfma_f32_16x16x32_bf16 v[88:91], a[36:39], a[88:91], v[88:91]
    ds_read_b128 a[112:115], v11 offset:40960
    v_add_f32 v0, v0, v24
    v_mfma_f32_16x16x32_bf16 v[92:95], a[36:39], a[92:95], v[92:95]
    ds_read_b64_tr_b16 a[148:149], v6 offset:45056
    v_lshlrev_b32 v24, 16, v18
    v_mfma_f32_16x16x32_bf16 v[96:99], a[40:43], a[64:67], v[96:99]
    ds_read_b64_tr_b16 a[150:151], v6 offset:46080
    v_and_b32 v25, s92, v18
    v_mfma_f32_16x16x32_bf16 v[100:103], a[40:43], a[68:71], v[100:103]
    ds_read_b128 a[116:119], v11 offset:43008
    s_add_u32 m0, s33, 6144
    v_add_f32 v24, v24, v25
    v_mfma_f32_16x16x32_bf16 v[104:107], a[40:43], a[72:75], v[104:107]
    ds_read_b64_tr_b16 a[152:153], v7 offset:45056
    buffer_load_dwordx4 v9, s[8:11], s30 offen lds
    v_mfma_f32_16x16x32_bf16 v[108:111], a[40:43], a[76:79], v[108:111]
    ds_read_b64_tr_b16 a[154:155], v7 offset:46080
    v_add_f32 v0, v0, v24
    v_mfma_f32_16x16x32_bf16 v[112:115], a[40:43], a[80:83], v[112:115]
    ds_read_b128 a[120:123], v11 offset:45056
    v_lshlrev_b32 v24, 16, v19
    v_mfma_f32_16x16x32_bf16 v[116:119], a[40:43], a[84:87], v[116:119]
    ds_read_b64_tr_b16 a[156:157], v8 offset:45056
    v_and_b32 v25, s92, v19
    v_mfma_f32_16x16x32_bf16 v[120:123], a[40:43], a[88:91], v[120:123]
    ds_read_b64_tr_b16 a[158:159], v8 offset:46080
    v_add_f32 v24, v24, v25
    v_mfma_f32_16x16x32_bf16 v[124:127], a[40:43], a[92:95], v[124:127]
    ds_read_b128 a[124:127], v11 offset:47104
    v_add_f32 v0, v0, v24
    v_mfma_f32_16x16x32_bf16 v[128:131], a[44:47], a[64:67], v[128:131]
    s_nop 1
    v_add_f32_dpp v0, v0, v0 quad_perm:[1,0,3,2] row_mask:0xf bank_mask:0xf
    s_nop 1
    v_add_f32_dpp v0, v0, v0 quad_perm:[2,3,0,1] row_mask:0xf bank_mask:0xf
    v_mfma_f32_16x16x32_bf16 v[132:135], a[44:47], a[68:71], v[132:135]
    s_add_u32 m0, s33, 7168
    s_nop 1
    v_add_f32_dpp v0, v0, v0 row_half_mirror row_mask:0xf bank_mask:0xf
    s_nop 1
    v_add_f32_dpp v0, v0, v0 row_mirror row_mask:0xf bank_mask:0xf
    v_mfma_f32_16x16x32_bf16 v[136:139], a[44:47], a[72:75], v[136:139]
    buffer_load_dwordx4 v9, s[8:11], s31 offen lds
    v_mov_b32 v24, v0
    v_mfma_f32_16x16x32_bf16 v[140:143], a[44:47], a[76:79], v[140:143]
    s_nop 1
    v_permlane16_swap_b32 v0, v24
    s_nop 1
    v_add_f32 v0, v0, v24
    v_mfma_f32_16x16x32_bf16 v[144:147], a[44:47], a[80:83], v[144:147]
    v_mul_f32 v0, 0x3b000000, v0
    v_lshlrev_b32 v24, 16, v12
    v_mfma_f32_16x16x32_bf16 v[148:151], a[44:47], a[84:87], v[148:151]
    v_and_b32 v25, s92, v12
    v_sub_f32 v24, v24, v0
    v_mfma_f32_16x16x32_bf16 v[152:155], a[44:47], a[88:91], v[152:155]
    s_add_u32 s8, s8, 524288
    s_addc_u32 s9, s9, 0
    v_sub_f32 v25, v25, v0
    v_mul_f32 v27, v24, v24
    v_mfma_f32_16x16x32_bf16 v[156:159], a[44:47], a[92:95], v[156:159]
    v_fma_f32 v27, v25, v25, v27
    v_lshlrev_b32 v24, 16, v13
    v_mfma_f32_16x16x32_bf16 v[160:163], a[48:51], a[64:67], v[160:163]
    v_and_b32 v25, s92, v13
    v_sub_f32 v24, v24, v0
    v_mfma_f32_16x16x32_bf16 v[164:167], a[48:51], a[68:71], v[164:167]
    v_sub_f32 v25, v25, v0
    v_fma_f32 v27, v24, v24, v27
    v_mfma_f32_16x16x32_bf16 v[168:171], a[48:51], a[72:75], v[168:171]
    s_mov_b32 s38, 0x80000
    s_mov_b32 s39, 0x00020000
    s_lshl_b32 s34, s2, 12
    v_fma_f32 v27, v25, v25, v27
    v_lshlrev_b32 v24, 16, v14
    v_mfma_f32_16x16x32_bf16 v[172:175], a[48:51], a[76:79], v[172:175]
    buffer_load_dwordx4 a[252:255], v23, s[36:39], s34 offen
    v_and_b32 v25, s92, v14
    v_mfma_f32_16x16x32_bf16 v[176:179], a[48:51], a[80:83], v[176:179]
    v_sub_f32 v24, v24, v0
    v_sub_f32 v25, v25, v0
    v_mfma_f32_16x16x32_bf16 v[180:183], a[48:51], a[84:87], v[180:183]
    v_fma_f32 v27, v24, v24, v27
    v_fma_f32 v27, v25, v25, v27
    v_mfma_f32_16x16x32_bf16 v[184:187], a[48:51], a[88:91], v[184:187]
    v_lshlrev_b32 v24, 16, v15
    v_and_b32 v25, s92, v15
    v_mfma_f32_16x16x32_bf16 v[188:191], a[48:51], a[92:95], v[188:191]
    v_sub_f32 v24, v24, v0
    v_sub_f32 v25, v25, v0
    v_mfma_f32_16x16x32_bf16 v[192:195], a[52:55], a[64:67], v[192:195]
    v_fma_f32 v27, v24, v24, v27
    v_fma_f32 v27, v25, v25, v27
    v_mfma_f32_16x16x32_bf16 v[196:199], a[52:55], a[68:71], v[196:199]
    v_lshlrev_b32 v24, 16, v16
    v_and_b32 v25, s92, v16
    v_mfma_f32_16x16x32_bf16 v[200:203], a[52:55], a[72:75], v[200:203]
    s_mov_b32 s50, 0x80000
    s_mov_b32 s51, 0x00020000
    s_lshl_b32 s34, s2, 12
    v_sub_f32 v24, v24, v0
    v_sub_f32 v25, v25, v0
    v_mfma_f32_16x16x32_bf16 v[204:207], a[52:55], a[76:79], v[204:207]
    buffer_load_dwordx4 a[252:255], v23, s[48:51], s34 offen
    v_fma_f32 v27, v24, v24, v27
    v_mfma_f32_16x16x32_bf16 v[208:211], a[52:55], a[80:83], v[208:211]
    v_fma_f32 v27, v25, v25, v27
    v_lshlrev_b32 v24, 16, v17
    v_mfma_f32_16x16x32_bf16 v[212:215], a[52:55], a[84:87], v[212:215]
    v_and_b32 v25, s92, v17
    v_sub_f32 v24, v24, v0
    v_mfma_f32_16x16x32_bf16 v[216:219], a[52:55], a[88:91], v[216:219]
    v_sub_f32 v25, v25, v0
    v_fma_f32 v27, v24, v24, v27
    v_mfma_f32_16x16x32_bf16 v[220:223], a[52:55], a[92:95], v[220:223]
    v_fma_f32 v27, v25, v25, v27
    v_lshlrev_b32 v24, 16, v18
    v_mfma_f32_16x16x32_bf16 v[224:227], a[56:59], a[64:67], v[224:227]
    v_and_b32 v25, s92, v18
    v_sub_f32 v24, v24, v0
    v_mfma_f32_16x16x32_bf16 v[228:231], a[56:59], a[68:71], v[228:231]
    v_sub_f32 v25, v25, v0
    v_fma_f32 v27, v24, v24, v27
    v_mfma_f32_16x16x32_bf16 v[232:235], a[56:59], a[72:75], v[232:235]
    v_fma_f32 v27, v25, v25, v27
    v_lshlrev_b32 v24, 16, v19
    v_mfma_f32_16x16x32_bf16 v[236:239], a[56:59], a[76:79], v[236:239]
    v_and_b32 v25, s92, v19
    v_sub_f32 v24, v24, v0
    v_mfma_f32_16x16x32_bf16 v[240:243], a[56:59], a[80:83], v[240:243]
    v_sub_f32 v25, v25, v0
    v_fma_f32 v27, v24, v24, v27
    v_mfma_f32_16x16x32_bf16 v[244:247], a[56:59], a[84:87], v[244:247]
    v_fma_f32 v27, v25, v25, v27
    s_nop 1
    v_add_f32_dpp v27, v27, v27 quad_perm:[1,0,3,2] row_mask:0xf bank_mask:0xf
    v_mfma_f32_16x16x32_bf16 v[248:251], a[56:59], a[88:91], v[248:251]
    s_nop 1
    v_add_f32_dpp v27, v27, v27 quad_perm:[2,3,0,1] row_mask:0xf bank_mask:0xf
    s_nop 1
    v_add_f32_dpp v27, v27, v27 row_half_mirror row_mask:0xf bank_mask:0xf
    v_mfma_f32_16x16x32_bf16 v[252:255], a[56:59], a[92:95], v[252:255]
    s_nop 1
    v_add_f32_dpp v27, v27, v27 row_mirror row_mask:0xf bank_mask:0xf
    v_mov_b32 v24, v27
    v_mfma_f32_16x16x32_bf16 a[0:3], a[60:63], a[64:67], a[0:3]
    s_nop 1
    v_permlane16_swap_b32 v27, v24
    s_nop 1
    v_add_f32 v27, v27, v24
    v_mfma_f32_16x16x32_bf16 a[4:7], a[60:63], a[68:71], a[4:7]
    v_mov_b32 v25, 0x3727c5ac
    v_fmac_f32 v25, 0x3b000000, v27
    v_mfma_f32_16x16x32_bf16 a[8:11], a[60:63], a[72:75], a[8:11]
    v_rsq_f32 v27, v25
    s_nop 0
    v_lshlrev_b32 v24, 16, v12
    v_mfma_f32_16x16x32_bf16 a[12:15], a[60:63], a[76:79], a[12:15]
    v_and_b32 v25, s92, v12
    v_sub_f32 v24, v24, v0
    v_mfma_f32_16x16x32_bf16 a[16:19], a[60:63], a[80:83], a[16:19]
    v_sub_f32 v25, v25, v0
    v_mul_f32 v24, v24, v27
    v_mfma_f32_16x16x32_bf16 a[20:23], a[60:63], a[84:87], a[20:23]
    v_mul_f32 v25, v25, v27
    v_cvt_pk_bf16_f32 v12, v24, v25
    v_mfma_f32_16x16x32_bf16 a[24:27], a[60:63], a[88:91], a[24:27]
    v_lshlrev_b32 v24, 16, v13
    v_and_b32 v25, s92, v13
    v_mfma_f32_16x16x32_bf16 a[28:31], a[60:63], a[92:95], a[28:31]
    v_sub_f32 v24, v24, v0
    v_sub_f32 v25, v25, v0
    s_waitcnt vmcnt(8) lgkmcnt(0)
    s_barrier
    v_mfma_f32_16x16x32_bf16 v[32:35], a[96:99], a[128:131], v[32:35]
    ds_read_b64_tr_b16 a[64:65], v5 offset:0
    v_mul_f32 v24, v24, v27
    v_mfma_f32_16x16x32_bf16 v[36:39], a[96:99], a[132:135], v[36:39]
    ds_read_b64_tr_b16 a[66:67], v5 offset:1024
    s_add_u32 m0, s32, 32768
    v_mul_f32 v25, v25, v27
    v_mfma_f32_16x16x32_bf16 v[40:43], a[96:99], a[136:139], v[40:43]
    ds_read_b128 a[32:35], v10 offset:0
    buffer_load_dwordx4 v3, s[4:7], s20 offen lds
    v_mfma_f32_16x16x32_bf16 v[44:47], a[96:99], a[140:143], v[44:47]
    ds_read_b64_tr_b16 a[68:69], v6 offset:0
    v_cvt_pk_bf16_f32 v13, v24, v25
    v_mfma_f32_16x16x32_bf16 v[48:51], a[96:99], a[144:147], v[48:51]
    ds_read_b64_tr_b16 a[70:71], v6 offset:1024
    v_lshlrev_b32 v24, 16, v14
    v_mfma_f32_16x16x32_bf16 v[52:55], a[96:99], a[148:151], v[52:55]
    ds_read_b128 a[36:39], v10 offset:2048
    s_add_u32 m0, s33, 32768
    v_and_b32 v25, s92, v14
    v_mfma_f32_16x16x32_bf16 v[56:59], a[96:99], a[152:155], v[56:59]
    ds_read_b64_tr_b16 a[72:73], v7 offset:0
    buffer_load_dwordx4 v9, s[8:11], s24 offen lds
    v_mfma_f32_16x16x32_bf16 v[60:63], a[96:99], a[156:159], v[60:63]
    ds_read_b64_tr_b16 a[74:75], v7 offset:1024
    v_sub_f32 v24, v24, v0
    v_mfma_f32_16x16x32_bf16 v[64:67], a[100:103], a[128:131], v[64:67]
    ds_read_b128 a[40:43], v10 offset:4096
    v_sub_f32 v25, v25, v0
    v_mfma_f32_16x16x32_bf16 v[68:71], a[100:103], a[132:135], v[68:71]
    ds_read_b64_tr_b16 a[76:77], v8 offset:0
    s_add_u32 m0, s32, 33792
    v_mul_f32 v24, v24, v27
    v_mfma_f32_16x16x32_bf16 v[72:75], a[100:103], a[136:139], v[72:75]
    ds_read_b64_tr_b16 a[78:79], v8 offset:1024
    buffer_load_dwordx4 v4, s[4:7], s20 offen lds
    v_mfma_f32_16x16x32_bf16 v[76:79], a[100:103], a[140:143], v[76:79]
    ds_read_b128 a[44:47], v10 offset:6144
    v_mul_f32 v25, v25, v27
    v_mfma_f32_16x16x32_bf16 v[80:83], a[100:103], a[144:147], v[80:83]
    ds_read_b64_tr_b16 a[80:81], v5 offset:8192
    v_cvt_pk_bf16_f32 v14, v24, v25
    v_mfma_f32_16x16x32_bf16 v[84:87], a[100:103], a[148:151], v[84:87]
    ds_read_b64_tr_b16 a[82:83], v5 offset:9216
    s_add_u32 m0, s33, 33792
    v_lshlrev_b32 v24, 16, v15
    v_mfma_f32_16x16x32_bf16 v[88:91], a[100:103], a[152:155], v[88:91]
    ds_read_b128 a[48:51], v10 offset:8192
    buffer_load_dwordx4 v9, s[8:11], s25 offen lds
    v_mfma_f32_16x16x32_bf16 v[92:95], a[100:103], a[156:159], v[92:95]
    ds_read_b64_tr_b16 a[84:85], v6 offset:8192
    v_and_b32 v25, s92, v15
    v_mfma_f32_16x16x32_bf16 v[96:99], a[104:107], a[128:131], v[96:99]
    ds_read_b64_tr_b16 a[86:87], v6 offset:9216
    v_sub_f32 v24, v24, v0
    v_mfma_f32_16x16x32_bf16 v[100:103], a[104:107], a[132:135], v[100:103]
    ds_read_b128 a[52:55], v10 offset:10240
    s_add_u32 m0, s32, 34816
    v_sub_f32 v25, v25, v0
    v_mfma_f32_16x16x32_bf16 v[104:107], a[104:107], a[136:139], v[104:107]
    ds_read_b64_tr_b16 a[88:89], v7 offset:8192
    buffer_load_dwordx4 v3, s[4:7], s21 offen lds
    v_mfma_f32_16x16x32_bf16 v[108:111], a[104:107], a[140:143], v[108:111]
    ds_read_b64_tr_b16 a[90:91], v7 offset:9216
    v_mul_f32 v24, v24, v27
    v_mfma_f32_16x16x32_bf16 v[112:115], a[104:107], a[144:147], v[112:115]
    ds_read_b128 a[56:59], v10 offset:12288
    v_mul_f32 v25, v25, v27
    v_mfma_f32_16x16x32_bf16 v[116:119], a[104:107], a[148:151], v[116:119]
    ds_read_b64_tr_b16 a[92:93], v8 offset:8192
    s_add_u32 m0, s33, 34816
    v_cvt_pk_bf16_f32 v15, v24, v25
    v_mfma_f32_16x16x32_bf16 v[120:123], a[104:107], a[152:155], v[120:123]
    ds_read_b64_tr_b16 a[94:95], v8 offset:9216
    buffer_load_dwordx4 v9, s[8:11], s26 offen lds
    v_mfma_f32_16x16x32_bf16 v[124:127], a[104:107], a[156:159], v[124:127]
    ds_read_b128 a[60:63], v10 offset:14336
    v_lshlrev_b32 v24, 16, v16
    v_mfma_f32_16x16x32_bf16 v[128:131], a[108:111], a[128:131], v[128:131]
    v_and_b32 v25, s92, v16
    v_sub_f32 v24, v24, v0
    v_mfma_f32_16x16x32_bf16 v[132:135], a[108:111], a[132:135], v[132:135]
    s_add_u32 m0, s32, 35840
    v_sub_f32 v25, v25, v0
    v_mul_f32 v24, v24, v27
    v_mfma_f32_16x16x32_bf16 v[136:139], a[108:111], a[136:139], v[136:139]
    buffer_load_dwordx4 v4, s[4:7], s21 offen lds
    v_mul_f32 v25, v25, v27
    v_mfma_f32_16x16x32_bf16 v[140:143], a[108:111], a[140:143], v[140:143]
    v_cvt_pk_bf16_f32 v16, v24, v25
    v_lshlrev_b32 v24, 16, v17
    v_mfma_f32_16x16x32_bf16 v[144:147], a[108:111], a[144:147], v[144:147]
    v_and_b32 v25, s92, v17
    v_sub_f32 v24, v24, v0
    v_mfma_f32_16x16x32_bf16 v[148:151], a[108:111], a[148:151], v[148:151]
    s_add_u32 m0, s33, 35840
    v_sub_f32 v25, v25, v0
    v_mul_f32 v24, v24, v27
    v_mfma_f32_16x16x32_bf16 v[152:155], a[108:111], a[152:155], v[152:155]
    s_load_dwordx2 s[36:37], s[0:1], 16
    buffer_load_dwordx4 v9, s[8:11], s27 offen lds
    v_mul_f32 v25, v25, v27
    v_mfma_f32_16x16x32_bf16 v[156:159], a[108:111], a[156:159], v[156:159]
    v_cvt_pk_bf16_f32 v17, v24, v25
    v_lshlrev_b32 v24, 16, v18
    v_mfma_f32_16x16x32_bf16 v[160:163], a[112:115], a[128:131], v[160:163]
    v_and_b32 v25, s92, v18
    v_sub_f32 v24, v24, v0
    v_mfma_f32_16x16x32_bf16 v[164:167], a[112:115], a[132:135], v[164:167]
    s_add_u32 m0, s32, 36864
    v_sub_f32 v25, v25, v0
    v_mul_f32 v24, v24, v27
    v_mfma_f32_16x16x32_bf16 v[168:171], a[112:115], a[136:139], v[168:171]
    buffer_load_dwordx4 v3, s[4:7], s22 offen lds
    v_mul_f32 v25, v25, v27
    v_mfma_f32_16x16x32_bf16 v[172:175], a[112:115], a[140:143], v[172:175]
    v_cvt_pk_bf16_f32 v18, v24, v25
    v_lshlrev_b32 v24, 16, v19
    v_mfma_f32_16x16x32_bf16 v[176:179], a[112:115], a[144:147], v[176:179]
    v_and_b32 v25, s92, v19
    v_sub_f32 v24, v24, v0
    v_mfma_f32_16x16x32_bf16 v[180:183], a[112:115], a[148:151], v[180:183]
    s_add_u32 m0, s32, 37888
    v_sub_f32 v25, v25, v0
    v_mul_f32 v24, v24, v27
    v_mfma_f32_16x16x32_bf16 v[184:187], a[112:115], a[152:155], v[184:187]
    buffer_load_dwordx4 v4, s[4:7], s22 offen lds
    v_mul_f32 v25, v25, v27
    v_mfma_f32_16x16x32_bf16 v[188:191], a[112:115], a[156:159], v[188:191]
    v_cvt_pk_bf16_f32 v19, v24, v25
    v_mfma_f32_16x16x32_bf16 v[192:195], a[116:119], a[128:131], v[192:195]
    v_mfma_f32_16x16x32_bf16 v[196:199], a[116:119], a[132:135], v[196:199]
    s_add_u32 m0, s32, 38912
    v_mfma_f32_16x16x32_bf16 v[200:203], a[116:119], a[136:139], v[200:203]
    buffer_load_dwordx4 v3, s[4:7], s23 offen lds
    v_mfma_f32_16x16x32_bf16 v[204:207], a[116:119], a[140:143], v[204:207]
    v_mfma_f32_16x16x32_bf16 v[208:211], a[116:119], a[144:147], v[208:211]
    v_mfma_f32_16x16x32_bf16 v[212:215], a[116:119], a[148:151], v[212:215]
    s_add_u32 m0, s32, 39936
    v_mfma_f32_16x16x32_bf16 v[216:219], a[116:119], a[152:155], v[216:219]
    buffer_load_dwordx4 v4, s[4:7], s23 offen lds
    v_mfma_f32_16x16x32_bf16 v[220:223], a[116:119], a[156:159], v[220:223]
    v_mfma_f32_16x16x32_bf16 v[224:227], a[120:123], a[128:131], v[224:227]
    v_mfma_f32_16x16x32_bf16 v[228:231], a[120:123], a[132:135], v[228:231]
    v_mfma_f32_16x16x32_bf16 v[232:235], a[120:123], a[136:139], v[232:235]
    v_mfma_f32_16x16x32_bf16 v[236:239], a[120:123], a[140:143], v[236:239]
    v_mfma_f32_16x16x32_bf16 v[240:243], a[120:123], a[144:147], v[240:243]
    v_mfma_f32_16x16x32_bf16 v[244:247], a[120:123], a[148:151], v[244:247]
    v_mfma_f32_16x16x32_bf16 v[248:251], a[120:123], a[152:155], v[248:251]
    v_mfma_f32_16x16x32_bf16 v[252:255], a[120:123], a[156:159], v[252:255]
    v_mfma_f32_16x16x32_bf16 a[0:3], a[124:127], a[128:131], a[0:3]
    v_mfma_f32_16x16x32_bf16 a[4:7], a[124:127], a[132:135], a[4:7]
    v_mfma_f32_16x16x32_bf16 a[8:11], a[124:127], a[136:139], a[8:11]
    buffer_store_dwordx4 v[12:15], v20, s[80:83], 0 offen sc1
    buffer_store_dwordx4 v[16:19], v20, s[80:83], s93 offen sc1
    v_mfma_f32_16x16x32_bf16 a[12:15], a[124:127], a[140:143], a[12:15]
    v_mfma_f32_16x16x32_bf16 a[16:19], a[124:127], a[144:147], a[16:19]
    v_mfma_f32_16x16x32_bf16 a[20:23], a[124:127], a[148:151], a[20:23]
    v_mfma_f32_16x16x32_bf16 a[24:27], a[124:127], a[152:155], a[24:27]
    s_add_u32 s4, s4, 128
    s_addc_u32 s5, s5, 0
    v_mfma_f32_16x16x32_bf16 a[28:31], a[124:127], a[156:159], a[28:31]
    s_waitcnt vmcnt(16) lgkmcnt(0)
    s_barrier
    v_mfma_f32_16x16x32_bf16 v[32:35], a[32:35], a[64:67], v[32:35]
    ds_read_b64_tr_b16 a[128:129], v5 offset:4096
    v_mfma_f32_16x16x32_bf16 v[36:39], a[32:35], a[68:71], v[36:39]
    ds_read_b64_tr_b16 a[130:131], v5 offset:5120
    s_add_u32 m0, s33, 36864
    v_mfma_f32_16x16x32_bf16 v[40:43], a[32:35], a[72:75], v[40:43]
    ds_read_b128 a[96:99], v11 offset:0
    buffer_load_dwordx4 v9, s[8:11], s28 offen lds
    v_mfma_f32_16x16x32_bf16 v[44:47], a[32:35], a[76:79], v[44:47]
    ds_read_b64_tr_b16 a[132:133], v6 offset:4096
    v_mfma_f32_16x16x32_bf16 v[48:51], a[32:35], a[80:83], v[48:51]
    ds_read_b64_tr_b16 a[134:135], v6 offset:5120
    v_mfma_f32_16x16x32_bf16 v[52:55], a[32:35], a[84:87], v[52:55]
    ds_read_b128 a[100:103], v11 offset:2048
    v_mfma_f32_16x16x32_bf16 v[56:59], a[32:35], a[88:91], v[56:59]
    ds_read_b64_tr_b16 a[136:137], v7 offset:4096
    v_mfma_f32_16x16x32_bf16 v[60:63], a[32:35], a[92:95], v[60:63]
    ds_read_b64_tr_b16 a[138:139], v7 offset:5120
    v_mfma_f32_16x16x32_bf16 v[64:67], a[36:39], a[64:67], v[64:67]
    ds_read_b128 a[104:107], v11 offset:4096
    v_mfma_f32_16x16x32_bf16 v[68:71], a[36:39], a[68:71], v[68:71]
    ds_read_b64_tr_b16 a[140:141], v8 offset:4096
    s_add_u32 m0, s33, 37888
    v_mfma_f32_16x16x32_bf16 v[72:75], a[36:39], a[72:75], v[72:75]
    ds_read_b64_tr_b16 a[142:143], v8 offset:5120
    buffer_load_dwordx4 v9, s[8:11], s29 offen lds
    v_mfma_f32_16x16x32_bf16 v[76:79], a[36:39], a[76:79], v[76:79]
    ds_read_b128 a[108:111], v11 offset:6144
    v_mfma_f32_16x16x32_bf16 v[80:83], a[36:39], a[80:83], v[80:83]
    ds_read_b64_tr_b16 a[144:145], v5 offset:12288
    v_mfma_f32_16x16x32_bf16 v[84:87], a[36:39], a[84:87], v[84:87]
    ds_read_b64_tr_b16 a[146:147], v5 offset:13312
    v_mfma_f32_16x16x32_bf16 v[88:91], a[36:39], a[88:91], v[88:91]
    ds_read_b128 a[112:115], v11 offset:8192
    v_mfma_f32_16x16x32_bf16 v[92:95], a[36:39], a[92:95], v[92:95]
    ds_read_b64_tr_b16 a[148:149], v6 offset:12288
    v_mfma_f32_16x16x32_bf16 v[96:99], a[40:43], a[64:67], v[96:99]
    ds_read_b64_tr_b16 a[150:151], v6 offset:13312
    v_mfma_f32_16x16x32_bf16 v[100:103], a[40:43], a[68:71], v[100:103]
    ds_read_b128 a[116:119], v11 offset:10240
    s_add_u32 m0, s33, 38912
    v_mfma_f32_16x16x32_bf16 v[104:107], a[40:43], a[72:75], v[104:107]
    ds_read_b64_tr_b16 a[152:153], v7 offset:12288
    buffer_load_dwordx4 v9, s[8:11], s30 offen lds
    v_mfma_f32_16x16x32_bf16 v[108:111], a[40:43], a[76:79], v[108:111]
    ds_read_b64_tr_b16 a[154:155], v7 offset:13312
    v_mfma_f32_16x16x32_bf16 v[112:115], a[40:43], a[80:83], v[112:115]
    ds_read_b128 a[120:123], v11 offset:12288
    v_mfma_f32_16x16x32_bf16 v[116:119], a[40:43], a[84:87], v[116:119]
    ds_read_b64_tr_b16 a[156:157], v8 offset:12288
    v_mfma_f32_16x16x32_bf16 v[120:123], a[40:43], a[88:91], v[120:123]
    ds_read_b64_tr_b16 a[158:159], v8 offset:13312
    v_mfma_f32_16x16x32_bf16 v[124:127], a[40:43], a[92:95], v[124:127]
    ds_read_b128 a[124:127], v11 offset:14336
    v_mfma_f32_16x16x32_bf16 v[128:131], a[44:47], a[64:67], v[128:131]
    v_mfma_f32_16x16x32_bf16 v[132:135], a[44:47], a[68:71], v[132:135]
    s_add_u32 m0, s33, 39936
    v_mfma_f32_16x16x32_bf16 v[136:139], a[44:47], a[72:75], v[136:139]
    buffer_load_dwordx4 v9, s[8:11], s31 offen lds
    v_mfma_f32_16x16x32_bf16 v[140:143], a[44:47], a[76:79], v[140:143]
    v_mfma_f32_16x16x32_bf16 v[144:147], a[44:47], a[80:83], v[144:147]
    v_mfma_f32_16x16x32_bf16 v[148:151], a[44:47], a[84:87], v[148:151]
    v_mfma_f32_16x16x32_bf16 v[152:155], a[44:47], a[88:91], v[152:155]
    s_add_u32 s8, s8, 524288
    s_addc_u32 s9, s9, 0
    v_mfma_f32_16x16x32_bf16 v[156:159], a[44:47], a[92:95], v[156:159]
    v_mfma_f32_16x16x32_bf16 v[160:163], a[48:51], a[64:67], v[160:163]
    v_mfma_f32_16x16x32_bf16 v[164:167], a[48:51], a[68:71], v[164:167]
    v_mfma_f32_16x16x32_bf16 v[168:171], a[48:51], a[72:75], v[168:171]
    s_mov_b32 s38, 0x400000
    s_mov_b32 s39, 0x00020000
    s_lshl_b32 s34, s2, 14
    v_mfma_f32_16x16x32_bf16 v[172:175], a[48:51], a[76:79], v[172:175]
    buffer_load_dwordx4 a[252:255], v23, s[36:39], s34 offen
    v_mfma_f32_16x16x32_bf16 v[176:179], a[48:51], a[80:83], v[176:179]
    v_mfma_f32_16x16x32_bf16 v[180:183], a[48:51], a[84:87], v[180:183]
    v_mfma_f32_16x16x32_bf16 v[184:187], a[48:51], a[88:91], v[184:187]
    v_mfma_f32_16x16x32_bf16 v[188:191], a[48:51], a[92:95], v[188:191]
    v_mfma_f32_16x16x32_bf16 v[192:195], a[52:55], a[64:67], v[192:195]
    v_mfma_f32_16x16x32_bf16 v[196:199], a[52:55], a[68:71], v[196:199]
    v_mfma_f32_16x16x32_bf16 v[200:203], a[52:55], a[72:75], v[200:203]
    s_lshl_b32 s34, s2, 14
    s_add_u32 s34, s34, 4096
    v_mfma_f32_16x16x32_bf16 v[204:207], a[52:55], a[76:79], v[204:207]
    buffer_load_dwordx4 a[252:255], v23, s[36:39], s34 offen
    v_mfma_f32_16x16x32_bf16 v[208:211], a[52:55], a[80:83], v[208:211]
    v_mfma_f32_16x16x32_bf16 v[212:215], a[52:55], a[84:87], v[212:215]
    v_mfma_f32_16x16x32_bf16 v[216:219], a[52:55], a[88:91], v[216:219]
    v_mfma_f32_16x16x32_bf16 v[220:223], a[52:55], a[92:95], v[220:223]
    v_mfma_f32_16x16x32_bf16 v[224:227], a[56:59], a[64:67], v[224:227]
    v_mfma_f32_16x16x32_bf16 v[228:231], a[56:59], a[68:71], v[228:231]
    v_mfma_f32_16x16x32_bf16 v[232:235], a[56:59], a[72:75], v[232:235]
    v_mfma_f32_16x16x32_bf16 v[236:239], a[56:59], a[76:79], v[236:239]
    v_mfma_f32_16x16x32_bf16 v[240:243], a[56:59], a[80:83], v[240:243]
    v_mfma_f32_16x16x32_bf16 v[244:247], a[56:59], a[84:87], v[244:247]
    v_mfma_f32_16x16x32_bf16 v[248:251], a[56:59], a[88:91], v[248:251]
    v_mfma_f32_16x16x32_bf16 v[252:255], a[56:59], a[92:95], v[252:255]
    v_mfma_f32_16x16x32_bf16 a[0:3], a[60:63], a[64:67], a[0:3]
    v_mfma_f32_16x16x32_bf16 a[4:7], a[60:63], a[68:71], a[4:7]
    v_mfma_f32_16x16x32_bf16 a[8:11], a[60:63], a[72:75], a[8:11]
    v_mfma_f32_16x16x32_bf16 a[12:15], a[60:63], a[76:79], a[12:15]
    v_mfma_f32_16x16x32_bf16 a[16:19], a[60:63], a[80:83], a[16:19]
    v_mfma_f32_16x16x32_bf16 a[20:23], a[60:63], a[84:87], a[20:23]
    v_mfma_f32_16x16x32_bf16 a[24:27], a[60:63], a[88:91], a[24:27]
    v_mfma_f32_16x16x32_bf16 a[28:31], a[60:63], a[92:95], a[28:31]
    s_waitcnt vmcnt(8) lgkmcnt(0)
    s_barrier
    v_mfma_f32_16x16x32_bf16 v[32:35], a[96:99], a[128:131], v[32:35]
    ds_read_b64_tr_b16 a[64:65], v5 offset:32768
    v_mfma_f32_16x16x32_bf16 v[36:39], a[96:99], a[132:135], v[36:39]
    ds_read_b64_tr_b16 a[66:67], v5 offset:33792
    s_add_u32 m0, s32, 0
    v_mfma_f32_16x16x32_bf16 v[40:43], a[96:99], a[136:139], v[40:43]
    ds_read_b128 a[32:35], v10 offset:32768
    buffer_load_dwordx4 v3, s[4:7], s20 offen lds
    v_mfma_f32_16x16x32_bf16 v[44:47], a[96:99], a[140:143], v[44:47]
    ds_read_b64_tr_b16 a[68:69], v6 offset:32768
    v_mfma_f32_16x16x32_bf16 v[48:51], a[96:99], a[144:147], v[48:51]
    ds_read_b64_tr_b16 a[70:71], v6 offset:33792
    v_mfma_f32_16x16x32_bf16 v[52:55], a[96:99], a[148:151], v[52:55]
    ds_read_b128 a[36:39], v10 offset:34816
    s_add_u32 m0, s33, 0
    v_mfma_f32_16x16x32_bf16 v[56:59], a[96:99], a[152:155], v[56:59]
    ds_read_b64_tr_b16 a[72:73], v7 offset:32768
    buffer_load_dwordx4 v9, s[8:11], s24 offen lds
    v_mfma_f32_16x16x32_bf16 v[60:63], a[96:99], a[156:159], v[60:63]
    ds_read_b64_tr_b16 a[74:75], v7 offset:33792
    v_mfma_f32_16x16x32_bf16 v[64:67], a[100:103], a[128:131], v[64:67]
    ds_read_b128 a[40:43], v10 offset:36864
    v_mfma_f32_16x16x32_bf16 v[68:71], a[100:103], a[132:135], v[68:71]
    ds_read_b64_tr_b16 a[76:77], v8 offset:32768
    s_add_u32 m0, s32, 1024
    v_mfma_f32_16x16x32_bf16 v[72:75], a[100:103], a[136:139], v[72:75]
    ds_read_b64_tr_b16 a[78:79], v8 offset:33792
    buffer_load_dwordx4 v4, s[4:7], s20 offen lds
    v_mfma_f32_16x16x32_bf16 v[76:79], a[100:103], a[140:143], v[76:79]
    ds_read_b128 a[44:47], v10 offset:38912
    v_mfma_f32_16x16x32_bf16 v[80:83], a[100:103], a[144:147], v[80:83]
    ds_read_b64_tr_b16 a[80:81], v5 offset:40960
    v_mfma_f32_16x16x32_bf16 v[84:87], a[100:103], a[148:151], v[84:87]
    ds_read_b64_tr_b16 a[82:83], v5 offset:41984
    s_add_u32 m0, s33, 1024
    v_mfma_f32_16x16x32_bf16 v[88:91], a[100:103], a[152:155], v[88:91]
    ds_read_b128 a[48:51], v10 offset:40960
    buffer_load_dwordx4 v9, s[8:11], s25 offen lds
    v_mfma_f32_16x16x32_bf16 v[92:95], a[100:103], a[156:159], v[92:95]
    ds_read_b64_tr_b16 a[84:85], v6 offset:40960
    v_mfma_f32_16x16x32_bf16 v[96:99], a[104:107], a[128:131], v[96:99]
    ds_read_b64_tr_b16 a[86:87], v6 offset:41984
    v_mfma_f32_16x16x32_bf16 v[100:103], a[104:107], a[132:135], v[100:103]
    ds_read_b128 a[52:55], v10 offset:43008
    s_add_u32 m0, s32, 2048
    v_mfma_f32_16x16x32_bf16 v[104:107], a[104:107], a[136:139], v[104:107]
    ds_read_b64_tr_b16 a[88:89], v7 offset:40960
    buffer_load_dwordx4 v3, s[4:7], s21 offen lds
    v_mfma_f32_16x16x32_bf16 v[108:111], a[104:107], a[140:143], v[108:111]
    ds_read_b64_tr_b16 a[90:91], v7 offset:41984
    v_mfma_f32_16x16x32_bf16 v[112:115], a[104:107], a[144:147], v[112:115]
    ds_read_b128 a[56:59], v10 offset:45056
    v_mfma_f32_16x16x32_bf16 v[116:119], a[104:107], a[148:151], v[116:119]
    ds_read_b64_tr_b16 a[92:93], v8 offset:40960
    s_add_u32 m0, s33, 2048
    v_mfma_f32_16x16x32_bf16 v[120:123], a[104:107], a[152:155], v[120:123]
    ds_read_b64_tr_b16 a[94:95], v8 offset:41984
    buffer_load_dwordx4 v9, s[8:11], s26 offen lds
    v_mfma_f32_16x16x32_bf16 v[124:127], a[104:107], a[156:159], v[124:127]
    ds_read_b128 a[60:63], v10 offset:47104
    v_mfma_f32_16x16x32_bf16 v[128:131], a[108:111], a[128:131], v[128:131]
    v_mfma_f32_16x16x32_bf16 v[132:135], a[108:111], a[132:135], v[132:135]
    s_add_u32 m0, s32, 3072
    v_mfma_f32_16x16x32_bf16 v[136:139], a[108:111], a[136:139], v[136:139]
    buffer_load_dwordx4 v4, s[4:7], s21 offen lds
    v_mfma_f32_16x16x32_bf16 v[140:143], a[108:111], a[140:143], v[140:143]
    v_mfma_f32_16x16x32_bf16 v[144:147], a[108:111], a[144:147], v[144:147]
    v_mfma_f32_16x16x32_bf16 v[148:151], a[108:111], a[148:151], v[148:151]
    s_add_u32 m0, s33, 3072
    v_mfma_f32_16x16x32_bf16 v[152:155], a[108:111], a[152:155], v[152:155]
    s_load_dwordx2 s[36:37], s[0:1], 16
    buffer_load_dwordx4 v9, s[8:11], s27 offen lds
    v_mfma_f32_16x16x32_bf16 v[156:159], a[108:111], a[156:159], v[156:159]
    s_load_dwordx2 s[48:49], s[0:1], 72
    v_mfma_f32_16x16x32_bf16 v[160:163], a[112:115], a[128:131], v[160:163]
    v_mfma_f32_16x16x32_bf16 v[164:167], a[112:115], a[132:135], v[164:167]
    s_add_u32 m0, s32, 4096
    v_mfma_f32_16x16x32_bf16 v[168:171], a[112:115], a[136:139], v[168:171]
    buffer_load_dwordx4 v3, s[4:7], s22 offen lds
    v_mfma_f32_16x16x32_bf16 v[172:175], a[112:115], a[140:143], v[172:175]
    v_mfma_f32_16x16x32_bf16 v[176:179], a[112:115], a[144:147], v[176:179]
    v_mfma_f32_16x16x32_bf16 v[180:183], a[112:115], a[148:151], v[180:183]
    s_add_u32 m0, s32, 5120
    v_mfma_f32_16x16x32_bf16 v[184:187], a[112:115], a[152:155], v[184:187]
    buffer_load_dwordx4 v4, s[4:7], s22 offen lds
    v_mfma_f32_16x16x32_bf16 v[188:191], a[112:115], a[156:159], v[188:191]
    v_mfma_f32_16x16x32_bf16 v[192:195], a[116:119], a[128:131], v[192:195]
    v_mfma_f32_16x16x32_bf16 v[196:199], a[116:119], a[132:135], v[196:199]
    s_add_u32 m0, s32, 6144
    v_mfma_f32_16x16x32_bf16 v[200:203], a[116:119], a[136:139], v[200:203]
    buffer_load_dwordx4 v3, s[4:7], s23 offen lds
    v_mfma_f32_16x16x32_bf16 v[204:207], a[116:119], a[140:143], v[204:207]
    v_mfma_f32_16x16x32_bf16 v[208:211], a[116:119], a[144:147], v[208:211]
    v_mfma_f32_16x16x32_bf16 v[212:215], a[116:119], a[148:151], v[212:215]
    s_add_u32 m0, s32, 7168
    v_mfma_f32_16x16x32_bf16 v[216:219], a[116:119], a[152:155], v[216:219]
    buffer_load_dwordx4 v4, s[4:7], s23 offen lds
    v_mfma_f32_16x16x32_bf16 v[220:223], a[116:119], a[156:159], v[220:223]
    v_mfma_f32_16x16x32_bf16 v[224:227], a[120:123], a[128:131], v[224:227]
    v_mfma_f32_16x16x32_bf16 v[228:231], a[120:123], a[132:135], v[228:231]
    v_mfma_f32_16x16x32_bf16 v[232:235], a[120:123], a[136:139], v[232:235]
    v_mfma_f32_16x16x32_bf16 v[236:239], a[120:123], a[140:143], v[236:239]
    v_mfma_f32_16x16x32_bf16 v[240:243], a[120:123], a[144:147], v[240:243]
    v_mfma_f32_16x16x32_bf16 v[244:247], a[120:123], a[148:151], v[244:247]
    v_mfma_f32_16x16x32_bf16 v[248:251], a[120:123], a[152:155], v[248:251]
    v_mfma_f32_16x16x32_bf16 v[252:255], a[120:123], a[156:159], v[252:255]
    v_mfma_f32_16x16x32_bf16 a[0:3], a[124:127], a[128:131], a[0:3]
    v_mfma_f32_16x16x32_bf16 a[4:7], a[124:127], a[132:135], a[4:7]
    v_mfma_f32_16x16x32_bf16 a[8:11], a[124:127], a[136:139], a[8:11]
    v_mfma_f32_16x16x32_bf16 a[12:15], a[124:127], a[140:143], a[12:15]
    v_mfma_f32_16x16x32_bf16 a[16:19], a[124:127], a[144:147], a[16:19]
    v_mfma_f32_16x16x32_bf16 a[20:23], a[124:127], a[148:151], a[20:23]
    v_mfma_f32_16x16x32_bf16 a[24:27], a[124:127], a[152:155], a[24:27]
    s_add_u32 s4, s4, 128
    s_addc_u32 s5, s5, 0
    v_mfma_f32_16x16x32_bf16 a[28:31], a[124:127], a[156:159], a[28:31]
    s_waitcnt vmcnt(14) lgkmcnt(0)
    s_barrier
    v_mfma_f32_16x16x32_bf16 v[32:35], a[32:35], a[64:67], v[32:35]
    ds_read_b64_tr_b16 a[128:129], v5 offset:36864
    v_mfma_f32_16x16x32_bf16 v[36:39], a[32:35], a[68:71], v[36:39]
    ds_read_b64_tr_b16 a[130:131], v5 offset:37888
    s_add_u32 m0, s33, 4096
    v_mfma_f32_16x16x32_bf16 v[40:43], a[32:35], a[72:75], v[40:43]
    ds_read_b128 a[96:99], v11 offset:32768
    buffer_load_dwordx4 v9, s[8:11], s28 offen lds
    v_mfma_f32_16x16x32_bf16 v[44:47], a[32:35], a[76:79], v[44:47]
    ds_read_b64_tr_b16 a[132:133], v6 offset:36864
    v_mfma_f32_16x16x32_bf16 v[48:51], a[32:35], a[80:83], v[48:51]
    ds_read_b64_tr_b16 a[134:135], v6 offset:37888
    v_mfma_f32_16x16x32_bf16 v[52:55], a[32:35], a[84:87], v[52:55]
    ds_read_b128 a[100:103], v11 offset:34816
    v_mfma_f32_16x16x32_bf16 v[56:59], a[32:35], a[88:91], v[56:59]
    ds_read_b64_tr_b16 a[136:137], v7 offset:36864
    v_mfma_f32_16x16x32_bf16 v[60:63], a[32:35], a[92:95], v[60:63]
    ds_read_b64_tr_b16 a[138:139], v7 offset:37888
    v_mfma_f32_16x16x32_bf16 v[64:67], a[36:39], a[64:67], v[64:67]
    ds_read_b128 a[104:107], v11 offset:36864
    v_mfma_f32_16x16x32_bf16 v[68:71], a[36:39], a[68:71], v[68:71]
    ds_read_b64_tr_b16 a[140:141], v8 offset:36864
    s_add_u32 m0, s33, 5120
    v_mfma_f32_16x16x32_bf16 v[72:75], a[36:39], a[72:75], v[72:75]
    ds_read_b64_tr_b16 a[142:143], v8 offset:37888
    buffer_load_dwordx4 v9, s[8:11], s29 offen lds
    v_mfma_f32_16x16x32_bf16 v[76:79], a[36:39], a[76:79], v[76:79]
    ds_read_b128 a[108:111], v11 offset:38912
    v_mfma_f32_16x16x32_bf16 v[80:83], a[36:39], a[80:83], v[80:83]
    ds_read_b64_tr_b16 a[144:145], v5 offset:45056
    v_mfma_f32_16x16x32_bf16 v[84:87], a[36:39], a[84:87], v[84:87]
    ds_read_b64_tr_b16 a[146:147], v5 offset:46080
    v_mfma_f32_16x16x32_bf16 v[88:91], a[36:39], a[88:91], v[88:91]
    ds_read_b128 a[112:115], v11 offset:40960
    v_mfma_f32_16x16x32_bf16 v[92:95], a[36:39], a[92:95], v[92:95]
    ds_read_b64_tr_b16 a[148:149], v6 offset:45056
    v_mfma_f32_16x16x32_bf16 v[96:99], a[40:43], a[64:67], v[96:99]
    ds_read_b64_tr_b16 a[150:151], v6 offset:46080
    v_mfma_f32_16x16x32_bf16 v[100:103], a[40:43], a[68:71], v[100:103]
    ds_read_b128 a[116:119], v11 offset:43008
    s_add_u32 m0, s33, 6144
    v_mfma_f32_16x16x32_bf16 v[104:107], a[40:43], a[72:75], v[104:107]
    ds_read_b64_tr_b16 a[152:153], v7 offset:45056
    buffer_load_dwordx4 v9, s[8:11], s30 offen lds
    v_mfma_f32_16x16x32_bf16 v[108:111], a[40:43], a[76:79], v[108:111]
    ds_read_b64_tr_b16 a[154:155], v7 offset:46080
    v_mfma_f32_16x16x32_bf16 v[112:115], a[40:43], a[80:83], v[112:115]
    ds_read_b128 a[120:123], v11 offset:45056
    v_mfma_f32_16x16x32_bf16 v[116:119], a[40:43], a[84:87], v[116:119]
    ds_read_b64_tr_b16 a[156:157], v8 offset:45056
    v_mfma_f32_16x16x32_bf16 v[120:123], a[40:43], a[88:91], v[120:123]
    ds_read_b64_tr_b16 a[158:159], v8 offset:46080
    v_mfma_f32_16x16x32_bf16 v[124:127], a[40:43], a[92:95], v[124:127]
    ds_read_b128 a[124:127], v11 offset:47104
    v_mfma_f32_16x16x32_bf16 v[128:131], a[44:47], a[64:67], v[128:131]
    v_mfma_f32_16x16x32_bf16 v[132:135], a[44:47], a[68:71], v[132:135]
    s_add_u32 m0, s33, 7168
    v_mfma_f32_16x16x32_bf16 v[136:139], a[44:47], a[72:75], v[136:139]
    buffer_load_dwordx4 v9, s[8:11], s31 offen lds
    v_mfma_f32_16x16x32_bf16 v[140:143], a[44:47], a[76:79], v[140:143]
    v_mfma_f32_16x16x32_bf16 v[144:147], a[44:47], a[80:83], v[144:147]
    v_mfma_f32_16x16x32_bf16 v[148:151], a[44:47], a[84:87], v[148:151]
    v_mfma_f32_16x16x32_bf16 v[152:155], a[44:47], a[88:91], v[152:155]
    s_add_u32 s8, s8, 524288
    s_addc_u32 s9, s9, 0
    v_mfma_f32_16x16x32_bf16 v[156:159], a[44:47], a[92:95], v[156:159]
    v_mfma_f32_16x16x32_bf16 v[160:163], a[48:51], a[64:67], v[160:163]
    v_mfma_f32_16x16x32_bf16 v[164:167], a[48:51], a[68:71], v[164:167]
    v_mfma_f32_16x16x32_bf16 v[168:171], a[48:51], a[72:75], v[168:171]
    s_mov_b32 s38, 0x400000
    s_mov_b32 s39, 0x00020000
    s_lshl_b32 s34, s2, 14
    s_add_u32 s34, s34, 8192
    v_mfma_f32_16x16x32_bf16 v[172:175], a[48:51], a[76:79], v[172:175]
    buffer_load_dwordx4 a[252:255], v23, s[36:39], s34 offen
    v_mfma_f32_16x16x32_bf16 v[176:179], a[48:51], a[80:83], v[176:179]
    v_mfma_f32_16x16x32_bf16 v[180:183], a[48:51], a[84:87], v[180:183]
    v_mfma_f32_16x16x32_bf16 v[184:187], a[48:51], a[88:91], v[184:187]
    v_mfma_f32_16x16x32_bf16 v[188:191], a[48:51], a[92:95], v[188:191]
    v_mfma_f32_16x16x32_bf16 v[192:195], a[52:55], a[64:67], v[192:195]
    v_mfma_f32_16x16x32_bf16 v[196:199], a[52:55], a[68:71], v[196:199]
    v_mfma_f32_16x16x32_bf16 v[200:203], a[52:55], a[72:75], v[200:203]
    s_lshl_b32 s34, s2, 14
    s_add_u32 s34, s34, 12288
    v_mfma_f32_16x16x32_bf16 v[204:207], a[52:55], a[76:79], v[204:207]
    buffer_load_dwordx4 a[252:255], v23, s[36:39], s34 offen
    v_mfma_f32_16x16x32_bf16 v[208:211], a[52:55], a[80:83], v[208:211]
    v_mfma_f32_16x16x32_bf16 v[212:215], a[52:55], a[84:87], v[212:215]
    v_mfma_f32_16x16x32_bf16 v[216:219], a[52:55], a[88:91], v[216:219]
    v_mfma_f32_16x16x32_bf16 v[220:223], a[52:55], a[92:95], v[220:223]
    v_mfma_f32_16x16x32_bf16 v[224:227], a[56:59], a[64:67], v[224:227]
    v_mfma_f32_16x16x32_bf16 v[228:231], a[56:59], a[68:71], v[228:231]
    v_mfma_f32_16x16x32_bf16 v[232:235], a[56:59], a[72:75], v[232:235]
    s_mov_b32 s50, 0x1c0000
    s_mov_b32 s51, 0x00020000
    s_lshl_b32 s34, s2, 13
    v_mfma_f32_16x16x32_bf16 v[236:239], a[56:59], a[76:79], v[236:239]
    buffer_load_dwordx4 a[252:255], v23, s[48:51], s34 offen
    v_mfma_f32_16x16x32_bf16 v[240:243], a[56:59], a[80:83], v[240:243]
    v_mfma_f32_16x16x32_bf16 v[244:247], a[56:59], a[84:87], v[244:247]
    v_mfma_f32_16x16x32_bf16 v[248:251], a[56:59], a[88:91], v[248:251]
    v_mfma_f32_16x16x32_bf16 v[252:255], a[56:59], a[92:95], v[252:255]
    v_mfma_f32_16x16x32_bf16 a[0:3], a[60:63], a[64:67], a[0:3]
    v_mfma_f32_16x16x32_bf16 a[4:7], a[60:63], a[68:71], a[4:7]
    v_mfma_f32_16x16x32_bf16 a[8:11], a[60:63], a[72:75], a[8:11]
    v_mfma_f32_16x16x32_bf16 a[12:15], a[60:63], a[76:79], a[12:15]
    v_mfma_f32_16x16x32_bf16 a[16:19], a[60:63], a[80:83], a[16:19]
    v_mfma_f32_16x16x32_bf16 a[20:23], a[60:63], a[84:87], a[20:23]
    v_mfma_f32_16x16x32_bf16 a[24:27], a[60:63], a[88:91], a[24:27]
    v_mfma_f32_16x16x32_bf16 a[28:31], a[60:63], a[92:95], a[28:31]
    buffer_atomic_add v21, v22, s[84:87], 0 offen sc1
    s_waitcnt vmcnt(8) lgkmcnt(0)
    s_barrier
    v_mfma_f32_16x16x32_bf16 v[32:35], a[96:99], a[128:131], v[32:35]
    ds_read_b64_tr_b16 a[64:65], v5 offset:0
    v_mfma_f32_16x16x32_bf16 v[36:39], a[96:99], a[132:135], v[36:39]
    ds_read_b64_tr_b16 a[66:67], v5 offset:1024
    s_add_u32 m0, s32, 32768
    v_mfma_f32_16x16x32_bf16 v[40:43], a[96:99], a[136:139], v[40:43]
    ds_read_b128 a[32:35], v10 offset:0
    buffer_load_dwordx4 v3, s[4:7], s20 offen lds
    v_mfma_f32_16x16x32_bf16 v[44:47], a[96:99], a[140:143], v[44:47]
    ds_read_b64_tr_b16 a[68:69], v6 offset:0
    v_mfma_f32_16x16x32_bf16 v[48:51], a[96:99], a[144:147], v[48:51]
    ds_read_b64_tr_b16 a[70:71], v6 offset:1024
    v_mfma_f32_16x16x32_bf16 v[52:55], a[96:99], a[148:151], v[52:55]
    ds_read_b128 a[36:39], v10 offset:2048
    s_add_u32 m0, s33, 32768
    v_mfma_f32_16x16x32_bf16 v[56:59], a[96:99], a[152:155], v[56:59]
    ds_read_b64_tr_b16 a[72:73], v7 offset:0
    buffer_load_dwordx4 v9, s[8:11], s24 offen lds
    v_mfma_f32_16x16x32_bf16 v[60:63], a[96:99], a[156:159], v[60:63]
    ds_read_b64_tr_b16 a[74:75], v7 offset:1024
    v_mfma_f32_16x16x32_bf16 v[64:67], a[100:103], a[128:131], v[64:67]
    ds_read_b128 a[40:43], v10 offset:4096
    v_mfma_f32_16x16x32_bf16 v[68:71], a[100:103], a[132:135], v[68:71]
    ds_read_b64_tr_b16 a[76:77], v8 offset:0
    s_add_u32 m0, s32, 33792
    v_mfma_f32_16x16x32_bf16 v[72:75], a[100:103], a[136:139], v[72:75]
    ds_read_b64_tr_b16 a[78:79], v8 offset:1024
    buffer_load_dwordx4 v4, s[4:7], s20 offen lds
    v_mfma_f32_16x16x32_bf16 v[76:79], a[100:103], a[140:143], v[76:79]
    ds_read_b128 a[44:47], v10 offset:6144
    v_mfma_f32_16x16x32_bf16 v[80:83], a[100:103], a[144:147], v[80:83]
    ds_read_b64_tr_b16 a[80:81], v5 offset:8192
    v_mfma_f32_16x16x32_bf16 v[84:87], a[100:103], a[148:151], v[84:87]
    ds_read_b64_tr_b16 a[82:83], v5 offset:9216
    s_add_u32 m0, s33, 33792
    v_mfma_f32_16x16x32_bf16 v[88:91], a[100:103], a[152:155], v[88:91]
    ds_read_b128 a[48:51], v10 offset:8192
    buffer_load_dwordx4 v9, s[8:11], s25 offen lds
    v_mfma_f32_16x16x32_bf16 v[92:95], a[100:103], a[156:159], v[92:95]
    ds_read_b64_tr_b16 a[84:85], v6 offset:8192
    v_mfma_f32_16x16x32_bf16 v[96:99], a[104:107], a[128:131], v[96:99]
    ds_read_b64_tr_b16 a[86:87], v6 offset:9216
    v_mfma_f32_16x16x32_bf16 v[100:103], a[104:107], a[132:135], v[100:103]
    ds_read_b128 a[52:55], v10 offset:10240
    s_add_u32 m0, s32, 34816
    v_mfma_f32_16x16x32_bf16 v[104:107], a[104:107], a[136:139], v[104:107]
    ds_read_b64_tr_b16 a[88:89], v7 offset:8192
    buffer_load_dwordx4 v3, s[4:7], s21 offen lds
    v_mfma_f32_16x16x32_bf16 v[108:111], a[104:107], a[140:143], v[108:111]
    ds_read_b64_tr_b16 a[90:91], v7 offset:9216
    v_mfma_f32_16x16x32_bf16 v[112:115], a[104:107], a[144:147], v[112:115]
    ds_read_b128 a[56:59], v10 offset:12288
    v_mfma_f32_16x16x32_bf16 v[116:119], a[104:107], a[148:151], v[116:119]
    ds_read_b64_tr_b16 a[92:93], v8 offset:8192
    s_add_u32 m0, s33, 34816
    v_mfma_f32_16x16x32_bf16 v[120:123], a[104:107], a[152:155], v[120:123]
    ds_read_b64_tr_b16 a[94:95], v8 offset:9216
    buffer_load_dwordx4 v9, s[8:11], s26 offen lds
    v_mfma_f32_16x16x32_bf16 v[124:127], a[104:107], a[156:159], v[124:127]
    ds_read_b128 a[60:63], v10 offset:14336
    v_mfma_f32_16x16x32_bf16 v[128:131], a[108:111], a[128:131], v[128:131]
    v_mfma_f32_16x16x32_bf16 v[132:135], a[108:111], a[132:135], v[132:135]
    s_add_u32 m0, s32, 35840
    v_mfma_f32_16x16x32_bf16 v[136:139], a[108:111], a[136:139], v[136:139]
    buffer_load_dwordx4 v4, s[4:7], s21 offen lds
    v_mfma_f32_16x16x32_bf16 v[140:143], a[108:111], a[140:143], v[140:143]
    v_mfma_f32_16x16x32_bf16 v[144:147], a[108:111], a[144:147], v[144:147]
    v_mfma_f32_16x16x32_bf16 v[148:151], a[108:111], a[148:151], v[148:151]
    s_add_u32 m0, s33, 35840
    v_mfma_f32_16x16x32_bf16 v[152:155], a[108:111], a[152:155], v[152:155]
    s_load_dwordx2 s[36:37], s[0:1], 72
    buffer_load_dwordx4 v9, s[8:11], s27 offen lds
    v_mfma_f32_16x16x32_bf16 v[156:159], a[108:111], a[156:159], v[156:159]
    s_load_dwordx2 s[48:49], s[0:1], 80
    v_mfma_f32_16x16x32_bf16 v[160:163], a[112:115], a[128:131], v[160:163]
    v_mfma_f32_16x16x32_bf16 v[164:167], a[112:115], a[132:135], v[164:167]
    s_add_u32 m0, s32, 36864
    v_mfma_f32_16x16x32_bf16 v[168:171], a[112:115], a[136:139], v[168:171]
    buffer_load_dwordx4 v3, s[4:7], s22 offen lds
    v_mfma_f32_16x16x32_bf16 v[172:175], a[112:115], a[140:143], v[172:175]
    v_mfma_f32_16x16x32_bf16 v[176:179], a[112:115], a[144:147], v[176:179]
    v_mfma_f32_16x16x32_bf16 v[180:183], a[112:115], a[148:151], v[180:183]
    s_add_u32 m0, s32, 37888
    v_mfma_f32_16x16x32_bf16 v[184:187], a[112:115], a[152:155], v[184:187]
    buffer_load_dwordx4 v4, s[4:7], s22 offen lds
    v_mfma_f32_16x16x32_bf16 v[188:191], a[112:115], a[156:159], v[188:191]
    v_mfma_f32_16x16x32_bf16 v[192:195], a[116:119], a[128:131], v[192:195]
    v_mfma_f32_16x16x32_bf16 v[196:199], a[116:119], a[132:135], v[196:199]
    s_add_u32 m0, s32, 38912
    v_mfma_f32_16x16x32_bf16 v[200:203], a[116:119], a[136:139], v[200:203]
    buffer_load_dwordx4 v3, s[4:7], s23 offen lds
    v_mfma_f32_16x16x32_bf16 v[204:207], a[116:119], a[140:143], v[204:207]
    v_mfma_f32_16x16x32_bf16 v[208:211], a[116:119], a[144:147], v[208:211]
    v_mfma_f32_16x16x32_bf16 v[212:215], a[116:119], a[148:151], v[212:215]
    s_add_u32 m0, s32, 39936
    v_mfma_f32_16x16x32_bf16 v[216:219], a[116:119], a[152:155], v[216:219]
    buffer_load_dwordx4 v4, s[4:7], s23 offen lds
    v_mfma_f32_16x16x32_bf16 v[220:223], a[116:119], a[156:159], v[220:223]
    v_mfma_f32_16x16x32_bf16 v[224:227], a[120:123], a[128:131], v[224:227]
    v_mfma_f32_16x16x32_bf16 v[228:231], a[120:123], a[132:135], v[228:231]
    v_mfma_f32_16x16x32_bf16 v[232:235], a[120:123], a[136:139], v[232:235]
    v_mfma_f32_16x16x32_bf16 v[236:239], a[120:123], a[140:143], v[236:239]
    v_mfma_f32_16x16x32_bf16 v[240:243], a[120:123], a[144:147], v[240:243]
    v_mfma_f32_16x16x32_bf16 v[244:247], a[120:123], a[148:151], v[244:247]
    v_mfma_f32_16x16x32_bf16 v[248:251], a[120:123], a[152:155], v[248:251]
    v_mfma_f32_16x16x32_bf16 v[252:255], a[120:123], a[156:159], v[252:255]
    v_mfma_f32_16x16x32_bf16 a[0:3], a[124:127], a[128:131], a[0:3]
    v_mfma_f32_16x16x32_bf16 a[4:7], a[124:127], a[132:135], a[4:7]
    v_mfma_f32_16x16x32_bf16 a[8:11], a[124:127], a[136:139], a[8:11]
    v_mfma_f32_16x16x32_bf16 a[12:15], a[124:127], a[140:143], a[12:15]
    v_mfma_f32_16x16x32_bf16 a[16:19], a[124:127], a[144:147], a[16:19]
    v_mfma_f32_16x16x32_bf16 a[20:23], a[124:127], a[148:151], a[20:23]
    v_mfma_f32_16x16x32_bf16 a[24:27], a[124:127], a[152:155], a[24:27]
    s_add_u32 s4, s4, 128
    s_addc_u32 s5, s5, 0
    v_mfma_f32_16x16x32_bf16 a[28:31], a[124:127], a[156:159], a[28:31]
    s_waitcnt vmcnt(16) lgkmcnt(0)
    s_barrier
    v_mfma_f32_16x16x32_bf16 v[32:35], a[32:35], a[64:67], v[32:35]
    ds_read_b64_tr_b16 a[128:129], v5 offset:4096
    v_mfma_f32_16x16x32_bf16 v[36:39], a[32:35], a[68:71], v[36:39]
    ds_read_b64_tr_b16 a[130:131], v5 offset:5120
    s_add_u32 m0, s33, 36864
    v_mfma_f32_16x16x32_bf16 v[40:43], a[32:35], a[72:75], v[40:43]
    ds_read_b128 a[96:99], v11 offset:0
    buffer_load_dwordx4 v9, s[8:11], s28 offen lds
    v_mfma_f32_16x16x32_bf16 v[44:47], a[32:35], a[76:79], v[44:47]
    ds_read_b64_tr_b16 a[132:133], v6 offset:4096
    v_mfma_f32_16x16x32_bf16 v[48:51], a[32:35], a[80:83], v[48:51]
    ds_read_b64_tr_b16 a[134:135], v6 offset:5120
    v_mfma_f32_16x16x32_bf16 v[52:55], a[32:35], a[84:87], v[52:55]
    ds_read_b128 a[100:103], v11 offset:2048
    v_mfma_f32_16x16x32_bf16 v[56:59], a[32:35], a[88:91], v[56:59]
    ds_read_b64_tr_b16 a[136:137], v7 offset:4096
    v_mfma_f32_16x16x32_bf16 v[60:63], a[32:35], a[92:95], v[60:63]
    ds_read_b64_tr_b16 a[138:139], v7 offset:5120
    v_mfma_f32_16x16x32_bf16 v[64:67], a[36:39], a[64:67], v[64:67]
    ds_read_b128 a[104:107], v11 offset:4096
    v_mfma_f32_16x16x32_bf16 v[68:71], a[36:39], a[68:71], v[68:71]
    ds_read_b64_tr_b16 a[140:141], v8 offset:4096
    s_add_u32 m0, s33, 37888
    v_mfma_f32_16x16x32_bf16 v[72:75], a[36:39], a[72:75], v[72:75]
    ds_read_b64_tr_b16 a[142:143], v8 offset:5120
    buffer_load_dwordx4 v9, s[8:11], s29 offen lds
    v_mfma_f32_16x16x32_bf16 v[76:79], a[36:39], a[76:79], v[76:79]
    ds_read_b128 a[108:111], v11 offset:6144
    v_mfma_f32_16x16x32_bf16 v[80:83], a[36:39], a[80:83], v[80:83]
    ds_read_b64_tr_b16 a[144:145], v5 offset:12288
    v_mfma_f32_16x16x32_bf16 v[84:87], a[36:39], a[84:87], v[84:87]
    ds_read_b64_tr_b16 a[146:147], v5 offset:13312
    v_mfma_f32_16x16x32_bf16 v[88:91], a[36:39], a[88:91], v[88:91]
    ds_read_b128 a[112:115], v11 offset:8192
    v_mfma_f32_16x16x32_bf16 v[92:95], a[36:39], a[92:95], v[92:95]
    ds_read_b64_tr_b16 a[148:149], v6 offset:12288
    v_mfma_f32_16x16x32_bf16 v[96:99], a[40:43], a[64:67], v[96:99]
    ds_read_b64_tr_b16 a[150:151], v6 offset:13312
    v_mfma_f32_16x16x32_bf16 v[100:103], a[40:43], a[68:71], v[100:103]
    ds_read_b128 a[116:119], v11 offset:10240
    s_add_u32 m0, s33, 38912
    v_mfma_f32_16x16x32_bf16 v[104:107], a[40:43], a[72:75], v[104:107]
    ds_read_b64_tr_b16 a[152:153], v7 offset:12288
    buffer_load_dwordx4 v9, s[8:11], s30 offen lds
    v_mfma_f32_16x16x32_bf16 v[108:111], a[40:43], a[76:79], v[108:111]
    ds_read_b64_tr_b16 a[154:155], v7 offset:13312
    v_mfma_f32_16x16x32_bf16 v[112:115], a[40:43], a[80:83], v[112:115]
    ds_read_b128 a[120:123], v11 offset:12288
    v_mfma_f32_16x16x32_bf16 v[116:119], a[40:43], a[84:87], v[116:119]
    ds_read_b64_tr_b16 a[156:157], v8 offset:12288
    v_mfma_f32_16x16x32_bf16 v[120:123], a[40:43], a[88:91], v[120:123]
    ds_read_b64_tr_b16 a[158:159], v8 offset:13312
    v_mfma_f32_16x16x32_bf16 v[124:127], a[40:43], a[92:95], v[124:127]
    ds_read_b128 a[124:127], v11 offset:14336
    v_mfma_f32_16x16x32_bf16 v[128:131], a[44:47], a[64:67], v[128:131]
    v_mfma_f32_16x16x32_bf16 v[132:135], a[44:47], a[68:71], v[132:135]
    s_add_u32 m0, s33, 39936
    v_mfma_f32_16x16x32_bf16 v[136:139], a[44:47], a[72:75], v[136:139]
    buffer_load_dwordx4 v9, s[8:11], s31 offen lds
    v_mfma_f32_16x16x32_bf16 v[140:143], a[44:47], a[76:79], v[140:143]
    v_mfma_f32_16x16x32_bf16 v[144:147], a[44:47], a[80:83], v[144:147]
    v_mfma_f32_16x16x32_bf16 v[148:151], a[44:47], a[84:87], v[148:151]
    v_mfma_f32_16x16x32_bf16 v[152:155], a[44:47], a[88:91], v[152:155]
    s_add_u32 s8, s8, 524288
    s_addc_u32 s9, s9, 0
    v_mfma_f32_16x16x32_bf16 v[156:159], a[44:47], a[92:95], v[156:159]
    v_mfma_f32_16x16x32_bf16 v[160:163], a[48:51], a[64:67], v[160:163]
    s_add_u32 m0, s60, 131072
    s_mov_b32 s61, 0
    v_mfma_f32_16x16x32_bf16 v[164:167], a[48:51], a[68:71], v[164:167]
    buffer_load_dwordx4 v30, s[52:55], s61 offen lds
    v_mfma_f32_16x16x32_bf16 v[168:171], a[48:51], a[72:75], v[168:171]
    s_mov_b32 s38, 0x1c0000
    s_mov_b32 s39, 0x00020000
    s_lshl_b32 s34, s2, 13
    s_add_u32 s34, s34, 4096
    v_mfma_f32_16x16x32_bf16 v[172:175], a[48:51], a[76:79], v[172:175]
    buffer_load_dwordx4 a[252:255], v23, s[36:39], s34 offen
    v_mfma_f32_16x16x32_bf16 v[176:179], a[48:51], a[80:83], v[176:179]
    v_mfma_f32_16x16x32_bf16 v[180:183], a[48:51], a[84:87], v[180:183]
    v_mfma_f32_16x16x32_bf16 v[184:187], a[48:51], a[88:91], v[184:187]
    v_mfma_f32_16x16x32_bf16 v[188:191], a[48:51], a[92:95], v[188:191]
    v_mfma_f32_16x16x32_bf16 v[192:195], a[52:55], a[64:67], v[192:195]
    s_add_u32 m0, s60, 132096
    s_mov_b32 s61, 8192
    v_mfma_f32_16x16x32_bf16 v[196:199], a[52:55], a[68:71], v[196:199]
    buffer_load_dwordx4 v30, s[52:55], s61 offen lds
    v_mfma_f32_16x16x32_bf16 v[200:203], a[52:55], a[72:75], v[200:203]
    s_mov_b32 s50, 0x1c0000
    s_mov_b32 s51, 0x00020000
    s_lshl_b32 s34, s2, 13
    v_mfma_f32_16x16x32_bf16 v[204:207], a[52:55], a[76:79], v[204:207]
    buffer_load_dwordx4 a[252:255], v23, s[48:51], s34 offen
    v_mfma_f32_16x16x32_bf16 v[208:211], a[52:55], a[80:83], v[208:211]
    v_mfma_f32_16x16x32_bf16 v[212:215], a[52:55], a[84:87], v[212:215]
    v_mfma_f32_16x16x32_bf16 v[216:219], a[52:55], a[88:91], v[216:219]
    v_mfma_f32_16x16x32_bf16 v[220:223], a[52:55], a[92:95], v[220:223]
    v_mfma_f32_16x16x32_bf16 v[224:227], a[56:59], a[64:67], v[224:227]
    s_add_u32 m0, s60, 133120
    s_mov_b32 s61, 16384
    v_mfma_f32_16x16x32_bf16 v[228:231], a[56:59], a[68:71], v[228:231]
    buffer_load_dwordx4 v30, s[52:55], s61 offen lds
    v_mfma_f32_16x16x32_bf16 v[232:235], a[56:59], a[72:75], v[232:235]
    s_lshl_b32 s34, s2, 13
    s_add_u32 s34, s34, 4096
    v_mfma_f32_16x16x32_bf16 v[236:239], a[56:59], a[76:79], v[236:239]
    buffer_load_dwordx4 a[252:255], v23, s[48:51], s34 offen
    v_mfma_f32_16x16x32_bf16 v[240:243], a[56:59], a[80:83], v[240:243]
    v_mfma_f32_16x16x32_bf16 v[244:247], a[56:59], a[84:87], v[244:247]
    v_mfma_f32_16x16x32_bf16 v[248:251], a[56:59], a[88:91], v[248:251]
    v_mfma_f32_16x16x32_bf16 v[252:255], a[56:59], a[92:95], v[252:255]
    v_mfma_f32_16x16x32_bf16 a[0:3], a[60:63], a[64:67], a[0:3]
    s_add_u32 m0, s60, 134144
    s_mov_b32 s61, 24576
    v_mfma_f32_16x16x32_bf16 a[4:7], a[60:63], a[68:71], a[4:7]
    buffer_load_dwordx4 v30, s[52:55], s61 offen lds
    v_mfma_f32_16x16x32_bf16 a[8:11], a[60:63], a[72:75], a[8:11]
    v_mfma_f32_16x16x32_bf16 a[12:15], a[60:63], a[76:79], a[12:15]
    v_mfma_f32_16x16x32_bf16 a[16:19], a[60:63], a[80:83], a[16:19]
    v_mfma_f32_16x16x32_bf16 a[20:23], a[60:63], a[84:87], a[20:23]
    v_mfma_f32_16x16x32_bf16 a[24:27], a[60:63], a[88:91], a[24:27]
    v_mfma_f32_16x16x32_bf16 a[28:31], a[60:63], a[92:95], a[28:31]
    s_waitcnt vmcnt(11) lgkmcnt(0)
    s_barrier
    v_mfma_f32_16x16x32_bf16 v[32:35], a[96:99], a[128:131], v[32:35]
    ds_read_b64_tr_b16 a[64:65], v5 offset:32768
    v_mfma_f32_16x16x32_bf16 v[36:39], a[96:99], a[132:135], v[36:39]
    ds_read_b64_tr_b16 a[66:67], v5 offset:33792
    s_add_u32 m0, s32, 0
    v_mfma_f32_16x16x32_bf16 v[40:43], a[96:99], a[136:139], v[40:43]
    ds_read_b128 a[32:35], v10 offset:32768
    buffer_load_dwordx4 v3, s[4:7], s20 offen lds
    v_mfma_f32_16x16x32_bf16 v[44:47], a[96:99], a[140:143], v[44:47]
    ds_read_b64_tr_b16 a[68:69], v6 offset:32768
    v_mfma_f32_16x16x32_bf16 v[48:51], a[96:99], a[144:147], v[48:51]
    ds_read_b64_tr_b16 a[70:71], v6 offset:33792
    v_mfma_f32_16x16x32_bf16 v[52:55], a[96:99], a[148:151], v[52:55]
    ds_read_b128 a[36:39], v10 offset:34816
    s_add_u32 m0, s33, 0
    v_mfma_f32_16x16x32_bf16 v[56:59], a[96:99], a[152:155], v[56:59]
    ds_read_b64_tr_b16 a[72:73], v7 offset:32768
    buffer_load_dwordx4 v9, s[8:11], s24 offen lds
    v_mfma_f32_16x16x32_bf16 v[60:63], a[96:99], a[156:159], v[60:63]
    ds_read_b64_tr_b16 a[74:75], v7 offset:33792
    v_mfma_f32_16x16x32_bf16 v[64:67], a[100:103], a[128:131], v[64:67]
    ds_read_b128 a[40:43], v10 offset:36864
    v_mfma_f32_16x16x32_bf16 v[68:71], a[100:103], a[132:135], v[68:71]
    ds_read_b64_tr_b16 a[76:77], v8 offset:32768
    s_add_u32 m0, s32, 1024
    v_mfma_f32_16x16x32_bf16 v[72:75], a[100:103], a[136:139], v[72:75]
    ds_read_b64_tr_b16 a[78:79], v8 offset:33792
    buffer_load_dwordx4 v4, s[4:7], s20 offen lds
    v_mfma_f32_16x16x32_bf16 v[76:79], a[100:103], a[140:143], v[76:79]
    ds_read_b128 a[44:47], v10 offset:38912
    v_mfma_f32_16x16x32_bf16 v[80:83], a[100:103], a[144:147], v[80:83]
    ds_read_b64_tr_b16 a[80:81], v5 offset:40960
    v_mfma_f32_16x16x32_bf16 v[84:87], a[100:103], a[148:151], v[84:87]
    ds_read_b64_tr_b16 a[82:83], v5 offset:41984
    s_add_u32 m0, s33, 1024
    v_mfma_f32_16x16x32_bf16 v[88:91], a[100:103], a[152:155], v[88:91]
    ds_read_b128 a[48:51], v10 offset:40960
    buffer_load_dwordx4 v9, s[8:11], s25 offen lds
    v_mfma_f32_16x16x32_bf16 v[92:95], a[100:103], a[156:159], v[92:95]
    ds_read_b64_tr_b16 a[84:85], v6 offset:40960
    v_mfma_f32_16x16x32_bf16 v[96:99], a[104:107], a[128:131], v[96:99]
    ds_read_b64_tr_b16 a[86:87], v6 offset:41984
    v_mfma_f32_16x16x32_bf16 v[100:103], a[104:107], a[132:135], v[100:103]
    ds_read_b128 a[52:55], v10 offset:43008
    s_add_u32 m0, s32, 2048
    v_mfma_f32_16x16x32_bf16 v[104:107], a[104:107], a[136:139], v[104:107]
    ds_read_b64_tr_b16 a[88:89], v7 offset:40960
    buffer_load_dwordx4 v3, s[4:7], s21 offen lds
    v_mfma_f32_16x16x32_bf16 v[108:111], a[104:107], a[140:143], v[108:111]
    ds_read_b64_tr_b16 a[90:91], v7 offset:41984
    v_mfma_f32_16x16x32_bf16 v[112:115], a[104:107], a[144:147], v[112:115]
    ds_read_b128 a[56:59], v10 offset:45056
    v_mfma_f32_16x16x32_bf16 v[116:119], a[104:107], a[148:151], v[116:119]
    ds_read_b64_tr_b16 a[92:93], v8 offset:40960
    s_add_u32 m0, s33, 2048
    v_mfma_f32_16x16x32_bf16 v[120:123], a[104:107], a[152:155], v[120:123]
    ds_read_b64_tr_b16 a[94:95], v8 offset:41984
    buffer_load_dwordx4 v9, s[8:11], s26 offen lds
    v_mfma_f32_16x16x32_bf16 v[124:127], a[104:107], a[156:159], v[124:127]
    ds_read_b128 a[60:63], v10 offset:47104
    v_mfma_f32_16x16x32_bf16 v[128:131], a[108:111], a[128:131], v[128:131]
    v_mfma_f32_16x16x32_bf16 v[132:135], a[108:111], a[132:135], v[132:135]
    s_add_u32 m0, s32, 3072
    v_mfma_f32_16x16x32_bf16 v[136:139], a[108:111], a[136:139], v[136:139]
    buffer_load_dwordx4 v4, s[4:7], s21 offen lds
    v_mfma_f32_16x16x32_bf16 v[140:143], a[108:111], a[140:143], v[140:143]
    v_mfma_f32_16x16x32_bf16 v[144:147], a[108:111], a[144:147], v[144:147]
    v_mfma_f32_16x16x32_bf16 v[148:151], a[108:111], a[148:151], v[148:151]
    s_add_u32 m0, s33, 3072
    v_mfma_f32_16x16x32_bf16 v[152:155], a[108:111], a[152:155], v[152:155]
    s_load_dwordx2 s[36:37], s[0:1], 40
    buffer_load_dwordx4 v9, s[8:11], s27 offen lds
    v_mfma_f32_16x16x32_bf16 v[156:159], a[108:111], a[156:159], v[156:159]
    v_mfma_f32_16x16x32_bf16 v[160:163], a[112:115], a[128:131], v[160:163]
    v_mfma_f32_16x16x32_bf16 v[164:167], a[112:115], a[132:135], v[164:167]
    s_add_u32 m0, s32, 4096
    v_mfma_f32_16x16x32_bf16 v[168:171], a[112:115], a[136:139], v[168:171]
    buffer_load_dwordx4 v3, s[4:7], s22 offen lds
    v_mfma_f32_16x16x32_bf16 v[172:175], a[112:115], a[140:143], v[172:175]
    v_mfma_f32_16x16x32_bf16 v[176:179], a[112:115], a[144:147], v[176:179]
    v_mfma_f32_16x16x32_bf16 v[180:183], a[112:115], a[148:151], v[180:183]
    s_add_u32 m0, s32, 5120
    v_mfma_f32_16x16x32_bf16 v[184:187], a[112:115], a[152:155], v[184:187]
    buffer_load_dwordx4 v4, s[4:7], s22 offen lds
    v_mfma_f32_16x16x32_bf16 v[188:191], a[112:115], a[156:159], v[188:191]
    v_mfma_f32_16x16x32_bf16 v[192:195], a[116:119], a[128:131], v[192:195]
    v_mfma_f32_16x16x32_bf16 v[196:199], a[116:119], a[132:135], v[196:199]
    s_add_u32 m0, s32, 6144
    v_mfma_f32_16x16x32_bf16 v[200:203], a[116:119], a[136:139], v[200:203]
    buffer_load_dwordx4 v3, s[4:7], s23 offen lds
    v_mfma_f32_16x16x32_bf16 v[204:207], a[116:119], a[140:143], v[204:207]
    v_mfma_f32_16x16x32_bf16 v[208:211], a[116:119], a[144:147], v[208:211]
    v_mfma_f32_16x16x32_bf16 v[212:215], a[116:119], a[148:151], v[212:215]
    s_add_u32 m0, s32, 7168
    v_mfma_f32_16x16x32_bf16 v[216:219], a[116:119], a[152:155], v[216:219]
    buffer_load_dwordx4 v4, s[4:7], s23 offen lds
    v_mfma_f32_16x16x32_bf16 v[220:223], a[116:119], a[156:159], v[220:223]
    v_mfma_f32_16x16x32_bf16 v[224:227], a[120:123], a[128:131], v[224:227]
    v_mfma_f32_16x16x32_bf16 v[228:231], a[120:123], a[132:135], v[228:231]
    v_mfma_f32_16x16x32_bf16 v[232:235], a[120:123], a[136:139], v[232:235]
    v_mfma_f32_16x16x32_bf16 v[236:239], a[120:123], a[140:143], v[236:239]
    v_mfma_f32_16x16x32_bf16 v[240:243], a[120:123], a[144:147], v[240:243]
    v_mfma_f32_16x16x32_bf16 v[244:247], a[120:123], a[148:151], v[244:247]
    v_mfma_f32_16x16x32_bf16 v[248:251], a[120:123], a[152:155], v[248:251]
    v_mfma_f32_16x16x32_bf16 v[252:255], a[120:123], a[156:159], v[252:255]
    v_mfma_f32_16x16x32_bf16 a[0:3], a[124:127], a[128:131], a[0:3]
    v_mfma_f32_16x16x32_bf16 a[4:7], a[124:127], a[132:135], a[4:7]
    v_mfma_f32_16x16x32_bf16 a[8:11], a[124:127], a[136:139], a[8:11]
    v_mfma_f32_16x16x32_bf16 a[12:15], a[124:127], a[140:143], a[12:15]
    v_mfma_f32_16x16x32_bf16 a[16:19], a[124:127], a[144:147], a[16:19]
    v_mfma_f32_16x16x32_bf16 a[20:23], a[124:127], a[148:151], a[20:23]
    v_mfma_f32_16x16x32_bf16 a[24:27], a[124:127], a[152:155], a[24:27]
    s_add_u32 s4, s4, 128
    s_addc_u32 s5, s5, 0
    v_mfma_f32_16x16x32_bf16 a[28:31], a[124:127], a[156:159], a[28:31]
    s_waitcnt vmcnt(19) lgkmcnt(0)
    s_barrier
    v_mfma_f32_16x16x32_bf16 v[32:35], a[32:35], a[64:67], v[32:35]
    ds_read_b64_tr_b16 a[128:129], v5 offset:36864
    v_mfma_f32_16x16x32_bf16 v[36:39], a[32:35], a[68:71], v[36:39]
    ds_read_b64_tr_b16 a[130:131], v5 offset:37888
    s_add_u32 m0, s33, 4096
    v_mfma_f32_16x16x32_bf16 v[40:43], a[32:35], a[72:75], v[40:43]
    ds_read_b128 a[96:99], v11 offset:32768
    buffer_load_dwordx4 v9, s[8:11], s28 offen lds
    v_mfma_f32_16x16x32_bf16 v[44:47], a[32:35], a[76:79], v[44:47]
    ds_read_b64_tr_b16 a[132:133], v6 offset:36864
    v_mfma_f32_16x16x32_bf16 v[48:51], a[32:35], a[80:83], v[48:51]
    ds_read_b64_tr_b16 a[134:135], v6 offset:37888
    v_mfma_f32_16x16x32_bf16 v[52:55], a[32:35], a[84:87], v[52:55]
    ds_read_b128 a[100:103], v11 offset:34816
    v_mfma_f32_16x16x32_bf16 v[56:59], a[32:35], a[88:91], v[56:59]
    ds_read_b64_tr_b16 a[136:137], v7 offset:36864
    v_mfma_f32_16x16x32_bf16 v[60:63], a[32:35], a[92:95], v[60:63]
    ds_read_b64_tr_b16 a[138:139], v7 offset:37888
    v_mfma_f32_16x16x32_bf16 v[64:67], a[36:39], a[64:67], v[64:67]
    ds_read_b128 a[104:107], v11 offset:36864
    v_mfma_f32_16x16x32_bf16 v[68:71], a[36:39], a[68:71], v[68:71]
    ds_read_b64_tr_b16 a[140:141], v8 offset:36864
    s_add_u32 m0, s33, 5120
    v_mfma_f32_16x16x32_bf16 v[72:75], a[36:39], a[72:75], v[72:75]
    ds_read_b64_tr_b16 a[142:143], v8 offset:37888
    buffer_load_dwordx4 v9, s[8:11], s29 offen lds
    v_mfma_f32_16x16x32_bf16 v[76:79], a[36:39], a[76:79], v[76:79]
    ds_read_b128 a[108:111], v11 offset:38912
    v_mfma_f32_16x16x32_bf16 v[80:83], a[36:39], a[80:83], v[80:83]
    ds_read_b64_tr_b16 a[144:145], v5 offset:45056
    v_mfma_f32_16x16x32_bf16 v[84:87], a[36:39], a[84:87], v[84:87]
    ds_read_b64_tr_b16 a[146:147], v5 offset:46080
    v_mfma_f32_16x16x32_bf16 v[88:91], a[36:39], a[88:91], v[88:91]
    ds_read_b128 a[112:115], v11 offset:40960
    v_mfma_f32_16x16x32_bf16 v[92:95], a[36:39], a[92:95], v[92:95]
    ds_read_b64_tr_b16 a[148:149], v6 offset:45056
    v_mfma_f32_16x16x32_bf16 v[96:99], a[40:43], a[64:67], v[96:99]
    ds_read_b64_tr_b16 a[150:151], v6 offset:46080
    v_mfma_f32_16x16x32_bf16 v[100:103], a[40:43], a[68:71], v[100:103]
    ds_read_b128 a[116:119], v11 offset:43008
    s_add_u32 m0, s33, 6144
    v_mfma_f32_16x16x32_bf16 v[104:107], a[40:43], a[72:75], v[104:107]
    ds_read_b64_tr_b16 a[152:153], v7 offset:45056
    buffer_load_dwordx4 v9, s[8:11], s30 offen lds
    v_mfma_f32_16x16x32_bf16 v[108:111], a[40:43], a[76:79], v[108:111]
    ds_read_b64_tr_b16 a[154:155], v7 offset:46080
    v_mfma_f32_16x16x32_bf16 v[112:115], a[40:43], a[80:83], v[112:115]
    ds_read_b128 a[120:123], v11 offset:45056
    v_mfma_f32_16x16x32_bf16 v[116:119], a[40:43], a[84:87], v[116:119]
    ds_read_b64_tr_b16 a[156:157], v8 offset:45056
    v_mfma_f32_16x16x32_bf16 v[120:123], a[40:43], a[88:91], v[120:123]
    ds_read_b64_tr_b16 a[158:159], v8 offset:46080
    v_mfma_f32_16x16x32_bf16 v[124:127], a[40:43], a[92:95], v[124:127]
    ds_read_b128 a[124:127], v11 offset:47104
    v_mfma_f32_16x16x32_bf16 v[128:131], a[44:47], a[64:67], v[128:131]
    v_mfma_f32_16x16x32_bf16 v[132:135], a[44:47], a[68:71], v[132:135]
    s_add_u32 m0, s33, 7168
    v_mfma_f32_16x16x32_bf16 v[136:139], a[44:47], a[72:75], v[136:139]
    buffer_load_dwordx4 v9, s[8:11], s31 offen lds
    v_mfma_f32_16x16x32_bf16 v[140:143], a[44:47], a[76:79], v[140:143]
    v_mfma_f32_16x16x32_bf16 v[144:147], a[44:47], a[80:83], v[144:147]
    v_mfma_f32_16x16x32_bf16 v[148:151], a[44:47], a[84:87], v[148:151]
    v_mfma_f32_16x16x32_bf16 v[152:155], a[44:47], a[88:91], v[152:155]
    s_add_u32 s8, s8, 524288
    s_addc_u32 s9, s9, 0
    v_mfma_f32_16x16x32_bf16 v[156:159], a[44:47], a[92:95], v[156:159]
    v_mfma_f32_16x16x32_bf16 v[160:163], a[48:51], a[64:67], v[160:163]
    s_add_u32 m0, s60, 147456
    s_mov_b32 s61, 131072
    v_mfma_f32_16x16x32_bf16 v[164:167], a[48:51], a[68:71], v[164:167]
    buffer_load_dwordx4 v30, s[52:55], s61 offen lds
    v_mfma_f32_16x16x32_bf16 v[168:171], a[48:51], a[72:75], v[168:171]
    s_mov_b32 s38, 0x400000
    s_mov_b32 s39, 0x00020000
    s_lshl_b32 s34, s2, 14
    v_mfma_f32_16x16x32_bf16 v[172:175], a[48:51], a[76:79], v[172:175]
    buffer_load_dwordx4 a[252:255], v23, s[36:39], s34 offen
    v_mfma_f32_16x16x32_bf16 v[176:179], a[48:51], a[80:83], v[176:179]
    v_mfma_f32_16x16x32_bf16 v[180:183], a[48:51], a[84:87], v[180:183]
    v_mfma_f32_16x16x32_bf16 v[184:187], a[48:51], a[88:91], v[184:187]
    v_mfma_f32_16x16x32_bf16 v[188:191], a[48:51], a[92:95], v[188:191]
    v_mfma_f32_16x16x32_bf16 v[192:195], a[52:55], a[64:67], v[192:195]
    s_add_u32 m0, s60, 148480
    s_mov_b32 s61, 139264
    v_mfma_f32_16x16x32_bf16 v[196:199], a[52:55], a[68:71], v[196:199]
    buffer_load_dwordx4 v30, s[52:55], s61 offen lds
    v_mfma_f32_16x16x32_bf16 v[200:203], a[52:55], a[72:75], v[200:203]
    s_lshl_b32 s34, s2, 14
    s_add_u32 s34, s34, 4096
    v_mfma_f32_16x16x32_bf16 v[204:207], a[52:55], a[76:79], v[204:207]
    buffer_load_dwordx4 a[252:255], v23, s[36:39], s34 offen
    v_mfma_f32_16x16x32_bf16 v[208:211], a[52:55], a[80:83], v[208:211]
    v_mfma_f32_16x16x32_bf16 v[212:215], a[52:55], a[84:87], v[212:215]
    v_mfma_f32_16x16x32_bf16 v[216:219], a[52:55], a[88:91], v[216:219]
    v_mfma_f32_16x16x32_bf16 v[220:223], a[52:55], a[92:95], v[220:223]
    v_mfma_f32_16x16x32_bf16 v[224:227], a[56:59], a[64:67], v[224:227]
    s_add_u32 m0, s60, 149504
    s_mov_b32 s61, 147456
    v_mfma_f32_16x16x32_bf16 v[228:231], a[56:59], a[68:71], v[228:231]
    buffer_load_dwordx4 v30, s[52:55], s61 offen lds
    v_mfma_f32_16x16x32_bf16 v[232:235], a[56:59], a[72:75], v[232:235]
    v_mfma_f32_16x16x32_bf16 v[236:239], a[56:59], a[76:79], v[236:239]
    v_mfma_f32_16x16x32_bf16 v[240:243], a[56:59], a[80:83], v[240:243]
    v_mfma_f32_16x16x32_bf16 v[244:247], a[56:59], a[84:87], v[244:247]
    v_mfma_f32_16x16x32_bf16 v[248:251], a[56:59], a[88:91], v[248:251]
    v_mfma_f32_16x16x32_bf16 v[252:255], a[56:59], a[92:95], v[252:255]
    v_mfma_f32_16x16x32_bf16 a[0:3], a[60:63], a[64:67], a[0:3]
    s_add_u32 m0, s60, 150528
    s_mov_b32 s61, 155648
    v_mfma_f32_16x16x32_bf16 a[4:7], a[60:63], a[68:71], a[4:7]
    buffer_load_dwordx4 v30, s[52:55], s61 offen lds
    v_mfma_f32_16x16x32_bf16 a[8:11], a[60:63], a[72:75], a[8:11]
    v_mfma_f32_16x16x32_bf16 a[12:15], a[60:63], a[76:79], a[12:15]
    v_mfma_f32_16x16x32_bf16 a[16:19], a[60:63], a[80:83], a[16:19]
    v_mfma_f32_16x16x32_bf16 a[20:23], a[60:63], a[84:87], a[20:23]
    v_mfma_f32_16x16x32_bf16 a[24:27], a[60:63], a[88:91], a[24:27]
    v_mfma_f32_16x16x32_bf16 a[28:31], a[60:63], a[92:95], a[28:31]
    s_waitcnt vmcnt(10) lgkmcnt(0)
    s_barrier
    v_mov_b32 v31, 0
    v_mfma_f32_16x16x32_bf16 v[32:35], a[96:99], a[128:131], v[32:35]
    ds_read_b64_tr_b16 a[64:65], v5 offset:0
    buffer_load_dword v31, v31, s[84:87], s88 offen sc1
    v_mfma_f32_16x16x32_bf16 v[36:39], a[96:99], a[132:135], v[36:39]
    ds_read_b64_tr_b16 a[66:67], v5 offset:1024
    s_add_u32 m0, s32, 32768
    v_mfma_f32_16x16x32_bf16 v[40:43], a[96:99], a[136:139], v[40:43]
    ds_read_b128 a[32:35], v10 offset:0
    buffer_load_dwordx4 v3, s[4:7], s20 offen lds
    v_mfma_f32_16x16x32_bf16 v[44:47], a[96:99], a[140:143], v[44:47]
    ds_read_b64_tr_b16 a[68:69], v6 offset:0
    v_mfma_f32_16x16x32_bf16 v[48:51], a[96:99], a[144:147], v[48:51]
    ds_read_b64_tr_b16 a[70:71], v6 offset:1024
    v_mfma_f32_16x16x32_bf16 v[52:55], a[96:99], a[148:151], v[52:55]
    ds_read_b128 a[36:39], v10 offset:2048
    s_add_u32 m0, s33, 32768
    v_mfma_f32_16x16x32_bf16 v[56:59], a[96:99], a[152:155], v[56:59]
    ds_read_b64_tr_b16 a[72:73], v7 offset:0
    buffer_load_dwordx4 v9, s[8:11], s24 offen lds
    v_mfma_f32_16x16x32_bf16 v[60:63], a[96:99], a[156:159], v[60:63]
    ds_read_b64_tr_b16 a[74:75], v7 offset:1024
    v_mfma_f32_16x16x32_bf16 v[64:67], a[100:103], a[128:131], v[64:67]
    ds_read_b128 a[40:43], v10 offset:4096
    v_mfma_f32_16x16x32_bf16 v[68:71], a[100:103], a[132:135], v[68:71]
    ds_read_b64_tr_b16 a[76:77], v8 offset:0
    s_add_u32 m0, s32, 33792
    v_mfma_f32_16x16x32_bf16 v[72:75], a[100:103], a[136:139], v[72:75]
    ds_read_b64_tr_b16 a[78:79], v8 offset:1024
    buffer_load_dwordx4 v4, s[4:7], s20 offen lds
    v_mfma_f32_16x16x32_bf16 v[76:79], a[100:103], a[140:143], v[76:79]
    ds_read_b128 a[44:47], v10 offset:6144
    v_mfma_f32_16x16x32_bf16 v[80:83], a[100:103], a[144:147], v[80:83]
    ds_read_b64_tr_b16 a[80:81], v5 offset:8192
    v_mfma_f32_16x16x32_bf16 v[84:87], a[100:103], a[148:151], v[84:87]
    ds_read_b64_tr_b16 a[82:83], v5 offset:9216
    s_add_u32 m0, s33, 33792
    v_mfma_f32_16x16x32_bf16 v[88:91], a[100:103], a[152:155], v[88:91]
    ds_read_b128 a[48:51], v10 offset:8192
    buffer_load_dwordx4 v9, s[8:11], s25 offen lds
    v_mfma_f32_16x16x32_bf16 v[92:95], a[100:103], a[156:159], v[92:95]
    ds_read_b64_tr_b16 a[84:85], v6 offset:8192
    v_mfma_f32_16x16x32_bf16 v[96:99], a[104:107], a[128:131], v[96:99]
    ds_read_b64_tr_b16 a[86:87], v6 offset:9216
    v_mfma_f32_16x16x32_bf16 v[100:103], a[104:107], a[132:135], v[100:103]
    ds_read_b128 a[52:55], v10 offset:10240
    s_add_u32 m0, s32, 34816
    v_mfma_f32_16x16x32_bf16 v[104:107], a[104:107], a[136:139], v[104:107]
    ds_read_b64_tr_b16 a[88:89], v7 offset:8192
    buffer_load_dwordx4 v3, s[4:7], s21 offen lds
    v_mfma_f32_16x16x32_bf16 v[108:111], a[104:107], a[140:143], v[108:111]
    ds_read_b64_tr_b16 a[90:91], v7 offset:9216
    v_mfma_f32_16x16x32_bf16 v[112:115], a[104:107], a[144:147], v[112:115]
    ds_read_b128 a[56:59], v10 offset:12288
    v_mfma_f32_16x16x32_bf16 v[116:119], a[104:107], a[148:151], v[116:119]
    ds_read_b64_tr_b16 a[92:93], v8 offset:8192
    s_add_u32 m0, s33, 34816
    v_mfma_f32_16x16x32_bf16 v[120:123], a[104:107], a[152:155], v[120:123]
    ds_read_b64_tr_b16 a[94:95], v8 offset:9216
    buffer_load_dwordx4 v9, s[8:11], s26 offen lds
    v_mfma_f32_16x16x32_bf16 v[124:127], a[104:107], a[156:159], v[124:127]
    ds_read_b128 a[60:63], v10 offset:14336
    v_mfma_f32_16x16x32_bf16 v[128:131], a[108:111], a[128:131], v[128:131]
    v_mfma_f32_16x16x32_bf16 v[132:135], a[108:111], a[132:135], v[132:135]
    s_add_u32 m0, s32, 35840
    v_mfma_f32_16x16x32_bf16 v[136:139], a[108:111], a[136:139], v[136:139]
    buffer_load_dwordx4 v4, s[4:7], s21 offen lds
    v_mfma_f32_16x16x32_bf16 v[140:143], a[108:111], a[140:143], v[140:143]
    v_mfma_f32_16x16x32_bf16 v[144:147], a[108:111], a[144:147], v[144:147]
    v_mfma_f32_16x16x32_bf16 v[148:151], a[108:111], a[148:151], v[148:151]
    s_add_u32 m0, s33, 35840
    v_mfma_f32_16x16x32_bf16 v[152:155], a[108:111], a[152:155], v[152:155]
    s_load_dwordx2 s[36:37], s[0:1], 40
    buffer_load_dwordx4 v9, s[8:11], s27 offen lds
    v_mfma_f32_16x16x32_bf16 v[156:159], a[108:111], a[156:159], v[156:159]
    v_mfma_f32_16x16x32_bf16 v[160:163], a[112:115], a[128:131], v[160:163]
    v_mfma_f32_16x16x32_bf16 v[164:167], a[112:115], a[132:135], v[164:167]
    s_add_u32 m0, s32, 36864
    v_mfma_f32_16x16x32_bf16 v[168:171], a[112:115], a[136:139], v[168:171]
    buffer_load_dwordx4 v3, s[4:7], s22 offen lds
    v_mfma_f32_16x16x32_bf16 v[172:175], a[112:115], a[140:143], v[172:175]
    v_mfma_f32_16x16x32_bf16 v[176:179], a[112:115], a[144:147], v[176:179]
    v_mfma_f32_16x16x32_bf16 v[180:183], a[112:115], a[148:151], v[180:183]
    s_add_u32 m0, s32, 37888
    v_mfma_f32_16x16x32_bf16 v[184:187], a[112:115], a[152:155], v[184:187]
    buffer_load_dwordx4 v4, s[4:7], s22 offen lds
    v_mfma_f32_16x16x32_bf16 v[188:191], a[112:115], a[156:159], v[188:191]
    v_mfma_f32_16x16x32_bf16 v[192:195], a[116:119], a[128:131], v[192:195]
    v_mfma_f32_16x16x32_bf16 v[196:199], a[116:119], a[132:135], v[196:199]
    s_add_u32 m0, s32, 38912
    v_mfma_f32_16x16x32_bf16 v[200:203], a[116:119], a[136:139], v[200:203]
    buffer_load_dwordx4 v3, s[4:7], s23 offen lds
    v_mfma_f32_16x16x32_bf16 v[204:207], a[116:119], a[140:143], v[204:207]
    v_mfma_f32_16x16x32_bf16 v[208:211], a[116:119], a[144:147], v[208:211]
    v_mfma_f32_16x16x32_bf16 v[212:215], a[116:119], a[148:151], v[212:215]
    s_add_u32 m0, s32, 39936
    v_mfma_f32_16x16x32_bf16 v[216:219], a[116:119], a[152:155], v[216:219]
    buffer_load_dwordx4 v4, s[4:7], s23 offen lds
    v_mfma_f32_16x16x32_bf16 v[220:223], a[116:119], a[156:159], v[220:223]
    v_mfma_f32_16x16x32_bf16 v[224:227], a[120:123], a[128:131], v[224:227]
    v_mfma_f32_16x16x32_bf16 v[228:231], a[120:123], a[132:135], v[228:231]
    v_mfma_f32_16x16x32_bf16 v[232:235], a[120:123], a[136:139], v[232:235]
    v_mfma_f32_16x16x32_bf16 v[236:239], a[120:123], a[140:143], v[236:239]
    v_mfma_f32_16x16x32_bf16 v[240:243], a[120:123], a[144:147], v[240:243]
    v_mfma_f32_16x16x32_bf16 v[244:247], a[120:123], a[148:151], v[244:247]
    v_mfma_f32_16x16x32_bf16 v[248:251], a[120:123], a[152:155], v[248:251]
    v_mfma_f32_16x16x32_bf16 v[252:255], a[120:123], a[156:159], v[252:255]
    v_mfma_f32_16x16x32_bf16 a[0:3], a[124:127], a[128:131], a[0:3]
    v_mfma_f32_16x16x32_bf16 a[4:7], a[124:127], a[132:135], a[4:7]
    v_mfma_f32_16x16x32_bf16 a[8:11], a[124:127], a[136:139], a[8:11]
    v_mfma_f32_16x16x32_bf16 a[12:15], a[124:127], a[140:143], a[12:15]
    v_mfma_f32_16x16x32_bf16 a[16:19], a[124:127], a[144:147], a[16:19]
    v_mfma_f32_16x16x32_bf16 a[20:23], a[124:127], a[148:151], a[20:23]
    v_mfma_f32_16x16x32_bf16 a[24:27], a[124:127], a[152:155], a[24:27]
    s_add_u32 s4, s4, 128
    s_addc_u32 s5, s5, 0
    v_mfma_f32_16x16x32_bf16 a[28:31], a[124:127], a[156:159], a[28:31]
    s_waitcnt vmcnt(12) lgkmcnt(0)
    s_barrier
    v_readfirstlane_b32 s61, v31
    s_and_b32 s61, s61, 0xff
    s_cmp_ge_u32 s61, 8
    s_cbranch_scc0 SPIN_100007
OK_100008:
    v_mfma_f32_16x16x32_bf16 v[32:35], a[32:35], a[64:67], v[32:35]
    ds_read_b64_tr_b16 a[128:129], v5 offset:4096
    v_mfma_f32_16x16x32_bf16 v[36:39], a[32:35], a[68:71], v[36:39]
    ds_read_b64_tr_b16 a[130:131], v5 offset:5120
    s_add_u32 m0, s33, 36864
    v_mfma_f32_16x16x32_bf16 v[40:43], a[32:35], a[72:75], v[40:43]
    ds_read_b128 a[96:99], v11 offset:0
    buffer_load_dwordx4 v9, s[8:11], s28 offen lds
    v_mfma_f32_16x16x32_bf16 v[44:47], a[32:35], a[76:79], v[44:47]
    ds_read_b64_tr_b16 a[132:133], v6 offset:4096
    v_mfma_f32_16x16x32_bf16 v[48:51], a[32:35], a[80:83], v[48:51]
    ds_read_b64_tr_b16 a[134:135], v6 offset:5120
    v_mfma_f32_16x16x32_bf16 v[52:55], a[32:35], a[84:87], v[52:55]
    ds_read_b128 a[100:103], v11 offset:2048
    v_mfma_f32_16x16x32_bf16 v[56:59], a[32:35], a[88:91], v[56:59]
    ds_read_b64_tr_b16 a[136:137], v7 offset:4096
    v_mfma_f32_16x16x32_bf16 v[60:63], a[32:35], a[92:95], v[60:63]
    ds_read_b64_tr_b16 a[138:139], v7 offset:5120
    v_mfma_f32_16x16x32_bf16 v[64:67], a[36:39], a[64:67], v[64:67]
    ds_read_b128 a[104:107], v11 offset:4096
    v_mfma_f32_16x16x32_bf16 v[68:71], a[36:39], a[68:71], v[68:71]
    ds_read_b64_tr_b16 a[140:141], v8 offset:4096
    s_add_u32 m0, s33, 37888
    v_mfma_f32_16x16x32_bf16 v[72:75], a[36:39], a[72:75], v[72:75]
    ds_read_b64_tr_b16 a[142:143], v8 offset:5120
    buffer_load_dwordx4 v9, s[8:11], s29 offen lds
    v_mfma_f32_16x16x32_bf16 v[76:79], a[36:39], a[76:79], v[76:79]
    ds_read_b128 a[108:111], v11 offset:6144
    v_mfma_f32_16x16x32_bf16 v[80:83], a[36:39], a[80:83], v[80:83]
    ds_read_b64_tr_b16 a[144:145], v5 offset:12288
    v_mfma_f32_16x16x32_bf16 v[84:87], a[36:39], a[84:87], v[84:87]
    ds_read_b64_tr_b16 a[146:147], v5 offset:13312
    v_mfma_f32_16x16x32_bf16 v[88:91], a[36:39], a[88:91], v[88:91]
    ds_read_b128 a[112:115], v11 offset:8192
    v_mfma_f32_16x16x32_bf16 v[92:95], a[36:39], a[92:95], v[92:95]
    ds_read_b64_tr_b16 a[148:149], v6 offset:12288
    v_mfma_f32_16x16x32_bf16 v[96:99], a[40:43], a[64:67], v[96:99]
    ds_read_b64_tr_b16 a[150:151], v6 offset:13312
    v_mfma_f32_16x16x32_bf16 v[100:103], a[40:43], a[68:71], v[100:103]
    ds_read_b128 a[116:119], v11 offset:10240
    s_add_u32 m0, s33, 38912
    v_mfma_f32_16x16x32_bf16 v[104:107], a[40:43], a[72:75], v[104:107]
    ds_read_b64_tr_b16 a[152:153], v7 offset:12288
    buffer_load_dwordx4 v9, s[8:11], s30 offen lds
    v_mfma_f32_16x16x32_bf16 v[108:111], a[40:43], a[76:79], v[108:111]
    ds_read_b64_tr_b16 a[154:155], v7 offset:13312
    v_mfma_f32_16x16x32_bf16 v[112:115], a[40:43], a[80:83], v[112:115]
    ds_read_b128 a[120:123], v11 offset:12288
    v_mfma_f32_16x16x32_bf16 v[116:119], a[40:43], a[84:87], v[116:119]
    ds_read_b64_tr_b16 a[156:157], v8 offset:12288
    v_mfma_f32_16x16x32_bf16 v[120:123], a[40:43], a[88:91], v[120:123]
    ds_read_b64_tr_b16 a[158:159], v8 offset:13312
    v_mfma_f32_16x16x32_bf16 v[124:127], a[40:43], a[92:95], v[124:127]
    ds_read_b128 a[124:127], v11 offset:14336
    v_mfma_f32_16x16x32_bf16 v[128:131], a[44:47], a[64:67], v[128:131]
    v_mfma_f32_16x16x32_bf16 v[132:135], a[44:47], a[68:71], v[132:135]
    s_add_u32 m0, s33, 39936
    v_mfma_f32_16x16x32_bf16 v[136:139], a[44:47], a[72:75], v[136:139]
    buffer_load_dwordx4 v9, s[8:11], s31 offen lds
    v_mfma_f32_16x16x32_bf16 v[140:143], a[44:47], a[76:79], v[140:143]
    v_mfma_f32_16x16x32_bf16 v[144:147], a[44:47], a[80:83], v[144:147]
    v_mfma_f32_16x16x32_bf16 v[148:151], a[44:47], a[84:87], v[148:151]
    v_mfma_f32_16x16x32_bf16 v[152:155], a[44:47], a[88:91], v[152:155]
    s_add_u32 s8, s8, 524288
    s_addc_u32 s9, s9, 0
    v_mfma_f32_16x16x32_bf16 v[156:159], a[44:47], a[92:95], v[156:159]
    v_mfma_f32_16x16x32_bf16 v[160:163], a[48:51], a[64:67], v[160:163]
    v_mfma_f32_16x16x32_bf16 v[164:167], a[48:51], a[68:71], v[164:167]
    s_mov_b32 s89, 0
    v_mfma_f32_16x16x32_bf16 v[168:171], a[48:51], a[72:75], v[168:171]
    s_mov_b32 s38, 0x400000
    s_mov_b32 s39, 0x00020000
    s_lshl_b32 s34, s2, 14
    s_add_u32 s34, s34, 8192
    buffer_load_dwordx4 a[160:163], v1, s[80:83], s89 offen offset:0 sc1
    v_mfma_f32_16x16x32_bf16 v[172:175], a[48:51], a[76:79], v[172:175]
    buffer_load_dwordx4 a[252:255], v23, s[36:39], s34 offen
    v_mfma_f32_16x16x32_bf16 v[176:179], a[48:51], a[80:83], v[176:179]
    v_mfma_f32_16x16x32_bf16 v[180:183], a[48:51], a[84:87], v[180:183]
    v_mfma_f32_16x16x32_bf16 v[184:187], a[48:51], a[88:91], v[184:187]
    v_mfma_f32_16x16x32_bf16 v[188:191], a[48:51], a[92:95], v[188:191]
    v_mfma_f32_16x16x32_bf16 v[192:195], a[52:55], a[64:67], v[192:195]
    v_mfma_f32_16x16x32_bf16 v[196:199], a[52:55], a[68:71], v[196:199]
    buffer_load_dwordx4 a[164:167], v1, s[80:83], s89 offen offset:512 sc1
    v_mfma_f32_16x16x32_bf16 v[200:203], a[52:55], a[72:75], v[200:203]
    s_lshl_b32 s34, s2, 14
    s_add_u32 s34, s34, 12288
    v_mfma_f32_16x16x32_bf16 v[204:207], a[52:55], a[76:79], v[204:207]
    buffer_load_dwordx4 a[252:255], v23, s[36:39], s34 offen
    v_mfma_f32_16x16x32_bf16 v[208:211], a[52:55], a[80:83], v[208:211]
    v_mfma_f32_16x16x32_bf16 v[212:215], a[52:55], a[84:87], v[212:215]
    v_mfma_f32_16x16x32_bf16 v[216:219], a[52:55], a[88:91], v[216:219]
    v_mfma_f32_16x16x32_bf16 v[220:223], a[52:55], a[92:95], v[220:223]
    v_mfma_f32_16x16x32_bf16 v[224:227], a[56:59], a[64:67], v[224:227]
    buffer_load_dwordx4 a[168:171], v1, s[80:83], s89 offen offset:1024 sc1
    v_mfma_f32_16x16x32_bf16 v[228:231], a[56:59], a[68:71], v[228:231]
    v_mfma_f32_16x16x32_bf16 v[232:235], a[56:59], a[72:75], v[232:235]
    v_mfma_f32_16x16x32_bf16 v[236:239], a[56:59], a[76:79], v[236:239]
    v_mfma_f32_16x16x32_bf16 v[240:243], a[56:59], a[80:83], v[240:243]
    v_mfma_f32_16x16x32_bf16 v[244:247], a[56:59], a[84:87], v[244:247]
    v_mfma_f32_16x16x32_bf16 v[248:251], a[56:59], a[88:91], v[248:251]
    v_mfma_f32_16x16x32_bf16 v[252:255], a[56:59], a[92:95], v[252:255]
    buffer_load_dwordx4 a[172:175], v1, s[80:83], s89 offen offset:1536 sc1
    v_mfma_f32_16x16x32_bf16 a[0:3], a[60:63], a[64:67], a[0:3]
    v_mfma_f32_16x16x32_bf16 a[4:7], a[60:63], a[68:71], a[4:7]
    v_mfma_f32_16x16x32_bf16 a[8:11], a[60:63], a[72:75], a[8:11]
    v_mfma_f32_16x16x32_bf16 a[12:15], a[60:63], a[76:79], a[12:15]
    v_mfma_f32_16x16x32_bf16 a[16:19], a[60:63], a[80:83], a[16:19]
    v_mfma_f32_16x16x32_bf16 a[20:23], a[60:63], a[84:87], a[20:23]
    v_mfma_f32_16x16x32_bf16 a[24:27], a[60:63], a[88:91], a[24:27]
    v_mfma_f32_16x16x32_bf16 a[28:31], a[60:63], a[92:95], a[28:31]
    s_waitcnt vmcnt(10) lgkmcnt(0)
    s_barrier
    v_mfma_f32_16x16x32_bf16 v[32:35], a[96:99], a[128:131], v[32:35]
    ds_read_b64_tr_b16 a[64:65], v5 offset:32768
    v_mfma_f32_16x16x32_bf16 v[36:39], a[96:99], a[132:135], v[36:39]
    ds_read_b64_tr_b16 a[66:67], v5 offset:33792
    s_add_u32 m0, s60, 0
    s_mov_b32 s61, 262144
    v_mfma_f32_16x16x32_bf16 v[40:43], a[96:99], a[136:139], v[40:43]
    ds_read_b128 a[32:35], v10 offset:32768
    buffer_load_dwordx4 v30, s[52:55], s61 offen lds
    v_mfma_f32_16x16x32_bf16 v[44:47], a[96:99], a[140:143], v[44:47]
    ds_read_b64_tr_b16 a[68:69], v6 offset:32768
    v_mfma_f32_16x16x32_bf16 v[48:51], a[96:99], a[144:147], v[48:51]
    ds_read_b64_tr_b16 a[70:71], v6 offset:33792
    v_mfma_f32_16x16x32_bf16 v[52:55], a[96:99], a[148:151], v[52:55]
    ds_read_b128 a[36:39], v10 offset:34816
    v_mfma_f32_16x16x32_bf16 v[56:59], a[96:99], a[152:155], v[56:59]
    ds_read_b64_tr_b16 a[72:73], v7 offset:32768
    v_mfma_f32_16x16x32_bf16 v[60:63], a[96:99], a[156:159], v[60:63]
    ds_read_b64_tr_b16 a[74:75], v7 offset:33792
    s_add_u32 m0, s60, 1024
    s_mov_b32 s61, 270336
    v_mfma_f32_16x16x32_bf16 v[64:67], a[100:103], a[128:131], v[64:67]
    ds_read_b128 a[40:43], v10 offset:36864
    buffer_load_dwordx4 v30, s[52:55], s61 offen lds
    v_mfma_f32_16x16x32_bf16 v[68:71], a[100:103], a[132:135], v[68:71]
    ds_read_b64_tr_b16 a[76:77], v8 offset:32768
    v_mfma_f32_16x16x32_bf16 v[72:75], a[100:103], a[136:139], v[72:75]
    ds_read_b64_tr_b16 a[78:79], v8 offset:33792
    v_mfma_f32_16x16x32_bf16 v[76:79], a[100:103], a[140:143], v[76:79]
    ds_read_b128 a[44:47], v10 offset:38912
    v_mfma_f32_16x16x32_bf16 v[80:83], a[100:103], a[144:147], v[80:83]
    ds_read_b64_tr_b16 a[80:81], v5 offset:40960
    v_mfma_f32_16x16x32_bf16 v[84:87], a[100:103], a[148:151], v[84:87]
    ds_read_b64_tr_b16 a[82:83], v5 offset:41984
    s_add_u32 m0, s60, 2048
    s_mov_b32 s61, 278528
    v_mfma_f32_16x16x32_bf16 v[88:91], a[100:103], a[152:155], v[88:91]
    ds_read_b128 a[48:51], v10 offset:40960
    buffer_load_dwordx4 v30, s[52:55], s61 offen lds
    v_mfma_f32_16x16x32_bf16 v[92:95], a[100:103], a[156:159], v[92:95]
    ds_read_b64_tr_b16 a[84:85], v6 offset:40960
    v_mfma_f32_16x16x32_bf16 v[96:99], a[104:107], a[128:131], v[96:99]
    ds_read_b64_tr_b16 a[86:87], v6 offset:41984
    v_mfma_f32_16x16x32_bf16 v[100:103], a[104:107], a[132:135], v[100:103]
    ds_read_b128 a[52:55], v10 offset:43008
    v_mfma_f32_16x16x32_bf16 v[104:107], a[104:107], a[136:139], v[104:107]
    ds_read_b64_tr_b16 a[88:89], v7 offset:40960
    v_mfma_f32_16x16x32_bf16 v[108:111], a[104:107], a[140:143], v[108:111]
    ds_read_b64_tr_b16 a[90:91], v7 offset:41984
    s_add_u32 m0, s60, 3072
    s_mov_b32 s61, 286720
    v_mfma_f32_16x16x32_bf16 v[112:115], a[104:107], a[144:147], v[112:115]
    ds_read_b128 a[56:59], v10 offset:45056
    buffer_load_dwordx4 v30, s[52:55], s61 offen lds
    v_mfma_f32_16x16x32_bf16 v[116:119], a[104:107], a[148:151], v[116:119]
    ds_read_b64_tr_b16 a[92:93], v8 offset:40960
    v_mfma_f32_16x16x32_bf16 v[120:123], a[104:107], a[152:155], v[120:123]
    ds_read_b64_tr_b16 a[94:95], v8 offset:41984
    v_mfma_f32_16x16x32_bf16 v[124:127], a[104:107], a[156:159], v[124:127]
    ds_read_b128 a[60:63], v10 offset:47104
    v_mfma_f32_16x16x32_bf16 v[128:131], a[108:111], a[128:131], v[128:131]
    v_mfma_f32_16x16x32_bf16 v[132:135], a[108:111], a[132:135], v[132:135]
    s_add_u32 m0, s60, 16384
    s_mov_b32 s61, 393216
    v_mfma_f32_16x16x32_bf16 v[136:139], a[108:111], a[136:139], v[136:139]
    buffer_load_dwordx4 v30, s[52:55], s61 offen lds
    v_mfma_f32_16x16x32_bf16 v[140:143], a[108:111], a[140:143], v[140:143]
    v_mfma_f32_16x16x32_bf16 v[144:147], a[108:111], a[144:147], v[144:147]
    v_mfma_f32_16x16x32_bf16 v[148:151], a[108:111], a[148:151], v[148:151]
    v_mfma_f32_16x16x32_bf16 v[152:155], a[108:111], a[152:155], v[152:155]
    v_mfma_f32_16x16x32_bf16 v[156:159], a[108:111], a[156:159], v[156:159]
    s_add_u32 m0, s60, 17408
    s_mov_b32 s61, 401408
    v_mfma_f32_16x16x32_bf16 v[160:163], a[112:115], a[128:131], v[160:163]
    buffer_load_dwordx4 v30, s[52:55], s61 offen lds
    v_mfma_f32_16x16x32_bf16 v[164:167], a[112:115], a[132:135], v[164:167]
    v_mfma_f32_16x16x32_bf16 v[168:171], a[112:115], a[136:139], v[168:171]
    v_mfma_f32_16x16x32_bf16 v[172:175], a[112:115], a[140:143], v[172:175]
    v_mfma_f32_16x16x32_bf16 v[176:179], a[112:115], a[144:147], v[176:179]
    v_mfma_f32_16x16x32_bf16 v[180:183], a[112:115], a[148:151], v[180:183]
    s_add_u32 m0, s60, 18432
    s_mov_b32 s61, 409600
    v_mfma_f32_16x16x32_bf16 v[184:187], a[112:115], a[152:155], v[184:187]
    buffer_load_dwordx4 v30, s[52:55], s61 offen lds
    v_mfma_f32_16x16x32_bf16 v[188:191], a[112:115], a[156:159], v[188:191]
    v_mfma_f32_16x16x32_bf16 v[192:195], a[116:119], a[128:131], v[192:195]
    v_mfma_f32_16x16x32_bf16 v[196:199], a[116:119], a[132:135], v[196:199]
    v_mfma_f32_16x16x32_bf16 v[200:203], a[116:119], a[136:139], v[200:203]
    v_mfma_f32_16x16x32_bf16 v[204:207], a[116:119], a[140:143], v[204:207]
    s_add_u32 m0, s60, 19456
    s_mov_b32 s61, 417792
    v_mfma_f32_16x16x32_bf16 v[208:211], a[116:119], a[144:147], v[208:211]
    buffer_load_dwordx4 v30, s[52:55], s61 offen lds
    v_mfma_f32_16x16x32_bf16 v[212:215], a[116:119], a[148:151], v[212:215]
    v_mfma_f32_16x16x32_bf16 v[216:219], a[116:119], a[152:155], v[216:219]
    v_mfma_f32_16x16x32_bf16 v[220:223], a[116:119], a[156:159], v[220:223]
    v_mfma_f32_16x16x32_bf16 v[224:227], a[120:123], a[128:131], v[224:227]
    v_mfma_f32_16x16x32_bf16 v[228:231], a[120:123], a[132:135], v[228:231]
    v_mfma_f32_16x16x32_bf16 v[232:235], a[120:123], a[136:139], v[232:235]
    s_mov_b32 s89, 0
    v_mfma_f32_16x16x32_bf16 v[236:239], a[120:123], a[140:143], v[236:239]
    buffer_load_dwordx4 a[176:179], v1, s[80:83], s89 offen offset:2048 sc1
    v_mfma_f32_16x16x32_bf16 v[240:243], a[120:123], a[144:147], v[240:243]
    v_mfma_f32_16x16x32_bf16 v[244:247], a[120:123], a[148:151], v[244:247]
    v_mfma_f32_16x16x32_bf16 v[248:251], a[120:123], a[152:155], v[248:251]
    buffer_load_dwordx4 a[180:183], v1, s[80:83], s89 offen offset:2560 sc1
    v_mfma_f32_16x16x32_bf16 v[252:255], a[120:123], a[156:159], v[252:255]
    v_mfma_f32_16x16x32_bf16 a[0:3], a[124:127], a[128:131], a[0:3]
    v_mfma_f32_16x16x32_bf16 a[4:7], a[124:127], a[132:135], a[4:7]
    buffer_load_dwordx4 a[184:187], v1, s[80:83], s89 offen offset:3072 sc1
    v_mfma_f32_16x16x32_bf16 a[8:11], a[124:127], a[136:139], a[8:11]
    v_mfma_f32_16x16x32_bf16 a[12:15], a[124:127], a[140:143], a[12:15]
    v_mfma_f32_16x16x32_bf16 a[16:19], a[124:127], a[144:147], a[16:19]
    buffer_load_dwordx4 a[188:191], v1, s[80:83], s89 offen offset:3584 sc1
    v_mfma_f32_16x16x32_bf16 a[20:23], a[124:127], a[148:151], a[20:23]
    v_mfma_f32_16x16x32_bf16 a[24:27], a[124:127], a[152:155], a[24:27]
    v_mfma_f32_16x16x32_bf16 a[28:31], a[124:127], a[156:159], a[28:31]
    s_waitcnt vmcnt(18) lgkmcnt(0)
    s_barrier
    v_mfma_f32_16x16x32_bf16 v[32:35], a[32:35], a[64:67], v[32:35]
    ds_read_b64_tr_b16 a[128:129], v5 offset:36864
    v_mfma_f32_16x16x32_bf16 v[36:39], a[32:35], a[68:71], v[36:39]
    ds_read_b64_tr_b16 a[130:131], v5 offset:37888
    s_mov_b32 s89, 4096
    v_mfma_f32_16x16x32_bf16 v[40:43], a[32:35], a[72:75], v[40:43]
    ds_read_b128 a[96:99], v11 offset:32768
    buffer_load_dwordx4 a[192:195], v1, s[80:83], s89 offen offset:0 sc1
    v_mfma_f32_16x16x32_bf16 v[44:47], a[32:35], a[76:79], v[44:47]
    ds_read_b64_tr_b16 a[132:133], v6 offset:36864
    v_mfma_f32_16x16x32_bf16 v[48:51], a[32:35], a[80:83], v[48:51]
    ds_read_b64_tr_b16 a[134:135], v6 offset:37888
    v_mfma_f32_16x16x32_bf16 v[52:55], a[32:35], a[84:87], v[52:55]
    ds_read_b128 a[100:103], v11 offset:34816
    v_mfma_f32_16x16x32_bf16 v[56:59], a[32:35], a[88:91], v[56:59]
    ds_read_b64_tr_b16 a[136:137], v7 offset:36864
    buffer_load_dwordx4 a[196:199], v1, s[80:83], s89 offen offset:512 sc1
    v_mfma_f32_16x16x32_bf16 v[60:63], a[32:35], a[92:95], v[60:63]
    ds_read_b64_tr_b16 a[138:139], v7 offset:37888
    v_mfma_f32_16x16x32_bf16 v[64:67], a[36:39], a[64:67], v[64:67]
    ds_read_b128 a[104:107], v11 offset:36864
    v_mfma_f32_16x16x32_bf16 v[68:71], a[36:39], a[68:71], v[68:71]
    ds_read_b64_tr_b16 a[140:141], v8 offset:36864
    v_mfma_f32_16x16x32_bf16 v[72:75], a[36:39], a[72:75], v[72:75]
    ds_read_b64_tr_b16 a[142:143], v8 offset:37888
    buffer_load_dwordx4 a[200:203], v1, s[80:83], s89 offen offset:1024 sc1
    v_mfma_f32_16x16x32_bf16 v[76:79], a[36:39], a[76:79], v[76:79]
    ds_read_b128 a[108:111], v11 offset:38912
    v_mfma_f32_16x16x32_bf16 v[80:83], a[36:39], a[80:83], v[80:83]
    ds_read_b64_tr_b16 a[144:145], v5 offset:45056
    v_mfma_f32_16x16x32_bf16 v[84:87], a[36:39], a[84:87], v[84:87]
    ds_read_b64_tr_b16 a[146:147], v5 offset:46080
    v_mfma_f32_16x16x32_bf16 v[88:91], a[36:39], a[88:91], v[88:91]
    ds_read_b128 a[112:115], v11 offset:40960
    buffer_load_dwordx4 a[204:207], v1, s[80:83], s89 offen offset:1536 sc1
    v_mfma_f32_16x16x32_bf16 v[92:95], a[36:39], a[92:95], v[92:95]
    ds_read_b64_tr_b16 a[148:149], v6 offset:45056
    v_mfma_f32_16x16x32_bf16 v[96:99], a[40:43], a[64:67], v[96:99]
    ds_read_b64_tr_b16 a[150:151], v6 offset:46080
    v_mfma_f32_16x16x32_bf16 v[100:103], a[40:43], a[68:71], v[100:103]
    ds_read_b128 a[116:119], v11 offset:43008
    v_mfma_f32_16x16x32_bf16 v[104:107], a[40:43], a[72:75], v[104:107]
    ds_read_b64_tr_b16 a[152:153], v7 offset:45056
    buffer_load_dwordx4 a[208:211], v1, s[80:83], s89 offen offset:2048 sc1
    v_mfma_f32_16x16x32_bf16 v[108:111], a[40:43], a[76:79], v[108:111]
    ds_read_b64_tr_b16 a[154:155], v7 offset:46080
    v_mfma_f32_16x16x32_bf16 v[112:115], a[40:43], a[80:83], v[112:115]
    ds_read_b128 a[120:123], v11 offset:45056
    v_mfma_f32_16x16x32_bf16 v[116:119], a[40:43], a[84:87], v[116:119]
    ds_read_b64_tr_b16 a[156:157], v8 offset:45056
    v_mfma_f32_16x16x32_bf16 v[120:123], a[40:43], a[88:91], v[120:123]
    ds_read_b64_tr_b16 a[158:159], v8 offset:46080
    buffer_load_dwordx4 a[212:215], v1, s[80:83], s89 offen offset:2560 sc1
    v_mfma_f32_16x16x32_bf16 v[124:127], a[40:43], a[92:95], v[124:127]
    ds_read_b128 a[124:127], v11 offset:47104
    v_mfma_f32_16x16x32_bf16 v[128:131], a[44:47], a[64:67], v[128:131]
    v_mfma_f32_16x16x32_bf16 v[132:135], a[44:47], a[68:71], v[132:135]
    v_mfma_f32_16x16x32_bf16 v[136:139], a[44:47], a[72:75], v[136:139]
    buffer_load_dwordx4 a[216:219], v1, s[80:83], s89 offen offset:3072 sc1
    v_mfma_f32_16x16x32_bf16 v[140:143], a[44:47], a[76:79], v[140:143]
    v_mfma_f32_16x16x32_bf16 v[144:147], a[44:47], a[80:83], v[144:147]
    v_mfma_f32_16x16x32_bf16 v[148:151], a[44:47], a[84:87], v[148:151]
    v_mfma_f32_16x16x32_bf16 v[152:155], a[44:47], a[88:91], v[152:155]
    buffer_load_dwordx4 a[220:223], v1, s[80:83], s89 offen offset:3584 sc1
    v_mfma_f32_16x16x32_bf16 v[156:159], a[44:47], a[92:95], v[156:159]
    v_mfma_f32_16x16x32_bf16 v[160:163], a[48:51], a[64:67], v[160:163]
    v_mfma_f32_16x16x32_bf16 v[164:167], a[48:51], a[68:71], v[164:167]
    s_mov_b32 s89, 8192
    v_mfma_f32_16x16x32_bf16 v[168:171], a[48:51], a[72:75], v[168:171]
    buffer_load_dwordx4 a[224:227], v1, s[80:83], s89 offen offset:0 sc1
    v_mfma_f32_16x16x32_bf16 v[172:175], a[48:51], a[76:79], v[172:175]
    v_mfma_f32_16x16x32_bf16 v[176:179], a[48:51], a[80:83], v[176:179]
    v_mfma_f32_16x16x32_bf16 v[180:183], a[48:51], a[84:87], v[180:183]
    v_mfma_f32_16x16x32_bf16 v[184:187], a[48:51], a[88:91], v[184:187]
    buffer_load_dwordx4 a[228:231], v1, s[80:83], s89 offen offset:512 sc1
    v_mfma_f32_16x16x32_bf16 v[188:191], a[48:51], a[92:95], v[188:191]
    v_mfma_f32_16x16x32_bf16 v[192:195], a[52:55], a[64:67], v[192:195]
    v_mfma_f32_16x16x32_bf16 v[196:199], a[52:55], a[68:71], v[196:199]
    v_mfma_f32_16x16x32_bf16 v[200:203], a[52:55], a[72:75], v[200:203]
    buffer_load_dwordx4 a[232:235], v1, s[80:83], s89 offen offset:1024 sc1
    v_mfma_f32_16x16x32_bf16 v[204:207], a[52:55], a[76:79], v[204:207]
    v_mfma_f32_16x16x32_bf16 v[208:211], a[52:55], a[80:83], v[208:211]
    v_mfma_f32_16x16x32_bf16 v[212:215], a[52:55], a[84:87], v[212:215]
    v_mfma_f32_16x16x32_bf16 v[216:219], a[52:55], a[88:91], v[216:219]
    buffer_load_dwordx4 a[236:239], v1, s[80:83], s89 offen offset:1536 sc1
    v_mfma_f32_16x16x32_bf16 v[220:223], a[52:55], a[92:95], v[220:223]
    v_mfma_f32_16x16x32_bf16 v[224:227], a[56:59], a[64:67], v[224:227]
    v_mfma_f32_16x16x32_bf16 v[228:231], a[56:59], a[68:71], v[228:231]
    v_mfma_f32_16x16x32_bf16 v[232:235], a[56:59], a[72:75], v[232:235]
    buffer_load_dwordx4 a[240:243], v1, s[80:83], s89 offen offset:2048 sc1
    v_mfma_f32_16x16x32_bf16 v[236:239], a[56:59], a[76:79], v[236:239]
    v_mfma_f32_16x16x32_bf16 v[240:243], a[56:59], a[80:83], v[240:243]
    v_mfma_f32_16x16x32_bf16 v[244:247], a[56:59], a[84:87], v[244:247]
    v_mfma_f32_16x16x32_bf16 v[248:251], a[56:59], a[88:91], v[248:251]
    buffer_load_dwordx4 a[244:247], v1, s[80:83], s89 offen offset:2560 sc1
    v_mfma_f32_16x16x32_bf16 v[252:255], a[56:59], a[92:95], v[252:255]
    v_mfma_f32_16x16x32_bf16 a[0:3], a[60:63], a[64:67], a[0:3]
    v_mfma_f32_16x16x32_bf16 a[4:7], a[60:63], a[68:71], a[4:7]
    v_mfma_f32_16x16x32_bf16 a[8:11], a[60:63], a[72:75], a[8:11]
    buffer_load_dwordx4 a[248:251], v1, s[80:83], s89 offen offset:3072 sc1
    v_mfma_f32_16x16x32_bf16 a[12:15], a[60:63], a[76:79], a[12:15]
    v_mfma_f32_16x16x32_bf16 a[16:19], a[60:63], a[80:83], a[16:19]
    v_mfma_f32_16x16x32_bf16 a[20:23], a[60:63], a[84:87], a[20:23]
    v_mfma_f32_16x16x32_bf16 a[24:27], a[60:63], a[88:91], a[24:27]
    buffer_load_dwordx4 a[252:255], v1, s[80:83], s89 offen offset:3584 sc1
    v_mfma_f32_16x16x32_bf16 a[28:31], a[60:63], a[92:95], a[28:31]
    s_waitcnt lgkmcnt(0)
    v_mfma_f32_16x16x32_bf16 v[32:35], a[96:99], a[128:131], v[32:35]
    v_mfma_f32_16x16x32_bf16 v[36:39], a[96:99], a[132:135], v[36:39]
    s_mov_b32 s89, 12288
    v_mfma_f32_16x16x32_bf16 v[40:43], a[96:99], a[136:139], v[40:43]
    buffer_load_dwordx4 a[32:35], v1, s[80:83], s89 offen offset:0 sc1
    v_mfma_f32_16x16x32_bf16 v[44:47], a[96:99], a[140:143], v[44:47]
    v_mfma_f32_16x16x32_bf16 v[48:51], a[96:99], a[144:147], v[48:51]
    v_mfma_f32_16x16x32_bf16 v[52:55], a[96:99], a[148:151], v[52:55]
    v_mfma_f32_16x16x32_bf16 v[56:59], a[96:99], a[152:155], v[56:59]
    v_mfma_f32_16x16x32_bf16 v[60:63], a[96:99], a[156:159], v[60:63]
    v_mfma_f32_16x16x32_bf16 v[64:67], a[100:103], a[128:131], v[64:67]
    buffer_load_dwordx4 a[36:39], v1, s[80:83], s89 offen offset:512 sc1
    v_mfma_f32_16x16x32_bf16 v[68:71], a[100:103], a[132:135], v[68:71]
    v_mfma_f32_16x16x32_bf16 v[72:75], a[100:103], a[136:139], v[72:75]
    v_mfma_f32_16x16x32_bf16 v[76:79], a[100:103], a[140:143], v[76:79]
    v_mfma_f32_16x16x32_bf16 v[80:83], a[100:103], a[144:147], v[80:83]
    v_mfma_f32_16x16x32_bf16 v[84:87], a[100:103], a[148:151], v[84:87]
    v_mfma_f32_16x16x32_bf16 v[88:91], a[100:103], a[152:155], v[88:91]
    buffer_load_dwordx4 a[40:43], v1, s[80:83], s89 offen offset:1024 sc1
    v_mfma_f32_16x16x32_bf16 v[92:95], a[100:103], a[156:159], v[92:95]
    v_mfma_f32_16x16x32_bf16 v[96:99], a[104:107], a[128:131], v[96:99]
    v_mfma_f32_16x16x32_bf16 v[100:103], a[104:107], a[132:135], v[100:103]
    v_mfma_f32_16x16x32_bf16 v[104:107], a[104:107], a[136:139], v[104:107]
    v_mfma_f32_16x16x32_bf16 v[108:111], a[104:107], a[140:143], v[108:111]
    v_mfma_f32_16x16x32_bf16 v[112:115], a[104:107], a[144:147], v[112:115]
    buffer_load_dwordx4 a[44:47], v1, s[80:83], s89 offen offset:1536 sc1
    v_mfma_f32_16x16x32_bf16 v[116:119], a[104:107], a[148:151], v[116:119]
    v_mfma_f32_16x16x32_bf16 v[120:123], a[104:107], a[152:155], v[120:123]
    v_mfma_f32_16x16x32_bf16 v[124:127], a[104:107], a[156:159], v[124:127]
    v_mfma_f32_16x16x32_bf16 v[128:131], a[108:111], a[128:131], v[128:131]
    v_mfma_f32_16x16x32_bf16 v[132:135], a[108:111], a[132:135], v[132:135]
    v_mfma_f32_16x16x32_bf16 v[136:139], a[108:111], a[136:139], v[136:139]
    buffer_load_dwordx4 a[48:51], v1, s[80:83], s89 offen offset:2048 sc1
    v_mfma_f32_16x16x32_bf16 v[140:143], a[108:111], a[140:143], v[140:143]
    v_mfma_f32_16x16x32_bf16 v[144:147], a[108:111], a[144:147], v[144:147]
    v_mfma_f32_16x16x32_bf16 v[148:151], a[108:111], a[148:151], v[148:151]
    v_mfma_f32_16x16x32_bf16 v[152:155], a[108:111], a[152:155], v[152:155]
    v_mfma_f32_16x16x32_bf16 v[156:159], a[108:111], a[156:159], v[156:159]
    v_mfma_f32_16x16x32_bf16 v[160:163], a[112:115], a[128:131], v[160:163]
    buffer_load_dwordx4 a[52:55], v1, s[80:83], s89 offen offset:2560 sc1
    v_mfma_f32_16x16x32_bf16 v[164:167], a[112:115], a[132:135], v[164:167]
    v_mfma_f32_16x16x32_bf16 v[168:171], a[112:115], a[136:139], v[168:171]
    v_mfma_f32_16x16x32_bf16 v[172:175], a[112:115], a[140:143], v[172:175]
    v_mfma_f32_16x16x32_bf16 v[176:179], a[112:115], a[144:147], v[176:179]
    v_mfma_f32_16x16x32_bf16 v[180:183], a[112:115], a[148:151], v[180:183]
    v_mfma_f32_16x16x32_bf16 v[184:187], a[112:115], a[152:155], v[184:187]
    buffer_load_dwordx4 a[56:59], v1, s[80:83], s89 offen offset:3072 sc1
    v_mfma_f32_16x16x32_bf16 v[188:191], a[112:115], a[156:159], v[188:191]
    v_mfma_f32_16x16x32_bf16 v[192:195], a[116:119], a[128:131], v[192:195]
    v_mfma_f32_16x16x32_bf16 v[196:199], a[116:119], a[132:135], v[196:199]
    v_mfma_f32_16x16x32_bf16 v[200:203], a[116:119], a[136:139], v[200:203]
    v_mfma_f32_16x16x32_bf16 v[204:207], a[116:119], a[140:143], v[204:207]
    v_mfma_f32_16x16x32_bf16 v[208:211], a[116:119], a[144:147], v[208:211]
    buffer_load_dwordx4 a[60:63], v1, s[80:83], s89 offen offset:3584 sc1
    v_mfma_f32_16x16x32_bf16 v[212:215], a[116:119], a[148:151], v[212:215]
    v_mfma_f32_16x16x32_bf16 v[216:219], a[116:119], a[152:155], v[216:219]
    v_mfma_f32_16x16x32_bf16 v[220:223], a[116:119], a[156:159], v[220:223]
    v_mfma_f32_16x16x32_bf16 v[224:227], a[120:123], a[128:131], v[224:227]
    v_mfma_f32_16x16x32_bf16 v[228:231], a[120:123], a[132:135], v[228:231]
    v_mfma_f32_16x16x32_bf16 v[232:235], a[120:123], a[136:139], v[232:235]
    v_mfma_f32_16x16x32_bf16 v[236:239], a[120:123], a[140:143], v[236:239]
    v_mfma_f32_16x16x32_bf16 v[240:243], a[120:123], a[144:147], v[240:243]
    v_mfma_f32_16x16x32_bf16 v[244:247], a[120:123], a[148:151], v[244:247]
    v_mfma_f32_16x16x32_bf16 v[248:251], a[120:123], a[152:155], v[248:251]
    v_mfma_f32_16x16x32_bf16 v[252:255], a[120:123], a[156:159], v[252:255]
    v_mfma_f32_16x16x32_bf16 a[0:3], a[124:127], a[128:131], a[0:3]
    v_mfma_f32_16x16x32_bf16 a[4:7], a[124:127], a[132:135], a[4:7]
    v_mfma_f32_16x16x32_bf16 a[8:11], a[124:127], a[136:139], a[8:11]
    v_mfma_f32_16x16x32_bf16 a[12:15], a[124:127], a[140:143], a[12:15]
    v_mfma_f32_16x16x32_bf16 a[16:19], a[124:127], a[144:147], a[16:19]
    v_mfma_f32_16x16x32_bf16 a[20:23], a[124:127], a[148:151], a[20:23]
    v_mfma_f32_16x16x32_bf16 a[24:27], a[124:127], a[152:155], a[24:27]
    v_mfma_f32_16x16x32_bf16 a[28:31], a[124:127], a[156:159], a[28:31]
    s_nop 7
    s_nop 7
    v_lshrrev_b32 v13, 4, v2
    v_lshrrev_b32 v14, 1, v13
    v_and_b32 v15, 1, v13
    v_and_b32 v17, 15, v2
    v_lshl_add_u32 v17, v15, 5, v17
    v_lshlrev_b32 v17, 4, v17
    v_lshl_add_u32 v12, v14, 12, v17
    v_add_u32 v12, 16384, v12
    v_cvt_pk_bf16_f32 v16, v32, v33
    v_cvt_pk_bf16_f32 v17, v34, v35
    v_cvt_pk_bf16_f32 v18, v64, v65
    v_cvt_pk_bf16_f32 v19, v66, v67
    s_mov_b32 s34, 0
    buffer_store_dwordx4 v[16:19], v12, s[12:15], s34 offen offset:0 sc1
    v_cvt_pk_bf16_f32 v20, v36, v37
    v_cvt_pk_bf16_f32 v21, v38, v39
    v_cvt_pk_bf16_f32 v22, v68, v69
    v_cvt_pk_bf16_f32 v23, v70, v71
    s_mov_b32 s34, 0
    buffer_store_dwordx4 v[20:23], v12, s[12:15], s34 offen offset:256 sc1
    v_cvt_pk_bf16_f32 v24, v40, v41
    v_cvt_pk_bf16_f32 v25, v42, v43
    v_cvt_pk_bf16_f32 v26, v72, v73
    v_cvt_pk_bf16_f32 v27, v74, v75
    s_mov_b32 s34, 0
    buffer_store_dwordx4 v[24:27], v12, s[12:15], s34 offen offset:1024 sc1
    v_cvt_pk_bf16_f32 v16, v44, v45
    v_cvt_pk_bf16_f32 v17, v46, v47
    v_cvt_pk_bf16_f32 v18, v76, v77
    v_cvt_pk_bf16_f32 v19, v78, v79
    s_mov_b32 s34, 0
    buffer_store_dwordx4 v[16:19], v12, s[12:15], s34 offen offset:1280 sc1
    v_cvt_pk_bf16_f32 v20, v48, v49
    v_cvt_pk_bf16_f32 v21, v50, v51
    v_cvt_pk_bf16_f32 v22, v80, v81
    v_cvt_pk_bf16_f32 v23, v82, v83
    s_mov_b32 s34, 0
    buffer_store_dwordx4 v[20:23], v12, s[12:15], s34 offen offset:2048 sc1
    v_cvt_pk_bf16_f32 v24, v52, v53
    v_cvt_pk_bf16_f32 v25, v54, v55
    v_cvt_pk_bf16_f32 v26, v84, v85
    v_cvt_pk_bf16_f32 v27, v86, v87
    s_mov_b32 s34, 0
    buffer_store_dwordx4 v[24:27], v12, s[12:15], s34 offen offset:2304 sc1
    v_cvt_pk_bf16_f32 v16, v56, v57
    v_cvt_pk_bf16_f32 v17, v58, v59
    v_cvt_pk_bf16_f32 v18, v88, v89
    v_cvt_pk_bf16_f32 v19, v90, v91
    s_mov_b32 s34, 0
    buffer_store_dwordx4 v[16:19], v12, s[12:15], s34 offen offset:3072 sc1
    v_cvt_pk_bf16_f32 v20, v60, v61
    v_cvt_pk_bf16_f32 v21, v62, v63
    v_cvt_pk_bf16_f32 v22, v92, v93
    v_cvt_pk_bf16_f32 v23, v94, v95
    s_mov_b32 s34, 0
    buffer_store_dwordx4 v[20:23], v12, s[12:15], s34 offen offset:3328 sc1
    v_cvt_pk_bf16_f32 v24, v96, v97
    v_cvt_pk_bf16_f32 v25, v98, v99
    v_cvt_pk_bf16_f32 v26, v128, v129
    v_cvt_pk_bf16_f32 v27, v130, v131
    s_mov_b32 s34, 8192
    buffer_store_dwordx4 v[24:27], v12, s[12:15], s34 offen offset:0 sc1
    v_cvt_pk_bf16_f32 v16, v100, v101
    v_cvt_pk_bf16_f32 v17, v102, v103
    v_cvt_pk_bf16_f32 v18, v132, v133
    v_cvt_pk_bf16_f32 v19, v134, v135
    s_mov_b32 s34, 8192
    buffer_store_dwordx4 v[16:19], v12, s[12:15], s34 offen offset:256 sc1
    v_cvt_pk_bf16_f32 v20, v104, v105
    v_cvt_pk_bf16_f32 v21, v106, v107
    v_cvt_pk_bf16_f32 v22, v136, v137
    v_cvt_pk_bf16_f32 v23, v138, v139
    s_mov_b32 s34, 8192
    buffer_store_dwordx4 v[20:23], v12, s[12:15], s34 offen offset:1024 sc1
    v_cvt_pk_bf16_f32 v24, v108, v109
    v_cvt_pk_bf16_f32 v25, v110, v111
    v_cvt_pk_bf16_f32 v26, v140, v141
    v_cvt_pk_bf16_f32 v27, v142, v143
    s_mov_b32 s34, 8192
    buffer_store_dwordx4 v[24:27], v12, s[12:15], s34 offen offset:1280 sc1
    v_cvt_pk_bf16_f32 v16, v112, v113
    v_cvt_pk_bf16_f32 v17, v114, v115
    v_cvt_pk_bf16_f32 v18, v144, v145
    v_cvt_pk_bf16_f32 v19, v146, v147
    s_mov_b32 s34, 8192
    buffer_store_dwordx4 v[16:19], v12, s[12:15], s34 offen offset:2048 sc1
    v_cvt_pk_bf16_f32 v20, v116, v117
    v_cvt_pk_bf16_f32 v21, v118, v119
    v_cvt_pk_bf16_f32 v22, v148, v149
    v_cvt_pk_bf16_f32 v23, v150, v151
    s_mov_b32 s34, 8192
    buffer_store_dwordx4 v[20:23], v12, s[12:15], s34 offen offset:2304 sc1
    v_cvt_pk_bf16_f32 v24, v120, v121
    v_cvt_pk_bf16_f32 v25, v122, v123
    v_cvt_pk_bf16_f32 v26, v152, v153
    v_cvt_pk_bf16_f32 v27, v154, v155
    s_mov_b32 s34, 8192
    buffer_store_dwordx4 v[24:27], v12, s[12:15], s34 offen offset:3072 sc1
    v_cvt_pk_bf16_f32 v16, v124, v125
    v_cvt_pk_bf16_f32 v17, v126, v127
    v_cvt_pk_bf16_f32 v18, v156, v157
    v_cvt_pk_bf16_f32 v19, v158, v159
    s_mov_b32 s34, 8192
    buffer_store_dwordx4 v[16:19], v12, s[12:15], s34 offen offset:3328 sc1
    v_cvt_pk_bf16_f32 v20, v160, v161
    v_cvt_pk_bf16_f32 v21, v162, v163
    v_cvt_pk_bf16_f32 v22, v192, v193
    v_cvt_pk_bf16_f32 v23, v194, v195
    s_mov_b32 s34, 32768
    buffer_store_dwordx4 v[20:23], v12, s[12:15], s34 offen offset:0 sc1
    v_cvt_pk_bf16_f32 v24, v164, v165
    v_cvt_pk_bf16_f32 v25, v166, v167
    v_cvt_pk_bf16_f32 v26, v196, v197
    v_cvt_pk_bf16_f32 v27, v198, v199
    s_mov_b32 s34, 32768
    buffer_store_dwordx4 v[24:27], v12, s[12:15], s34 offen offset:256 sc1
    v_cvt_pk_bf16_f32 v16, v168, v169
    v_cvt_pk_bf16_f32 v17, v170, v171
    v_cvt_pk_bf16_f32 v18, v200, v201
    v_cvt_pk_bf16_f32 v19, v202, v203
    s_mov_b32 s34, 32768
    buffer_store_dwordx4 v[16:19], v12, s[12:15], s34 offen offset:1024 sc1
    v_cvt_pk_bf16_f32 v20, v172, v173
    v_cvt_pk_bf16_f32 v21, v174, v175
    v_cvt_pk_bf16_f32 v22, v204, v205
    v_cvt_pk_bf16_f32 v23, v206, v207
    s_mov_b32 s34, 32768
    buffer_store_dwordx4 v[20:23], v12, s[12:15], s34 offen offset:1280 sc1
    v_cvt_pk_bf16_f32 v24, v176, v177
    v_cvt_pk_bf16_f32 v25, v178, v179
    v_cvt_pk_bf16_f32 v26, v208, v209
    v_cvt_pk_bf16_f32 v27, v210, v211
    s_mov_b32 s34, 32768
    buffer_store_dwordx4 v[24:27], v12, s[12:15], s34 offen offset:2048 sc1
    v_cvt_pk_bf16_f32 v16, v180, v181
    v_cvt_pk_bf16_f32 v17, v182, v183
    v_cvt_pk_bf16_f32 v18, v212, v213
    v_cvt_pk_bf16_f32 v19, v214, v215
    s_mov_b32 s34, 32768
    buffer_store_dwordx4 v[16:19], v12, s[12:15], s34 offen offset:2304 sc1
    v_cvt_pk_bf16_f32 v20, v184, v185
    v_cvt_pk_bf16_f32 v21, v186, v187
    v_cvt_pk_bf16_f32 v22, v216, v217
    v_cvt_pk_bf16_f32 v23, v218, v219
    s_mov_b32 s34, 32768
    buffer_store_dwordx4 v[20:23], v12, s[12:15], s34 offen offset:3072 sc1
    v_cvt_pk_bf16_f32 v24, v188, v189
    v_cvt_pk_bf16_f32 v25, v190, v191
    v_cvt_pk_bf16_f32 v26, v220, v221
    v_cvt_pk_bf16_f32 v27, v222, v223
    s_mov_b32 s34, 32768
    buffer_store_dwordx4 v[24:27], v12, s[12:15], s34 offen offset:3328 sc1
    v_accvgpr_read_b32 v9, a0
    v_accvgpr_read_b32 v10, a1
    v_accvgpr_read_b32 v11, a2
    v_accvgpr_read_b32 v13, a3
    v_cvt_pk_bf16_f32 v16, v224, v225
    v_cvt_pk_bf16_f32 v17, v226, v227
    v_cvt_pk_bf16_f32 v18, v9, v10
    v_cvt_pk_bf16_f32 v19, v11, v13
    s_mov_b32 s34, 40960
    buffer_store_dwordx4 v[16:19], v12, s[12:15], s34 offen offset:0 sc1
    v_accvgpr_read_b32 v9, a4
    v_accvgpr_read_b32 v10, a5
    v_accvgpr_read_b32 v11, a6
    v_accvgpr_read_b32 v13, a7
    v_cvt_pk_bf16_f32 v20, v228, v229
    v_cvt_pk_bf16_f32 v21, v230, v231
    v_cvt_pk_bf16_f32 v22, v9, v10
    v_cvt_pk_bf16_f32 v23, v11, v13
    s_mov_b32 s34, 40960
    buffer_store_dwordx4 v[20:23], v12, s[12:15], s34 offen offset:256 sc1
    v_accvgpr_read_b32 v9, a8
    v_accvgpr_read_b32 v10, a9
    v_accvgpr_read_b32 v11, a10
    v_accvgpr_read_b32 v13, a11
    v_cvt_pk_bf16_f32 v24, v232, v233
    v_cvt_pk_bf16_f32 v25, v234, v235
    v_cvt_pk_bf16_f32 v26, v9, v10
    v_cvt_pk_bf16_f32 v27, v11, v13
    s_mov_b32 s34, 40960
    buffer_store_dwordx4 v[24:27], v12, s[12:15], s34 offen offset:1024 sc1
    v_accvgpr_read_b32 v9, a12
    v_accvgpr_read_b32 v10, a13
    v_accvgpr_read_b32 v11, a14
    v_accvgpr_read_b32 v13, a15
    v_cvt_pk_bf16_f32 v16, v236, v237
    v_cvt_pk_bf16_f32 v17, v238, v239
    v_cvt_pk_bf16_f32 v18, v9, v10
    v_cvt_pk_bf16_f32 v19, v11, v13
    s_mov_b32 s34, 40960
    buffer_store_dwordx4 v[16:19], v12, s[12:15], s34 offen offset:1280 sc1
    v_accvgpr_read_b32 v9, a16
    v_accvgpr_read_b32 v10, a17
    v_accvgpr_read_b32 v11, a18
    v_accvgpr_read_b32 v13, a19
    v_cvt_pk_bf16_f32 v20, v240, v241
    v_cvt_pk_bf16_f32 v21, v242, v243
    v_cvt_pk_bf16_f32 v22, v9, v10
    v_cvt_pk_bf16_f32 v23, v11, v13
    s_mov_b32 s34, 40960
    buffer_store_dwordx4 v[20:23], v12, s[12:15], s34 offen offset:2048 sc1
    v_accvgpr_read_b32 v9, a20
    v_accvgpr_read_b32 v10, a21
    v_accvgpr_read_b32 v11, a22
    v_accvgpr_read_b32 v13, a23
    v_cvt_pk_bf16_f32 v24, v244, v245
    v_cvt_pk_bf16_f32 v25, v246, v247
    v_cvt_pk_bf16_f32 v26, v9, v10
    v_cvt_pk_bf16_f32 v27, v11, v13
    s_mov_b32 s34, 40960
    buffer_store_dwordx4 v[24:27], v12, s[12:15], s34 offen offset:2304 sc1
    v_accvgpr_read_b32 v9, a24
    v_accvgpr_read_b32 v10, a25
    v_accvgpr_read_b32 v11, a26
    v_accvgpr_read_b32 v13, a27
    v_cvt_pk_bf16_f32 v16, v248, v249
    v_cvt_pk_bf16_f32 v17, v250, v251
    v_cvt_pk_bf16_f32 v18, v9, v10
    v_cvt_pk_bf16_f32 v19, v11, v13
    s_mov_b32 s34, 40960
    buffer_store_dwordx4 v[16:19], v12, s[12:15], s34 offen offset:3072 sc1
    v_accvgpr_read_b32 v9, a28
    v_accvgpr_read_b32 v10, a29
    v_accvgpr_read_b32 v11, a30
    v_accvgpr_read_b32 v13, a31
    v_cvt_pk_bf16_f32 v20, v252, v253
    v_cvt_pk_bf16_f32 v21, v254, v255
    v_cvt_pk_bf16_f32 v22, v9, v10
    v_cvt_pk_bf16_f32 v23, v11, v13
    s_mov_b32 s34, 40960
    buffer_store_dwordx4 v[20:23], v12, s[12:15], s34 offen offset:3328 sc1
KVE_100004:
    s_waitcnt vmcnt(32)
    s_barrier
    v_and_b32 v61, 31, v2
    v_lshlrev_b32 v61, 3, v61
    v_add_u32 v61, 4, v61
    buffer_load_dword v60, v61, s[84:87], 0 offen sc1
    ds_read_b64_tr_b16 a[64:65], v29 offset:0
    ds_read_b64_tr_b16 a[66:67], v29 offset:512
    ds_read_b64_tr_b16 a[68:69], v29 offset:2048
    ds_read_b64_tr_b16 a[70:71], v29 offset:2560
    ds_read_b64_tr_b16 a[72:73], v29 offset:4096
    ds_read_b64_tr_b16 a[74:75], v29 offset:4608
    ds_read_b64_tr_b16 a[76:77], v29 offset:6144
    ds_read_b64_tr_b16 a[78:79], v29 offset:6656
    ds_read_b64_tr_b16 a[80:81], v29 offset:8192
    ds_read_b64_tr_b16 a[82:83], v29 offset:8704
    ds_read_b64_tr_b16 a[84:85], v29 offset:10240
    ds_read_b64_tr_b16 a[86:87], v29 offset:10752
    ds_read_b64_tr_b16 a[88:89], v29 offset:12288
    ds_read_b64_tr_b16 a[90:91], v29 offset:12800
    ds_read_b64_tr_b16 a[92:93], v29 offset:14336
    ds_read_b64_tr_b16 a[94:95], v29 offset:14848
    s_waitcnt lgkmcnt(0)
    v_mfma_f32_32x32x16_bf16 v[32:47], a[64:67], a[160:163], 0
    ds_read_b64_tr_b16 a[96:97], v29 offset:16384
    ds_read_b64_tr_b16 a[98:99], v29 offset:16896
    v_mfma_f32_32x32x16_bf16 v[32:47], a[68:71], a[164:167], v[32:47]
    ds_read_b64_tr_b16 a[100:101], v29 offset:18432
    ds_read_b64_tr_b16 a[102:103], v29 offset:18944
    v_mfma_f32_32x32x16_bf16 v[32:47], a[72:75], a[168:171], v[32:47]
    ds_read_b64_tr_b16 a[104:105], v29 offset:20480
    ds_read_b64_tr_b16 a[106:107], v29 offset:20992
    v_mfma_f32_32x32x16_bf16 v[32:47], a[76:79], a[172:175], v[32:47]
    ds_read_b64_tr_b16 a[108:109], v29 offset:22528
    ds_read_b64_tr_b16 a[110:111], v29 offset:23040
    v_mfma_f32_32x32x16_bf16 v[32:47], a[80:83], a[176:179], v[32:47]
    ds_read_b64_tr_b16 a[112:113], v29 offset:24576
    ds_read_b64_tr_b16 a[114:115], v29 offset:25088
    v_mfma_f32_32x32x16_bf16 v[32:47], a[84:87], a[180:183], v[32:47]
    ds_read_b64_tr_b16 a[116:117], v29 offset:26624
    ds_read_b64_tr_b16 a[118:119], v29 offset:27136
    v_mfma_f32_32x32x16_bf16 v[32:47], a[88:91], a[184:187], v[32:47]
    ds_read_b64_tr_b16 a[120:121], v29 offset:28672
    ds_read_b64_tr_b16 a[122:123], v29 offset:29184
    v_mfma_f32_32x32x16_bf16 v[32:47], a[92:95], a[188:191], v[32:47]
    ds_read_b64_tr_b16 a[124:125], v29 offset:30720
    ds_read_b64_tr_b16 a[126:127], v29 offset:31232
    s_waitcnt lgkmcnt(0)
    v_mfma_f32_32x32x16_bf16 v[32:47], a[96:99], a[192:195], v[32:47]
    ds_read_b64_tr_b16 a[64:65], v28 offset:0
    ds_read_b64_tr_b16 a[66:67], v28 offset:512
    v_mfma_f32_32x32x16_bf16 v[32:47], a[100:103], a[196:199], v[32:47]
    ds_read_b64_tr_b16 a[68:69], v28 offset:2048
    ds_read_b64_tr_b16 a[70:71], v28 offset:2560
    v_mfma_f32_32x32x16_bf16 v[32:47], a[104:107], a[200:203], v[32:47]
    ds_read_b64_tr_b16 a[72:73], v28 offset:4096
    ds_read_b64_tr_b16 a[74:75], v28 offset:4608
    v_mfma_f32_32x32x16_bf16 v[32:47], a[108:111], a[204:207], v[32:47]
    ds_read_b64_tr_b16 a[76:77], v28 offset:6144
    ds_read_b64_tr_b16 a[78:79], v28 offset:6656
    v_mfma_f32_32x32x16_bf16 v[32:47], a[112:115], a[208:211], v[32:47]
    ds_read_b64_tr_b16 a[80:81], v28 offset:8192
    ds_read_b64_tr_b16 a[82:83], v28 offset:8704
    v_mfma_f32_32x32x16_bf16 v[32:47], a[116:119], a[212:215], v[32:47]
    ds_read_b64_tr_b16 a[84:85], v28 offset:10240
    ds_read_b64_tr_b16 a[86:87], v28 offset:10752
    v_mfma_f32_32x32x16_bf16 v[32:47], a[120:123], a[216:219], v[32:47]
    ds_read_b64_tr_b16 a[88:89], v28 offset:12288
    ds_read_b64_tr_b16 a[90:91], v28 offset:12800
    v_mfma_f32_32x32x16_bf16 v[32:47], a[124:127], a[220:223], v[32:47]
    ds_read_b64_tr_b16 a[92:93], v28 offset:14336
    ds_read_b64_tr_b16 a[94:95], v28 offset:14848
    s_waitcnt lgkmcnt(0)
    v_mfma_f32_32x32x16_bf16 v[32:47], a[64:67], a[224:227], v[32:47]
    ds_read_b64_tr_b16 a[96:97], v28 offset:16384
    ds_read_b64_tr_b16 a[98:99], v28 offset:16896
    v_mfma_f32_32x32x16_bf16 v[32:47], a[68:71], a[228:231], v[32:47]
    ds_read_b64_tr_b16 a[100:101], v28 offset:18432
    ds_read_b64_tr_b16 a[102:103], v28 offset:18944
    v_mfma_f32_32x32x16_bf16 v[32:47], a[72:75], a[232:235], v[32:47]
    ds_read_b64_tr_b16 a[104:105], v28 offset:20480
    ds_read_b64_tr_b16 a[106:107], v28 offset:20992
    v_mfma_f32_32x32x16_bf16 v[32:47], a[76:79], a[236:239], v[32:47]
    ds_read_b64_tr_b16 a[108:109], v28 offset:22528
    ds_read_b64_tr_b16 a[110:111], v28 offset:23040
    v_mfma_f32_32x32x16_bf16 v[32:47], a[80:83], a[240:243], v[32:47]
    ds_read_b64_tr_b16 a[112:113], v28 offset:24576
    ds_read_b64_tr_b16 a[114:115], v28 offset:25088
    v_mfma_f32_32x32x16_bf16 v[32:47], a[84:87], a[244:247], v[32:47]
    ds_read_b64_tr_b16 a[116:117], v28 offset:26624
    ds_read_b64_tr_b16 a[118:119], v28 offset:27136
    v_mfma_f32_32x32x16_bf16 v[32:47], a[88:91], a[248:251], v[32:47]
    ds_read_b64_tr_b16 a[120:121], v28 offset:28672
    ds_read_b64_tr_b16 a[122:123], v28 offset:29184
    v_mfma_f32_32x32x16_bf16 v[32:47], a[92:95], a[252:255], v[32:47]
    ds_read_b64_tr_b16 a[124:125], v28 offset:30720
    ds_read_b64_tr_b16 a[126:127], v28 offset:31232
    s_waitcnt lgkmcnt(0)
    v_mfma_f32_32x32x16_bf16 v[32:47], a[96:99], a[32:35], v[32:47]
    v_mfma_f32_32x32x16_bf16 v[32:47], a[100:103], a[36:39], v[32:47]
    v_mfma_f32_32x32x16_bf16 v[32:47], a[104:107], a[40:43], v[32:47]
    v_mfma_f32_32x32x16_bf16 v[32:47], a[108:111], a[44:47], v[32:47]
    v_mfma_f32_32x32x16_bf16 v[32:47], a[112:115], a[48:51], v[32:47]
    v_mfma_f32_32x32x16_bf16 v[32:47], a[116:119], a[52:55], v[32:47]
    v_mfma_f32_32x32x16_bf16 v[32:47], a[120:123], a[56:59], v[32:47]
    v_mfma_f32_32x32x16_bf16 v[32:47], a[124:127], a[60:63], v[32:47]
    v_mov_b32 v48, 0xc0135761
    v_mov_b32 v49, 0xc0135761
    v_mov_b32 v50, 0xbdd2d3e8
    v_mov_b32 v51, 0xbdd2d3e8
    s_nop 7
    s_nop 7
    v_pk_mul_f32 v[64:65], v[32:33], v[32:33]
    v_pk_mul_f32 v[66:67], v[34:35], v[34:35]
    v_pk_mul_f32 v[68:69], v[36:37], v[36:37]
    v_pk_mul_f32 v[70:71], v[38:39], v[38:39]
    v_pk_mul_f32 v[72:73], v[40:41], v[40:41]
    v_pk_mul_f32 v[74:75], v[42:43], v[42:43]
    v_pk_mul_f32 v[76:77], v[44:45], v[44:45]
    v_pk_mul_f32 v[78:79], v[46:47], v[46:47]
    v_pk_fma_f32 v[64:65], v[64:65], v[50:51], v[48:49]
    v_pk_fma_f32 v[66:67], v[66:67], v[50:51], v[48:49]
    v_pk_fma_f32 v[68:69], v[68:69], v[50:51], v[48:49]
    v_pk_fma_f32 v[70:71], v[70:71], v[50:51], v[48:49]
    v_pk_fma_f32 v[72:73], v[72:73], v[50:51], v[48:49]
    v_pk_fma_f32 v[74:75], v[74:75], v[50:51], v[48:49]
    v_pk_fma_f32 v[76:77], v[76:77], v[50:51], v[48:49]
    v_pk_fma_f32 v[78:79], v[78:79], v[50:51], v[48:49]
    v_pk_mul_f32 v[64:65], v[64:65], v[32:33]
    v_pk_mul_f32 v[66:67], v[66:67], v[34:35]
    v_pk_mul_f32 v[68:69], v[68:69], v[36:37]
    v_pk_mul_f32 v[70:71], v[70:71], v[38:39]
    v_pk_mul_f32 v[72:73], v[72:73], v[40:41]
    v_pk_mul_f32 v[74:75], v[74:75], v[42:43]
    v_pk_mul_f32 v[76:77], v[76:77], v[44:45]
    v_pk_mul_f32 v[78:79], v[78:79], v[46:47]
    v_exp_f32 v64, v64
    v_exp_f32 v65, v65
    v_exp_f32 v66, v66
    v_exp_f32 v67, v67
    v_exp_f32 v68, v68
    v_exp_f32 v69, v69
    v_exp_f32 v70, v70
    v_exp_f32 v71, v71
    v_exp_f32 v72, v72
    v_exp_f32 v73, v73
    v_exp_f32 v74, v74
    v_exp_f32 v75, v75
    v_exp_f32 v76, v76
    v_exp_f32 v77, v77
    v_exp_f32 v78, v78
    v_exp_f32 v79, v79
    s_nop 0
    v_add_f32 v64, 1.0, v64
    v_add_f32 v65, 1.0, v65
    v_add_f32 v66, 1.0, v66
    v_add_f32 v67, 1.0, v67
    v_add_f32 v68, 1.0, v68
    v_add_f32 v69, 1.0, v69
    v_add_f32 v70, 1.0, v70
    v_add_f32 v71, 1.0, v71
    v_add_f32 v72, 1.0, v72
    v_add_f32 v73, 1.0, v73
    v_add_f32 v74, 1.0, v74
    v_add_f32 v75, 1.0, v75
    v_add_f32 v76, 1.0, v76
    v_add_f32 v77, 1.0, v77
    v_add_f32 v78, 1.0, v78
    v_add_f32 v79, 1.0, v79
    v_rcp_f32 v64, v64
    v_rcp_f32 v65, v65
    v_rcp_f32 v66, v66
    v_rcp_f32 v67, v67
    v_rcp_f32 v68, v68
    v_rcp_f32 v69, v69
    v_rcp_f32 v70, v70
    v_rcp_f32 v71, v71
    v_rcp_f32 v72, v72
    v_rcp_f32 v73, v73
    v_rcp_f32 v74, v74
    v_rcp_f32 v75, v75
    v_rcp_f32 v76, v76
    v_rcp_f32 v77, v77
    v_rcp_f32 v78, v78
    v_rcp_f32 v79, v79
    s_nop 0
    v_pk_mul_f32 v[32:33], v[32:33], v[64:65]
    v_pk_mul_f32 v[34:35], v[34:35], v[66:67]
    v_pk_mul_f32 v[36:37], v[36:37], v[68:69]
    v_pk_mul_f32 v[38:39], v[38:39], v[70:71]
    v_pk_mul_f32 v[40:41], v[40:41], v[72:73]
    v_pk_mul_f32 v[42:43], v[42:43], v[74:75]
    v_pk_mul_f32 v[44:45], v[44:45], v[76:77]
    v_pk_mul_f32 v[46:47], v[46:47], v[78:79]
    v_cvt_pk_bf16_f32 v52, v32, v33
    v_cvt_pk_bf16_f32 v53, v34, v35
    v_cvt_pk_bf16_f32 v54, v36, v37
    v_cvt_pk_bf16_f32 v55, v38, v39
    v_cvt_pk_bf16_f32 v56, v40, v41
    v_cvt_pk_bf16_f32 v57, v42, v43
    v_cvt_pk_bf16_f32 v58, v44, v45
    v_cvt_pk_bf16_f32 v59, v46, v47
    buffer_store_dwordx4 v[52:55], v1, s[56:59], s90 offen sc1
    buffer_store_dwordx4 v[56:59], v1, s[56:59], s90 offen offset:512 sc1
    s_waitcnt vmcnt(2)
    v_and_b32 v60, 0xff, v60
    v_cmp_le_u32 vcc, 8, v60
    s_cmp_eq_u64 vcc, -1
    s_cbranch_scc0 GSPIN_100009
GOK_100010:
    s_branch K1E_100011
SPIN_100005:
    s_mov_b32 s34, 65536
SP_100012:
    v_mov_b32 v31, 0
    buffer_load_dword v31, v31, s[84:87], s88 offen sc1
    s_waitcnt vmcnt(0)
    v_readfirstlane_b32 s61, v31
    s_and_b32 s61, s61, 0xff
    s_cmp_ge_u32 s61, 8
    s_cbranch_scc1 OK_100006
    s_sleep 8
    s_sub_u32 s34, s34, 1
    s_cmp_lg_u32 s34, 0
    s_cbranch_scc1 SP_100012
    s_branch OK_100006
SPIN_100007:
    s_mov_b32 s34, 65536
SP_100013:
    v_mov_b32 v31, 0
    buffer_load_dword v31, v31, s[84:87], s88 offen sc1
    s_waitcnt vmcnt(0)
    v_readfirstlane_b32 s61, v31
    s_and_b32 s61, s61, 0xff
    s_cmp_ge_u32 s61, 8
    s_cbranch_scc1 OK_100008
    s_sleep 8
    s_sub_u32 s34, s34, 1
    s_cmp_lg_u32 s34, 0
    s_cbranch_scc1 SP_100013
    s_branch OK_100008
GSPIN_100009:
    s_mov_b32 s34, 65536
SP_100014:
    s_sleep 8
    buffer_load_dword v60, v61, s[84:87], 0 offen sc1
    s_waitcnt vmcnt(0)
    v_and_b32 v60, 0xff, v60
    v_cmp_le_u32 vcc, 8, v60
    s_cmp_eq_u64 vcc, -1
    s_cbranch_scc1 GOK_100010
    s_sub_u32 s34, s34, 1
    s_cmp_lg_u32 s34, 0
    s_cbranch_scc1 SP_100014
    s_branch GOK_100010
K1E_100011:
    s_getpc_b64 s[74:75]
PC_100015:
    s_lshr_b32 s72, s2, 3
    s_and_b32 s72, s72, 1
    s_lshl_b32 s72, s72, 14
    s_lshl_b32 s73, s16, 12
    s_add_u32 s72, s72, s73
    v_mbcnt_lo_u32_b32 v250, -1, 0
    v_mbcnt_hi_u32_b32 v250, -1, v250
    v_lshlrev_b32 v250, 6, v250
    v_add_u32 v250, s72, v250
    v_min_u32 v250, END_100001-PC_100015, v250
    v_mov_b32 v251, s75
    v_add_co_u32 v250, vcc, s74, v250
    s_nop 1
    v_addc_co_u32 v251, vcc, 0, v251, vcc
    global_load_dword v250, v[250:251], off
    s_barrier
    v_mbcnt_lo_u32_b32 v0, -1, 0
    v_mbcnt_hi_u32_b32 v0, -1, v0
    v_lshl_add_u32 v0, s16, 6, v0
    s_load_dwordx2 s[40:41], s[0:1], 16
    s_load_dwordx2 s[42:43], s[0:1], 104
    s_load_dwordx2 s[80:81], s[0:1], 64
    s_load_dwordx2 s[84:85], s[0:1], 96
    s_load_dwordx2 s[100:101], s[0:1], 72
    v_lshrrev_b32 v10, 6, v0
    v_and_b32 v11, 63, v0
    v_readfirstlane_b32 s20, v10
    s_and_b32 s21, s2, 7
    s_lshr_b32 s37, s2, 3
    s_and_b32 s37, s37, 3
    s_lshl_b32 s37, s37, 3
    s_add_u32 s21, s21, s37
    s_lshr_b32 s22, s2, 5
    s_lshl_b32 s31, s22, 2
    s_add_u32 s31, s31, s20
    s_sub_u32 s32, 15, s22
    s_lshl_b32 s32, s32, 2
    s_add_u32 s32, s32, s20
    s_lshl_b32 s30, s20, 12
    s_lshl_b32 s36, s21, 12
    v_lshlrev_b32 v2, 4, v11
    v_add_u32 v3, s30, v2
    s_cmp_eq_u32 s22, 0
    s_cselect_b32 s24, 0, 0x10000
    s_waitcnt lgkmcnt(0)
    s_lshl_b32 s37, s21, 20
    s_add_u32 s4, s42, s37
    s_addc_u32 s5, s43, 0
    s_mov_b32 s6, 0x100000
    s_mov_b32 s7, 0x00020000
    s_lshl_b32 s37, s21, 8
    s_add_u32 s8, s40, s37
    s_addc_u32 s9, s41, 0
    s_sub_u32 s10, 0x400000, s37
    s_mov_b32 s11, 0x00020000
    s_add_u32 s12, s42, 0x3000000
    s_addc_u32 s13, s43, 0
    s_mov_b32 s14, 0x200000
    s_mov_b32 s15, 0x00020000
    s_add_u32 s16, s42, 0x2000000
    s_addc_u32 s17, s43, 0
    s_mov_b32 s18, 0x1000000
    s_mov_b32 s19, 0x00020000
    s_add_u32 s56, s42, 0x5000000
    s_addc_u32 s57, s43, 0
    s_mov_b32 s58, 0x800000
    s_mov_b32 s59, 0x00020000
    v_lshrrev_b32 v13, 4, v11
    v_and_b32 v14, 15, v11
    v_lshlrev_b32 v15, 2, v13
    v_xor_b32 v15, v14, v15
    v_lshlrev_b32 v15, 4, v15
    v_lshl_add_u32 v12, v13, 13, v15
    s_lshl_b32 s37, s20, 18
    v_add_u32 v12, s37, v12
    v_and_b32 v18, 1, v13
    v_lshrrev_b32 v19, 5, v11
    v_lshl_add_u32 v20, v19, 4, v14
    v_lshlrev_b32 v20, 4, v20
    v_lshl_add_u32 v21, v18, 14, v20
    s_lshl_b32 s37, s31, 15
    v_add_u32 v16, s37, v21
    s_lshl_b32 s37, s32, 15
    v_add_u32 v17, s37, v21
    v_lshrrev_b32 v26, 2, v14
    v_lshrrev_b32 v27, 1, v13
    v_lshl_add_u32 v27, v27, 3, v26
    v_lshlrev_b32 v27, 8, v27
    v_bfe_u32 v28, v14, 1, 1
    v_lshl_add_u32 v28, v18, 1, v28
    v_lshl_add_u32 v27, v28, 4, v27
    v_and_b32 v28, 1, v14
    v_lshl_add_u32 v27, v28, 3, v27
    v_xor_b32 v28, 0, v26
    v_lshl_add_u32 v22, v28, 6, v27
    v_xor_b32 v28, 1, v26
    v_lshl_add_u32 v23, v28, 6, v27
    v_xor_b32 v28, 2, v26
    v_lshl_add_u32 v24, v28, 6, v27
    v_xor_b32 v28, 3, v26
    v_lshl_add_u32 v25, v28, 6, v27
    s_lshl_b32 s44, s20, 13
    s_mov_b32 s45, 0
    s_mov_b32 s46, 4096
    s_mov_b32 s47, 8192
    s_mov_b32 s48, 12288
    s_add_u32 m0, s44, 131072
    s_mov_b32 s39, 0
    buffer_load_dwordx4 v12, s[8:11], s39 offen lds
    s_add_u32 m0, s44, 132096
    s_mov_b32 s39, 32768
    buffer_load_dwordx4 v12, s[8:11], s39 offen lds
    s_add_u32 m0, s44, 133120
    s_mov_b32 s39, 65536
    buffer_load_dwordx4 v12, s[8:11], s39 offen lds
    s_add_u32 m0, s44, 134144
    s_mov_b32 s39, 98304
    buffer_load_dwordx4 v12, s[8:11], s39 offen lds
    s_add_u32 m0, s44, 135168
    s_mov_b32 s39, 131072
    buffer_load_dwordx4 v12, s[8:11], s39 offen lds
    s_add_u32 m0, s44, 136192
    s_mov_b32 s39, 163840
    buffer_load_dwordx4 v12, s[8:11], s39 offen lds
    s_add_u32 m0, s44, 137216
    s_mov_b32 s39, 196608
    buffer_load_dwordx4 v12, s[8:11], s39 offen lds
    s_add_u32 m0, s44, 138240
    s_mov_b32 s39, 229376
    buffer_load_dwordx4 v12, s[8:11], s39 offen lds
    buffer_load_dwordx4 a[0:3], v16, s[12:15], s45 offen offset:0
    buffer_load_dwordx4 a[32:35], v17, s[12:15], s45 offen offset:0
    buffer_load_dwordx4 a[4:7], v16, s[12:15], s45 offen offset:512
    buffer_load_dwordx4 a[36:39], v17, s[12:15], s45 offen offset:512
    buffer_load_dwordx4 a[8:11], v16, s[12:15], s45 offen offset:1024
    buffer_load_dwordx4 a[40:43], v17, s[12:15], s45 offen offset:1024
    buffer_load_dwordx4 a[12:15], v16, s[12:15], s45 offen offset:1536
    buffer_load_dwordx4 a[44:47], v17, s[12:15], s45 offen offset:1536
    buffer_load_dwordx4 a[16:19], v16, s[12:15], s45 offen offset:2048
    buffer_load_dwordx4 a[48:51], v17, s[12:15], s45 offen offset:2048
    buffer_load_dwordx4 a[20:23], v16, s[12:15], s45 offen offset:2560
    buffer_load_dwordx4 a[52:55], v17, s[12:15], s45 offen offset:2560
    buffer_load_dwordx4 a[24:27], v16, s[12:15], s45 offen offset:3072
    buffer_load_dwordx4 a[56:59], v17, s[12:15], s45 offen offset:3072
    buffer_load_dwordx4 a[28:31], v16, s[12:15], s45 offen offset:3584
    buffer_load_dwordx4 a[60:63], v17, s[12:15], s45 offen offset:3584
    s_add_u32 m0, s44, 65536
    s_mov_b32 s39, 1048576
    buffer_load_dwordx4 v12, s[8:11], s39 offen lds
    s_add_u32 m0, s44, 66560
    s_mov_b32 s39, 1081344
    buffer_load_dwordx4 v12, s[8:11], s39 offen lds
    s_add_u32 m0, s44, 67584
    s_mov_b32 s39, 1114112
    buffer_load_dwordx4 v12, s[8:11], s39 offen lds
    s_add_u32 m0, s44, 68608
    s_mov_b32 s39, 1146880
    buffer_load_dwordx4 v12, s[8:11], s39 offen lds
    s_add_u32 m0, s44, 69632
    s_mov_b32 s39, 1179648
    buffer_load_dwordx4 v12, s[8:11], s39 offen lds
    s_add_u32 m0, s44, 70656
    s_mov_b32 s39, 1212416
    buffer_load_dwordx4 v12, s[8:11], s39 offen lds
    s_add_u32 m0, s44, 71680
    s_mov_b32 s39, 1245184
    buffer_load_dwordx4 v12, s[8:11], s39 offen lds
    s_add_u32 m0, s44, 72704
    s_mov_b32 s39, 1277952
    buffer_load_dwordx4 v12, s[8:11], s39 offen lds
    s_and_b32 s49, s2, 7
    s_lshr_b32 s60, s2, 6
    s_and_b32 s60, s60, 3
    s_lshl_b32 s60, s60, 3
    s_add_u32 s49, s49, s60
    s_lshr_b32 s55, s2, 3
    s_and_b32 s55, s55, 7
    s_lshl_b32 s60, s49, 6
    s_lshr_b32 s61, s20, 1
    s_lshl_b32 s61, s61, 5
    s_add_u32 s60, s60, s61
    v_and_b32 v103, 31, v11
    v_add_u32 v103, s60, v103
    v_lshrrev_b32 v104, 5, v11
    v_lshlrev_b32 v104, 8, v104
    v_lshrrev_b32 v105, 4, v103
    v_lshlrev_b32 v105, 14, v105
    v_and_b32 v106, 15, v103
    v_lshl_add_u32 v105, v106, 4, v105
    v_add_u32 v96, v105, v104
    v_add_u32 v107, -1, v103
    v_lshrrev_b32 v105, 4, v107
    v_lshlrev_b32 v105, 14, v105
    v_and_b32 v106, 15, v107
    v_lshl_add_u32 v105, v106, 4, v105
    v_add_u32 v97, v105, v104
    v_mov_b32 v108, 0x800
    v_cmp_gt_u32 vcc, v108, v107
    v_bfrev_b32 v108, 1
    v_cndmask_b32 v97, v108, v97, vcc
    v_add_u32 v107, 1, v103
    v_lshrrev_b32 v105, 4, v107
    v_lshlrev_b32 v105, 14, v105
    v_and_b32 v106, 15, v107
    v_lshl_add_u32 v105, v106, 4, v105
    v_add_u32 v98, v105, v104
    v_mov_b32 v108, 0x800
    v_cmp_gt_u32 vcc, v108, v107
    v_bfrev_b32 v108, 1
    v_cndmask_b32 v98, v108, v98, vcc
    v_add_u32 v107, -2, v103
    v_lshrrev_b32 v105, 4, v107
    v_lshlrev_b32 v105, 14, v105
    v_and_b32 v106, 15, v107
    v_lshl_add_u32 v105, v106, 4, v105
    v_add_u32 v99, v105, v104
    v_mov_b32 v108, 0x800
    v_cmp_gt_u32 vcc, v108, v107
    v_bfrev_b32 v108, 1
    v_cndmask_b32 v99, v108, v99, vcc
    v_add_u32 v107, 2, v103
    v_lshrrev_b32 v105, 4, v107
    v_lshlrev_b32 v105, 14, v105
    v_and_b32 v106, 15, v107
    v_lshl_add_u32 v105, v106, 4, v105
    v_add_u32 v100, v105, v104
    v_mov_b32 v108, 0x800
    v_cmp_gt_u32 vcc, v108, v107
    v_bfrev_b32 v108, 1
    v_cndmask_b32 v100, v108, v100, vcc
    v_lshrrev_b32 v104, 3, v11
    v_lshlrev_b32 v104, 10, v104
    v_bfe_u32 v105, v11, 4, 1
    v_lshlrev_b32 v105, 2, v105
    v_and_b32 v106, 7, v11
    v_xor_b32 v105, v105, v106
    v_lshl_add_u32 v101, v105, 4, v104
    s_lshl_b32 s60, s20, 15
    v_add_u32 v101, s60, v101
    v_and_b32 v104, 15, v11
    v_lshrrev_b32 v105, 4, v11
    v_lshrrev_b32 v106, 1, v105
    v_lshlrev_b32 v106, 3, v106
    v_lshrrev_b32 v107, 2, v104
    v_add_u32 v106, v106, v107
    v_and_b32 v105, 1, v105
    v_lshlrev_b32 v105, 1, v105
    v_and_b32 v107, 1, v104
    v_add_u32 v105, v105, v107
    s_and_b32 s60, s20, 1
    s_lshl_b32 s60, s60, 2
    v_add_u32 v105, s60, v105
    v_bfe_u32 v107, v104, 3, 1
    v_lshlrev_b32 v107, 2, v107
    v_xor_b32 v105, v105, v107
    v_lshlrev_b32 v105, 4, v105
    v_lshl_add_u32 v102, v106, 7, v105
    v_bfe_u32 v107, v104, 1, 1
    v_lshl_add_u32 v102, v107, 3, v102
    s_lshl_b32 s60, s49, 3
    v_mov_b32 v62, s60
    v_bfrev_b32 v104, 1
    s_lshl_b32 s61, s20, 6
    v_add_u32 v105, s61, v11
    v_cmp_eq_u32 vcc, 0, v105
    s_nop 1
    v_cndmask_b32 v62, v104, v62, vcc
    v_mov_b32 v63, 1
    s_lshl_b32 s60, s55, 7
    s_add_u32 s80, s80, s60
    s_addc_u32 s81, s81, 0
    s_sub_u32 s82, 0x80000, s60
    s_mov_b32 s83, 0x00020000
    s_add_u32 s76, s42, 0x3200000
    s_addc_u32 s77, s43, 0
    s_mov_b32 s78, 0xdc0000
    s_mov_b32 s79, 0x00020000
    s_mov_b32 s86, 256
    s_mov_b32 s87, 0x00020000
    s_lshl_b32 s88, s20, 12
    s_lshl_b32 s89, s55, 1
    s_and_b32 s60, s20, 1
    s_add_u32 s89, s89, s60
    s_lshl_b32 s90, s89, 3
    s_add_u32 s90, s90, 0xd80000
    s_lshl_b32 s89, s89, 10
    s_lshr_b32 s37, s2, 3
    s_lshl_b32 s37, s37, 3
    s_add_u32 s37, s37, 4
    v_mov_b32 v58, s37
    v_bfrev_b32 v59, 1
    s_lshl_b32 s37, s20, 6
    v_add_u32 v56, s37, v11
    v_cmp_eq_u32 vcc, 0, v56
    s_nop 1
    v_cndmask_b32 v58, v59, v58, vcc
    v_mov_b32 v59, 0x100
    v_and_b32 v56, 31, v11
    v_lshlrev_b32 v56, 3, v56
    v_add_u32 v56, 4, v56
    v_add_u32 v22, 131072, v22
    v_add_u32 v23, 131072, v23
    v_add_u32 v24, 131072, v24
    v_add_u32 v25, 131072, v25
    s_waitcnt vmcnt(8)
    s_barrier
    buffer_atomic_add v59, v58, s[84:87], 0 offen sc1
    ds_read_b64_tr_b16 a[128:129], v22 offset:0
    ds_read_b64_tr_b16 a[130:131], v22 offset:1024
    ds_read_b64_tr_b16 a[132:133], v23 offset:0
    ds_read_b64_tr_b16 a[134:135], v23 offset:1024
    ds_read_b64_tr_b16 a[136:137], v24 offset:0
    ds_read_b64_tr_b16 a[138:139], v24 offset:1024
    ds_read_b64_tr_b16 a[140:141], v25 offset:0
    ds_read_b64_tr_b16 a[142:143], v25 offset:1024
    s_waitcnt lgkmcnt(0)
    v_mfma_f32_32x32x16_bf16 v[128:143], a[128:131], a[0:3], 0
    ds_read_b64_tr_b16 a[144:145], v22 offset:4096
    buffer_load_dwordx4 a[64:67], v16, s[12:15], s46 offen offset:0
    v_mfma_f32_32x32x16_bf16 v[192:207], a[128:131], a[32:35], 0
    ds_read_b64_tr_b16 a[146:147], v22 offset:5120
    v_mfma_f32_32x32x16_bf16 v[144:159], a[132:135], a[0:3], 0
    ds_read_b64_tr_b16 a[148:149], v23 offset:4096
    buffer_load_dwordx4 a[96:99], v17, s[12:15], s46 offen offset:0
    v_mfma_f32_32x32x16_bf16 v[208:223], a[132:135], a[32:35], 0
    ds_read_b64_tr_b16 a[150:151], v23 offset:5120
    v_mfma_f32_32x32x16_bf16 v[160:175], a[136:139], a[0:3], 0
    ds_read_b64_tr_b16 a[152:153], v24 offset:4096
    buffer_load_dwordx4 a[68:71], v16, s[12:15], s46 offen offset:512
    v_mfma_f32_32x32x16_bf16 v[224:239], a[136:139], a[32:35], 0
    ds_read_b64_tr_b16 a[154:155], v24 offset:5120
    v_mfma_f32_32x32x16_bf16 v[176:191], a[140:143], a[0:3], 0
    ds_read_b64_tr_b16 a[156:157], v25 offset:4096
    buffer_load_dwordx4 a[100:103], v17, s[12:15], s46 offen offset:512
    v_mfma_f32_32x32x16_bf16 v[240:255], a[140:143], a[32:35], 0
    ds_read_b64_tr_b16 a[158:159], v25 offset:5120
    s_waitcnt lgkmcnt(0)
    v_mfma_f32_32x32x16_bf16 v[128:143], a[144:147], a[4:7], v[128:143]
    ds_read_b64_tr_b16 a[128:129], v22 offset:8192
    buffer_load_dwordx4 a[72:75], v16, s[12:15], s46 offen offset:1024
    v_mfma_f32_32x32x16_bf16 v[192:207], a[144:147], a[36:39], v[192:207]
    ds_read_b64_tr_b16 a[130:131], v22 offset:9216
    buffer_load_dwordx4 a[104:107], v17, s[12:15], s46 offen offset:1024
    v_mfma_f32_32x32x16_bf16 v[144:159], a[148:151], a[4:7], v[144:159]
    ds_read_b64_tr_b16 a[132:133], v23 offset:8192
    buffer_load_dwordx4 a[76:79], v16, s[12:15], s46 offen offset:1536
    v_mfma_f32_32x32x16_bf16 v[208:223], a[148:151], a[36:39], v[208:223]
    ds_read_b64_tr_b16 a[134:135], v23 offset:9216
    v_mfma_f32_32x32x16_bf16 v[160:175], a[152:155], a[4:7], v[160:175]
    ds_read_b64_tr_b16 a[136:137], v24 offset:8192
    buffer_load_dwordx4 a[108:111], v17, s[12:15], s46 offen offset:1536
    v_mfma_f32_32x32x16_bf16 v[224:239], a[152:155], a[36:39], v[224:239]
    ds_read_b64_tr_b16 a[138:139], v24 offset:9216
    buffer_load_dwordx4 a[0:3], v16, s[12:15], s47 offen offset:0
    v_mfma_f32_32x32x16_bf16 v[176:191], a[156:159], a[4:7], v[176:191]
    ds_read_b64_tr_b16 a[140:141], v25 offset:8192
    buffer_load_dwordx4 a[32:35], v17, s[12:15], s47 offen offset:0
    v_mfma_f32_32x32x16_bf16 v[240:255], a[156:159], a[36:39], v[240:255]
    ds_read_b64_tr_b16 a[142:143], v25 offset:9216
    s_waitcnt lgkmcnt(0)
    v_mfma_f32_32x32x16_bf16 v[128:143], a[128:131], a[8:11], v[128:143]
    ds_read_b64_tr_b16 a[144:145], v22 offset:12288
    buffer_load_dwordx4 a[80:83], v16, s[12:15], s46 offen offset:2048
    v_mfma_f32_32x32x16_bf16 v[192:207], a[128:131], a[40:43], v[192:207]
    ds_read_b64_tr_b16 a[146:147], v22 offset:13312
    buffer_load_dwordx4 a[112:115], v17, s[12:15], s46 offen offset:2048
    v_mfma_f32_32x32x16_bf16 v[144:159], a[132:135], a[8:11], v[144:159]
    ds_read_b64_tr_b16 a[148:149], v23 offset:12288
    buffer_load_dwordx4 a[84:87], v16, s[12:15], s46 offen offset:2560
    v_mfma_f32_32x32x16_bf16 v[208:223], a[132:135], a[40:43], v[208:223]
    ds_read_b64_tr_b16 a[150:151], v23 offset:13312
    v_mfma_f32_32x32x16_bf16 v[160:175], a[136:139], a[8:11], v[160:175]
    ds_read_b64_tr_b16 a[152:153], v24 offset:12288
    buffer_load_dwordx4 a[116:119], v17, s[12:15], s46 offen offset:2560
    v_mfma_f32_32x32x16_bf16 v[224:239], a[136:139], a[40:43], v[224:239]
    ds_read_b64_tr_b16 a[154:155], v24 offset:13312
    buffer_load_dwordx4 a[4:7], v16, s[12:15], s47 offen offset:512
    v_mfma_f32_32x32x16_bf16 v[176:191], a[140:143], a[8:11], v[176:191]
    ds_read_b64_tr_b16 a[156:157], v25 offset:12288
    buffer_load_dwordx4 a[36:39], v17, s[12:15], s47 offen offset:512
    v_mfma_f32_32x32x16_bf16 v[240:255], a[140:143], a[40:43], v[240:255]
    ds_read_b64_tr_b16 a[158:159], v25 offset:13312
    s_waitcnt lgkmcnt(0)
    v_mfma_f32_32x32x16_bf16 v[128:143], a[144:147], a[12:15], v[128:143]
    ds_read_b64_tr_b16 a[128:129], v22 offset:16384
    buffer_load_dwordx4 a[88:91], v16, s[12:15], s46 offen offset:3072
    v_mfma_f32_32x32x16_bf16 v[192:207], a[144:147], a[44:47], v[192:207]
    ds_read_b64_tr_b16 a[130:131], v22 offset:17408
    buffer_load_dwordx4 a[120:123], v17, s[12:15], s46 offen offset:3072
    v_mfma_f32_32x32x16_bf16 v[144:159], a[148:151], a[12:15], v[144:159]
    ds_read_b64_tr_b16 a[132:133], v23 offset:16384
    buffer_load_dwordx4 a[92:95], v16, s[12:15], s46 offen offset:3584
    v_mfma_f32_32x32x16_bf16 v[208:223], a[148:151], a[44:47], v[208:223]
    ds_read_b64_tr_b16 a[134:135], v23 offset:17408
    v_mfma_f32_32x32x16_bf16 v[160:175], a[152:155], a[12:15], v[160:175]
    ds_read_b64_tr_b16 a[136:137], v24 offset:16384
    buffer_load_dwordx4 a[124:127], v17, s[12:15], s46 offen offset:3584
    v_mfma_f32_32x32x16_bf16 v[224:239], a[152:155], a[44:47], v[224:239]
    ds_read_b64_tr_b16 a[138:139], v24 offset:17408
    buffer_load_dwordx4 a[8:11], v16, s[12:15], s47 offen offset:1024
    v_mfma_f32_32x32x16_bf16 v[176:191], a[156:159], a[12:15], v[176:191]
    ds_read_b64_tr_b16 a[140:141], v25 offset:16384
    buffer_load_dwordx4 a[40:43], v17, s[12:15], s47 offen offset:1024
    v_mfma_f32_32x32x16_bf16 v[240:255], a[156:159], a[44:47], v[240:255]
    ds_read_b64_tr_b16 a[142:143], v25 offset:17408
    s_waitcnt lgkmcnt(0)
    v_mfma_f32_32x32x16_bf16 v[128:143], a[128:131], a[16:19], v[128:143]
    ds_read_b64_tr_b16 a[144:145], v22 offset:20480
    s_add_u32 m0, s44, 98304
    s_mov_b32 s39, 2097152
    v_mfma_f32_32x32x16_bf16 v[192:207], a[128:131], a[48:51], v[192:207]
    ds_read_b64_tr_b16 a[146:147], v22 offset:21504
    buffer_load_dwordx4 v12, s[8:11], s39 offen lds
    s_add_u32 m0, s44, 99328
    v_mfma_f32_32x32x16_bf16 v[144:159], a[132:135], a[16:19], v[144:159]
    ds_read_b64_tr_b16 a[148:149], v23 offset:20480
    s_mov_b32 s39, 2129920
    buffer_load_dwordx4 v12, s[8:11], s39 offen lds
    v_mfma_f32_32x32x16_bf16 v[208:223], a[132:135], a[48:51], v[208:223]
    ds_read_b64_tr_b16 a[150:151], v23 offset:21504
    s_add_u32 m0, s44, 100352
    v_mfma_f32_32x32x16_bf16 v[160:175], a[136:139], a[16:19], v[160:175]
    ds_read_b64_tr_b16 a[152:153], v24 offset:20480
    s_mov_b32 s39, 2162688
    buffer_load_dwordx4 v12, s[8:11], s39 offen lds
    v_mfma_f32_32x32x16_bf16 v[224:239], a[136:139], a[48:51], v[224:239]
    ds_read_b64_tr_b16 a[154:155], v24 offset:21504
    s_add_u32 m0, s44, 101376
    s_mov_b32 s39, 2195456
    v_mfma_f32_32x32x16_bf16 v[176:191], a[140:143], a[16:19], v[176:191]
    ds_read_b64_tr_b16 a[156:157], v25 offset:20480
    buffer_load_dwordx4 v12, s[8:11], s39 offen lds
    buffer_load_dwordx4 a[12:15], v16, s[12:15], s47 offen offset:1536
    v_mfma_f32_32x32x16_bf16 v[240:255], a[140:143], a[48:51], v[240:255]
    ds_read_b64_tr_b16 a[158:159], v25 offset:21504
    buffer_load_dwordx4 a[44:47], v17, s[12:15], s47 offen offset:1536
    s_waitcnt lgkmcnt(0)
    v_mfma_f32_32x32x16_bf16 v[128:143], a[144:147], a[20:23], v[128:143]
    ds_read_b64_tr_b16 a[128:129], v22 offset:24576
    s_add_u32 m0, s44, 102400
    s_mov_b32 s39, 2228224
    v_mfma_f32_32x32x16_bf16 v[192:207], a[144:147], a[52:55], v[192:207]
    ds_read_b64_tr_b16 a[130:131], v22 offset:25600
    buffer_load_dwordx4 v12, s[8:11], s39 offen lds
    s_add_u32 m0, s44, 103424
    v_mfma_f32_32x32x16_bf16 v[144:159], a[148:151], a[20:23], v[144:159]
    ds_read_b64_tr_b16 a[132:133], v23 offset:24576
    s_mov_b32 s39, 2260992
    buffer_load_dwordx4 v12, s[8:11], s39 offen lds
    v_mfma_f32_32x32x16_bf16 v[208:223], a[148:151], a[52:55], v[208:223]
    ds_read_b64_tr_b16 a[134:135], v23 offset:25600
    s_add_u32 m0, s44, 104448
    v_mfma_f32_32x32x16_bf16 v[160:175], a[152:155], a[20:23], v[160:175]
    ds_read_b64_tr_b16 a[136:137], v24 offset:24576
    s_mov_b32 s39, 2293760
    buffer_load_dwordx4 v12, s[8:11], s39 offen lds
    v_mfma_f32_32x32x16_bf16 v[224:239], a[152:155], a[52:55], v[224:239]
    ds_read_b64_tr_b16 a[138:139], v24 offset:25600
    s_add_u32 m0, s44, 105472
    s_mov_b32 s39, 2326528
    v_mfma_f32_32x32x16_bf16 v[176:191], a[156:159], a[20:23], v[176:191]
    ds_read_b64_tr_b16 a[140:141], v25 offset:24576
    buffer_load_dwordx4 v12, s[8:11], s39 offen lds
    buffer_load_dwordx4 a[16:19], v16, s[12:15], s47 offen offset:2048
    v_mfma_f32_32x32x16_bf16 v[240:255], a[156:159], a[52:55], v[240:255]
    ds_read_b64_tr_b16 a[142:143], v25 offset:25600
    buffer_load_dwordx4 a[48:51], v17, s[12:15], s47 offen offset:2048
    s_waitcnt lgkmcnt(0)
    v_mfma_f32_32x32x16_bf16 v[128:143], a[128:131], a[24:27], v[128:143]
    ds_read_b64_tr_b16 a[144:145], v22 offset:28672
    buffer_load_dwordx4 a[20:23], v16, s[12:15], s47 offen offset:2560
    v_mfma_f32_32x32x16_bf16 v[192:207], a[128:131], a[56:59], v[192:207]
    ds_read_b64_tr_b16 a[146:147], v22 offset:29696
    v_mfma_f32_32x32x16_bf16 v[144:159], a[132:135], a[24:27], v[144:159]
    ds_read_b64_tr_b16 a[148:149], v23 offset:28672
    v_mfma_f32_32x32x16_bf16 v[208:223], a[132:135], a[56:59], v[208:223]
    ds_read_b64_tr_b16 a[150:151], v23 offset:29696
    v_mfma_f32_32x32x16_bf16 v[160:175], a[136:139], a[24:27], v[160:175]
    ds_read_b64_tr_b16 a[152:153], v24 offset:28672
    buffer_load_dwordx4 a[52:55], v17, s[12:15], s47 offen offset:2560
    v_mfma_f32_32x32x16_bf16 v[224:239], a[136:139], a[56:59], v[224:239]
    ds_read_b64_tr_b16 a[154:155], v24 offset:29696
    v_mfma_f32_32x32x16_bf16 v[176:191], a[140:143], a[24:27], v[176:191]
    ds_read_b64_tr_b16 a[156:157], v25 offset:28672
    v_mfma_f32_32x32x16_bf16 v[240:255], a[140:143], a[56:59], v[240:255]
    ds_read_b64_tr_b16 a[158:159], v25 offset:29696
    s_waitcnt vmcnt(16) lgkmcnt(0)
    s_barrier
    v_subrev_u32 v22, 65536, v22
    v_subrev_u32 v23, 65536, v23
    v_subrev_u32 v24, 65536, v24
    v_subrev_u32 v25, 65536, v25
    v_mfma_f32_32x32x16_bf16 v[128:143], a[144:147], a[28:31], v[128:143]
    ds_read_b64_tr_b16 a[128:129], v22 offset:0
    buffer_load_dwordx4 a[24:27], v16, s[12:15], s47 offen offset:3072
    buffer_load_dwordx4 a[56:59], v17, s[12:15], s47 offen offset:3072
    s_add_u32 m0, s44, 131072
    s_mov_b32 s39, 3145728
    v_mfma_f32_32x32x16_bf16 v[192:207], a[144:147], a[60:63], v[192:207]
    ds_read_b64_tr_b16 a[130:131], v22 offset:1024
    buffer_load_dwordx4 v12, s[8:11], s39 offen lds
    s_add_u32 m0, s44, 132096
    s_mov_b32 s39, 3178496
    v_mfma_f32_32x32x16_bf16 v[144:159], a[148:151], a[28:31], v[144:159]
    ds_read_b64_tr_b16 a[132:133], v23 offset:0
    buffer_load_dwordx4 v12, s[8:11], s39 offen lds
    s_add_u32 m0, s44, 133120
    s_mov_b32 s39, 3211264
    v_mfma_f32_32x32x16_bf16 v[208:223], a[148:151], a[60:63], v[208:223]
    ds_read_b64_tr_b16 a[134:135], v23 offset:1024
    buffer_load_dwordx4 v12, s[8:11], s39 offen lds
    s_add_u32 m0, s44, 134144
    s_mov_b32 s39, 3244032
    v_mfma_f32_32x32x16_bf16 v[160:175], a[152:155], a[28:31], v[160:175]
    ds_read_b64_tr_b16 a[136:137], v24 offset:0
    buffer_load_dwordx4 v12, s[8:11], s39 offen lds
    s_add_u32 m0, s44, 135168
    s_mov_b32 s39, 3276800
    buffer_load_dwordx4 v12, s[8:11], s39 offen lds
    v_mfma_f32_32x32x16_bf16 v[224:239], a[152:155], a[60:63], v[224:239]
    ds_read_b64_tr_b16 a[138:139], v24 offset:1024
    s_add_u32 m0, s44, 136192
    s_mov_b32 s39, 3309568
    buffer_load_dwordx4 v12, s[8:11], s39 offen lds
    v_mfma_f32_32x32x16_bf16 v[176:191], a[156:159], a[28:31], v[176:191]
    ds_read_b64_tr_b16 a[140:141], v25 offset:0
    s_add_u32 m0, s44, 137216
    s_mov_b32 s39, 3342336
    buffer_load_dwordx4 v12, s[8:11], s39 offen lds
    v_mfma_f32_32x32x16_bf16 v[240:255], a[156:159], a[60:63], v[240:255]
    ds_read_b64_tr_b16 a[142:143], v25 offset:1024
    s_add_u32 m0, s44, 138240
    s_mov_b32 s39, 3375104
    buffer_load_dwordx4 v12, s[8:11], s39 offen lds
    buffer_load_dwordx4 a[28:31], v16, s[12:15], s47 offen offset:3584
    buffer_load_dwordx4 a[60:63], v17, s[12:15], s47 offen offset:3584
    s_waitcnt lgkmcnt(0)
    v_mfma_f32_32x32x16_bf16 v[128:143], a[128:131], a[64:67], v[128:143]
    ds_read_b64_tr_b16 a[144:145], v22 offset:4096
    s_add_u32 m0, s88, 0
    v_mfma_f32_32x32x16_bf16 v[192:207], a[128:131], a[96:99], v[192:207]
    ds_read_b64_tr_b16 a[146:147], v22 offset:5120
    s_mov_b32 s61, 0
    v_mfma_f32_32x32x16_bf16 v[144:159], a[132:135], a[64:67], v[144:159]
    ds_read_b64_tr_b16 a[148:149], v23 offset:4096
    buffer_load_dwordx4 v101, s[80:83], s61 offen lds
    v_mfma_f32_32x32x16_bf16 v[208:223], a[132:135], a[96:99], v[208:223]
    ds_read_b64_tr_b16 a[150:151], v23 offset:5120
    v_mfma_f32_32x32x16_bf16 v[160:175], a[136:139], a[64:67], v[160:175]
    ds_read_b64_tr_b16 a[152:153], v24 offset:4096
    s_add_u32 m0, s88, 1024
    v_mfma_f32_32x32x16_bf16 v[224:239], a[136:139], a[96:99], v[224:239]
    ds_read_b64_tr_b16 a[154:155], v24 offset:5120
    s_mov_b32 s61, 8192
    v_mfma_f32_32x32x16_bf16 v[176:191], a[140:143], a[64:67], v[176:191]
    ds_read_b64_tr_b16 a[156:157], v25 offset:4096
    buffer_load_dwordx4 v101, s[80:83], s61 offen lds
    v_mfma_f32_32x32x16_bf16 v[240:255], a[140:143], a[96:99], v[240:255]
    ds_read_b64_tr_b16 a[158:159], v25 offset:5120
    s_waitcnt lgkmcnt(0)
    v_mfma_f32_32x32x16_bf16 v[128:143], a[144:147], a[68:71], v[128:143]
    ds_read_b64_tr_b16 a[128:129], v22 offset:8192
    s_add_u32 m0, s88, 2048
    v_mfma_f32_32x32x16_bf16 v[192:207], a[144:147], a[100:103], v[192:207]
    ds_read_b64_tr_b16 a[130:131], v22 offset:9216
    s_mov_b32 s61, 16384
    v_mfma_f32_32x32x16_bf16 v[144:159], a[148:151], a[68:71], v[144:159]
    ds_read_b64_tr_b16 a[132:133], v23 offset:8192
    buffer_load_dwordx4 v101, s[80:83], s61 offen lds
    v_mfma_f32_32x32x16_bf16 v[208:223], a[148:151], a[100:103], v[208:223]
    ds_read_b64_tr_b16 a[134:135], v23 offset:9216
    s_add_u32 m0, s88, 3072
    v_mfma_f32_32x32x16_bf16 v[160:175], a[152:155], a[68:71], v[160:175]
    ds_read_b64_tr_b16 a[136:137], v24 offset:8192
    s_mov_b32 s61, 24576
    v_mfma_f32_32x32x16_bf16 v[224:239], a[152:155], a[100:103], v[224:239]
    ds_read_b64_tr_b16 a[138:139], v24 offset:9216
    buffer_load_dwordx4 v101, s[80:83], s61 offen lds
    v_mfma_f32_32x32x16_bf16 v[176:191], a[156:159], a[68:71], v[176:191]
    ds_read_b64_tr_b16 a[140:141], v25 offset:8192
    buffer_load_dwordx4 a[64:67], v16, s[12:15], s48 offen offset:0
    v_mfma_f32_32x32x16_bf16 v[240:255], a[156:159], a[100:103], v[240:255]
    ds_read_b64_tr_b16 a[142:143], v25 offset:9216
    buffer_load_dwordx4 a[96:99], v17, s[12:15], s48 offen offset:0
    s_waitcnt lgkmcnt(0)
    v_mfma_f32_32x32x16_bf16 v[128:143], a[128:131], a[72:75], v[128:143]
    ds_read_b64_tr_b16 a[144:145], v22 offset:12288
    s_add_u32 m0, s88, 16384
    v_mfma_f32_32x32x16_bf16 v[192:207], a[128:131], a[104:107], v[192:207]
    ds_read_b64_tr_b16 a[146:147], v22 offset:13312
    s_mov_b32 s61, 131072
    v_mfma_f32_32x32x16_bf16 v[144:159], a[132:135], a[72:75], v[144:159]
    ds_read_b64_tr_b16 a[148:149], v23 offset:12288
    buffer_load_dwordx4 v101, s[80:83], s61 offen lds
    v_mfma_f32_32x32x16_bf16 v[208:223], a[132:135], a[104:107], v[208:223]
    ds_read_b64_tr_b16 a[150:151], v23 offset:13312
    s_add_u32 m0, s88, 17408
    v_mfma_f32_32x32x16_bf16 v[160:175], a[136:139], a[72:75], v[160:175]
    ds_read_b64_tr_b16 a[152:153], v24 offset:12288
    s_mov_b32 s61, 139264
    v_mfma_f32_32x32x16_bf16 v[224:239], a[136:139], a[104:107], v[224:239]
    ds_read_b64_tr_b16 a[154:155], v24 offset:13312
    buffer_load_dwordx4 v101, s[80:83], s61 offen lds
    v_mfma_f32_32x32x16_bf16 v[176:191], a[140:143], a[72:75], v[176:191]
    ds_read_b64_tr_b16 a[156:157], v25 offset:12288
    buffer_load_dwordx4 a[68:71], v16, s[12:15], s48 offen offset:512
    v_mfma_f32_32x32x16_bf16 v[240:255], a[140:143], a[104:107], v[240:255]
    ds_read_b64_tr_b16 a[158:159], v25 offset:13312
    buffer_load_dwordx4 a[100:103], v17, s[12:15], s48 offen offset:512
    s_waitcnt lgkmcnt(0)
    v_mfma_f32_32x32x16_bf16 v[128:143], a[144:147], a[76:79], v[128:143]
    ds_read_b64_tr_b16 a[128:129], v22 offset:16384
    s_add_u32 m0, s88, 18432
    v_mfma_f32_32x32x16_bf16 v[192:207], a[144:147], a[108:111], v[192:207]
    ds_read_b64_tr_b16 a[130:131], v22 offset:17408
    s_mov_b32 s61, 147456
    v_mfma_f32_32x32x16_bf16 v[144:159], a[148:151], a[76:79], v[144:159]
    ds_read_b64_tr_b16 a[132:133], v23 offset:16384
    buffer_load_dwordx4 v101, s[80:83], s61 offen lds
    v_mfma_f32_32x32x16_bf16 v[208:223], a[148:151], a[108:111], v[208:223]
    ds_read_b64_tr_b16 a[134:135], v23 offset:17408
    s_add_u32 m0, s88, 19456
    v_mfma_f32_32x32x16_bf16 v[160:175], a[152:155], a[76:79], v[160:175]
    ds_read_b64_tr_b16 a[136:137], v24 offset:16384
    s_mov_b32 s61, 155648
    v_mfma_f32_32x32x16_bf16 v[224:239], a[152:155], a[108:111], v[224:239]
    ds_read_b64_tr_b16 a[138:139], v24 offset:17408
    buffer_load_dwordx4 v101, s[80:83], s61 offen lds
    v_mfma_f32_32x32x16_bf16 v[176:191], a[156:159], a[76:79], v[176:191]
    ds_read_b64_tr_b16 a[140:141], v25 offset:16384
    buffer_load_dwordx4 a[72:75], v16, s[12:15], s48 offen offset:1024
    v_mfma_f32_32x32x16_bf16 v[240:255], a[156:159], a[108:111], v[240:255]
    ds_read_b64_tr_b16 a[142:143], v25 offset:17408
    buffer_load_dwordx4 a[104:107], v17, s[12:15], s48 offen offset:1024
    s_waitcnt lgkmcnt(0)
    v_mfma_f32_32x32x16_bf16 v[128:143], a[128:131], a[80:83], v[128:143]
    ds_read_b64_tr_b16 a[144:145], v22 offset:20480
    s_add_u32 m0, s88, 32768
    v_mfma_f32_32x32x16_bf16 v[192:207], a[128:131], a[112:115], v[192:207]
    ds_read_b64_tr_b16 a[146:147], v22 offset:21504
    s_mov_b32 s61, 262144
    v_mfma_f32_32x32x16_bf16 v[144:159], a[132:135], a[80:83], v[144:159]
    ds_read_b64_tr_b16 a[148:149], v23 offset:20480
    buffer_load_dwordx4 v101, s[80:83], s61 offen lds
    v_mfma_f32_32x32x16_bf16 v[208:223], a[132:135], a[112:115], v[208:223]
    ds_read_b64_tr_b16 a[150:151], v23 offset:21504
    s_add_u32 m0, s88, 33792
    v_mfma_f32_32x32x16_bf16 v[160:175], a[136:139], a[80:83], v[160:175]
    ds_read_b64_tr_b16 a[152:153], v24 offset:20480
    s_mov_b32 s61, 270336
    v_mfma_f32_32x32x16_bf16 v[224:239], a[136:139], a[112:115], v[224:239]
    ds_read_b64_tr_b16 a[154:155], v24 offset:21504
    buffer_load_dwordx4 v101, s[80:83], s61 offen lds
    v_mfma_f32_32x32x16_bf16 v[176:191], a[140:143], a[80:83], v[176:191]
    ds_read_b64_tr_b16 a[156:157], v25 offset:20480
    buffer_load_dwordx4 a[76:79], v16, s[12:15], s48 offen offset:1536
    v_mfma_f32_32x32x16_bf16 v[240:255], a[140:143], a[112:115], v[240:255]
    ds_read_b64_tr_b16 a[158:159], v25 offset:21504
    buffer_load_dwordx4 a[108:111], v17, s[12:15], s48 offen offset:1536
    s_waitcnt lgkmcnt(0)
    v_mfma_f32_32x32x16_bf16 v[128:143], a[144:147], a[84:87], v[128:143]
    ds_read_b64_tr_b16 a[128:129], v22 offset:24576
    s_add_u32 m0, s88, 34816
    v_mfma_f32_32x32x16_bf16 v[192:207], a[144:147], a[116:119], v[192:207]
    ds_read_b64_tr_b16 a[130:131], v22 offset:25600
    s_mov_b32 s61, 278528
    v_mfma_f32_32x32x16_bf16 v[144:159], a[148:151], a[84:87], v[144:159]
    ds_read_b64_tr_b16 a[132:133], v23 offset:24576
    buffer_load_dwordx4 v101, s[80:83], s61 offen lds
    v_mfma_f32_32x32x16_bf16 v[208:223], a[148:151], a[116:119], v[208:223]
    ds_read_b64_tr_b16 a[134:135], v23 offset:25600
    s_add_u32 m0, s88, 35840
    v_mfma_f32_32x32x16_bf16 v[160:175], a[152:155], a[84:87], v[160:175]
    ds_read_b64_tr_b16 a[136:137], v24 offset:24576
    s_mov_b32 s61, 286720
    v_mfma_f32_32x32x16_bf16 v[224:239], a[152:155], a[116:119], v[224:239]
    ds_read_b64_tr_b16 a[138:139], v24 offset:25600
    buffer_load_dwordx4 v101, s[80:83], s61 offen lds
    v_mfma_f32_32x32x16_bf16 v[176:191], a[156:159], a[84:87], v[176:191]
    ds_read_b64_tr_b16 a[140:141], v25 offset:24576
    buffer_load_dwordx4 a[80:83], v16, s[12:15], s48 offen offset:2048
    v_mfma_f32_32x32x16_bf16 v[240:255], a[156:159], a[116:119], v[240:255]
    ds_read_b64_tr_b16 a[142:143], v25 offset:25600
    buffer_load_dwordx4 a[112:115], v17, s[12:15], s48 offen offset:2048
    s_waitcnt lgkmcnt(0)
    v_mfma_f32_32x32x16_bf16 v[128:143], a[128:131], a[88:91], v[128:143]
    ds_read_b64_tr_b16 a[144:145], v22 offset:28672
    buffer_load_dword v57, v56, s[84:87], 0 offen sc1
    s_add_u32 m0, s88, 49152
    v_mfma_f32_32x32x16_bf16 v[192:207], a[128:131], a[120:123], v[192:207]
    ds_read_b64_tr_b16 a[146:147], v22 offset:29696
    s_mov_b32 s61, 393216
    v_mfma_f32_32x32x16_bf16 v[144:159], a[132:135], a[88:91], v[144:159]
    ds_read_b64_tr_b16 a[148:149], v23 offset:28672
    buffer_load_dwordx4 v101, s[80:83], s61 offen lds
    v_mfma_f32_32x32x16_bf16 v[208:223], a[132:135], a[120:123], v[208:223]
    ds_read_b64_tr_b16 a[150:151], v23 offset:29696
    s_add_u32 m0, s88, 50176
    v_mfma_f32_32x32x16_bf16 v[160:175], a[136:139], a[88:91], v[160:175]
    ds_read_b64_tr_b16 a[152:153], v24 offset:28672
    s_mov_b32 s61, 401408
    v_mfma_f32_32x32x16_bf16 v[224:239], a[136:139], a[120:123], v[224:239]
    ds_read_b64_tr_b16 a[154:155], v24 offset:29696
    buffer_load_dwordx4 v101, s[80:83], s61 offen lds
    v_mfma_f32_32x32x16_bf16 v[176:191], a[140:143], a[88:91], v[176:191]
    ds_read_b64_tr_b16 a[156:157], v25 offset:28672
    buffer_load_dwordx4 a[84:87], v16, s[12:15], s48 offen offset:2560
    v_mfma_f32_32x32x16_bf16 v[240:255], a[140:143], a[120:123], v[240:255]
    ds_read_b64_tr_b16 a[158:159], v25 offset:29696
    buffer_load_dwordx4 a[116:119], v17, s[12:15], s48 offen offset:2560
    s_waitcnt vmcnt(4) lgkmcnt(0)
    v_and_b32 v57, 0xffff, v57
    v_cmp_eq_u32 vcc, 0x808, v57
    s_barrier
    v_add_u32 v22, 32768, v22
    v_add_u32 v23, 32768, v23
    v_add_u32 v24, 32768, v24
    v_add_u32 v25, 32768, v25
    s_cmp_eq_u64 vcc, -1
    s_cbranch_scc0 GSPIN_100016
GOK_100017:
    v_mfma_f32_32x32x16_bf16 v[128:143], a[144:147], a[92:95], v[128:143]
    ds_read_b64_tr_b16 a[128:129], v22 offset:0
    s_add_u32 m0, s88, 51200
    s_mov_b32 s61, 409600
    v_mfma_f32_32x32x16_bf16 v[192:207], a[144:147], a[124:127], v[192:207]
    ds_read_b64_tr_b16 a[130:131], v22 offset:1024
    buffer_load_dwordx4 v101, s[80:83], s61 offen lds
    s_add_u32 m0, s88, 52224
    v_mfma_f32_32x32x16_bf16 v[144:159], a[148:151], a[92:95], v[144:159]
    ds_read_b64_tr_b16 a[132:133], v23 offset:0
    s_mov_b32 s61, 417792
    v_mfma_f32_32x32x16_bf16 v[208:223], a[148:151], a[124:127], v[208:223]
    ds_read_b64_tr_b16 a[134:135], v23 offset:1024
    buffer_load_dwordx4 v101, s[80:83], s61 offen lds
    buffer_load_dwordx4 a[88:91], v16, s[12:15], s48 offen offset:3072
    v_mfma_f32_32x32x16_bf16 v[160:175], a[152:155], a[92:95], v[160:175]
    ds_read_b64_tr_b16 a[136:137], v24 offset:0
    buffer_load_dwordx4 a[120:123], v17, s[12:15], s48 offen offset:3072
    s_add_u32 m0, s30, 65536
    v_mfma_f32_32x32x16_bf16 v[224:239], a[152:155], a[124:127], v[224:239]
    ds_read_b64_tr_b16 a[138:139], v24 offset:1024
    buffer_load_dwordx4 v3, s[4:7], s24 offen offset:0 lds
    v_mfma_f32_32x32x16_bf16 v[176:191], a[156:159], a[92:95], v[176:191]
    ds_read_b64_tr_b16 a[140:141], v25 offset:0
    buffer_load_dwordx4 v3, s[4:7], s24 offen offset:1024 lds
    buffer_load_dwordx4 v3, s[4:7], s24 offen offset:2048 lds
    v_mfma_f32_32x32x16_bf16 v[240:255], a[156:159], a[124:127], v[240:255]
    ds_read_b64_tr_b16 a[142:143], v25 offset:1024
    buffer_load_dwordx4 v3, s[4:7], s24 offen offset:3072 lds
    buffer_load_dwordx4 a[92:95], v16, s[12:15], s48 offen offset:3584
    buffer_load_dwordx4 a[124:127], v17, s[12:15], s48 offen offset:3584
    s_waitcnt lgkmcnt(0)
    v_mfma_f32_32x32x16_bf16 v[128:143], a[128:131], a[0:3], v[128:143]
    ds_read_b64_tr_b16 a[144:145], v22 offset:4096
    s_mov_b32 s60, 0
    v_mfma_f32_32x32x16_bf16 v[192:207], a[128:131], a[32:35], v[192:207]
    ds_read_b64_tr_b16 a[146:147], v22 offset:5120
    buffer_load_dwordx4 a[160:163], v97, s[76:79], s60 offen offset:0
    v_mfma_f32_32x32x16_bf16 v[144:159], a[132:135], a[0:3], v[144:159]
    ds_read_b64_tr_b16 a[148:149], v23 offset:4096
    v_mfma_f32_32x32x16_bf16 v[208:223], a[132:135], a[32:35], v[208:223]
    ds_read_b64_tr_b16 a[150:151], v23 offset:5120
    buffer_load_dwordx4 a[164:167], v97, s[76:79], s60 offen offset:512
    v_mfma_f32_32x32x16_bf16 v[160:175], a[136:139], a[0:3], v[160:175]
    ds_read_b64_tr_b16 a[152:153], v24 offset:4096
    buffer_load_dwordx4 a[168:171], v97, s[76:79], s60 offen offset:1024
    v_mfma_f32_32x32x16_bf16 v[224:239], a[136:139], a[32:35], v[224:239]
    ds_read_b64_tr_b16 a[154:155], v24 offset:5120
    v_mfma_f32_32x32x16_bf16 v[176:191], a[140:143], a[0:3], v[176:191]
    ds_read_b64_tr_b16 a[156:157], v25 offset:4096
    buffer_load_dwordx4 a[172:175], v97, s[76:79], s60 offen offset:1536
    v_mfma_f32_32x32x16_bf16 v[240:255], a[140:143], a[32:35], v[240:255]
    ds_read_b64_tr_b16 a[158:159], v25 offset:5120
    s_waitcnt lgkmcnt(0)
    v_mfma_f32_32x32x16_bf16 v[128:143], a[144:147], a[4:7], v[128:143]
    ds_read_b64_tr_b16 a[128:129], v22 offset:8192
    buffer_load_dwordx4 a[176:179], v97, s[76:79], s60 offen offset:2048
    v_mfma_f32_32x32x16_bf16 v[192:207], a[144:147], a[36:39], v[192:207]
    ds_read_b64_tr_b16 a[130:131], v22 offset:9216
    v_mfma_f32_32x32x16_bf16 v[144:159], a[148:151], a[4:7], v[144:159]
    ds_read_b64_tr_b16 a[132:133], v23 offset:8192
    buffer_load_dwordx4 a[180:183], v97, s[76:79], s60 offen offset:2560
    v_mfma_f32_32x32x16_bf16 v[208:223], a[148:151], a[36:39], v[208:223]
    ds_read_b64_tr_b16 a[134:135], v23 offset:9216
    v_mfma_f32_32x32x16_bf16 v[160:175], a[152:155], a[4:7], v[160:175]
    ds_read_b64_tr_b16 a[136:137], v24 offset:8192
    buffer_load_dwordx4 a[184:187], v97, s[76:79], s60 offen offset:3072
    v_mfma_f32_32x32x16_bf16 v[224:239], a[152:155], a[36:39], v[224:239]
    ds_read_b64_tr_b16 a[138:139], v24 offset:9216
    v_mfma_f32_32x32x16_bf16 v[176:191], a[156:159], a[4:7], v[176:191]
    ds_read_b64_tr_b16 a[140:141], v25 offset:8192
    buffer_load_dwordx4 a[188:191], v97, s[76:79], s60 offen offset:3584
    v_mfma_f32_32x32x16_bf16 v[240:255], a[156:159], a[36:39], v[240:255]
    ds_read_b64_tr_b16 a[142:143], v25 offset:9216
    s_waitcnt lgkmcnt(0)
    v_mfma_f32_32x32x16_bf16 v[128:143], a[128:131], a[8:11], v[128:143]
    ds_read_b64_tr_b16 a[144:145], v22 offset:12288
    s_mov_b32 s60, 4096
    v_mfma_f32_32x32x16_bf16 v[192:207], a[128:131], a[40:43], v[192:207]
    ds_read_b64_tr_b16 a[146:147], v22 offset:13312
    buffer_load_dwordx4 a[192:195], v98, s[76:79], s60 offen offset:0
    v_mfma_f32_32x32x16_bf16 v[144:159], a[132:135], a[8:11], v[144:159]
    ds_read_b64_tr_b16 a[148:149], v23 offset:12288
    v_mfma_f32_32x32x16_bf16 v[208:223], a[132:135], a[40:43], v[208:223]
    ds_read_b64_tr_b16 a[150:151], v23 offset:13312
    buffer_load_dwordx4 a[196:199], v98, s[76:79], s60 offen offset:512
    v_mfma_f32_32x32x16_bf16 v[160:175], a[136:139], a[8:11], v[160:175]
    ds_read_b64_tr_b16 a[152:153], v24 offset:12288
    buffer_load_dwordx4 a[200:203], v98, s[76:79], s60 offen offset:1024
    v_mfma_f32_32x32x16_bf16 v[224:239], a[136:139], a[40:43], v[224:239]
    ds_read_b64_tr_b16 a[154:155], v24 offset:13312
    v_mfma_f32_32x32x16_bf16 v[176:191], a[140:143], a[8:11], v[176:191]
    ds_read_b64_tr_b16 a[156:157], v25 offset:12288
    buffer_load_dwordx4 a[204:207], v98, s[76:79], s60 offen offset:1536
    v_mfma_f32_32x32x16_bf16 v[240:255], a[140:143], a[40:43], v[240:255]
    ds_read_b64_tr_b16 a[158:159], v25 offset:13312
    s_waitcnt lgkmcnt(0)
    v_mfma_f32_32x32x16_bf16 v[128:143], a[144:147], a[12:15], v[128:143]
    ds_read_b64_tr_b16 a[128:129], v22 offset:16384
    buffer_load_dwordx4 a[208:211], v98, s[76:79], s60 offen offset:2048
    v_mfma_f32_32x32x16_bf16 v[192:207], a[144:147], a[44:47], v[192:207]
    ds_read_b64_tr_b16 a[130:131], v22 offset:17408
    v_mfma_f32_32x32x16_bf16 v[144:159], a[148:151], a[12:15], v[144:159]
    ds_read_b64_tr_b16 a[132:133], v23 offset:16384
    buffer_load_dwordx4 a[212:215], v98, s[76:79], s60 offen offset:2560
    v_mfma_f32_32x32x16_bf16 v[208:223], a[148:151], a[44:47], v[208:223]
    ds_read_b64_tr_b16 a[134:135], v23 offset:17408
    v_mfma_f32_32x32x16_bf16 v[160:175], a[152:155], a[12:15], v[160:175]
    ds_read_b64_tr_b16 a[136:137], v24 offset:16384
    buffer_load_dwordx4 a[216:219], v98, s[76:79], s60 offen offset:3072
    v_mfma_f32_32x32x16_bf16 v[224:239], a[152:155], a[44:47], v[224:239]
    ds_read_b64_tr_b16 a[138:139], v24 offset:17408
    v_mfma_f32_32x32x16_bf16 v[176:191], a[156:159], a[12:15], v[176:191]
    ds_read_b64_tr_b16 a[140:141], v25 offset:16384
    buffer_load_dwordx4 a[220:223], v98, s[76:79], s60 offen offset:3584
    v_mfma_f32_32x32x16_bf16 v[240:255], a[156:159], a[44:47], v[240:255]
    ds_read_b64_tr_b16 a[142:143], v25 offset:17408
    s_waitcnt lgkmcnt(0)
    v_mfma_f32_32x32x16_bf16 v[128:143], a[128:131], a[16:19], v[128:143]
    ds_read_b64_tr_b16 a[144:145], v22 offset:20480
    s_mov_b32 s60, 8192
    v_mfma_f32_32x32x16_bf16 v[192:207], a[128:131], a[48:51], v[192:207]
    ds_read_b64_tr_b16 a[146:147], v22 offset:21504
    buffer_load_dwordx4 a[224:227], v99, s[76:79], s60 offen offset:0
    v_mfma_f32_32x32x16_bf16 v[144:159], a[132:135], a[16:19], v[144:159]
    ds_read_b64_tr_b16 a[148:149], v23 offset:20480
    v_mfma_f32_32x32x16_bf16 v[208:223], a[132:135], a[48:51], v[208:223]
    ds_read_b64_tr_b16 a[150:151], v23 offset:21504
    buffer_load_dwordx4 a[228:231], v99, s[76:79], s60 offen offset:512
    v_mfma_f32_32x32x16_bf16 v[160:175], a[136:139], a[16:19], v[160:175]
    ds_read_b64_tr_b16 a[152:153], v24 offset:20480
    buffer_load_dwordx4 a[232:235], v99, s[76:79], s60 offen offset:1024
    v_mfma_f32_32x32x16_bf16 v[224:239], a[136:139], a[48:51], v[224:239]
    ds_read_b64_tr_b16 a[154:155], v24 offset:21504
    v_mfma_f32_32x32x16_bf16 v[176:191], a[140:143], a[16:19], v[176:191]
    ds_read_b64_tr_b16 a[156:157], v25 offset:20480
    buffer_load_dwordx4 a[236:239], v99, s[76:79], s60 offen offset:1536
    v_mfma_f32_32x32x16_bf16 v[240:255], a[140:143], a[48:51], v[240:255]
    ds_read_b64_tr_b16 a[158:159], v25 offset:21504
    s_waitcnt lgkmcnt(0)
    v_mfma_f32_32x32x16_bf16 v[128:143], a[144:147], a[20:23], v[128:143]
    ds_read_b64_tr_b16 a[128:129], v22 offset:24576
    buffer_load_dwordx4 a[240:243], v99, s[76:79], s60 offen offset:2048
    v_mfma_f32_32x32x16_bf16 v[192:207], a[144:147], a[52:55], v[192:207]
    ds_read_b64_tr_b16 a[130:131], v22 offset:25600
    v_mfma_f32_32x32x16_bf16 v[144:159], a[148:151], a[20:23], v[144:159]
    ds_read_b64_tr_b16 a[132:133], v23 offset:24576
    buffer_load_dwordx4 a[244:247], v99, s[76:79], s60 offen offset:2560
    v_mfma_f32_32x32x16_bf16 v[208:223], a[148:151], a[52:55], v[208:223]
    ds_read_b64_tr_b16 a[134:135], v23 offset:25600
    v_mfma_f32_32x32x16_bf16 v[160:175], a[152:155], a[20:23], v[160:175]
    ds_read_b64_tr_b16 a[136:137], v24 offset:24576
    buffer_load_dwordx4 a[248:251], v99, s[76:79], s60 offen offset:3072
    v_mfma_f32_32x32x16_bf16 v[224:239], a[152:155], a[52:55], v[224:239]
    ds_read_b64_tr_b16 a[138:139], v24 offset:25600
    v_mfma_f32_32x32x16_bf16 v[176:191], a[156:159], a[20:23], v[176:191]
    ds_read_b64_tr_b16 a[140:141], v25 offset:24576
    buffer_load_dwordx4 a[252:255], v99, s[76:79], s60 offen offset:3584
    v_mfma_f32_32x32x16_bf16 v[240:255], a[156:159], a[52:55], v[240:255]
    ds_read_b64_tr_b16 a[142:143], v25 offset:25600
    s_waitcnt lgkmcnt(0)
    v_mfma_f32_32x32x16_bf16 v[128:143], a[128:131], a[24:27], v[128:143]
    ds_read_b64_tr_b16 a[144:145], v22 offset:28672
    s_mov_b32 s60, 12288
    v_mfma_f32_32x32x16_bf16 v[192:207], a[128:131], a[56:59], v[192:207]
    ds_read_b64_tr_b16 a[146:147], v22 offset:29696
    buffer_load_dwordx4 v[64:67], v100, s[76:79], s60 offen offset:0
    v_mfma_f32_32x32x16_bf16 v[144:159], a[132:135], a[24:27], v[144:159]
    ds_read_b64_tr_b16 a[148:149], v23 offset:28672
    v_mfma_f32_32x32x16_bf16 v[208:223], a[132:135], a[56:59], v[208:223]
    ds_read_b64_tr_b16 a[150:151], v23 offset:29696
    buffer_load_dwordx4 v[68:71], v100, s[76:79], s60 offen offset:512
    v_mfma_f32_32x32x16_bf16 v[160:175], a[136:139], a[24:27], v[160:175]
    ds_read_b64_tr_b16 a[152:153], v24 offset:28672
    buffer_load_dwordx4 v[72:75], v100, s[76:79], s60 offen offset:1024
    v_mfma_f32_32x32x16_bf16 v[224:239], a[136:139], a[56:59], v[224:239]
    ds_read_b64_tr_b16 a[154:155], v24 offset:29696
    v_mfma_f32_32x32x16_bf16 v[176:191], a[140:143], a[24:27], v[176:191]
    ds_read_b64_tr_b16 a[156:157], v25 offset:28672
    buffer_load_dwordx4 v[76:79], v100, s[76:79], s60 offen offset:1536
    v_mfma_f32_32x32x16_bf16 v[240:255], a[140:143], a[56:59], v[240:255]
    ds_read_b64_tr_b16 a[158:159], v25 offset:29696
    s_waitcnt vmcnt(28) lgkmcnt(0)
    s_barrier
    v_add_u32 v22, 32768, v22
    v_add_u32 v23, 32768, v23
    v_add_u32 v24, 32768, v24
    v_add_u32 v25, 32768, v25
    v_mfma_f32_32x32x16_bf16 v[128:143], a[144:147], a[28:31], v[128:143]
    ds_read_b64_tr_b16 a[128:129], v22 offset:0
    buffer_load_dwordx4 v[80:83], v100, s[76:79], s60 offen offset:2048
    v_mfma_f32_32x32x16_bf16 v[192:207], a[144:147], a[60:63], v[192:207]
    ds_read_b64_tr_b16 a[130:131], v22 offset:1024
    v_mfma_f32_32x32x16_bf16 v[144:159], a[148:151], a[28:31], v[144:159]
    ds_read_b64_tr_b16 a[132:133], v23 offset:0
    buffer_load_dwordx4 v[84:87], v100, s[76:79], s60 offen offset:2560
    v_mfma_f32_32x32x16_bf16 v[208:223], a[148:151], a[60:63], v[208:223]
    ds_read_b64_tr_b16 a[134:135], v23 offset:1024
    v_mfma_f32_32x32x16_bf16 v[160:175], a[152:155], a[28:31], v[160:175]
    ds_read_b64_tr_b16 a[136:137], v24 offset:0
    buffer_load_dwordx4 v[88:91], v100, s[76:79], s60 offen offset:3072
    v_mfma_f32_32x32x16_bf16 v[224:239], a[152:155], a[60:63], v[224:239]
    ds_read_b64_tr_b16 a[138:139], v24 offset:1024
    v_mfma_f32_32x32x16_bf16 v[176:191], a[156:159], a[28:31], v[176:191]
    ds_read_b64_tr_b16 a[140:141], v25 offset:0
    buffer_load_dwordx4 v[92:95], v100, s[76:79], s60 offen offset:3584
    v_mfma_f32_32x32x16_bf16 v[240:255], a[156:159], a[60:63], v[240:255]
    ds_read_b64_tr_b16 a[142:143], v25 offset:1024
    s_waitcnt lgkmcnt(0)
    v_mfma_f32_32x32x16_bf16 v[128:143], a[128:131], a[64:67], v[128:143]
    ds_read_b64_tr_b16 a[144:145], v22 offset:4096
    buffer_load_dwordx4 v[48:51], v96, s[12:15], s89 offen
    v_mfma_f32_32x32x16_bf16 v[192:207], a[128:131], a[96:99], v[192:207]
    ds_read_b64_tr_b16 a[146:147], v22 offset:5120
    v_mfma_f32_32x32x16_bf16 v[144:159], a[132:135], a[64:67], v[144:159]
    ds_read_b64_tr_b16 a[148:149], v23 offset:4096
    v_mfma_f32_32x32x16_bf16 v[208:223], a[132:135], a[96:99], v[208:223]
    ds_read_b64_tr_b16 a[150:151], v23 offset:5120
    v_mfma_f32_32x32x16_bf16 v[160:175], a[136:139], a[64:67], v[160:175]
    ds_read_b64_tr_b16 a[152:153], v24 offset:4096
    buffer_load_dwordx4 v[52:55], v96, s[12:15], s89 offen offset:512
    v_mfma_f32_32x32x16_bf16 v[224:239], a[136:139], a[96:99], v[224:239]
    ds_read_b64_tr_b16 a[154:155], v24 offset:5120
    v_mfma_f32_32x32x16_bf16 v[176:191], a[140:143], a[64:67], v[176:191]
    ds_read_b64_tr_b16 a[156:157], v25 offset:4096
    v_mfma_f32_32x32x16_bf16 v[240:255], a[140:143], a[96:99], v[240:255]
    ds_read_b64_tr_b16 a[158:159], v25 offset:5120
    s_waitcnt lgkmcnt(0)
    v_mfma_f32_32x32x16_bf16 v[128:143], a[144:147], a[68:71], v[128:143]
    ds_read_b64_tr_b16 a[128:129], v22 offset:8192
    v_mfma_f32_32x32x16_bf16 v[192:207], a[144:147], a[100:103], v[192:207]
    ds_read_b64_tr_b16 a[130:131], v22 offset:9216
    v_mfma_f32_32x32x16_bf16 v[144:159], a[148:151], a[68:71], v[144:159]
    ds_read_b64_tr_b16 a[132:133], v23 offset:8192
    v_mfma_f32_32x32x16_bf16 v[208:223], a[148:151], a[100:103], v[208:223]
    ds_read_b64_tr_b16 a[134:135], v23 offset:9216
    v_mfma_f32_32x32x16_bf16 v[160:175], a[152:155], a[68:71], v[160:175]
    ds_read_b64_tr_b16 a[136:137], v24 offset:8192
    v_mfma_f32_32x32x16_bf16 v[224:239], a[152:155], a[100:103], v[224:239]
    ds_read_b64_tr_b16 a[138:139], v24 offset:9216
    v_mfma_f32_32x32x16_bf16 v[176:191], a[156:159], a[68:71], v[176:191]
    ds_read_b64_tr_b16 a[140:141], v25 offset:8192
    v_mfma_f32_32x32x16_bf16 v[240:255], a[156:159], a[100:103], v[240:255]
    ds_read_b64_tr_b16 a[142:143], v25 offset:9216
    s_waitcnt lgkmcnt(0)
    v_mfma_f32_32x32x16_bf16 v[128:143], a[128:131], a[72:75], v[128:143]
    ds_read_b64_tr_b16 a[144:145], v22 offset:12288
    v_mfma_f32_32x32x16_bf16 v[192:207], a[128:131], a[104:107], v[192:207]
    ds_read_b64_tr_b16 a[146:147], v22 offset:13312
    v_mfma_f32_32x32x16_bf16 v[144:159], a[132:135], a[72:75], v[144:159]
    ds_read_b64_tr_b16 a[148:149], v23 offset:12288
    v_mfma_f32_32x32x16_bf16 v[208:223], a[132:135], a[104:107], v[208:223]
    ds_read_b64_tr_b16 a[150:151], v23 offset:13312
    v_mfma_f32_32x32x16_bf16 v[160:175], a[136:139], a[72:75], v[160:175]
    ds_read_b64_tr_b16 a[152:153], v24 offset:12288
    v_mfma_f32_32x32x16_bf16 v[224:239], a[136:139], a[104:107], v[224:239]
    ds_read_b64_tr_b16 a[154:155], v24 offset:13312
    v_mfma_f32_32x32x16_bf16 v[176:191], a[140:143], a[72:75], v[176:191]
    ds_read_b64_tr_b16 a[156:157], v25 offset:12288
    v_mfma_f32_32x32x16_bf16 v[240:255], a[140:143], a[104:107], v[240:255]
    ds_read_b64_tr_b16 a[158:159], v25 offset:13312
    s_waitcnt lgkmcnt(0)
    v_mfma_f32_32x32x16_bf16 v[128:143], a[144:147], a[76:79], v[128:143]
    ds_read_b64_tr_b16 a[128:129], v22 offset:16384
    v_mfma_f32_32x32x16_bf16 v[192:207], a[144:147], a[108:111], v[192:207]
    ds_read_b64_tr_b16 a[130:131], v22 offset:17408
    v_mfma_f32_32x32x16_bf16 v[144:159], a[148:151], a[76:79], v[144:159]
    ds_read_b64_tr_b16 a[132:133], v23 offset:16384
    v_mfma_f32_32x32x16_bf16 v[208:223], a[148:151], a[108:111], v[208:223]
    ds_read_b64_tr_b16 a[134:135], v23 offset:17408
    v_mfma_f32_32x32x16_bf16 v[160:175], a[152:155], a[76:79], v[160:175]
    ds_read_b64_tr_b16 a[136:137], v24 offset:16384
    v_mfma_f32_32x32x16_bf16 v[224:239], a[152:155], a[108:111], v[224:239]
    ds_read_b64_tr_b16 a[138:139], v24 offset:17408
    v_mfma_f32_32x32x16_bf16 v[176:191], a[156:159], a[76:79], v[176:191]
    ds_read_b64_tr_b16 a[140:141], v25 offset:16384
    v_mfma_f32_32x32x16_bf16 v[240:255], a[156:159], a[108:111], v[240:255]
    ds_read_b64_tr_b16 a[142:143], v25 offset:17408
    s_waitcnt lgkmcnt(0)
    v_mfma_f32_32x32x16_bf16 v[128:143], a[128:131], a[80:83], v[128:143]
    ds_read_b64_tr_b16 a[144:145], v22 offset:20480
    v_mfma_f32_32x32x16_bf16 v[192:207], a[128:131], a[112:115], v[192:207]
    ds_read_b64_tr_b16 a[146:147], v22 offset:21504
    v_mfma_f32_32x32x16_bf16 v[144:159], a[132:135], a[80:83], v[144:159]
    ds_read_b64_tr_b16 a[148:149], v23 offset:20480
    v_mfma_f32_32x32x16_bf16 v[208:223], a[132:135], a[112:115], v[208:223]
    ds_read_b64_tr_b16 a[150:151], v23 offset:21504
    v_mfma_f32_32x32x16_bf16 v[160:175], a[136:139], a[80:83], v[160:175]
    ds_read_b64_tr_b16 a[152:153], v24 offset:20480
    v_mfma_f32_32x32x16_bf16 v[224:239], a[136:139], a[112:115], v[224:239]
    ds_read_b64_tr_b16 a[154:155], v24 offset:21504
    v_mfma_f32_32x32x16_bf16 v[176:191], a[140:143], a[80:83], v[176:191]
    ds_read_b64_tr_b16 a[156:157], v25 offset:20480
    v_mfma_f32_32x32x16_bf16 v[240:255], a[140:143], a[112:115], v[240:255]
    ds_read_b64_tr_b16 a[158:159], v25 offset:21504
    s_waitcnt lgkmcnt(0)
    v_mfma_f32_32x32x16_bf16 v[128:143], a[144:147], a[84:87], v[128:143]
    ds_read_b64_tr_b16 a[128:129], v22 offset:24576
    v_mfma_f32_32x32x16_bf16 v[192:207], a[144:147], a[116:119], v[192:207]
    ds_read_b64_tr_b16 a[130:131], v22 offset:25600
    v_mfma_f32_32x32x16_bf16 v[144:159], a[148:151], a[84:87], v[144:159]
    ds_read_b64_tr_b16 a[132:133], v23 offset:24576
    v_mfma_f32_32x32x16_bf16 v[208:223], a[148:151], a[116:119], v[208:223]
    ds_read_b64_tr_b16 a[134:135], v23 offset:25600
    v_mfma_f32_32x32x16_bf16 v[160:175], a[152:155], a[84:87], v[160:175]
    ds_read_b64_tr_b16 a[136:137], v24 offset:24576
    v_mfma_f32_32x32x16_bf16 v[224:239], a[152:155], a[116:119], v[224:239]
    ds_read_b64_tr_b16 a[138:139], v24 offset:25600
    v_mfma_f32_32x32x16_bf16 v[176:191], a[156:159], a[84:87], v[176:191]
    ds_read_b64_tr_b16 a[140:141], v25 offset:24576
    v_mfma_f32_32x32x16_bf16 v[240:255], a[156:159], a[116:119], v[240:255]
    ds_read_b64_tr_b16 a[142:143], v25 offset:25600
    s_waitcnt lgkmcnt(0)
    v_mfma_f32_32x32x16_bf16 v[128:143], a[128:131], a[88:91], v[128:143]
    ds_read_b64_tr_b16 a[144:145], v22 offset:28672
    v_mfma_f32_32x32x16_bf16 v[192:207], a[128:131], a[120:123], v[192:207]
    ds_read_b64_tr_b16 a[146:147], v22 offset:29696
    v_mfma_f32_32x32x16_bf16 v[144:159], a[132:135], a[88:91], v[144:159]
    ds_read_b64_tr_b16 a[148:149], v23 offset:28672
    v_mfma_f32_32x32x16_bf16 v[208:223], a[132:135], a[120:123], v[208:223]
    ds_read_b64_tr_b16 a[150:151], v23 offset:29696
    v_mfma_f32_32x32x16_bf16 v[160:175], a[136:139], a[88:91], v[160:175]
    ds_read_b64_tr_b16 a[152:153], v24 offset:28672
    v_mfma_f32_32x32x16_bf16 v[224:239], a[136:139], a[120:123], v[224:239]
    ds_read_b64_tr_b16 a[154:155], v24 offset:29696
    v_mfma_f32_32x32x16_bf16 v[176:191], a[140:143], a[88:91], v[176:191]
    ds_read_b64_tr_b16 a[156:157], v25 offset:28672
    v_mfma_f32_32x32x16_bf16 v[240:255], a[140:143], a[120:123], v[240:255]
    ds_read_b64_tr_b16 a[158:159], v25 offset:29696
    s_waitcnt lgkmcnt(0)
    s_barrier
    v_mfma_f32_32x32x16_bf16 v[128:143], a[144:147], a[92:95], v[128:143]
    v_mfma_f32_32x32x16_bf16 v[192:207], a[144:147], a[124:127], v[192:207]
    v_mfma_f32_32x32x16_bf16 v[144:159], a[148:151], a[92:95], v[144:159]
    v_mfma_f32_32x32x16_bf16 v[208:223], a[148:151], a[124:127], v[208:223]
    v_mfma_f32_32x32x16_bf16 v[160:175], a[152:155], a[92:95], v[160:175]
    v_mfma_f32_32x32x16_bf16 v[224:239], a[152:155], a[124:127], v[224:239]
    v_mfma_f32_32x32x16_bf16 v[176:191], a[156:159], a[92:95], v[176:191]
    v_mfma_f32_32x32x16_bf16 v[240:255], a[156:159], a[124:127], v[240:255]
    s_waitcnt vmcnt(0)
    s_barrier
    ds_read_b64_tr_b16 a[0:1], v102 offset:0
    ds_read_b64_tr_b16 a[2:3], v102 offset:512
    ds_read_b64_tr_b16 a[4:5], v102 offset:2048
    ds_read_b64_tr_b16 a[6:7], v102 offset:2560
    ds_read_b64_tr_b16 a[8:9], v102 offset:4096
    ds_read_b64_tr_b16 a[10:11], v102 offset:4608
    ds_read_b64_tr_b16 a[12:13], v102 offset:6144
    ds_read_b64_tr_b16 a[14:15], v102 offset:6656
    ds_read_b64_tr_b16 a[16:17], v102 offset:8192
    ds_read_b64_tr_b16 a[18:19], v102 offset:8704
    ds_read_b64_tr_b16 a[20:21], v102 offset:10240
    ds_read_b64_tr_b16 a[22:23], v102 offset:10752
    ds_read_b64_tr_b16 a[24:25], v102 offset:12288
    ds_read_b64_tr_b16 a[26:27], v102 offset:12800
    ds_read_b64_tr_b16 a[28:29], v102 offset:14336
    ds_read_b64_tr_b16 a[30:31], v102 offset:14848
    ds_read_b64_tr_b16 a[32:33], v102 offset:16384
    ds_read_b64_tr_b16 a[34:35], v102 offset:16896
    s_waitcnt lgkmcnt(15)
    v_mfma_f32_32x32x16_bf16 v[32:47], a[0:3], a[160:163], 0
    ds_read_b64_tr_b16 a[36:37], v102 offset:18432
    ds_read_b64_tr_b16 a[38:39], v102 offset:18944
    s_waitcnt lgkmcnt(15)
    v_mfma_f32_32x32x16_bf16 v[32:47], a[4:7], a[164:167], v[32:47]
    ds_read_b64_tr_b16 a[40:41], v102 offset:20480
    ds_read_b64_tr_b16 a[42:43], v102 offset:20992
    s_waitcnt lgkmcnt(15)
    v_mfma_f32_32x32x16_bf16 v[32:47], a[8:11], a[168:171], v[32:47]
    ds_read_b64_tr_b16 a[44:45], v102 offset:22528
    ds_read_b64_tr_b16 a[46:47], v102 offset:23040
    s_waitcnt lgkmcnt(15)
    v_mfma_f32_32x32x16_bf16 v[32:47], a[12:15], a[172:175], v[32:47]
    ds_read_b64_tr_b16 a[48:49], v102 offset:24576
    ds_read_b64_tr_b16 a[50:51], v102 offset:25088
    s_waitcnt lgkmcnt(15)
    v_mfma_f32_32x32x16_bf16 v[32:47], a[16:19], a[176:179], v[32:47]
    ds_read_b64_tr_b16 a[52:53], v102 offset:26624
    ds_read_b64_tr_b16 a[54:55], v102 offset:27136
    s_waitcnt lgkmcnt(15)
    v_mfma_f32_32x32x16_bf16 v[32:47], a[20:23], a[180:183], v[32:47]
    ds_read_b64_tr_b16 a[56:57], v102 offset:28672
    ds_read_b64_tr_b16 a[58:59], v102 offset:29184
    s_waitcnt lgkmcnt(15)
    v_mfma_f32_32x32x16_bf16 v[32:47], a[24:27], a[184:187], v[32:47]
    ds_read_b64_tr_b16 a[60:61], v102 offset:30720
    ds_read_b64_tr_b16 a[62:63], v102 offset:31232
    s_waitcnt lgkmcnt(15)
    v_mfma_f32_32x32x16_bf16 v[32:47], a[28:31], a[188:191], v[32:47]
    ds_read_b64_tr_b16 a[64:65], v102 offset:32768
    ds_read_b64_tr_b16 a[66:67], v102 offset:33280
    s_waitcnt lgkmcnt(15)
    v_mfma_f32_32x32x16_bf16 v[32:47], a[32:35], a[192:195], v[32:47]
    ds_read_b64_tr_b16 a[68:69], v102 offset:34816
    ds_read_b64_tr_b16 a[70:71], v102 offset:35328
    s_waitcnt lgkmcnt(15)
    v_mfma_f32_32x32x16_bf16 v[32:47], a[36:39], a[196:199], v[32:47]
    ds_read_b64_tr_b16 a[72:73], v102 offset:36864
    ds_read_b64_tr_b16 a[74:75], v102 offset:37376
    s_waitcnt lgkmcnt(15)
    v_mfma_f32_32x32x16_bf16 v[32:47], a[40:43], a[200:203], v[32:47]
    ds_read_b64_tr_b16 a[76:77], v102 offset:38912
    ds_read_b64_tr_b16 a[78:79], v102 offset:39424
    s_waitcnt lgkmcnt(15)
    v_mfma_f32_32x32x16_bf16 v[32:47], a[44:47], a[204:207], v[32:47]
    ds_read_b64_tr_b16 a[80:81], v102 offset:40960
    ds_read_b64_tr_b16 a[82:83], v102 offset:41472
    s_waitcnt lgkmcnt(15)
    v_mfma_f32_32x32x16_bf16 v[32:47], a[48:51], a[208:211], v[32:47]
    ds_read_b64_tr_b16 a[84:85], v102 offset:43008
    ds_read_b64_tr_b16 a[86:87], v102 offset:43520
    s_waitcnt lgkmcnt(15)
    v_mfma_f32_32x32x16_bf16 v[32:47], a[52:55], a[212:215], v[32:47]
    ds_read_b64_tr_b16 a[88:89], v102 offset:45056
    ds_read_b64_tr_b16 a[90:91], v102 offset:45568
    s_waitcnt lgkmcnt(15)
    v_mfma_f32_32x32x16_bf16 v[32:47], a[56:59], a[216:219], v[32:47]
    ds_read_b64_tr_b16 a[92:93], v102 offset:47104
    ds_read_b64_tr_b16 a[94:95], v102 offset:47616
    s_waitcnt lgkmcnt(15)
    v_mfma_f32_32x32x16_bf16 v[32:47], a[60:63], a[220:223], v[32:47]
    ds_read_b64_tr_b16 a[96:97], v102 offset:49152
    ds_read_b64_tr_b16 a[98:99], v102 offset:49664
    s_waitcnt lgkmcnt(15)
    v_mfma_f32_32x32x16_bf16 v[32:47], a[64:67], a[224:227], v[32:47]
    ds_read_b64_tr_b16 a[100:101], v102 offset:51200
    ds_read_b64_tr_b16 a[102:103], v102 offset:51712
    s_waitcnt lgkmcnt(15)
    v_mfma_f32_32x32x16_bf16 v[32:47], a[68:71], a[228:231], v[32:47]
    ds_read_b64_tr_b16 a[104:105], v102 offset:53248
    ds_read_b64_tr_b16 a[106:107], v102 offset:53760
    s_waitcnt lgkmcnt(15)
    v_mfma_f32_32x32x16_bf16 v[32:47], a[72:75], a[232:235], v[32:47]
    ds_read_b64_tr_b16 a[108:109], v102 offset:55296
    ds_read_b64_tr_b16 a[110:111], v102 offset:55808
    s_waitcnt lgkmcnt(15)
    v_mfma_f32_32x32x16_bf16 v[32:47], a[76:79], a[236:239], v[32:47]
    ds_read_b64_tr_b16 a[112:113], v102 offset:57344
    ds_read_b64_tr_b16 a[114:115], v102 offset:57856
    s_waitcnt lgkmcnt(15)
    v_mfma_f32_32x32x16_bf16 v[32:47], a[80:83], a[240:243], v[32:47]
    ds_read_b64_tr_b16 a[116:117], v102 offset:59392
    ds_read_b64_tr_b16 a[118:119], v102 offset:59904
    s_waitcnt lgkmcnt(15)
    v_mfma_f32_32x32x16_bf16 v[32:47], a[84:87], a[244:247], v[32:47]
    ds_read_b64_tr_b16 a[120:121], v102 offset:61440
    ds_read_b64_tr_b16 a[122:123], v102 offset:61952
    s_waitcnt lgkmcnt(15)
    v_mfma_f32_32x32x16_bf16 v[32:47], a[88:91], a[248:251], v[32:47]
    ds_read_b64_tr_b16 a[124:125], v102 offset:63488
    ds_read_b64_tr_b16 a[126:127], v102 offset:64000
    s_waitcnt lgkmcnt(15)
    v_mfma_f32_32x32x16_bf16 v[32:47], a[92:95], a[252:255], v[32:47]
    s_waitcnt lgkmcnt(14)
    v_mfma_f32_32x32x16_bf16 v[32:47], a[96:99], v[64:67], v[32:47]
    s_waitcnt lgkmcnt(12)
    v_mfma_f32_32x32x16_bf16 v[32:47], a[100:103], v[68:71], v[32:47]
    s_waitcnt lgkmcnt(10)
    v_mfma_f32_32x32x16_bf16 v[32:47], a[104:107], v[72:75], v[32:47]
    s_waitcnt lgkmcnt(8)
    v_mfma_f32_32x32x16_bf16 v[32:47], a[108:111], v[76:79], v[32:47]
    s_waitcnt lgkmcnt(6)
    v_mfma_f32_32x32x16_bf16 v[32:47], a[112:115], v[80:83], v[32:47]
    s_waitcnt lgkmcnt(4)
    v_mfma_f32_32x32x16_bf16 v[32:47], a[116:119], v[84:87], v[32:47]
    s_waitcnt lgkmcnt(2)
    v_mfma_f32_32x32x16_bf16 v[32:47], a[120:123], v[88:91], v[32:47]
    s_waitcnt lgkmcnt(0)
    v_mfma_f32_32x32x16_bf16 v[32:47], a[124:127], v[92:95], v[32:47]
    s_barrier
    s_add_u32 m0, s30, 0
    s_mov_b32 s39, 0
    buffer_load_dwordx4 v3, s[4:7], s39 offen offset:0 lds
    buffer_load_dwordx4 v3, s[4:7], s39 offen offset:1024 lds
    buffer_load_dwordx4 v3, s[4:7], s39 offen offset:2048 lds
    buffer_load_dwordx4 v3, s[4:7], s39 offen offset:3072 lds
    s_add_u32 m0, s30, 16384
    s_mov_b32 s39, 32768
    buffer_load_dwordx4 v3, s[4:7], s39 offen offset:0 lds
    buffer_load_dwordx4 v3, s[4:7], s39 offen offset:1024 lds
    buffer_load_dwordx4 v3, s[4:7], s39 offen offset:2048 lds
    buffer_load_dwordx4 v3, s[4:7], s39 offen offset:3072 lds
    s_add_u32 m0, s30, 32768
    s_mov_b32 s39, 16384
    buffer_load_dwordx4 v3, s[4:7], s39 offen offset:0 lds
    buffer_load_dwordx4 v3, s[4:7], s39 offen offset:1024 lds
    buffer_load_dwordx4 v3, s[4:7], s39 offen offset:2048 lds
    buffer_load_dwordx4 v3, s[4:7], s39 offen offset:3072 lds
    s_add_u32 m0, s30, 49152
    s_mov_b32 s39, 49152
    buffer_load_dwordx4 v3, s[4:7], s39 offen offset:0 lds
    buffer_load_dwordx4 v3, s[4:7], s39 offen offset:1024 lds
    buffer_load_dwordx4 v3, s[4:7], s39 offen offset:2048 lds
    buffer_load_dwordx4 v3, s[4:7], s39 offen offset:3072 lds
    v_lshlrev_b32 v64, 16, v48
    v_and_b32 v65, 0xffff0000, v48
    v_lshlrev_b32 v66, 16, v49
    v_and_b32 v67, 0xffff0000, v49
    v_lshlrev_b32 v68, 16, v50
    v_and_b32 v69, 0xffff0000, v50
    v_lshlrev_b32 v70, 16, v51
    v_and_b32 v71, 0xffff0000, v51
    v_lshlrev_b32 v72, 16, v52
    v_and_b32 v73, 0xffff0000, v52
    v_lshlrev_b32 v74, 16, v53
    v_and_b32 v75, 0xffff0000, v53
    v_lshlrev_b32 v76, 16, v54
    v_and_b32 v77, 0xffff0000, v54
    v_lshlrev_b32 v78, 16, v55
    v_and_b32 v79, 0xffff0000, v55
    s_nop 7
    v_add_f32 v32, v32, v64
    v_add_f32 v33, v33, v65
    v_add_f32 v34, v34, v66
    v_add_f32 v35, v35, v67
    v_add_f32 v36, v36, v68
    v_add_f32 v37, v37, v69
    v_add_f32 v38, v38, v70
    v_add_f32 v39, v39, v71
    v_add_f32 v40, v40, v72
    v_add_f32 v41, v41, v73
    v_add_f32 v42, v42, v74
    v_add_f32 v43, v43, v75
    v_add_f32 v44, v44, v76
    v_add_f32 v45, v45, v77
    v_add_f32 v46, v46, v78
    v_add_f32 v47, v47, v79
    v_cvt_pk_bf16_f32 v80, v32, v33
    v_cvt_pk_bf16_f32 v81, v34, v35
    v_cvt_pk_bf16_f32 v82, v36, v37
    v_cvt_pk_bf16_f32 v83, v38, v39
    v_cvt_pk_bf16_f32 v84, v40, v41
    v_cvt_pk_bf16_f32 v85, v42, v43
    v_cvt_pk_bf16_f32 v86, v44, v45
    v_cvt_pk_bf16_f32 v87, v46, v47
    s_add_u32 s60, s89, 0x200000
    buffer_store_dwordx4 v[80:83], v96, s[76:79], s60 offen sc1
    buffer_store_dwordx4 v[84:87], v96, s[76:79], s60 offen offset:512 sc1
    v_lshlrev_b32 v64, 16, v80
    v_and_b32 v65, 0xffff0000, v80
    v_lshlrev_b32 v66, 16, v81
    v_and_b32 v67, 0xffff0000, v81
    v_lshlrev_b32 v68, 16, v82
    v_and_b32 v69, 0xffff0000, v82
    v_lshlrev_b32 v70, 16, v83
    v_and_b32 v71, 0xffff0000, v83
    v_lshlrev_b32 v72, 16, v84
    v_and_b32 v73, 0xffff0000, v84
    v_lshlrev_b32 v74, 16, v85
    v_and_b32 v75, 0xffff0000, v85
    v_lshlrev_b32 v76, 16, v86
    v_and_b32 v77, 0xffff0000, v86
    v_lshlrev_b32 v78, 16, v87
    v_and_b32 v79, 0xffff0000, v87
    v_add_f32 v88, v64, v65
    v_add_f32 v88, v88, v66
    v_add_f32 v88, v88, v67
    v_add_f32 v88, v88, v68
    v_add_f32 v88, v88, v69
    v_add_f32 v88, v88, v70
    v_add_f32 v88, v88, v71
    v_add_f32 v88, v88, v72
    v_add_f32 v88, v88, v73
    v_add_f32 v88, v88, v74
    v_add_f32 v88, v88, v75
    v_add_f32 v88, v88, v76
    v_add_f32 v88, v88, v77
    v_add_f32 v88, v88, v78
    v_add_f32 v88, v88, v79
    v_mov_b32 v90, v88
    s_nop 1
    v_permlane32_swap_b32 v88, v90
    s_nop 1
    v_add_f32 v88, v88, v90
    v_mul_f32 v88, 0x3d000000, v88
    v_sub_f32 v64, v64, v88
    v_sub_f32 v65, v65, v88
    v_sub_f32 v66, v66, v88
    v_sub_f32 v67, v67, v88
    v_sub_f32 v68, v68, v88
    v_sub_f32 v69, v69, v88
    v_sub_f32 v70, v70, v88
    v_sub_f32 v71, v71, v88
    v_sub_f32 v72, v72, v88
    v_sub_f32 v73, v73, v88
    v_sub_f32 v74, v74, v88
    v_sub_f32 v75, v75, v88
    v_sub_f32 v76, v76, v88
    v_sub_f32 v77, v77, v88
    v_sub_f32 v78, v78, v88
    v_sub_f32 v79, v79, v88
    v_mul_f32 v89, v64, v64
    v_fma_f32 v89, v65, v65, v89
    v_fma_f32 v89, v66, v66, v89
    v_fma_f32 v89, v67, v67, v89
    v_fma_f32 v89, v68, v68, v89
    v_fma_f32 v89, v69, v69, v89
    v_fma_f32 v89, v70, v70, v89
    v_fma_f32 v89, v71, v71, v89
    v_fma_f32 v89, v72, v72, v89
    v_fma_f32 v89, v73, v73, v89
    v_fma_f32 v89, v74, v74, v89
    v_fma_f32 v89, v75, v75, v89
    v_fma_f32 v89, v76, v76, v89
    v_fma_f32 v89, v77, v77, v89
    v_fma_f32 v89, v78, v78, v89
    v_fma_f32 v89, v79, v79, v89
    v_mov_b32 v90, v89
    s_nop 1
    v_permlane32_swap_b32 v89, v90
    s_nop 1
    v_add_f32 v89, v89, v90
    v_lshlrev_b32 v90, 7, v103
    buffer_store_dwordx2 v[88:89], v90, s[76:79], s90 offen sc1
    v_and_b32 v11, 63, v0
    v_lshlrev_b32 v2, 4, v11
    s_lshl_b32 s37, s20, 13
    s_add_u32 s38, s37, 131072
    v_add_u32 v0, s38, v2
    s_add_u32 s38, s37, 98304
    v_add_u32 v4, s38, v2
    v_xor_b32 v5, 0x2000, v4
    s_lshl_b32 s38, s2, 15
    s_add_u32 s38, s38, s37
    s_mov_b32 s33, s38
    v_mov_b32 v16, 0
    v_mov_b32 v17, 0
    v_mov_b32 v18, 0
    v_mov_b32 v19, 0
    s_nop 1
    s_add_u32 s34, s33, 4096
    v_mfma_f32_32x32x16_bf16 a[0:15], v[16:19], v[16:19], 0
    v_mfma_f32_32x32x16_bf16 a[16:31], v[16:19], v[16:19], 0
    v_mfma_f32_32x32x16_bf16 a[32:47], v[16:19], v[16:19], 0
    v_cvt_pk_bf16_f32 v64, v128, v129
    v_cvt_pk_bf16_f32 v65, v130, v131
    v_cvt_pk_bf16_f32 v66, v132, v133
    v_cvt_pk_bf16_f32 v67, v134, v135
    ds_write_b128 v4, v[64:67] offset:0
    v_cvt_pk_bf16_f32 v68, v136, v137
    v_cvt_pk_bf16_f32 v69, v138, v139
    v_cvt_pk_bf16_f32 v70, v140, v141
    v_cvt_pk_bf16_f32 v71, v142, v143
    ds_write_b128 v4, v[68:71] offset:1024
    v_mfma_f32_32x32x16_bf16 a[48:63], v[16:19], v[16:19], 0
    v_cvt_pk_bf16_f32 v72, v144, v145
    v_cvt_pk_bf16_f32 v73, v146, v147
    v_cvt_pk_bf16_f32 v74, v148, v149
    v_cvt_pk_bf16_f32 v75, v150, v151
    ds_write_b128 v4, v[72:75] offset:2048
    v_cvt_pk_bf16_f32 v76, v152, v153
    v_cvt_pk_bf16_f32 v77, v154, v155
    v_cvt_pk_bf16_f32 v78, v156, v157
    v_cvt_pk_bf16_f32 v79, v158, v159
    ds_write_b128 v4, v[76:79] offset:3072
    v_mfma_f32_32x32x16_bf16 a[64:79], v[16:19], v[16:19], 0
    v_cvt_pk_bf16_f32 v80, v160, v161
    v_cvt_pk_bf16_f32 v81, v162, v163
    v_cvt_pk_bf16_f32 v82, v164, v165
    v_cvt_pk_bf16_f32 v83, v166, v167
    ds_write_b128 v4, v[80:83] offset:4096
    v_cvt_pk_bf16_f32 v84, v168, v169
    v_cvt_pk_bf16_f32 v85, v170, v171
    v_cvt_pk_bf16_f32 v86, v172, v173
    v_cvt_pk_bf16_f32 v87, v174, v175
    ds_write_b128 v4, v[84:87] offset:5120
    v_mfma_f32_32x32x16_bf16 a[80:95], v[16:19], v[16:19], 0
    v_cvt_pk_bf16_f32 v88, v176, v177
    v_cvt_pk_bf16_f32 v89, v178, v179
    v_cvt_pk_bf16_f32 v90, v180, v181
    v_cvt_pk_bf16_f32 v91, v182, v183
    ds_write_b128 v4, v[88:91] offset:6144
    v_cvt_pk_bf16_f32 v92, v184, v185
    v_cvt_pk_bf16_f32 v93, v186, v187
    v_cvt_pk_bf16_f32 v94, v188, v189
    v_cvt_pk_bf16_f32 v95, v190, v191
    ds_write_b128 v4, v[92:95] offset:7168
    v_mfma_f32_32x32x16_bf16 a[96:111], v[16:19], v[16:19], 0
    v_cvt_pk_bf16_f32 v96, v192, v193
    v_cvt_pk_bf16_f32 v97, v194, v195
    v_cvt_pk_bf16_f32 v98, v196, v197
    v_cvt_pk_bf16_f32 v99, v198, v199
    ds_write_b128 v0, v[96:99] offset:0
    v_cvt_pk_bf16_f32 v100, v200, v201
    v_cvt_pk_bf16_f32 v101, v202, v203
    v_cvt_pk_bf16_f32 v102, v204, v205
    v_cvt_pk_bf16_f32 v103, v206, v207
    ds_write_b128 v0, v[100:103] offset:1024
    v_mfma_f32_32x32x16_bf16 a[112:127], v[16:19], v[16:19], 0
    v_cvt_pk_bf16_f32 v104, v208, v209
    v_cvt_pk_bf16_f32 v105, v210, v211
    v_cvt_pk_bf16_f32 v106, v212, v213
    v_cvt_pk_bf16_f32 v107, v214, v215
    ds_write_b128 v0, v[104:107] offset:2048
    v_cvt_pk_bf16_f32 v108, v216, v217
    v_cvt_pk_bf16_f32 v109, v218, v219
    v_cvt_pk_bf16_f32 v110, v220, v221
    v_cvt_pk_bf16_f32 v111, v222, v223
    ds_write_b128 v0, v[108:111] offset:3072
    v_mfma_f32_32x32x16_bf16 a[128:143], v[16:19], v[16:19], 0
    v_cvt_pk_bf16_f32 v112, v224, v225
    v_cvt_pk_bf16_f32 v113, v226, v227
    v_cvt_pk_bf16_f32 v114, v228, v229
    v_cvt_pk_bf16_f32 v115, v230, v231
    ds_write_b128 v0, v[112:115] offset:4096
    v_cvt_pk_bf16_f32 v116, v232, v233
    v_cvt_pk_bf16_f32 v117, v234, v235
    v_cvt_pk_bf16_f32 v118, v236, v237
    v_cvt_pk_bf16_f32 v119, v238, v239
    ds_write_b128 v0, v[116:119] offset:5120
    v_mfma_f32_32x32x16_bf16 a[144:159], v[16:19], v[16:19], 0
    v_cvt_pk_bf16_f32 v120, v240, v241
    v_cvt_pk_bf16_f32 v121, v242, v243
    v_cvt_pk_bf16_f32 v122, v244, v245
    v_cvt_pk_bf16_f32 v123, v246, v247
    ds_write_b128 v0, v[120:123] offset:6144
    v_cvt_pk_bf16_f32 v124, v248, v249
    v_cvt_pk_bf16_f32 v125, v250, v251
    v_cvt_pk_bf16_f32 v126, v252, v253
    v_cvt_pk_bf16_f32 v127, v254, v255
    ds_write_b128 v0, v[124:127] offset:7168
    v_mfma_f32_32x32x16_bf16 a[160:175], v[16:19], v[16:19], 0
    buffer_store_dwordx4 v[64:67], v2, s[56:59], s33 offen offset:0
    buffer_store_dwordx4 v[68:71], v2, s[56:59], s33 offen offset:1024
    v_mfma_f32_32x32x16_bf16 a[176:191], v[16:19], v[16:19], 0
    buffer_store_dwordx4 v[72:75], v2, s[56:59], s33 offen offset:2048
    buffer_store_dwordx4 v[76:79], v2, s[56:59], s33 offen offset:3072
    v_mfma_f32_32x32x16_bf16 a[192:207], v[16:19], v[16:19], 0
    buffer_store_dwordx4 v[80:83], v2, s[56:59], s34 offen offset:0
    buffer_store_dwordx4 v[84:87], v2, s[56:59], s34 offen offset:1024
    v_mfma_f32_32x32x16_bf16 a[208:223], v[16:19], v[16:19], 0
    buffer_store_dwordx4 v[88:91], v2, s[56:59], s34 offen offset:2048
    buffer_store_dwordx4 v[92:95], v2, s[56:59], s34 offen offset:3072
    v_mfma_f32_32x32x16_bf16 a[224:239], v[16:19], v[16:19], 0
    v_mfma_f32_32x32x16_bf16 a[240:255], v[16:19], v[16:19], 0
    s_and_b32 s37, s20, 1
    s_lshl_b32 s37, s37, 13
    v_add_u32 v2, s37, v2
    v_add_u32 v1, 0x10000, v2
    s_add_u32 s23, s30, 0x10000
    s_add_u32 s25, s24, 0x8000
    s_add_u32 s26, s24, 0x4000
    s_add_u32 s27, s24, 0xc000
    s_waitcnt vmcnt(11) lgkmcnt(0)
    s_barrier
    ds_read_b128 v[96:99], v5 offset:0
    ds_read_b128 v[100:103], v5 offset:1024
    ds_read_b128 v[104:107], v5 offset:2048
    ds_read_b128 v[108:111], v5 offset:3072
    ds_read_b128 v[112:115], v5 offset:4096
    ds_read_b128 v[116:119], v5 offset:5120
    ds_read_b128 v[120:123], v5 offset:6144
    ds_read_b128 v[124:127], v5 offset:7168
    ds_read_b128 v[128:131], v2 offset:0
    ds_read_b128 v[132:135], v2 offset:1024
    ds_read_b128 v[136:139], v2 offset:2048
    ds_read_b128 v[140:143], v2 offset:3072
    ds_read_b128 v[144:147], v2 offset:4096
    ds_read_b128 v[148:151], v2 offset:5120
    ds_read_b128 v[152:155], v2 offset:6144
    ds_read_b128 v[156:159], v2 offset:7168
    v_and_b32 v11, 31, v11
    v_bfe_u32 v12, v2, 9, 1
    v_lshlrev_b32 v12, 2, v12
    v_sub_u32 v11, v11, v12
    v_mov_b32 v12, 0xff800000
    s_cmp_lt_u32 s20, 2
    s_cselect_b32 s33, -1, 0
    s_cselect_b32 s34, 0xff800000, 0
    s_cselect_b32 s35, 0, -1
    s_cmp_eq_u32 s20, 1
    s_cselect_b32 s37, 0xff800000, 0
    s_cmp_eq_u32 s20, 2
    s_cselect_b32 s38, 0, 0xff800000
    v_cmp_gt_i32 vcc, 0, v11
    v_mov_b32 v208, s37
    v_mov_b32 v240, s38
    v_cndmask_b32 v13, 0, v12, vcc
    v_and_b32 v192, s33, v13
    v_and_b32 v13, s35, v13
    v_or_b32 v224, s34, v13
    v_cmp_gt_i32 vcc, 1, v11
    v_mov_b32 v209, s37
    v_mov_b32 v241, s38
    v_cndmask_b32 v13, 0, v12, vcc
    v_and_b32 v193, s33, v13
    v_and_b32 v13, s35, v13
    v_or_b32 v225, s34, v13
    v_cmp_gt_i32 vcc, 2, v11
    v_mov_b32 v210, s37
    v_mov_b32 v242, s38
    v_cndmask_b32 v13, 0, v12, vcc
    v_and_b32 v194, s33, v13
    v_and_b32 v13, s35, v13
    v_or_b32 v226, s34, v13
    v_cmp_gt_i32 vcc, 3, v11
    v_mov_b32 v211, s37
    v_mov_b32 v243, s38
    v_cndmask_b32 v13, 0, v12, vcc
    v_and_b32 v195, s33, v13
    v_and_b32 v13, s35, v13
    v_or_b32 v227, s34, v13
    v_cmp_gt_i32 vcc, 16, v11
    v_mov_b32 v212, s37
    v_mov_b32 v244, s38
    v_cndmask_b32 v13, 0, v12, vcc
    v_and_b32 v196, s33, v13
    v_and_b32 v13, s35, v13
    v_or_b32 v228, s34, v13
    v_cmp_gt_i32 vcc, 17, v11
    v_mov_b32 v213, s37
    v_mov_b32 v245, s38
    v_cndmask_b32 v13, 0, v12, vcc
    v_and_b32 v197, s33, v13
    v_and_b32 v13, s35, v13
    v_or_b32 v229, s34, v13
    v_cmp_gt_i32 vcc, 18, v11
    v_mov_b32 v214, s37
    v_mov_b32 v246, s38
    v_cndmask_b32 v13, 0, v12, vcc
    v_and_b32 v198, s33, v13
    v_and_b32 v13, s35, v13
    v_or_b32 v230, s34, v13
    v_cmp_gt_i32 vcc, 19, v11
    v_mov_b32 v215, s37
    v_mov_b32 v247, s38
    v_cndmask_b32 v13, 0, v12, vcc
    v_and_b32 v199, s33, v13
    v_and_b32 v13, s35, v13
    v_or_b32 v231, s34, v13
    v_cmp_gt_i32 vcc, 8, v11
    v_mov_b32 v216, s37
    v_mov_b32 v248, s38
    v_cndmask_b32 v13, 0, v12, vcc
    v_and_b32 v200, s33, v13
    v_and_b32 v13, s35, v13
    v_or_b32 v232, s34, v13
    v_cmp_gt_i32 vcc, 9, v11
    v_mov_b32 v217, s37
    v_mov_b32 v249, s38
    v_cndmask_b32 v13, 0, v12, vcc
    v_and_b32 v201, s33, v13
    v_and_b32 v13, s35, v13
    v_or_b32 v233, s34, v13
    v_cmp_gt_i32 vcc, 10, v11
    v_mov_b32 v218, s37
    v_mov_b32 v250, s38
    v_cndmask_b32 v13, 0, v12, vcc
    v_and_b32 v202, s33, v13
    v_and_b32 v13, s35, v13
    v_or_b32 v234, s34, v13
    v_cmp_gt_i32 vcc, 11, v11
    v_mov_b32 v219, s37
    v_mov_b32 v251, s38
    v_cndmask_b32 v13, 0, v12, vcc
    v_and_b32 v203, s33, v13
    v_and_b32 v13, s35, v13
    v_or_b32 v235, s34, v13
    v_cmp_gt_i32 vcc, 24, v11
    v_mov_b32 v220, s37
    v_mov_b32 v252, s38
    v_cndmask_b32 v13, 0, v12, vcc
    v_and_b32 v204, s33, v13
    v_and_b32 v13, s35, v13
    v_or_b32 v236, s34, v13
    v_cmp_gt_i32 vcc, 25, v11
    v_mov_b32 v221, s37
    v_mov_b32 v253, s38
    v_cndmask_b32 v13, 0, v12, vcc
    v_and_b32 v205, s33, v13
    v_and_b32 v13, s35, v13
    v_or_b32 v237, s34, v13
    v_cmp_gt_i32 vcc, 26, v11
    v_mov_b32 v222, s37
    v_mov_b32 v254, s38
    v_cndmask_b32 v13, 0, v12, vcc
    v_and_b32 v206, s33, v13
    v_and_b32 v13, s35, v13
    v_or_b32 v238, s34, v13
    v_cmp_gt_i32 vcc, 27, v11
    v_mov_b32 v223, s37
    v_mov_b32 v255, s38
    v_cndmask_b32 v13, 0, v12, vcc
    v_and_b32 v207, s33, v13
    v_and_b32 v13, s35, v13
    v_or_b32 v239, s34, v13
    s_cmp_eq_u32 s22, 0
    s_cselect_b32 s33, -1, 0
    v_and_b32 v16, s33, v192
    v_and_b32 v32, s33, v208
    v_and_b32 v17, s33, v193
    v_and_b32 v33, s33, v209
    v_and_b32 v18, s33, v194
    v_and_b32 v34, s33, v210
    v_and_b32 v19, s33, v195
    v_and_b32 v35, s33, v211
    v_and_b32 v20, s33, v196
    v_and_b32 v36, s33, v212
    v_and_b32 v21, s33, v197
    v_and_b32 v37, s33, v213
    v_and_b32 v22, s33, v198
    v_and_b32 v38, s33, v214
    v_and_b32 v23, s33, v199
    v_and_b32 v39, s33, v215
    v_and_b32 v24, s33, v200
    v_and_b32 v40, s33, v216
    v_and_b32 v25, s33, v201
    v_and_b32 v41, s33, v217
    v_and_b32 v26, s33, v202
    v_and_b32 v42, s33, v218
    v_and_b32 v27, s33, v203
    v_and_b32 v43, s33, v219
    v_and_b32 v28, s33, v204
    v_and_b32 v44, s33, v220
    v_and_b32 v29, s33, v205
    v_and_b32 v45, s33, v221
    v_and_b32 v30, s33, v206
    v_and_b32 v46, s33, v222
    v_and_b32 v31, s33, v207
    v_and_b32 v47, s33, v223
    v_mov_b32 v8, 0
    v_mov_b32 v9, 0
    v_mov_b32 v10, 0
    v_mov_b32 v11, 0
    v_mov_b32 v12, 0
    v_mov_b32 v13, 0
    v_mov_b32 v14, 0
    v_mov_b32 v15, 0
    s_waitcnt vmcnt(8) lgkmcnt(0)
    s_barrier
    buffer_atomic_add v63, v62, s[84:87], 0 offen sc1
    v_mfma_f32_32x32x16_bf16 v[16:31], v[128:131], v[64:67], v[16:31]
    v_mfma_f32_32x32x16_bf16 v[16:31], v[132:135], v[68:71], v[16:31]
    s_or_b32 m0, s23, 0x8000
    s_nop 0
    buffer_load_dwordx4 v3, s[4:7], s26 offen offset:0 lds
    v_mfma_f32_32x32x16_bf16 v[16:31], v[136:139], v[72:75], v[16:31]
    v_mfma_f32_32x32x16_bf16 v[16:31], v[140:143], v[76:79], v[16:31]
    buffer_load_dwordx4 v3, s[4:7], s26 offen offset:1024 lds
    v_mfma_f32_32x32x16_bf16 v[16:31], v[144:147], v[80:83], v[16:31]
    v_mfma_f32_32x32x16_bf16 v[16:31], v[148:151], v[84:87], v[16:31]
    v_mfma_f32_32x32x16_bf16 v[16:31], v[152:155], v[88:91], v[16:31]
    v_mfma_f32_32x32x16_bf16 v[16:31], v[156:159], v[92:95], v[16:31]
    buffer_load_dwordx4 v3, s[4:7], s26 offen offset:2048 lds
    buffer_load_dwordx4 v3, s[4:7], s26 offen offset:3072 lds
    s_or_b32 m0, s23, 0x4000
    buffer_load_dwordx4 v3, s[4:7], s25 offen offset:0 lds
    s_waitcnt vmcnt(5)
    s_barrier
    s_nop 7
    s_nop 7
    v_mfma_f32_32x32x16_bf16 v[32:47], v[128:131], v[96:99], v[32:47]
    v_exp_f32 v4, v16
    v_exp_f32 v5, v17
    s_nop 0
    v_mfma_f32_32x32x16_bf16 v[32:47], v[132:135], v[100:103], v[32:47]
    v_cvt_pk_bf16_f32 v48, v4, v5
    ds_read_b128 v[128:131], v2 offset:16384
    buffer_load_dwordx4 v3, s[4:7], s25 offen offset:1024 lds
    v_mfma_f32_32x32x16_bf16 v[32:47], v[136:139], v[104:107], v[32:47]
    v_exp_f32 v6, v18
    v_exp_f32 v7, v19
    v_add_f32 v8, v8, v4
    v_add_f32 v9, v9, v5
    v_mfma_f32_32x32x16_bf16 v[32:47], v[140:143], v[108:111], v[32:47]
    v_cvt_pk_bf16_f32 v49, v6, v7
    ds_read_b128 v[132:135], v2 offset:17408
    buffer_load_dwordx4 v3, s[4:7], s25 offen offset:2048 lds
    v_mfma_f32_32x32x16_bf16 v[32:47], v[144:147], v[112:115], v[32:47]
    v_exp_f32 v4, v20
    v_exp_f32 v5, v21
    v_add_f32 v8, v8, v6
    v_add_f32 v9, v9, v7
    v_mfma_f32_32x32x16_bf16 v[32:47], v[148:151], v[116:119], v[32:47]
    v_cvt_pk_bf16_f32 v50, v4, v5
    ds_read_b128 v[136:139], v2 offset:18432
    buffer_load_dwordx4 v3, s[4:7], s25 offen offset:3072 lds
    v_mfma_f32_32x32x16_bf16 v[32:47], v[152:155], v[120:123], v[32:47]
    v_exp_f32 v6, v22
    v_exp_f32 v7, v23
    v_add_f32 v8, v8, v4
    v_add_f32 v9, v9, v5
    v_mfma_f32_32x32x16_bf16 v[32:47], v[156:159], v[124:127], v[32:47]
    v_cvt_pk_bf16_f32 v51, v6, v7
    ds_read_b128 v[140:143], v2 offset:19456
    v_exp_f32 v4, v24
    v_exp_f32 v5, v25
    v_add_f32 v8, v8, v6
    v_add_f32 v9, v9, v7
    v_cvt_pk_bf16_f32 v52, v4, v5
    ds_read_b128 v[144:147], v2 offset:20480
    ds_read_b128 v[160:163], v2 offset:32768
    v_exp_f32 v6, v26
    v_exp_f32 v7, v27
    v_add_f32 v8, v8, v4
    v_add_f32 v9, v9, v5
    v_cvt_pk_bf16_f32 v53, v6, v7
    ds_read_b128 v[148:151], v2 offset:21504
    ds_read_b128 v[164:167], v2 offset:33792
    v_exp_f32 v4, v28
    v_exp_f32 v5, v29
    v_add_f32 v8, v8, v6
    v_add_f32 v9, v9, v7
    v_cvt_pk_bf16_f32 v54, v4, v5
    ds_read_b128 v[152:155], v2 offset:22528
    ds_read_b128 v[168:171], v2 offset:34816
    v_exp_f32 v6, v30
    v_exp_f32 v7, v31
    v_add_f32 v8, v8, v4
    v_add_f32 v9, v9, v5
    v_cvt_pk_bf16_f32 v55, v6, v7
    ds_read_b128 v[156:159], v2 offset:23552
    ds_read_b128 v[172:175], v2 offset:35840
    s_waitcnt lgkmcnt(4)
    v_xor_b32 v1, 0x10000, v1
    v_xor_b32 v2, 0x10000, v2
    s_xor_b32 s23, s23, 0x10000
    s_cmp_eq_u32 s22, 0
    s_cbranch_scc1 SL_100020
    s_sub_u32 s28, s22, 1
    s_cmp_eq_u32 s28, 0
    s_cbranch_scc1 SP_100019
SR_100021:
    v_mfma_f32_32x32x16_bf16 v[16:31], v[128:131], v[64:67], 0
    v_exp_f32 v4, v32
    v_exp_f32 v5, v33
    v_add_f32 v8, v8, v6
    v_add_f32 v9, v9, v7
    v_mfma_f32_32x32x16_bf16 v[16:31], v[132:135], v[68:71], v[16:31]
    s_xor_b32 m0, s23, 0x1c000
    v_cvt_pk_bf16_f32 v56, v4, v5
    ds_read_b128 v[176:179], v1 offset:36864
    buffer_load_dwordx4 v3, s[4:7], s27 offen offset:0 lds
    v_mfma_f32_32x32x16_bf16 v[16:31], v[136:139], v[72:75], v[16:31]
    v_exp_f32 v6, v34
    v_exp_f32 v7, v35
    v_add_f32 v10, v10, v4
    v_add_f32 v11, v11, v5
    v_mfma_f32_32x32x16_bf16 v[16:31], v[140:143], v[76:79], v[16:31]
    v_cvt_pk_bf16_f32 v57, v6, v7
    ds_read_b128 v[180:183], v1 offset:37888
    buffer_load_dwordx4 v3, s[4:7], s27 offen offset:1024 lds
    v_mfma_f32_32x32x16_bf16 v[16:31], v[144:147], v[80:83], v[16:31]
    v_exp_f32 v4, v36
    v_exp_f32 v5, v37
    v_add_f32 v10, v10, v6
    v_add_f32 v11, v11, v7
    v_mfma_f32_32x32x16_bf16 v[16:31], v[148:151], v[84:87], v[16:31]
    v_cvt_pk_bf16_f32 v58, v4, v5
    ds_read_b128 v[184:187], v1 offset:38912
    s_waitcnt lgkmcnt(3)
    s_add_u32 s24, s24, 0x10000
    v_mfma_f32_32x32x16_bf16 v[16:31], v[152:155], v[88:91], v[16:31]
    v_exp_f32 v6, v38
    v_exp_f32 v7, v39
    v_add_f32 v10, v10, v4
    v_add_f32 v11, v11, v5
    v_mfma_f32_32x32x16_bf16 v[16:31], v[156:159], v[92:95], v[16:31]
    v_cvt_pk_bf16_f32 v59, v6, v7
    ds_read_b128 v[188:191], v1 offset:39936
    buffer_load_dwordx4 v3, s[4:7], s27 offen offset:2048 lds
    v_mfma_f32_32x32x16_bf16 a[0:15], v[160:163], v[48:51], a[0:15]
    v_exp_f32 v4, v40
    v_exp_f32 v5, v41
    v_add_f32 v10, v10, v6
    v_add_f32 v11, v11, v7
    v_mfma_f32_32x32x16_bf16 a[16:31], v[164:167], v[48:51], a[16:31]
    v_cvt_pk_bf16_f32 v60, v4, v5
    buffer_load_dwordx4 v3, s[4:7], s27 offen offset:3072 lds
    v_mfma_f32_32x32x16_bf16 a[32:47], v[168:171], v[48:51], a[32:47]
    v_exp_f32 v6, v42
    v_exp_f32 v7, v43
    v_add_f32 v10, v10, v4
    v_add_f32 v11, v11, v5
    v_mfma_f32_32x32x16_bf16 a[48:63], v[172:175], v[48:51], a[48:63]
    v_cvt_pk_bf16_f32 v61, v6, v7
    s_waitcnt lgkmcnt(0)
    s_mov_b32 m0, s23
    v_mfma_f32_32x32x16_bf16 a[0:15], v[176:179], v[52:55], a[0:15]
    v_exp_f32 v4, v44
    v_exp_f32 v5, v45
    v_add_f32 v10, v10, v6
    v_add_f32 v11, v11, v7
    v_mfma_f32_32x32x16_bf16 a[16:31], v[180:183], v[52:55], a[16:31]
    v_cvt_pk_bf16_f32 v62, v4, v5
    buffer_load_dwordx4 v3, s[4:7], s24 offen offset:0 lds
    v_mfma_f32_32x32x16_bf16 a[32:47], v[184:187], v[52:55], a[32:47]
    v_exp_f32 v6, v46
    v_exp_f32 v7, v47
    v_add_f32 v10, v10, v4
    v_add_f32 v11, v11, v5
    v_mfma_f32_32x32x16_bf16 a[48:63], v[188:191], v[52:55], a[48:63]
    v_cvt_pk_bf16_f32 v63, v6, v7
    s_waitcnt vmcnt(13)
    s_barrier
    v_mfma_f32_32x32x16_bf16 v[32:47], v[128:131], v[96:99], 0
    v_exp_f32 v4, v16
    v_exp_f32 v5, v17
    v_add_f32 v10, v10, v6
    v_add_f32 v11, v11, v7
    v_mfma_f32_32x32x16_bf16 v[32:47], v[132:135], v[100:103], v[32:47]
    v_cvt_pk_bf16_f32 v48, v4, v5
    ds_read_b128 v[128:131], v2 offset:0
    buffer_load_dwordx4 v3, s[4:7], s24 offen offset:1024 lds
    v_mfma_f32_32x32x16_bf16 v[32:47], v[136:139], v[104:107], v[32:47]
    v_exp_f32 v6, v18
    v_exp_f32 v7, v19
    v_add_f32 v8, v8, v4
    v_add_f32 v9, v9, v5
    v_mfma_f32_32x32x16_bf16 v[32:47], v[140:143], v[108:111], v[32:47]
    v_cvt_pk_bf16_f32 v49, v6, v7
    ds_read_b128 v[132:135], v2 offset:1024
    buffer_load_dwordx4 v3, s[4:7], s24 offen offset:2048 lds
    v_mfma_f32_32x32x16_bf16 v[32:47], v[144:147], v[112:115], v[32:47]
    v_exp_f32 v4, v20
    v_exp_f32 v5, v21
    v_add_f32 v8, v8, v6
    v_add_f32 v9, v9, v7
    v_mfma_f32_32x32x16_bf16 v[32:47], v[148:151], v[116:119], v[32:47]
    v_cvt_pk_bf16_f32 v50, v4, v5
    ds_read_b128 v[136:139], v2 offset:2048
    buffer_load_dwordx4 v3, s[4:7], s24 offen offset:3072 lds
    v_mfma_f32_32x32x16_bf16 v[32:47], v[152:155], v[120:123], v[32:47]
    v_exp_f32 v6, v22
    v_exp_f32 v7, v23
    v_add_f32 v8, v8, v4
    v_add_f32 v9, v9, v5
    v_mfma_f32_32x32x16_bf16 v[32:47], v[156:159], v[124:127], v[32:47]
    v_cvt_pk_bf16_f32 v51, v6, v7
    ds_read_b128 v[140:143], v2 offset:3072
    s_add_u32 s25, s24, 0x8000
    s_add_u32 s26, s24, 0x4000
    v_mfma_f32_32x32x16_bf16 a[64:79], v[160:163], v[56:59], a[64:79]
    v_exp_f32 v4, v24
    v_exp_f32 v5, v25
    v_add_f32 v8, v8, v6
    v_add_f32 v9, v9, v7
    v_mfma_f32_32x32x16_bf16 a[80:95], v[164:167], v[56:59], a[80:95]
    v_cvt_pk_bf16_f32 v52, v4, v5
    ds_read_b128 v[144:147], v2 offset:4096
    ds_read_b128 v[160:163], v1 offset:49152
    v_mfma_f32_32x32x16_bf16 a[96:111], v[168:171], v[56:59], a[96:111]
    v_exp_f32 v6, v26
    v_exp_f32 v7, v27
    v_add_f32 v8, v8, v4
    v_add_f32 v9, v9, v5
    v_mfma_f32_32x32x16_bf16 a[112:127], v[172:175], v[56:59], a[112:127]
    v_cvt_pk_bf16_f32 v53, v6, v7
    ds_read_b128 v[148:151], v2 offset:5120
    ds_read_b128 v[164:167], v1 offset:50176
    v_mfma_f32_32x32x16_bf16 a[64:79], v[176:179], v[60:63], a[64:79]
    v_exp_f32 v4, v28
    v_exp_f32 v5, v29
    v_add_f32 v8, v8, v6
    v_add_f32 v9, v9, v7
    v_mfma_f32_32x32x16_bf16 a[80:95], v[180:183], v[60:63], a[80:95]
    v_cvt_pk_bf16_f32 v54, v4, v5
    ds_read_b128 v[152:155], v2 offset:6144
    ds_read_b128 v[168:171], v1 offset:51200
    v_mfma_f32_32x32x16_bf16 a[96:111], v[184:187], v[60:63], a[96:111]
    v_exp_f32 v6, v30
    v_exp_f32 v7, v31
    v_add_f32 v8, v8, v4
    v_add_f32 v9, v9, v5
    v_mfma_f32_32x32x16_bf16 a[112:127], v[188:191], v[60:63], a[112:127]
    v_cvt_pk_bf16_f32 v55, v6, v7
    ds_read_b128 v[156:159], v2 offset:7168
    ds_read_b128 v[172:175], v1 offset:52224
    s_waitcnt lgkmcnt(4)
    v_mfma_f32_32x32x16_bf16 v[16:31], v[128:131], v[64:67], 0
    v_exp_f32 v4, v32
    v_exp_f32 v5, v33
    v_add_f32 v8, v8, v6
    v_add_f32 v9, v9, v7
    v_mfma_f32_32x32x16_bf16 v[16:31], v[132:135], v[68:71], v[16:31]
    s_or_b32 m0, s23, 0x8000
    v_cvt_pk_bf16_f32 v56, v4, v5
    ds_read_b128 v[176:179], v1 offset:53248
    buffer_load_dwordx4 v3, s[4:7], s26 offen offset:0 lds
    v_mfma_f32_32x32x16_bf16 v[16:31], v[136:139], v[72:75], v[16:31]
    v_exp_f32 v6, v34
    v_exp_f32 v7, v35
    v_add_f32 v10, v10, v4
    v_add_f32 v11, v11, v5
    v_mfma_f32_32x32x16_bf16 v[16:31], v[140:143], v[76:79], v[16:31]
    v_cvt_pk_bf16_f32 v57, v6, v7
    ds_read_b128 v[180:183], v1 offset:54272
    buffer_load_dwordx4 v3, s[4:7], s26 offen offset:1024 lds
    v_mfma_f32_32x32x16_bf16 v[16:31], v[144:147], v[80:83], v[16:31]
    v_exp_f32 v4, v36
    v_exp_f32 v5, v37
    v_add_f32 v10, v10, v6
    v_add_f32 v11, v11, v7
    v_mfma_f32_32x32x16_bf16 v[16:31], v[148:151], v[84:87], v[16:31]
    v_cvt_pk_bf16_f32 v58, v4, v5
    ds_read_b128 v[184:187], v1 offset:55296
    s_waitcnt lgkmcnt(3)
    v_mfma_f32_32x32x16_bf16 v[16:31], v[152:155], v[88:91], v[16:31]
    v_exp_f32 v6, v38
    v_exp_f32 v7, v39
    v_add_f32 v10, v10, v4
    v_add_f32 v11, v11, v5
    v_mfma_f32_32x32x16_bf16 v[16:31], v[156:159], v[92:95], v[16:31]
    v_cvt_pk_bf16_f32 v59, v6, v7
    ds_read_b128 v[188:191], v1 offset:56320
    buffer_load_dwordx4 v3, s[4:7], s26 offen offset:2048 lds
    v_mfma_f32_32x32x16_bf16 a[0:15], v[160:163], v[48:51], a[0:15]
    v_exp_f32 v4, v40
    v_exp_f32 v5, v41
    v_add_f32 v10, v10, v6
    v_add_f32 v11, v11, v7
    v_mfma_f32_32x32x16_bf16 a[16:31], v[164:167], v[48:51], a[16:31]
    v_cvt_pk_bf16_f32 v60, v4, v5
    buffer_load_dwordx4 v3, s[4:7], s26 offen offset:3072 lds
    v_mfma_f32_32x32x16_bf16 a[32:47], v[168:171], v[48:51], a[32:47]
    v_exp_f32 v6, v42
    v_exp_f32 v7, v43
    v_add_f32 v10, v10, v4
    v_add_f32 v11, v11, v5
    v_mfma_f32_32x32x16_bf16 a[48:63], v[172:175], v[48:51], a[48:63]
    v_cvt_pk_bf16_f32 v61, v6, v7
    s_waitcnt lgkmcnt(0)
    s_or_b32 m0, s23, 0x4000
    v_mfma_f32_32x32x16_bf16 a[0:15], v[176:179], v[52:55], a[0:15]
    v_exp_f32 v4, v44
    v_exp_f32 v5, v45
    v_add_f32 v10, v10, v6
    v_add_f32 v11, v11, v7
    v_mfma_f32_32x32x16_bf16 a[16:31], v[180:183], v[52:55], a[16:31]
    v_cvt_pk_bf16_f32 v62, v4, v5
    buffer_load_dwordx4 v3, s[4:7], s25 offen offset:0 lds
    v_mfma_f32_32x32x16_bf16 a[32:47], v[184:187], v[52:55], a[32:47]
    v_exp_f32 v6, v46
    v_exp_f32 v7, v47
    v_add_f32 v10, v10, v4
    v_add_f32 v11, v11, v5
    v_mfma_f32_32x32x16_bf16 a[48:63], v[188:191], v[52:55], a[48:63]
    v_cvt_pk_bf16_f32 v63, v6, v7
    s_waitcnt vmcnt(13)
    s_barrier
    v_mfma_f32_32x32x16_bf16 v[32:47], v[128:131], v[96:99], 0
    v_exp_f32 v4, v16
    v_exp_f32 v5, v17
    v_add_f32 v10, v10, v6
    v_add_f32 v11, v11, v7
    v_mfma_f32_32x32x16_bf16 v[32:47], v[132:135], v[100:103], v[32:47]
    v_cvt_pk_bf16_f32 v48, v4, v5
    ds_read_b128 v[128:131], v2 offset:16384
    buffer_load_dwordx4 v3, s[4:7], s25 offen offset:1024 lds
    v_mfma_f32_32x32x16_bf16 v[32:47], v[136:139], v[104:107], v[32:47]
    v_exp_f32 v6, v18
    v_exp_f32 v7, v19
    v_add_f32 v8, v8, v4
    v_add_f32 v9, v9, v5
    v_mfma_f32_32x32x16_bf16 v[32:47], v[140:143], v[108:111], v[32:47]
    v_cvt_pk_bf16_f32 v49, v6, v7
    ds_read_b128 v[132:135], v2 offset:17408
    buffer_load_dwordx4 v3, s[4:7], s25 offen offset:2048 lds
    v_mfma_f32_32x32x16_bf16 v[32:47], v[144:147], v[112:115], v[32:47]
    v_exp_f32 v4, v20
    v_exp_f32 v5, v21
    v_add_f32 v8, v8, v6
    v_add_f32 v9, v9, v7
    v_mfma_f32_32x32x16_bf16 v[32:47], v[148:151], v[116:119], v[32:47]
    v_cvt_pk_bf16_f32 v50, v4, v5
    ds_read_b128 v[136:139], v2 offset:18432
    buffer_load_dwordx4 v3, s[4:7], s25 offen offset:3072 lds
    v_mfma_f32_32x32x16_bf16 v[32:47], v[152:155], v[120:123], v[32:47]
    v_exp_f32 v6, v22
    v_exp_f32 v7, v23
    v_add_f32 v8, v8, v4
    v_add_f32 v9, v9, v5
    v_mfma_f32_32x32x16_bf16 v[32:47], v[156:159], v[124:127], v[32:47]
    v_cvt_pk_bf16_f32 v51, v6, v7
    ds_read_b128 v[140:143], v2 offset:19456
    s_add_u32 s27, s24, 0xc000
    v_mfma_f32_32x32x16_bf16 a[64:79], v[160:163], v[56:59], a[64:79]
    v_exp_f32 v4, v24
    v_exp_f32 v5, v25
    v_add_f32 v8, v8, v6
    v_add_f32 v9, v9, v7
    v_mfma_f32_32x32x16_bf16 a[80:95], v[164:167], v[56:59], a[80:95]
    v_cvt_pk_bf16_f32 v52, v4, v5
    ds_read_b128 v[144:147], v2 offset:20480
    ds_read_b128 v[160:163], v2 offset:32768
    v_mfma_f32_32x32x16_bf16 a[96:111], v[168:171], v[56:59], a[96:111]
    v_exp_f32 v6, v26
    v_exp_f32 v7, v27
    v_add_f32 v8, v8, v4
    v_add_f32 v9, v9, v5
    v_mfma_f32_32x32x16_bf16 a[112:127], v[172:175], v[56:59], a[112:127]
    v_cvt_pk_bf16_f32 v53, v6, v7
    ds_read_b128 v[148:151], v2 offset:21504
    ds_read_b128 v[164:167], v2 offset:33792
    v_mfma_f32_32x32x16_bf16 a[64:79], v[176:179], v[60:63], a[64:79]
    v_exp_f32 v4, v28
    v_exp_f32 v5, v29
    v_add_f32 v8, v8, v6
    v_add_f32 v9, v9, v7
    v_mfma_f32_32x32x16_bf16 a[80:95], v[180:183], v[60:63], a[80:95]
    v_cvt_pk_bf16_f32 v54, v4, v5
    ds_read_b128 v[152:155], v2 offset:22528
    ds_read_b128 v[168:171], v2 offset:34816
    v_mfma_f32_32x32x16_bf16 a[96:111], v[184:187], v[60:63], a[96:111]
    v_exp_f32 v6, v30
    v_exp_f32 v7, v31
    v_add_f32 v8, v8, v4
    v_add_f32 v9, v9, v5
    v_mfma_f32_32x32x16_bf16 a[112:127], v[188:191], v[60:63], a[112:127]
    v_cvt_pk_bf16_f32 v55, v6, v7
    ds_read_b128 v[156:159], v2 offset:23552
    ds_read_b128 v[172:175], v2 offset:35840
    s_waitcnt lgkmcnt(4)
    v_xor_b32 v1, 0x10000, v1
    v_xor_b32 v2, 0x10000, v2
    s_xor_b32 s23, s23, 0x10000
    s_sub_u32 s28, s28, 1
    s_cmp_lg_u32 s28, 0
    s_cbranch_scc1 SR_100021
SP_100019:
    v_mfma_f32_32x32x16_bf16 v[16:31], v[128:131], v[64:67], 0
    v_exp_f32 v4, v32
    v_exp_f32 v5, v33
    v_add_f32 v8, v8, v6
    v_add_f32 v9, v9, v7
    v_mfma_f32_32x32x16_bf16 v[16:31], v[132:135], v[68:71], v[16:31]
    s_xor_b32 m0, s23, 0x1c000
    v_cvt_pk_bf16_f32 v56, v4, v5
    ds_read_b128 v[176:179], v1 offset:36864
    buffer_load_dwordx4 v3, s[4:7], s27 offen offset:0 lds
    v_mfma_f32_32x32x16_bf16 v[16:31], v[136:139], v[72:75], v[16:31]
    v_exp_f32 v6, v34
    v_exp_f32 v7, v35
    v_add_f32 v10, v10, v4
    v_add_f32 v11, v11, v5
    v_mfma_f32_32x32x16_bf16 v[16:31], v[140:143], v[76:79], v[16:31]
    v_cvt_pk_bf16_f32 v57, v6, v7
    ds_read_b128 v[180:183], v1 offset:37888
    buffer_load_dwordx4 v3, s[4:7], s27 offen offset:1024 lds
    v_mfma_f32_32x32x16_bf16 v[16:31], v[144:147], v[80:83], v[16:31]
    v_exp_f32 v4, v36
    v_exp_f32 v5, v37
    v_add_f32 v10, v10, v6
    v_add_f32 v11, v11, v7
    v_mfma_f32_32x32x16_bf16 v[16:31], v[148:151], v[84:87], v[16:31]
    v_cvt_pk_bf16_f32 v58, v4, v5
    ds_read_b128 v[184:187], v1 offset:38912
    s_waitcnt lgkmcnt(3)
    s_mov_b32 s24, 0
    v_mfma_f32_32x32x16_bf16 v[16:31], v[152:155], v[88:91], v[16:31]
    v_exp_f32 v6, v38
    v_exp_f32 v7, v39
    v_add_f32 v10, v10, v4
    v_add_f32 v11, v11, v5
    v_mfma_f32_32x32x16_bf16 v[16:31], v[156:159], v[92:95], v[16:31]
    v_cvt_pk_bf16_f32 v59, v6, v7
    ds_read_b128 v[188:191], v1 offset:39936
    buffer_load_dwordx4 v3, s[4:7], s27 offen offset:2048 lds
    v_mfma_f32_32x32x16_bf16 a[0:15], v[160:163], v[48:51], a[0:15]
    v_exp_f32 v4, v40
    v_exp_f32 v5, v41
    v_add_f32 v10, v10, v6
    v_add_f32 v11, v11, v7
    v_mfma_f32_32x32x16_bf16 a[16:31], v[164:167], v[48:51], a[16:31]
    v_cvt_pk_bf16_f32 v60, v4, v5
    buffer_load_dwordx4 v3, s[4:7], s27 offen offset:3072 lds
    v_mfma_f32_32x32x16_bf16 a[32:47], v[168:171], v[48:51], a[32:47]
    v_exp_f32 v6, v42
    v_exp_f32 v7, v43
    v_add_f32 v10, v10, v4
    v_add_f32 v11, v11, v5
    v_mfma_f32_32x32x16_bf16 a[48:63], v[172:175], v[48:51], a[48:63]
    v_cvt_pk_bf16_f32 v61, v6, v7
    s_waitcnt lgkmcnt(0)
    s_mov_b32 m0, s23
    v_mfma_f32_32x32x16_bf16 a[0:15], v[176:179], v[52:55], a[0:15]
    v_exp_f32 v4, v44
    v_exp_f32 v5, v45
    v_add_f32 v10, v10, v6
    v_add_f32 v11, v11, v7
    v_mfma_f32_32x32x16_bf16 a[16:31], v[180:183], v[52:55], a[16:31]
    v_cvt_pk_bf16_f32 v62, v4, v5
    buffer_load_dwordx4 v3, s[4:7], s24 offen offset:0 lds
    v_mfma_f32_32x32x16_bf16 a[32:47], v[184:187], v[52:55], a[32:47]
    v_exp_f32 v6, v46
    v_exp_f32 v7, v47
    v_add_f32 v10, v10, v4
    v_add_f32 v11, v11, v5
    v_mfma_f32_32x32x16_bf16 a[48:63], v[188:191], v[52:55], a[48:63]
    v_cvt_pk_bf16_f32 v63, v6, v7
    s_waitcnt vmcnt(13)
    s_barrier
    v_mfma_f32_32x32x16_bf16 v[32:47], v[128:131], v[96:99], 0
    v_exp_f32 v4, v16
    v_exp_f32 v5, v17
    v_add_f32 v10, v10, v6
    v_add_f32 v11, v11, v7
    v_mfma_f32_32x32x16_bf16 v[32:47], v[132:135], v[100:103], v[32:47]
    v_cvt_pk_bf16_f32 v48, v4, v5
    ds_read_b128 v[128:131], v2 offset:0
    buffer_load_dwordx4 v3, s[4:7], s24 offen offset:1024 lds
    v_mfma_f32_32x32x16_bf16 v[32:47], v[136:139], v[104:107], v[32:47]
    v_exp_f32 v6, v18
    v_exp_f32 v7, v19
    v_add_f32 v8, v8, v4
    v_add_f32 v9, v9, v5
    v_mfma_f32_32x32x16_bf16 v[32:47], v[140:143], v[108:111], v[32:47]
    v_cvt_pk_bf16_f32 v49, v6, v7
    ds_read_b128 v[132:135], v2 offset:1024
    buffer_load_dwordx4 v3, s[4:7], s24 offen offset:2048 lds
    v_mfma_f32_32x32x16_bf16 v[32:47], v[144:147], v[112:115], v[32:47]
    v_exp_f32 v4, v20
    v_exp_f32 v5, v21
    v_add_f32 v8, v8, v6
    v_add_f32 v9, v9, v7
    v_mfma_f32_32x32x16_bf16 v[32:47], v[148:151], v[116:119], v[32:47]
    v_cvt_pk_bf16_f32 v50, v4, v5
    ds_read_b128 v[136:139], v2 offset:2048
    buffer_load_dwordx4 v3, s[4:7], s24 offen offset:3072 lds
    v_mfma_f32_32x32x16_bf16 v[32:47], v[152:155], v[120:123], v[32:47]
    v_exp_f32 v6, v22
    v_exp_f32 v7, v23
    v_add_f32 v8, v8, v4
    v_add_f32 v9, v9, v5
    v_mfma_f32_32x32x16_bf16 v[32:47], v[156:159], v[124:127], v[32:47]
    v_cvt_pk_bf16_f32 v51, v6, v7
    ds_read_b128 v[140:143], v2 offset:3072
    s_add_u32 s25, s24, 0x8000
    s_add_u32 s26, s24, 0x4000
    v_mfma_f32_32x32x16_bf16 a[64:79], v[160:163], v[56:59], a[64:79]
    v_exp_f32 v4, v24
    v_exp_f32 v5, v25
    v_add_f32 v8, v8, v6
    v_add_f32 v9, v9, v7
    v_mfma_f32_32x32x16_bf16 a[80:95], v[164:167], v[56:59], a[80:95]
    v_cvt_pk_bf16_f32 v52, v4, v5
    ds_read_b128 v[144:147], v2 offset:4096
    ds_read_b128 v[160:163], v1 offset:49152
    v_mfma_f32_32x32x16_bf16 a[96:111], v[168:171], v[56:59], a[96:111]
    v_exp_f32 v6, v26
    v_exp_f32 v7, v27
    v_add_f32 v8, v8, v4
    v_add_f32 v9, v9, v5
    v_mfma_f32_32x32x16_bf16 a[112:127], v[172:175], v[56:59], a[112:127]
    v_cvt_pk_bf16_f32 v53, v6, v7
    ds_read_b128 v[148:151], v2 offset:5120
    ds_read_b128 v[164:167], v1 offset:50176
    v_mfma_f32_32x32x16_bf16 a[64:79], v[176:179], v[60:63], a[64:79]
    v_exp_f32 v4, v28
    v_exp_f32 v5, v29
    v_add_f32 v8, v8, v6
    v_add_f32 v9, v9, v7
    v_mfma_f32_32x32x16_bf16 a[80:95], v[180:183], v[60:63], a[80:95]
    v_cvt_pk_bf16_f32 v54, v4, v5
    ds_read_b128 v[152:155], v2 offset:6144
    ds_read_b128 v[168:171], v1 offset:51200
    v_mfma_f32_32x32x16_bf16 a[96:111], v[184:187], v[60:63], a[96:111]
    v_exp_f32 v6, v30
    v_exp_f32 v7, v31
    v_add_f32 v8, v8, v4
    v_add_f32 v9, v9, v5
    v_mfma_f32_32x32x16_bf16 a[112:127], v[188:191], v[60:63], a[112:127]
    v_cvt_pk_bf16_f32 v55, v6, v7
    ds_read_b128 v[156:159], v2 offset:7168
    ds_read_b128 v[172:175], v1 offset:52224
    s_waitcnt lgkmcnt(4)
    v_mfma_f32_32x32x16_bf16 v[16:31], v[128:131], v[64:67], v[192:207]
    v_exp_f32 v4, v32
    v_exp_f32 v5, v33
    v_add_f32 v8, v8, v6
    v_add_f32 v9, v9, v7
    v_mfma_f32_32x32x16_bf16 v[16:31], v[132:135], v[68:71], v[16:31]
    s_or_b32 m0, s23, 0x8000
    v_cvt_pk_bf16_f32 v56, v4, v5
    ds_read_b128 v[176:179], v1 offset:53248
    buffer_load_dwordx4 v3, s[4:7], s26 offen offset:0 lds
    v_mfma_f32_32x32x16_bf16 v[16:31], v[136:139], v[72:75], v[16:31]
    v_exp_f32 v6, v34
    v_exp_f32 v7, v35
    v_add_f32 v10, v10, v4
    v_add_f32 v11, v11, v5
    v_mfma_f32_32x32x16_bf16 v[16:31], v[140:143], v[76:79], v[16:31]
    v_cvt_pk_bf16_f32 v57, v6, v7
    ds_read_b128 v[180:183], v1 offset:54272
    buffer_load_dwordx4 v3, s[4:7], s26 offen offset:1024 lds
    v_mfma_f32_32x32x16_bf16 v[16:31], v[144:147], v[80:83], v[16:31]
    v_exp_f32 v4, v36
    v_exp_f32 v5, v37
    v_add_f32 v10, v10, v6
    v_add_f32 v11, v11, v7
    v_mfma_f32_32x32x16_bf16 v[16:31], v[148:151], v[84:87], v[16:31]
    v_cvt_pk_bf16_f32 v58, v4, v5
    ds_read_b128 v[184:187], v1 offset:55296
    s_waitcnt lgkmcnt(3)
    v_mfma_f32_32x32x16_bf16 v[16:31], v[152:155], v[88:91], v[16:31]
    v_exp_f32 v6, v38
    v_exp_f32 v7, v39
    v_add_f32 v10, v10, v4
    v_add_f32 v11, v11, v5
    v_mfma_f32_32x32x16_bf16 v[16:31], v[156:159], v[92:95], v[16:31]
    v_cvt_pk_bf16_f32 v59, v6, v7
    ds_read_b128 v[188:191], v1 offset:56320
    buffer_load_dwordx4 v3, s[4:7], s26 offen offset:2048 lds
    v_mfma_f32_32x32x16_bf16 a[0:15], v[160:163], v[48:51], a[0:15]
    v_exp_f32 v4, v40
    v_exp_f32 v5, v41
    v_add_f32 v10, v10, v6
    v_add_f32 v11, v11, v7
    v_mfma_f32_32x32x16_bf16 a[16:31], v[164:167], v[48:51], a[16:31]
    v_cvt_pk_bf16_f32 v60, v4, v5
    buffer_load_dwordx4 v3, s[4:7], s26 offen offset:3072 lds
    v_mfma_f32_32x32x16_bf16 a[32:47], v[168:171], v[48:51], a[32:47]
    v_exp_f32 v6, v42
    v_exp_f32 v7, v43
    v_add_f32 v10, v10, v4
    v_add_f32 v11, v11, v5
    v_mfma_f32_32x32x16_bf16 a[48:63], v[172:175], v[48:51], a[48:63]
    v_cvt_pk_bf16_f32 v61, v6, v7
    s_waitcnt lgkmcnt(0)
    s_or_b32 m0, s23, 0x4000
    v_mfma_f32_32x32x16_bf16 a[0:15], v[176:179], v[52:55], a[0:15]
    v_exp_f32 v4, v44
    v_exp_f32 v5, v45
    v_add_f32 v10, v10, v6
    v_add_f32 v11, v11, v7
    v_mfma_f32_32x32x16_bf16 a[16:31], v[180:183], v[52:55], a[16:31]
    v_cvt_pk_bf16_f32 v62, v4, v5
    buffer_load_dwordx4 v3, s[4:7], s25 offen offset:0 lds
    v_mfma_f32_32x32x16_bf16 a[32:47], v[184:187], v[52:55], a[32:47]
    v_exp_f32 v6, v46
    v_exp_f32 v7, v47
    v_add_f32 v10, v10, v4
    v_add_f32 v11, v11, v5
    v_mfma_f32_32x32x16_bf16 a[48:63], v[188:191], v[52:55], a[48:63]
    v_cvt_pk_bf16_f32 v63, v6, v7
    s_waitcnt vmcnt(13)
    s_barrier
    v_mfma_f32_32x32x16_bf16 v[32:47], v[128:131], v[96:99], v[208:223]
    v_exp_f32 v4, v16
    v_exp_f32 v5, v17
    v_add_f32 v10, v10, v6
    v_add_f32 v11, v11, v7
    v_mfma_f32_32x32x16_bf16 v[32:47], v[132:135], v[100:103], v[32:47]
    v_cvt_pk_bf16_f32 v48, v4, v5
    ds_read_b128 v[128:131], v2 offset:16384
    buffer_load_dwordx4 v3, s[4:7], s25 offen offset:1024 lds
    v_mfma_f32_32x32x16_bf16 v[32:47], v[136:139], v[104:107], v[32:47]
    v_exp_f32 v6, v18
    v_exp_f32 v7, v19
    v_add_f32 v8, v8, v4
    v_add_f32 v9, v9, v5
    v_mfma_f32_32x32x16_bf16 v[32:47], v[140:143], v[108:111], v[32:47]
    v_cvt_pk_bf16_f32 v49, v6, v7
    ds_read_b128 v[132:135], v2 offset:17408
    buffer_load_dwordx4 v3, s[4:7], s25 offen offset:2048 lds
    v_mfma_f32_32x32x16_bf16 v[32:47], v[144:147], v[112:115], v[32:47]
    v_exp_f32 v4, v20
    v_exp_f32 v5, v21
    v_add_f32 v8, v8, v6
    v_add_f32 v9, v9, v7
    v_mfma_f32_32x32x16_bf16 v[32:47], v[148:151], v[116:119], v[32:47]
    v_cvt_pk_bf16_f32 v50, v4, v5
    ds_read_b128 v[136:139], v2 offset:18432
    buffer_load_dwordx4 v3, s[4:7], s25 offen offset:3072 lds
    v_mfma_f32_32x32x16_bf16 v[32:47], v[152:155], v[120:123], v[32:47]
    v_exp_f32 v6, v22
    v_exp_f32 v7, v23
    v_add_f32 v8, v8, v4
    v_add_f32 v9, v9, v5
    v_mfma_f32_32x32x16_bf16 v[32:47], v[156:159], v[124:127], v[32:47]
    v_cvt_pk_bf16_f32 v51, v6, v7
    ds_read_b128 v[140:143], v2 offset:19456
    s_add_u32 s27, s24, 0xc000
    v_mfma_f32_32x32x16_bf16 a[64:79], v[160:163], v[56:59], a[64:79]
    v_exp_f32 v4, v24
    v_exp_f32 v5, v25
    v_add_f32 v8, v8, v6
    v_add_f32 v9, v9, v7
    v_mfma_f32_32x32x16_bf16 a[80:95], v[164:167], v[56:59], a[80:95]
    v_cvt_pk_bf16_f32 v52, v4, v5
    ds_read_b128 v[144:147], v2 offset:20480
    ds_read_b128 v[160:163], v2 offset:32768
    v_mfma_f32_32x32x16_bf16 a[96:111], v[168:171], v[56:59], a[96:111]
    v_exp_f32 v6, v26
    v_exp_f32 v7, v27
    v_add_f32 v8, v8, v4
    v_add_f32 v9, v9, v5
    v_mfma_f32_32x32x16_bf16 a[112:127], v[172:175], v[56:59], a[112:127]
    v_cvt_pk_bf16_f32 v53, v6, v7
    ds_read_b128 v[148:151], v2 offset:21504
    ds_read_b128 v[164:167], v2 offset:33792
    v_mfma_f32_32x32x16_bf16 a[64:79], v[176:179], v[60:63], a[64:79]
    v_exp_f32 v4, v28
    v_exp_f32 v5, v29
    v_add_f32 v8, v8, v6
    v_add_f32 v9, v9, v7
    v_mfma_f32_32x32x16_bf16 a[80:95], v[180:183], v[60:63], a[80:95]
    v_cvt_pk_bf16_f32 v54, v4, v5
    ds_read_b128 v[152:155], v2 offset:22528
    ds_read_b128 v[168:171], v2 offset:34816
    v_mfma_f32_32x32x16_bf16 a[96:111], v[184:187], v[60:63], a[96:111]
    v_exp_f32 v6, v30
    v_exp_f32 v7, v31
    v_add_f32 v8, v8, v4
    v_add_f32 v9, v9, v5
    v_mfma_f32_32x32x16_bf16 a[112:127], v[188:191], v[60:63], a[112:127]
    v_cvt_pk_bf16_f32 v55, v6, v7
    ds_read_b128 v[156:159], v2 offset:23552
    ds_read_b128 v[172:175], v2 offset:35840
    s_waitcnt lgkmcnt(4)
    v_xor_b32 v1, 0x10000, v1
    v_xor_b32 v2, 0x10000, v2
    s_xor_b32 s23, s23, 0x10000
SL_100020:
    v_mfma_f32_32x32x16_bf16 v[16:31], v[128:131], v[64:67], v[224:239]
    v_exp_f32 v4, v32
    v_exp_f32 v5, v33
    v_add_f32 v8, v8, v6
    v_add_f32 v9, v9, v7
    v_mfma_f32_32x32x16_bf16 v[16:31], v[132:135], v[68:71], v[16:31]
    s_xor_b32 m0, s23, 0x1c000
    v_cvt_pk_bf16_f32 v56, v4, v5
    ds_read_b128 v[176:179], v1 offset:36864
    buffer_load_dwordx4 v3, s[4:7], s27 offen offset:0 lds
    v_mfma_f32_32x32x16_bf16 v[16:31], v[136:139], v[72:75], v[16:31]
    v_exp_f32 v6, v34
    v_exp_f32 v7, v35
    v_add_f32 v10, v10, v4
    v_add_f32 v11, v11, v5
    v_mfma_f32_32x32x16_bf16 v[16:31], v[140:143], v[76:79], v[16:31]
    v_cvt_pk_bf16_f32 v57, v6, v7
    ds_read_b128 v[180:183], v1 offset:37888
    buffer_load_dwordx4 v3, s[4:7], s27 offen offset:1024 lds
    v_mfma_f32_32x32x16_bf16 v[16:31], v[144:147], v[80:83], v[16:31]
    v_exp_f32 v4, v36
    v_exp_f32 v5, v37
    v_add_f32 v10, v10, v6
    v_add_f32 v11, v11, v7
    v_mfma_f32_32x32x16_bf16 v[16:31], v[148:151], v[84:87], v[16:31]
    v_cvt_pk_bf16_f32 v58, v4, v5
    ds_read_b128 v[184:187], v1 offset:38912
    ds_read_b128 v[64:67], v0 offset:0
    s_waitcnt lgkmcnt(4)
    s_add_u32 s24, s24, 0x10000
    v_mfma_f32_32x32x16_bf16 v[16:31], v[152:155], v[88:91], v[16:31]
    v_exp_f32 v6, v38
    v_exp_f32 v7, v39
    v_add_f32 v10, v10, v4
    v_add_f32 v11, v11, v5
    v_mfma_f32_32x32x16_bf16 v[16:31], v[156:159], v[92:95], v[16:31]
    v_cvt_pk_bf16_f32 v59, v6, v7
    ds_read_b128 v[188:191], v1 offset:39936
    buffer_load_dwordx4 v3, s[4:7], s27 offen offset:2048 lds
    v_mfma_f32_32x32x16_bf16 a[0:15], v[160:163], v[48:51], a[0:15]
    v_exp_f32 v4, v40
    v_exp_f32 v5, v41
    v_add_f32 v10, v10, v6
    v_add_f32 v11, v11, v7
    v_mfma_f32_32x32x16_bf16 a[16:31], v[164:167], v[48:51], a[16:31]
    v_cvt_pk_bf16_f32 v60, v4, v5
    ds_read_b128 v[68:71], v0 offset:1024
    buffer_load_dwordx4 v3, s[4:7], s27 offen offset:3072 lds
    v_mfma_f32_32x32x16_bf16 a[32:47], v[168:171], v[48:51], a[32:47]
    v_exp_f32 v6, v42
    v_exp_f32 v7, v43
    v_add_f32 v10, v10, v4
    v_add_f32 v11, v11, v5
    v_mfma_f32_32x32x16_bf16 a[48:63], v[172:175], v[48:51], a[48:63]
    v_cvt_pk_bf16_f32 v61, v6, v7
    ds_read_b128 v[72:75], v0 offset:2048
    ds_read_b128 v[76:79], v0 offset:3072
    s_waitcnt lgkmcnt(3)
    s_mov_b32 m0, s23
    v_mfma_f32_32x32x16_bf16 a[0:15], v[176:179], v[52:55], a[0:15]
    v_exp_f32 v4, v44
    v_exp_f32 v5, v45
    v_add_f32 v10, v10, v6
    v_add_f32 v11, v11, v7
    v_mfma_f32_32x32x16_bf16 a[16:31], v[180:183], v[52:55], a[16:31]
    v_cvt_pk_bf16_f32 v62, v4, v5
    ds_read_b128 v[80:83], v0 offset:4096
    buffer_load_dwordx4 v3, s[4:7], s24 offen offset:0 lds
    v_mfma_f32_32x32x16_bf16 a[32:47], v[184:187], v[52:55], a[32:47]
    v_exp_f32 v6, v46
    v_exp_f32 v7, v47
    v_add_f32 v10, v10, v4
    v_add_f32 v11, v11, v5
    v_mfma_f32_32x32x16_bf16 a[48:63], v[188:191], v[52:55], a[48:63]
    v_cvt_pk_bf16_f32 v63, v6, v7
    ds_read_b128 v[84:87], v0 offset:5120
    ds_read_b128 v[88:91], v0 offset:6144
    s_waitcnt vmcnt(13)
    s_barrier
    v_mfma_f32_32x32x16_bf16 v[32:47], v[128:131], v[96:99], v[240:255]
    v_exp_f32 v4, v16
    v_exp_f32 v5, v17
    v_add_f32 v10, v10, v6
    v_add_f32 v11, v11, v7
    v_mfma_f32_32x32x16_bf16 v[32:47], v[132:135], v[100:103], v[32:47]
    v_cvt_pk_bf16_f32 v48, v4, v5
    ds_read_b128 v[128:131], v2 offset:0
    buffer_load_dwordx4 v3, s[4:7], s24 offen offset:1024 lds
    v_mfma_f32_32x32x16_bf16 v[32:47], v[136:139], v[104:107], v[32:47]
    v_exp_f32 v6, v18
    v_exp_f32 v7, v19
    v_add_f32 v8, v8, v4
    v_add_f32 v9, v9, v5
    v_mfma_f32_32x32x16_bf16 v[32:47], v[140:143], v[108:111], v[32:47]
    v_cvt_pk_bf16_f32 v49, v6, v7
    ds_read_b128 v[132:135], v2 offset:1024
    buffer_load_dwordx4 v3, s[4:7], s24 offen offset:2048 lds
    v_mfma_f32_32x32x16_bf16 v[32:47], v[144:147], v[112:115], v[32:47]
    v_exp_f32 v4, v20
    v_exp_f32 v5, v21
    v_add_f32 v8, v8, v6
    v_add_f32 v9, v9, v7
    v_mfma_f32_32x32x16_bf16 v[32:47], v[148:151], v[116:119], v[32:47]
    v_cvt_pk_bf16_f32 v50, v4, v5
    ds_read_b128 v[136:139], v2 offset:2048
    buffer_load_dwordx4 v3, s[4:7], s24 offen offset:3072 lds
    v_mfma_f32_32x32x16_bf16 v[32:47], v[152:155], v[120:123], v[32:47]
    v_exp_f32 v6, v22
    v_exp_f32 v7, v23
    v_add_f32 v8, v8, v4
    v_add_f32 v9, v9, v5
    v_mfma_f32_32x32x16_bf16 v[32:47], v[156:159], v[124:127], v[32:47]
    v_cvt_pk_bf16_f32 v51, v6, v7
    ds_read_b128 v[140:143], v2 offset:3072
    ds_read_b128 v[92:95], v0 offset:7168
    s_add_u32 s25, s24, 0x8000
    s_add_u32 s26, s24, 0x4000
    v_xor_b32 v0, 0x2000, v0
    v_mfma_f32_32x32x16_bf16 a[64:79], v[160:163], v[56:59], a[64:79]
    v_exp_f32 v4, v24
    v_exp_f32 v5, v25
    v_add_f32 v8, v8, v6
    v_add_f32 v9, v9, v7
    v_mfma_f32_32x32x16_bf16 a[80:95], v[164:167], v[56:59], a[80:95]
    v_cvt_pk_bf16_f32 v52, v4, v5
    ds_read_b128 v[144:147], v2 offset:4096
    ds_read_b128 v[160:163], v1 offset:49152
    ds_read_b128 v[96:99], v0 offset:0
    v_mfma_f32_32x32x16_bf16 a[96:111], v[168:171], v[56:59], a[96:111]
    v_exp_f32 v6, v26
    v_exp_f32 v7, v27
    v_add_f32 v8, v8, v4
    v_add_f32 v9, v9, v5
    v_mfma_f32_32x32x16_bf16 a[112:127], v[172:175], v[56:59], a[112:127]
    v_cvt_pk_bf16_f32 v53, v6, v7
    ds_read_b128 v[148:151], v2 offset:5120
    ds_read_b128 v[164:167], v1 offset:50176
    ds_read_b128 v[100:103], v0 offset:1024
    v_mfma_f32_32x32x16_bf16 a[64:79], v[176:179], v[60:63], a[64:79]
    v_exp_f32 v4, v28
    v_exp_f32 v5, v29
    v_add_f32 v8, v8, v6
    v_add_f32 v9, v9, v7
    v_mfma_f32_32x32x16_bf16 a[80:95], v[180:183], v[60:63], a[80:95]
    v_cvt_pk_bf16_f32 v54, v4, v5
    ds_read_b128 v[152:155], v2 offset:6144
    ds_read_b128 v[168:171], v1 offset:51200
    ds_read_b128 v[104:107], v0 offset:2048
    v_mfma_f32_32x32x16_bf16 a[96:111], v[184:187], v[60:63], a[96:111]
    v_exp_f32 v6, v30
    v_exp_f32 v7, v31
    v_add_f32 v8, v8, v4
    v_add_f32 v9, v9, v5
    v_mfma_f32_32x32x16_bf16 a[112:127], v[188:191], v[60:63], a[112:127]
    v_cvt_pk_bf16_f32 v55, v6, v7
    ds_read_b128 v[156:159], v2 offset:7168
    ds_read_b128 v[172:175], v1 offset:52224
    s_waitcnt lgkmcnt(6)
    v_mfma_f32_32x32x16_bf16 v[16:31], v[128:131], v[64:67], 0
    v_exp_f32 v4, v32
    v_exp_f32 v5, v33
    v_add_f32 v8, v8, v6
    v_add_f32 v9, v9, v7
    v_mfma_f32_32x32x16_bf16 v[16:31], v[132:135], v[68:71], v[16:31]
    s_or_b32 m0, s23, 0x8000
    v_cvt_pk_bf16_f32 v56, v4, v5
    ds_read_b128 v[176:179], v1 offset:53248
    buffer_load_dwordx4 v3, s[4:7], s26 offen offset:0 lds
    v_mfma_f32_32x32x16_bf16 v[16:31], v[136:139], v[72:75], v[16:31]
    v_exp_f32 v6, v34
    v_exp_f32 v7, v35
    v_add_f32 v10, v10, v4
    v_add_f32 v11, v11, v5
    v_mfma_f32_32x32x16_bf16 v[16:31], v[140:143], v[76:79], v[16:31]
    v_cvt_pk_bf16_f32 v57, v6, v7
    ds_read_b128 v[180:183], v1 offset:54272
    buffer_load_dwordx4 v3, s[4:7], s26 offen offset:1024 lds
    v_mfma_f32_32x32x16_bf16 v[16:31], v[144:147], v[80:83], v[16:31]
    v_exp_f32 v4, v36
    v_exp_f32 v5, v37
    v_add_f32 v10, v10, v6
    v_add_f32 v11, v11, v7
    v_mfma_f32_32x32x16_bf16 v[16:31], v[148:151], v[84:87], v[16:31]
    v_cvt_pk_bf16_f32 v58, v4, v5
    ds_read_b128 v[184:187], v1 offset:55296
    ds_read_b128 v[108:111], v0 offset:3072
    s_waitcnt lgkmcnt(4)
    v_mfma_f32_32x32x16_bf16 v[16:31], v[152:155], v[88:91], v[16:31]
    v_exp_f32 v6, v38
    v_exp_f32 v7, v39
    v_add_f32 v10, v10, v4
    v_add_f32 v11, v11, v5
    v_mfma_f32_32x32x16_bf16 v[16:31], v[156:159], v[92:95], v[16:31]
    v_cvt_pk_bf16_f32 v59, v6, v7
    ds_read_b128 v[188:191], v1 offset:56320
    buffer_load_dwordx4 v3, s[4:7], s26 offen offset:2048 lds
    v_mfma_f32_32x32x16_bf16 a[0:15], v[160:163], v[48:51], a[0:15]
    v_exp_f32 v4, v40
    v_exp_f32 v5, v41
    v_add_f32 v10, v10, v6
    v_add_f32 v11, v11, v7
    v_mfma_f32_32x32x16_bf16 a[16:31], v[164:167], v[48:51], a[16:31]
    v_cvt_pk_bf16_f32 v60, v4, v5
    ds_read_b128 v[112:115], v0 offset:4096
    buffer_load_dwordx4 v3, s[4:7], s26 offen offset:3072 lds
    v_mfma_f32_32x32x16_bf16 a[32:47], v[168:171], v[48:51], a[32:47]
    v_exp_f32 v6, v42
    v_exp_f32 v7, v43
    v_add_f32 v10, v10, v4
    v_add_f32 v11, v11, v5
    v_mfma_f32_32x32x16_bf16 a[48:63], v[172:175], v[48:51], a[48:63]
    v_cvt_pk_bf16_f32 v61, v6, v7
    ds_read_b128 v[116:119], v0 offset:5120
    ds_read_b128 v[120:123], v0 offset:6144
    s_waitcnt lgkmcnt(3)
    s_or_b32 m0, s23, 0x4000
    v_mfma_f32_32x32x16_bf16 a[0:15], v[176:179], v[52:55], a[0:15]
    v_exp_f32 v4, v44
    v_exp_f32 v5, v45
    v_add_f32 v10, v10, v6
    v_add_f32 v11, v11, v7
    v_mfma_f32_32x32x16_bf16 a[16:31], v[180:183], v[52:55], a[16:31]
    v_cvt_pk_bf16_f32 v62, v4, v5
    ds_read_b128 v[124:127], v0 offset:7168
    buffer_load_dwordx4 v3, s[4:7], s25 offen offset:0 lds
    v_mfma_f32_32x32x16_bf16 a[32:47], v[184:187], v[52:55], a[32:47]
    v_exp_f32 v6, v46
    v_exp_f32 v7, v47
    v_add_f32 v10, v10, v4
    v_add_f32 v11, v11, v5
    v_mfma_f32_32x32x16_bf16 a[48:63], v[188:191], v[52:55], a[48:63]
    v_cvt_pk_bf16_f32 v63, v6, v7
    s_waitcnt lgkmcnt(0)
    s_waitcnt vmcnt(13)
    s_barrier
    v_mfma_f32_32x32x16_bf16 v[32:47], v[128:131], v[96:99], 0
    v_exp_f32 v4, v16
    v_exp_f32 v5, v17
    v_add_f32 v10, v10, v6
    v_add_f32 v11, v11, v7
    v_mfma_f32_32x32x16_bf16 v[32:47], v[132:135], v[100:103], v[32:47]
    v_cvt_pk_bf16_f32 v48, v4, v5
    ds_read_b128 v[128:131], v2 offset:16384
    buffer_load_dwordx4 v3, s[4:7], s25 offen offset:1024 lds
    v_mfma_f32_32x32x16_bf16 v[32:47], v[136:139], v[104:107], v[32:47]
    v_exp_f32 v6, v18
    v_exp_f32 v7, v19
    v_add_f32 v12, v12, v4
    v_add_f32 v13, v13, v5
    v_mfma_f32_32x32x16_bf16 v[32:47], v[140:143], v[108:111], v[32:47]
    v_cvt_pk_bf16_f32 v49, v6, v7
    ds_read_b128 v[132:135], v2 offset:17408
    buffer_load_dwordx4 v3, s[4:7], s25 offen offset:2048 lds
    v_mfma_f32_32x32x16_bf16 v[32:47], v[144:147], v[112:115], v[32:47]
    v_exp_f32 v4, v20
    v_exp_f32 v5, v21
    v_add_f32 v12, v12, v6
    v_add_f32 v13, v13, v7
    v_mfma_f32_32x32x16_bf16 v[32:47], v[148:151], v[116:119], v[32:47]
    v_cvt_pk_bf16_f32 v50, v4, v5
    ds_read_b128 v[136:139], v2 offset:18432
    buffer_load_dwordx4 v3, s[4:7], s25 offen offset:3072 lds
    v_mfma_f32_32x32x16_bf16 v[32:47], v[152:155], v[120:123], v[32:47]
    v_exp_f32 v6, v22
    v_exp_f32 v7, v23
    v_add_f32 v12, v12, v4
    v_add_f32 v13, v13, v5
    v_mfma_f32_32x32x16_bf16 v[32:47], v[156:159], v[124:127], v[32:47]
    v_cvt_pk_bf16_f32 v51, v6, v7
    ds_read_b128 v[140:143], v2 offset:19456
    s_add_u32 s27, s24, 0xc000
    v_mfma_f32_32x32x16_bf16 a[64:79], v[160:163], v[56:59], a[64:79]
    v_exp_f32 v4, v24
    v_exp_f32 v5, v25
    v_add_f32 v12, v12, v6
    v_add_f32 v13, v13, v7
    v_mfma_f32_32x32x16_bf16 a[80:95], v[164:167], v[56:59], a[80:95]
    v_cvt_pk_bf16_f32 v52, v4, v5
    ds_read_b128 v[144:147], v2 offset:20480
    ds_read_b128 v[160:163], v2 offset:32768
    v_mfma_f32_32x32x16_bf16 a[96:111], v[168:171], v[56:59], a[96:111]
    v_exp_f32 v6, v26
    v_exp_f32 v7, v27
    v_add_f32 v12, v12, v4
    v_add_f32 v13, v13, v5
    v_mfma_f32_32x32x16_bf16 a[112:127], v[172:175], v[56:59], a[112:127]
    v_cvt_pk_bf16_f32 v53, v6, v7
    ds_read_b128 v[148:151], v2 offset:21504
    ds_read_b128 v[164:167], v2 offset:33792
    v_mfma_f32_32x32x16_bf16 a[64:79], v[176:179], v[60:63], a[64:79]
    v_exp_f32 v4, v28
    v_exp_f32 v5, v29
    v_add_f32 v12, v12, v6
    v_add_f32 v13, v13, v7
    v_mfma_f32_32x32x16_bf16 a[80:95], v[180:183], v[60:63], a[80:95]
    v_cvt_pk_bf16_f32 v54, v4, v5
    ds_read_b128 v[152:155], v2 offset:22528
    ds_read_b128 v[168:171], v2 offset:34816
    v_mfma_f32_32x32x16_bf16 a[96:111], v[184:187], v[60:63], a[96:111]
    v_exp_f32 v6, v30
    v_exp_f32 v7, v31
    v_add_f32 v12, v12, v4
    v_add_f32 v13, v13, v5
    v_mfma_f32_32x32x16_bf16 a[112:127], v[188:191], v[60:63], a[112:127]
    v_cvt_pk_bf16_f32 v55, v6, v7
    ds_read_b128 v[156:159], v2 offset:23552
    ds_read_b128 v[172:175], v2 offset:35840
    s_waitcnt lgkmcnt(4)
    v_xor_b32 v1, 0x10000, v1
    v_xor_b32 v2, 0x10000, v2
    s_xor_b32 s23, s23, 0x10000
    s_lshr_b32 s49, s2, 3
    s_lshr_b32 s55, s49, 1
    s_lshl_b32 s90, s55, 2
    s_lshl_b32 s55, s55, 8
    s_add_u32 s80, s100, s55
    s_addc_u32 s81, s101, 0
    s_sub_u32 s82, 1835008, s55
    s_mov_b32 s83, 0x00020000
    s_cmp_ge_u32 s2, 224
    s_cselect_b32 s82, 0, s82
    s_cselect_b32 s78, 0, s78
    s_and_b32 s49, s49, 1
    s_lshl_b32 s49, s49, 3
    s_and_b32 s55, s2, 7
    s_add_u32 s49, s49, s55
    s_lshl_b32 s49, s49, 2
    s_add_u32 s49, s49, s20
    s_lshr_b32 s88, s49, 1
    s_lshl_b32 s88, s88, 3
    s_lshl_b32 s89, s49, 5
    s_mov_b32 s45, 0x200000
    s_mov_b32 s46, 0x201000
    s_mov_b32 s47, 0x202000
    s_mov_b32 s48, 0x203000
    v_bfe_u32 v4, v3, 8, 2
    v_bfe_u32 v5, v3, 4, 4
    v_lshlrev_b32 v0, 2, v4
    v_xor_b32 v0, v5, v0
    v_lshlrev_b32 v0, 4, v0
    v_mul_u32_u24 v4, 3584, v4
    v_add_u32 v0, v0, v4
    s_mul_i32 s49, s20, 57344
    v_add_u32 v0, s49, v0
    v_add_f32 v8, v8, v9
    v_add_f32 v10, v10, v11
    s_and_b32 s49, s88, 0xfffffff0
    buffer_load_dword v9, off, s[84:87], s49 sc1
    buffer_load_dword v11, off, s[84:87], s49 offset:8 sc1
    s_sub_u32 s28, 14, s22
LR_100022:
    v_mfma_f32_32x32x16_bf16 v[16:31], v[128:131], v[64:67], 0
    v_exp_f32 v4, v32
    v_exp_f32 v5, v33
    v_add_f32 v12, v12, v6
    v_add_f32 v13, v13, v7
    v_mfma_f32_32x32x16_bf16 v[16:31], v[132:135], v[68:71], v[16:31]
    s_xor_b32 m0, s23, 0x1c000
    v_cvt_pk_bf16_f32 v56, v4, v5
    ds_read_b128 v[176:179], v1 offset:36864
    buffer_load_dwordx4 v3, s[4:7], s27 offen offset:0 lds
    v_mfma_f32_32x32x16_bf16 v[16:31], v[136:139], v[72:75], v[16:31]
    v_exp_f32 v6, v34
    v_exp_f32 v7, v35
    v_add_f32 v14, v14, v4
    v_add_f32 v15, v15, v5
    v_mfma_f32_32x32x16_bf16 v[16:31], v[140:143], v[76:79], v[16:31]
    v_cvt_pk_bf16_f32 v57, v6, v7
    ds_read_b128 v[180:183], v1 offset:37888
    buffer_load_dwordx4 v3, s[4:7], s27 offen offset:1024 lds
    v_mfma_f32_32x32x16_bf16 v[16:31], v[144:147], v[80:83], v[16:31]
    v_exp_f32 v4, v36
    v_exp_f32 v5, v37
    v_add_f32 v14, v14, v6
    v_add_f32 v15, v15, v7
    v_mfma_f32_32x32x16_bf16 v[16:31], v[148:151], v[84:87], v[16:31]
    v_cvt_pk_bf16_f32 v58, v4, v5
    ds_read_b128 v[184:187], v1 offset:38912
    s_waitcnt lgkmcnt(3)
    s_add_u32 s24, s24, 0x10000
    v_mfma_f32_32x32x16_bf16 v[16:31], v[152:155], v[88:91], v[16:31]
    v_exp_f32 v6, v38
    v_exp_f32 v7, v39
    v_add_f32 v14, v14, v4
    v_add_f32 v15, v15, v5
    v_mfma_f32_32x32x16_bf16 v[16:31], v[156:159], v[92:95], v[16:31]
    v_cvt_pk_bf16_f32 v59, v6, v7
    ds_read_b128 v[188:191], v1 offset:39936
    buffer_load_dwordx4 v3, s[4:7], s27 offen offset:2048 lds
    v_mfma_f32_32x32x16_bf16 a[128:143], v[160:163], v[48:51], a[128:143]
    v_exp_f32 v4, v40
    v_exp_f32 v5, v41
    v_add_f32 v14, v14, v6
    v_add_f32 v15, v15, v7
    v_mfma_f32_32x32x16_bf16 a[144:159], v[164:167], v[48:51], a[144:159]
    v_cvt_pk_bf16_f32 v60, v4, v5
    buffer_load_dwordx4 v3, s[4:7], s27 offen offset:3072 lds
    v_mfma_f32_32x32x16_bf16 a[160:175], v[168:171], v[48:51], a[160:175]
    v_exp_f32 v6, v42
    v_exp_f32 v7, v43
    v_add_f32 v14, v14, v4
    v_add_f32 v15, v15, v5
    v_mfma_f32_32x32x16_bf16 a[176:191], v[172:175], v[48:51], a[176:191]
    v_cvt_pk_bf16_f32 v61, v6, v7
    s_waitcnt lgkmcnt(0)
    s_mov_b32 m0, s23
    v_mfma_f32_32x32x16_bf16 a[128:143], v[176:179], v[52:55], a[128:143]
    v_exp_f32 v4, v44
    v_exp_f32 v5, v45
    v_add_f32 v14, v14, v6
    v_add_f32 v15, v15, v7
    v_mfma_f32_32x32x16_bf16 a[144:159], v[180:183], v[52:55], a[144:159]
    v_cvt_pk_bf16_f32 v62, v4, v5
    buffer_load_dwordx4 v3, s[4:7], s24 offen offset:0 lds
    v_mfma_f32_32x32x16_bf16 a[160:175], v[184:187], v[52:55], a[160:175]
    v_exp_f32 v6, v46
    v_exp_f32 v7, v47
    v_add_f32 v14, v14, v4
    v_add_f32 v15, v15, v5
    v_mfma_f32_32x32x16_bf16 a[176:191], v[188:191], v[52:55], a[176:191]
    v_cvt_pk_bf16_f32 v63, v6, v7
    s_waitcnt vmcnt(13)
    s_barrier
    v_mfma_f32_32x32x16_bf16 v[32:47], v[128:131], v[96:99], 0
    v_exp_f32 v4, v16
    v_exp_f32 v5, v17
    v_add_f32 v14, v14, v6
    v_add_f32 v15, v15, v7
    v_mfma_f32_32x32x16_bf16 v[32:47], v[132:135], v[100:103], v[32:47]
    v_cvt_pk_bf16_f32 v48, v4, v5
    ds_read_b128 v[128:131], v2 offset:0
    buffer_load_dwordx4 v3, s[4:7], s24 offen offset:1024 lds
    v_mfma_f32_32x32x16_bf16 v[32:47], v[136:139], v[104:107], v[32:47]
    v_exp_f32 v6, v18
    v_exp_f32 v7, v19
    v_add_f32 v12, v12, v4
    v_add_f32 v13, v13, v5
    v_mfma_f32_32x32x16_bf16 v[32:47], v[140:143], v[108:111], v[32:47]
    v_cvt_pk_bf16_f32 v49, v6, v7
    ds_read_b128 v[132:135], v2 offset:1024
    buffer_load_dwordx4 v3, s[4:7], s24 offen offset:2048 lds
    v_mfma_f32_32x32x16_bf16 v[32:47], v[144:147], v[112:115], v[32:47]
    v_exp_f32 v4, v20
    v_exp_f32 v5, v21
    v_add_f32 v12, v12, v6
    v_add_f32 v13, v13, v7
    v_mfma_f32_32x32x16_bf16 v[32:47], v[148:151], v[116:119], v[32:47]
    v_cvt_pk_bf16_f32 v50, v4, v5
    ds_read_b128 v[136:139], v2 offset:2048
    buffer_load_dwordx4 v3, s[4:7], s24 offen offset:3072 lds
    v_mfma_f32_32x32x16_bf16 v[32:47], v[152:155], v[120:123], v[32:47]
    v_exp_f32 v6, v22
    v_exp_f32 v7, v23
    v_add_f32 v12, v12, v4
    v_add_f32 v13, v13, v5
    v_mfma_f32_32x32x16_bf16 v[32:47], v[156:159], v[124:127], v[32:47]
    v_cvt_pk_bf16_f32 v51, v6, v7
    ds_read_b128 v[140:143], v2 offset:3072
    s_add_u32 s25, s24, 0x8000
    s_add_u32 s26, s24, 0x4000
    v_mfma_f32_32x32x16_bf16 a[192:207], v[160:163], v[56:59], a[192:207]
    v_exp_f32 v4, v24
    v_exp_f32 v5, v25
    v_add_f32 v12, v12, v6
    v_add_f32 v13, v13, v7
    v_mfma_f32_32x32x16_bf16 a[208:223], v[164:167], v[56:59], a[208:223]
    v_cvt_pk_bf16_f32 v52, v4, v5
    ds_read_b128 v[144:147], v2 offset:4096
    ds_read_b128 v[160:163], v1 offset:49152
    v_mfma_f32_32x32x16_bf16 a[224:239], v[168:171], v[56:59], a[224:239]
    v_exp_f32 v6, v26
    v_exp_f32 v7, v27
    v_add_f32 v12, v12, v4
    v_add_f32 v13, v13, v5
    v_mfma_f32_32x32x16_bf16 a[240:255], v[172:175], v[56:59], a[240:255]
    v_cvt_pk_bf16_f32 v53, v6, v7
    ds_read_b128 v[148:151], v2 offset:5120
    ds_read_b128 v[164:167], v1 offset:50176
    v_mfma_f32_32x32x16_bf16 a[192:207], v[176:179], v[60:63], a[192:207]
    v_exp_f32 v4, v28
    v_exp_f32 v5, v29
    v_add_f32 v12, v12, v6
    v_add_f32 v13, v13, v7
    v_mfma_f32_32x32x16_bf16 a[208:223], v[180:183], v[60:63], a[208:223]
    v_cvt_pk_bf16_f32 v54, v4, v5
    ds_read_b128 v[152:155], v2 offset:6144
    ds_read_b128 v[168:171], v1 offset:51200
    v_mfma_f32_32x32x16_bf16 a[224:239], v[184:187], v[60:63], a[224:239]
    v_exp_f32 v6, v30
    v_exp_f32 v7, v31
    v_add_f32 v12, v12, v4
    v_add_f32 v13, v13, v5
    v_mfma_f32_32x32x16_bf16 a[240:255], v[188:191], v[60:63], a[240:255]
    v_cvt_pk_bf16_f32 v55, v6, v7
    ds_read_b128 v[156:159], v2 offset:7168
    ds_read_b128 v[172:175], v1 offset:52224
    s_waitcnt lgkmcnt(4)
    v_mfma_f32_32x32x16_bf16 v[16:31], v[128:131], v[64:67], 0
    v_exp_f32 v4, v32
    v_exp_f32 v5, v33
    v_add_f32 v12, v12, v6
    v_add_f32 v13, v13, v7
    v_mfma_f32_32x32x16_bf16 v[16:31], v[132:135], v[68:71], v[16:31]
    s_or_b32 m0, s23, 0x8000
    v_cvt_pk_bf16_f32 v56, v4, v5
    ds_read_b128 v[176:179], v1 offset:53248
    buffer_load_dwordx4 v3, s[4:7], s26 offen offset:0 lds
    v_mfma_f32_32x32x16_bf16 v[16:31], v[136:139], v[72:75], v[16:31]
    v_exp_f32 v6, v34
    v_exp_f32 v7, v35
    v_add_f32 v14, v14, v4
    v_add_f32 v15, v15, v5
    v_mfma_f32_32x32x16_bf16 v[16:31], v[140:143], v[76:79], v[16:31]
    v_cvt_pk_bf16_f32 v57, v6, v7
    ds_read_b128 v[180:183], v1 offset:54272
    buffer_load_dwordx4 v3, s[4:7], s26 offen offset:1024 lds
    v_mfma_f32_32x32x16_bf16 v[16:31], v[144:147], v[80:83], v[16:31]
    v_exp_f32 v4, v36
    v_exp_f32 v5, v37
    v_add_f32 v14, v14, v6
    v_add_f32 v15, v15, v7
    v_mfma_f32_32x32x16_bf16 v[16:31], v[148:151], v[84:87], v[16:31]
    v_cvt_pk_bf16_f32 v58, v4, v5
    ds_read_b128 v[184:187], v1 offset:55296
    s_waitcnt lgkmcnt(3)
    v_mfma_f32_32x32x16_bf16 v[16:31], v[152:155], v[88:91], v[16:31]
    v_exp_f32 v6, v38
    v_exp_f32 v7, v39
    v_add_f32 v14, v14, v4
    v_add_f32 v15, v15, v5
    v_mfma_f32_32x32x16_bf16 v[16:31], v[156:159], v[92:95], v[16:31]
    v_cvt_pk_bf16_f32 v59, v6, v7
    ds_read_b128 v[188:191], v1 offset:56320
    buffer_load_dwordx4 v3, s[4:7], s26 offen offset:2048 lds
    v_mfma_f32_32x32x16_bf16 a[128:143], v[160:163], v[48:51], a[128:143]
    v_exp_f32 v4, v40
    v_exp_f32 v5, v41
    v_add_f32 v14, v14, v6
    v_add_f32 v15, v15, v7
    v_mfma_f32_32x32x16_bf16 a[144:159], v[164:167], v[48:51], a[144:159]
    v_cvt_pk_bf16_f32 v60, v4, v5
    buffer_load_dwordx4 v3, s[4:7], s26 offen offset:3072 lds
    v_mfma_f32_32x32x16_bf16 a[160:175], v[168:171], v[48:51], a[160:175]
    v_exp_f32 v6, v42
    v_exp_f32 v7, v43
    v_add_f32 v14, v14, v4
    v_add_f32 v15, v15, v5
    v_mfma_f32_32x32x16_bf16 a[176:191], v[172:175], v[48:51], a[176:191]
    v_cvt_pk_bf16_f32 v61, v6, v7
    s_waitcnt lgkmcnt(0)
    s_or_b32 m0, s23, 0x4000
    v_mfma_f32_32x32x16_bf16 a[128:143], v[176:179], v[52:55], a[128:143]
    v_exp_f32 v4, v44
    v_exp_f32 v5, v45
    v_add_f32 v14, v14, v6
    v_add_f32 v15, v15, v7
    v_mfma_f32_32x32x16_bf16 a[144:159], v[180:183], v[52:55], a[144:159]
    v_cvt_pk_bf16_f32 v62, v4, v5
    buffer_load_dwordx4 v3, s[4:7], s25 offen offset:0 lds
    v_mfma_f32_32x32x16_bf16 a[160:175], v[184:187], v[52:55], a[160:175]
    v_exp_f32 v6, v46
    v_exp_f32 v7, v47
    v_add_f32 v14, v14, v4
    v_add_f32 v15, v15, v5
    v_mfma_f32_32x32x16_bf16 a[176:191], v[188:191], v[52:55], a[176:191]
    v_cvt_pk_bf16_f32 v63, v6, v7
    s_waitcnt vmcnt(13)
    s_barrier
    v_mfma_f32_32x32x16_bf16 v[32:47], v[128:131], v[96:99], 0
    v_exp_f32 v4, v16
    v_exp_f32 v5, v17
    v_add_f32 v14, v14, v6
    v_add_f32 v15, v15, v7
    v_mfma_f32_32x32x16_bf16 v[32:47], v[132:135], v[100:103], v[32:47]
    v_cvt_pk_bf16_f32 v48, v4, v5
    ds_read_b128 v[128:131], v2 offset:16384
    buffer_load_dwordx4 v3, s[4:7], s25 offen offset:1024 lds
    v_mfma_f32_32x32x16_bf16 v[32:47], v[136:139], v[104:107], v[32:47]
    v_exp_f32 v6, v18
    v_exp_f32 v7, v19
    v_add_f32 v12, v12, v4
    v_add_f32 v13, v13, v5
    v_mfma_f32_32x32x16_bf16 v[32:47], v[140:143], v[108:111], v[32:47]
    v_cvt_pk_bf16_f32 v49, v6, v7
    ds_read_b128 v[132:135], v2 offset:17408
    buffer_load_dwordx4 v3, s[4:7], s25 offen offset:2048 lds
    v_mfma_f32_32x32x16_bf16 v[32:47], v[144:147], v[112:115], v[32:47]
    v_exp_f32 v4, v20
    v_exp_f32 v5, v21
    v_add_f32 v12, v12, v6
    v_add_f32 v13, v13, v7
    v_mfma_f32_32x32x16_bf16 v[32:47], v[148:151], v[116:119], v[32:47]
    v_cvt_pk_bf16_f32 v50, v4, v5
    ds_read_b128 v[136:139], v2 offset:18432
    buffer_load_dwordx4 v3, s[4:7], s25 offen offset:3072 lds
    v_mfma_f32_32x32x16_bf16 v[32:47], v[152:155], v[120:123], v[32:47]
    v_exp_f32 v6, v22
    v_exp_f32 v7, v23
    v_add_f32 v12, v12, v4
    v_add_f32 v13, v13, v5
    v_mfma_f32_32x32x16_bf16 v[32:47], v[156:159], v[124:127], v[32:47]
    v_cvt_pk_bf16_f32 v51, v6, v7
    ds_read_b128 v[140:143], v2 offset:19456
    s_add_u32 s27, s24, 0xc000
    v_mfma_f32_32x32x16_bf16 a[192:207], v[160:163], v[56:59], a[192:207]
    v_exp_f32 v4, v24
    v_exp_f32 v5, v25
    v_add_f32 v12, v12, v6
    v_add_f32 v13, v13, v7
    v_mfma_f32_32x32x16_bf16 a[208:223], v[164:167], v[56:59], a[208:223]
    v_cvt_pk_bf16_f32 v52, v4, v5
    ds_read_b128 v[144:147], v2 offset:20480
    ds_read_b128 v[160:163], v2 offset:32768
    v_mfma_f32_32x32x16_bf16 a[224:239], v[168:171], v[56:59], a[224:239]
    v_exp_f32 v6, v26
    v_exp_f32 v7, v27
    v_add_f32 v12, v12, v4
    v_add_f32 v13, v13, v5
    v_mfma_f32_32x32x16_bf16 a[240:255], v[172:175], v[56:59], a[240:255]
    v_cvt_pk_bf16_f32 v53, v6, v7
    ds_read_b128 v[148:151], v2 offset:21504
    ds_read_b128 v[164:167], v2 offset:33792
    v_mfma_f32_32x32x16_bf16 a[192:207], v[176:179], v[60:63], a[192:207]
    v_exp_f32 v4, v28
    v_exp_f32 v5, v29
    v_add_f32 v12, v12, v6
    v_add_f32 v13, v13, v7
    v_mfma_f32_32x32x16_bf16 a[208:223], v[180:183], v[60:63], a[208:223]
    v_cvt_pk_bf16_f32 v54, v4, v5
    ds_read_b128 v[152:155], v2 offset:22528
    ds_read_b128 v[168:171], v2 offset:34816
    v_mfma_f32_32x32x16_bf16 a[224:239], v[184:187], v[60:63], a[224:239]
    v_exp_f32 v6, v30
    v_exp_f32 v7, v31
    v_add_f32 v12, v12, v4
    v_add_f32 v13, v13, v5
    v_mfma_f32_32x32x16_bf16 a[240:255], v[188:191], v[60:63], a[240:255]
    v_cvt_pk_bf16_f32 v55, v6, v7
    ds_read_b128 v[156:159], v2 offset:23552
    ds_read_b128 v[172:175], v2 offset:35840
    s_waitcnt lgkmcnt(4)
    v_xor_b32 v1, 0x10000, v1
    v_xor_b32 v2, 0x10000, v2
    s_xor_b32 s23, s23, 0x10000
    s_sub_u32 s28, s28, 1
    s_cmp_lg_u32 s28, 0
    s_cbranch_scc1 LR_100022
    v_mfma_f32_32x32x16_bf16 v[16:31], v[128:131], v[64:67], 0
    v_exp_f32 v4, v32
    v_exp_f32 v5, v33
    v_add_f32 v12, v12, v6
    v_add_f32 v13, v13, v7
    v_mfma_f32_32x32x16_bf16 v[16:31], v[132:135], v[68:71], v[16:31]
    s_xor_b32 m0, s23, 0x1c000
    v_cvt_pk_bf16_f32 v56, v4, v5
    ds_read_b128 v[176:179], v1 offset:36864
    buffer_load_dwordx4 v3, s[4:7], s27 offen offset:0 lds
    v_mfma_f32_32x32x16_bf16 v[16:31], v[136:139], v[72:75], v[16:31]
    v_exp_f32 v6, v34
    v_exp_f32 v7, v35
    v_add_f32 v14, v14, v4
    v_add_f32 v15, v15, v5
    v_mfma_f32_32x32x16_bf16 v[16:31], v[140:143], v[76:79], v[16:31]
    v_cvt_pk_bf16_f32 v57, v6, v7
    ds_read_b128 v[180:183], v1 offset:37888
    buffer_load_dwordx4 v3, s[4:7], s27 offen offset:1024 lds
    v_mfma_f32_32x32x16_bf16 v[16:31], v[144:147], v[80:83], v[16:31]
    v_exp_f32 v4, v36
    v_exp_f32 v5, v37
    v_add_f32 v14, v14, v6
    v_add_f32 v15, v15, v7
    v_mfma_f32_32x32x16_bf16 v[16:31], v[148:151], v[84:87], v[16:31]
    v_cvt_pk_bf16_f32 v58, v4, v5
    ds_read_b128 v[184:187], v1 offset:38912
    s_waitcnt lgkmcnt(3)
    v_mfma_f32_32x32x16_bf16 v[16:31], v[152:155], v[88:91], v[16:31]
    v_exp_f32 v6, v38
    v_exp_f32 v7, v39
    v_add_f32 v14, v14, v4
    v_add_f32 v15, v15, v5
    v_mfma_f32_32x32x16_bf16 v[16:31], v[156:159], v[92:95], v[16:31]
    v_cvt_pk_bf16_f32 v59, v6, v7
    ds_read_b128 v[188:191], v1 offset:39936
    buffer_load_dwordx4 v3, s[4:7], s27 offen offset:2048 lds
    v_mfma_f32_32x32x16_bf16 a[128:143], v[160:163], v[48:51], a[128:143]
    v_exp_f32 v4, v40
    v_exp_f32 v5, v41
    v_add_f32 v14, v14, v6
    v_add_f32 v15, v15, v7
    v_mfma_f32_32x32x16_bf16 a[144:159], v[164:167], v[48:51], a[144:159]
    v_cvt_pk_bf16_f32 v60, v4, v5
    buffer_load_dwordx4 v3, s[4:7], s27 offen offset:3072 lds
    v_mfma_f32_32x32x16_bf16 a[160:175], v[168:171], v[48:51], a[160:175]
    v_exp_f32 v6, v42
    v_exp_f32 v7, v43
    v_add_f32 v14, v14, v4
    v_add_f32 v15, v15, v5
    v_mfma_f32_32x32x16_bf16 a[176:191], v[172:175], v[48:51], a[176:191]
    v_cvt_pk_bf16_f32 v61, v6, v7
    s_waitcnt lgkmcnt(0)
    v_mfma_f32_32x32x16_bf16 a[128:143], v[176:179], v[52:55], a[128:143]
    v_exp_f32 v4, v44
    v_exp_f32 v5, v45
    v_add_f32 v14, v14, v6
    v_add_f32 v15, v15, v7
    v_mfma_f32_32x32x16_bf16 a[144:159], v[180:183], v[52:55], a[144:159]
    v_cvt_pk_bf16_f32 v62, v4, v5
    v_mfma_f32_32x32x16_bf16 a[160:175], v[184:187], v[52:55], a[160:175]
    v_exp_f32 v6, v46
    v_exp_f32 v7, v47
    v_add_f32 v14, v14, v4
    v_add_f32 v15, v15, v5
    v_mfma_f32_32x32x16_bf16 a[176:191], v[188:191], v[52:55], a[176:191]
    v_cvt_pk_bf16_f32 v63, v6, v7
    s_waitcnt vmcnt(12)
    s_barrier
    v_mfma_f32_32x32x16_bf16 v[32:47], v[128:131], v[96:99], 0
    v_exp_f32 v4, v16
    v_exp_f32 v5, v17
    v_add_f32 v14, v14, v6
    v_add_f32 v15, v15, v7
    v_readfirstlane_b32 s49, v9
    v_readfirstlane_b32 s55, v11
    s_min_u32 s49, s49, s55
    s_cmp_ge_u32 s49, 8
    s_cbranch_scc0 G3SPIN_100023
G3OK_100024:
    v_mfma_f32_32x32x16_bf16 v[32:47], v[132:135], v[100:103], v[32:47]
    v_cvt_pk_bf16_f32 v48, v4, v5
    ds_read_b128 v[128:131], v2 offset:0
    v_mfma_f32_32x32x16_bf16 v[32:47], v[136:139], v[104:107], v[32:47]
    v_exp_f32 v6, v18
    v_exp_f32 v7, v19
    v_add_f32 v12, v12, v4
    v_add_f32 v13, v13, v5
    v_and_b32 v11, 0x3f0, v3
    s_and_b32 s55, s20, 1
    s_lshl_b32 s55, s55, 13
    v_mfma_f32_32x32x16_bf16 v[32:47], v[140:143], v[108:111], v[32:47]
    v_cvt_pk_bf16_f32 v49, v6, v7
    ds_read_b128 v[132:135], v2 offset:1024
    v_mfma_f32_32x32x16_bf16 v[32:47], v[144:147], v[112:115], v[32:47]
    v_exp_f32 v4, v20
    v_exp_f32 v5, v21
    v_add_f32 v12, v12, v6
    v_add_f32 v13, v13, v7
    v_lshlrev_b32 v11, 3, v11
    v_mfma_f32_32x32x16_bf16 v[32:47], v[148:151], v[116:119], v[32:47]
    v_cvt_pk_bf16_f32 v50, v4, v5
    ds_read_b128 v[136:139], v2 offset:2048
    v_mfma_f32_32x32x16_bf16 v[32:47], v[152:155], v[120:123], v[32:47]
    v_exp_f32 v6, v22
    v_exp_f32 v7, v23
    v_add_f32 v12, v12, v4
    v_add_f32 v13, v13, v5
    v_add_u32 v11, s55, v11
    s_lshr_b32 s49, s89, 7
    s_lshl_b32 s55, s49, 14
    s_add_u32 s55, s55, 0xd80000
    s_lshl_b32 s49, s49, 3
    s_bfe_u32 s50, s2, 0x30004
    s_add_u32 s49, s49, s50
    s_lshl_b32 s49, s49, 14
    s_add_u32 s49, s49, 0x200000
    s_cmp_lt_u32 s20, 2
    s_cselect_b32 s55, s49, s55
    s_mov_b32 m0, 151552
    s_nop 0
    buffer_load_dword v11, s[76:79], s55 offen lds
    v_mfma_f32_32x32x16_bf16 v[32:47], v[156:159], v[124:127], v[32:47]
    v_cvt_pk_bf16_f32 v51, v6, v7
    ds_read_b128 v[140:143], v2 offset:3072
    s_add_u32 m0, s30, 65536
    s_mov_b32 s49, 0
    buffer_load_dwordx4 v0, s[80:83], s49 offen lds
    v_mfma_f32_32x32x16_bf16 a[192:207], v[160:163], v[56:59], a[192:207]
    v_exp_f32 v4, v24
    v_exp_f32 v5, v25
    v_add_f32 v12, v12, v6
    v_add_f32 v13, v13, v7
    s_add_u32 m0, s30, 66560
    s_mov_b32 s49, 14336
    buffer_load_dwordx4 v0, s[80:83], s49 offen lds
    v_mfma_f32_32x32x16_bf16 a[208:223], v[164:167], v[56:59], a[208:223]
    v_cvt_pk_bf16_f32 v52, v4, v5
    ds_read_b128 v[144:147], v2 offset:4096
    ds_read_b128 v[160:163], v1 offset:49152
    s_add_u32 m0, s30, 67584
    s_mov_b32 s49, 28672
    buffer_load_dwordx4 v0, s[80:83], s49 offen lds
    v_mfma_f32_32x32x16_bf16 a[224:239], v[168:171], v[56:59], a[224:239]
    v_exp_f32 v6, v26
    v_exp_f32 v7, v27
    v_add_f32 v12, v12, v4
    v_add_f32 v13, v13, v5
    s_add_u32 m0, s30, 68608
    s_mov_b32 s49, 43008
    buffer_load_dwordx4 v0, s[80:83], s49 offen lds
    v_mfma_f32_32x32x16_bf16 a[240:255], v[172:175], v[56:59], a[240:255]
    v_cvt_pk_bf16_f32 v53, v6, v7
    ds_read_b128 v[148:151], v2 offset:5120
    ds_read_b128 v[164:167], v1 offset:50176
    s_add_u32 m0, s30, 81920
    s_mov_b32 s49, 229376
    buffer_load_dwordx4 v0, s[80:83], s49 offen lds
    v_mfma_f32_32x32x16_bf16 a[192:207], v[176:179], v[60:63], a[192:207]
    v_exp_f32 v4, v28
    v_exp_f32 v5, v29
    v_add_f32 v12, v12, v6
    v_add_f32 v13, v13, v7
    s_add_u32 m0, s30, 82944
    s_mov_b32 s49, 243712
    buffer_load_dwordx4 v0, s[80:83], s49 offen lds
    v_mfma_f32_32x32x16_bf16 a[208:223], v[180:183], v[60:63], a[208:223]
    v_cvt_pk_bf16_f32 v54, v4, v5
    ds_read_b128 v[152:155], v2 offset:6144
    ds_read_b128 v[168:171], v1 offset:51200
    s_add_u32 m0, s30, 83968
    s_mov_b32 s49, 258048
    buffer_load_dwordx4 v0, s[80:83], s49 offen lds
    v_mfma_f32_32x32x16_bf16 a[224:239], v[184:187], v[60:63], a[224:239]
    v_exp_f32 v6, v30
    v_exp_f32 v7, v31
    v_add_f32 v12, v12, v4
    v_add_f32 v13, v13, v5
    v_mfma_f32_32x32x16_bf16 a[240:255], v[188:191], v[60:63], a[240:255]
    v_cvt_pk_bf16_f32 v55, v6, v7
    ds_read_b128 v[156:159], v2 offset:7168
    ds_read_b128 v[172:175], v1 offset:52224
    s_waitcnt lgkmcnt(4)
    s_add_u32 m0, s30, 84992
    s_mov_b32 s49, 272384
    buffer_load_dwordx4 v0, s[80:83], s49 offen lds
    v_mfma_f32_32x32x16_bf16 v[16:31], v[128:131], v[64:67], v[192:207]
    v_exp_f32 v4, v32
    v_exp_f32 v5, v33
    v_add_f32 v12, v12, v6
    v_add_f32 v13, v13, v7
    v_mfma_f32_32x32x16_bf16 v[16:31], v[132:135], v[68:71], v[16:31]
    v_cvt_pk_bf16_f32 v56, v4, v5
    ds_read_b128 v[176:179], v1 offset:53248
    s_add_u32 m0, s30, 98304
    s_mov_b32 s49, 458752
    buffer_load_dwordx4 v0, s[80:83], s49 offen lds
    v_mfma_f32_32x32x16_bf16 v[16:31], v[136:139], v[72:75], v[16:31]
    v_exp_f32 v6, v34
    v_exp_f32 v7, v35
    v_add_f32 v14, v14, v4
    v_add_f32 v15, v15, v5
    v_mfma_f32_32x32x16_bf16 v[16:31], v[140:143], v[76:79], v[16:31]
    v_cvt_pk_bf16_f32 v57, v6, v7
    ds_read_b128 v[180:183], v1 offset:54272
    s_add_u32 m0, s30, 99328
    s_mov_b32 s49, 473088
    buffer_load_dwordx4 v0, s[80:83], s49 offen lds
    v_mfma_f32_32x32x16_bf16 v[16:31], v[144:147], v[80:83], v[16:31]
    v_exp_f32 v4, v36
    v_exp_f32 v5, v37
    v_add_f32 v14, v14, v6
    v_add_f32 v15, v15, v7
    v_mfma_f32_32x32x16_bf16 v[16:31], v[148:151], v[84:87], v[16:31]
    v_cvt_pk_bf16_f32 v58, v4, v5
    ds_read_b128 v[184:187], v1 offset:55296
    s_waitcnt lgkmcnt(3)
    s_add_u32 m0, s30, 100352
    s_mov_b32 s49, 487424
    buffer_load_dwordx4 v0, s[80:83], s49 offen lds
    v_mfma_f32_32x32x16_bf16 v[16:31], v[152:155], v[88:91], v[16:31]
    v_exp_f32 v6, v38
    v_exp_f32 v7, v39
    v_add_f32 v14, v14, v4
    v_add_f32 v15, v15, v5
    v_mfma_f32_32x32x16_bf16 v[16:31], v[156:159], v[92:95], v[16:31]
    v_cvt_pk_bf16_f32 v59, v6, v7
    ds_read_b128 v[188:191], v1 offset:56320
    s_add_u32 m0, s30, 101376
    s_mov_b32 s49, 501760
    buffer_load_dwordx4 v0, s[80:83], s49 offen lds
    v_mfma_f32_32x32x16_bf16 a[128:143], v[160:163], v[48:51], a[128:143]
    v_exp_f32 v4, v40
    v_exp_f32 v5, v41
    v_add_f32 v14, v14, v6
    v_add_f32 v15, v15, v7
    v_mfma_f32_32x32x16_bf16 a[144:159], v[164:167], v[48:51], a[144:159]
    v_cvt_pk_bf16_f32 v60, v4, v5
    s_add_u32 m0, s30, 133120
    s_mov_b32 s49, 688128
    buffer_load_dwordx4 v0, s[80:83], s49 offen lds
    v_mfma_f32_32x32x16_bf16 a[160:175], v[168:171], v[48:51], a[160:175]
    v_exp_f32 v6, v42
    v_exp_f32 v7, v43
    v_add_f32 v14, v14, v4
    v_add_f32 v15, v15, v5
    v_mfma_f32_32x32x16_bf16 a[176:191], v[172:175], v[48:51], a[176:191]
    v_cvt_pk_bf16_f32 v61, v6, v7
    s_waitcnt lgkmcnt(0)
    s_add_u32 m0, s30, 134144
    s_mov_b32 s49, 702464
    buffer_load_dwordx4 v0, s[80:83], s49 offen lds
    v_mfma_f32_32x32x16_bf16 a[128:143], v[176:179], v[52:55], a[128:143]
    v_exp_f32 v4, v44
    v_exp_f32 v5, v45
    v_add_f32 v14, v14, v6
    v_add_f32 v15, v15, v7
    v_mfma_f32_32x32x16_bf16 a[144:159], v[180:183], v[52:55], a[144:159]
    v_cvt_pk_bf16_f32 v62, v4, v5
    s_add_u32 m0, s30, 135168
    s_mov_b32 s49, 716800
    buffer_load_dwordx4 v0, s[80:83], s49 offen lds
    v_mfma_f32_32x32x16_bf16 a[160:175], v[184:187], v[52:55], a[160:175]
    v_exp_f32 v6, v46
    v_exp_f32 v7, v47
    v_add_f32 v14, v14, v4
    v_add_f32 v15, v15, v5
    v_mfma_f32_32x32x16_bf16 a[176:191], v[188:191], v[52:55], a[176:191]
    v_cvt_pk_bf16_f32 v63, v6, v7
    s_waitcnt vmcnt(20)
    s_barrier
    v_mfma_f32_32x32x16_bf16 v[32:47], v[128:131], v[96:99], v[208:223]
    v_exp_f32 v4, v16
    v_exp_f32 v5, v17
    v_add_f32 v14, v14, v6
    v_add_f32 v15, v15, v7
    v_mfma_f32_32x32x16_bf16 v[32:47], v[132:135], v[100:103], v[32:47]
    v_cvt_pk_bf16_f32 v48, v4, v5
    ds_read_b128 v[128:131], v2 offset:16384
    s_add_u32 m0, s30, 136192
    s_mov_b32 s49, 731136
    buffer_load_dwordx4 v0, s[80:83], s49 offen lds
    v_mfma_f32_32x32x16_bf16 v[32:47], v[136:139], v[104:107], v[32:47]
    v_exp_f32 v6, v18
    v_exp_f32 v7, v19
    v_add_f32 v12, v12, v4
    v_add_f32 v13, v13, v5
    v_mfma_f32_32x32x16_bf16 v[32:47], v[140:143], v[108:111], v[32:47]
    v_cvt_pk_bf16_f32 v49, v6, v7
    ds_read_b128 v[132:135], v2 offset:17408
    v_mfma_f32_32x32x16_bf16 v[32:47], v[144:147], v[112:115], v[32:47]
    v_exp_f32 v4, v20
    v_exp_f32 v5, v21
    v_add_f32 v12, v12, v6
    v_add_f32 v13, v13, v7
    v_mfma_f32_32x32x16_bf16 v[32:47], v[148:151], v[116:119], v[32:47]
    v_cvt_pk_bf16_f32 v50, v4, v5
    ds_read_b128 v[136:139], v2 offset:18432
    v_mfma_f32_32x32x16_bf16 v[32:47], v[152:155], v[120:123], v[32:47]
    v_exp_f32 v6, v22
    v_exp_f32 v7, v23
    v_add_f32 v12, v12, v4
    v_add_f32 v13, v13, v5
    v_mfma_f32_32x32x16_bf16 v[32:47], v[156:159], v[124:127], v[32:47]
    v_cvt_pk_bf16_f32 v51, v6, v7
    ds_read_b128 v[140:143], v2 offset:19456
    v_mfma_f32_32x32x16_bf16 a[192:207], v[160:163], v[56:59], a[192:207]
    v_exp_f32 v4, v24
    v_exp_f32 v5, v25
    v_add_f32 v12, v12, v6
    v_add_f32 v13, v13, v7
    v_mfma_f32_32x32x16_bf16 a[208:223], v[164:167], v[56:59], a[208:223]
    v_cvt_pk_bf16_f32 v52, v4, v5
    ds_read_b128 v[144:147], v2 offset:20480
    ds_read_b128 v[160:163], v2 offset:32768
    v_mfma_f32_32x32x16_bf16 a[224:239], v[168:171], v[56:59], a[224:239]
    v_exp_f32 v6, v26
    v_exp_f32 v7, v27
    v_add_f32 v12, v12, v4
    v_add_f32 v13, v13, v5
    v_mfma_f32_32x32x16_bf16 a[240:255], v[172:175], v[56:59], a[240:255]
    v_cvt_pk_bf16_f32 v53, v6, v7
    ds_read_b128 v[148:151], v2 offset:21504
    ds_read_b128 v[164:167], v2 offset:33792
    v_mfma_f32_32x32x16_bf16 a[192:207], v[176:179], v[60:63], a[192:207]
    v_exp_f32 v4, v28
    v_exp_f32 v5, v29
    v_add_f32 v12, v12, v6
    v_add_f32 v13, v13, v7
    v_mfma_f32_32x32x16_bf16 a[208:223], v[180:183], v[60:63], a[208:223]
    v_cvt_pk_bf16_f32 v54, v4, v5
    ds_read_b128 v[152:155], v2 offset:22528
    ds_read_b128 v[168:171], v2 offset:34816
    v_mfma_f32_32x32x16_bf16 a[224:239], v[184:187], v[60:63], a[224:239]
    v_exp_f32 v6, v30
    v_exp_f32 v7, v31
    v_add_f32 v12, v12, v4
    v_add_f32 v13, v13, v5
    v_mfma_f32_32x32x16_bf16 a[240:255], v[188:191], v[60:63], a[240:255]
    v_cvt_pk_bf16_f32 v55, v6, v7
    ds_read_b128 v[156:159], v2 offset:23552
    ds_read_b128 v[172:175], v2 offset:35840
    s_waitcnt lgkmcnt(4)
    v_xor_b32 v1, 0x10000, v1
    v_xor_b32 v2, 0x10000, v2
    s_xor_b32 s23, s23, 0x10000
    v_mfma_f32_32x32x16_bf16 v[16:31], v[128:131], v[64:67], v[224:239]
    v_exp_f32 v4, v32
    v_exp_f32 v5, v33
    v_add_f32 v12, v12, v6
    v_add_f32 v13, v13, v7
    v_mfma_f32_32x32x16_bf16 v[16:31], v[132:135], v[68:71], v[16:31]
    v_cvt_pk_bf16_f32 v56, v4, v5
    ds_read_b128 v[176:179], v1 offset:36864
    s_add_u32 m0, s30, 114688
    s_mov_b32 s49, 917504
    buffer_load_dwordx4 v0, s[80:83], s49 offen lds
    v_mfma_f32_32x32x16_bf16 v[16:31], v[136:139], v[72:75], v[16:31]
    v_exp_f32 v6, v34
    v_exp_f32 v7, v35
    v_add_f32 v14, v14, v4
    v_add_f32 v15, v15, v5
    v_mfma_f32_32x32x16_bf16 v[16:31], v[140:143], v[76:79], v[16:31]
    v_cvt_pk_bf16_f32 v57, v6, v7
    ds_read_b128 v[180:183], v1 offset:37888
    s_add_u32 m0, s30, 115712
    s_mov_b32 s49, 931840
    buffer_load_dwordx4 v0, s[80:83], s49 offen lds
    v_mfma_f32_32x32x16_bf16 v[16:31], v[144:147], v[80:83], v[16:31]
    v_exp_f32 v4, v36
    v_exp_f32 v5, v37
    v_add_f32 v14, v14, v6
    v_add_f32 v15, v15, v7
    v_mfma_f32_32x32x16_bf16 v[16:31], v[148:151], v[84:87], v[16:31]
    v_cvt_pk_bf16_f32 v58, v4, v5
    ds_read_b128 v[184:187], v1 offset:38912
    s_waitcnt lgkmcnt(3)
    s_add_u32 m0, s30, 116736
    s_mov_b32 s49, 946176
    buffer_load_dwordx4 v0, s[80:83], s49 offen lds
    v_mfma_f32_32x32x16_bf16 v[16:31], v[152:155], v[88:91], v[16:31]
    v_exp_f32 v6, v38
    v_exp_f32 v7, v39
    v_add_f32 v14, v14, v4
    v_add_f32 v15, v15, v5
    v_mfma_f32_32x32x16_bf16 v[16:31], v[156:159], v[92:95], v[16:31]
    v_cvt_pk_bf16_f32 v59, v6, v7
    ds_read_b128 v[188:191], v1 offset:39936
    s_add_u32 m0, s30, 117760
    s_mov_b32 s49, 960512
    buffer_load_dwordx4 v0, s[80:83], s49 offen lds
    v_mfma_f32_32x32x16_bf16 a[128:143], v[160:163], v[48:51], a[128:143]
    v_exp_f32 v4, v40
    v_exp_f32 v5, v41
    v_add_f32 v14, v14, v6
    v_add_f32 v15, v15, v7
    v_mfma_f32_32x32x16_bf16 a[144:159], v[164:167], v[48:51], a[144:159]
    v_cvt_pk_bf16_f32 v60, v4, v5
    v_mfma_f32_32x32x16_bf16 a[160:175], v[168:171], v[48:51], a[160:175]
    v_exp_f32 v6, v42
    v_exp_f32 v7, v43
    v_add_f32 v14, v14, v4
    v_add_f32 v15, v15, v5
    v_mfma_f32_32x32x16_bf16 a[176:191], v[172:175], v[48:51], a[176:191]
    v_cvt_pk_bf16_f32 v61, v6, v7
    s_waitcnt lgkmcnt(0)
    v_mfma_f32_32x32x16_bf16 a[128:143], v[176:179], v[52:55], a[128:143]
    v_exp_f32 v4, v44
    v_exp_f32 v5, v45
    v_add_f32 v14, v14, v6
    v_add_f32 v15, v15, v7
    v_mfma_f32_32x32x16_bf16 a[144:159], v[180:183], v[52:55], a[144:159]
    v_cvt_pk_bf16_f32 v62, v4, v5
    v_mfma_f32_32x32x16_bf16 a[160:175], v[184:187], v[52:55], a[160:175]
    v_exp_f32 v6, v46
    v_exp_f32 v7, v47
    v_add_f32 v14, v14, v4
    v_add_f32 v15, v15, v5
    v_mfma_f32_32x32x16_bf16 a[176:191], v[188:191], v[52:55], a[176:191]
    v_cvt_pk_bf16_f32 v63, v6, v7
    s_waitcnt vmcnt(21)
    s_barrier
    v_mfma_f32_32x32x16_bf16 v[32:47], v[128:131], v[96:99], v[240:255]
    v_exp_f32 v4, v16
    v_exp_f32 v5, v17
    v_add_f32 v14, v14, v6
    v_add_f32 v15, v15, v7
    v_mfma_f32_32x32x16_bf16 v[32:47], v[132:135], v[100:103], v[32:47]
    v_cvt_pk_bf16_f32 v48, v4, v5
    v_mfma_f32_32x32x16_bf16 v[32:47], v[136:139], v[104:107], v[32:47]
    v_exp_f32 v6, v18
    v_exp_f32 v7, v19
    v_add_f32 v12, v12, v4
    v_add_f32 v13, v13, v5
    v_mfma_f32_32x32x16_bf16 v[32:47], v[140:143], v[108:111], v[32:47]
    v_cvt_pk_bf16_f32 v49, v6, v7
    v_mfma_f32_32x32x16_bf16 v[32:47], v[144:147], v[112:115], v[32:47]
    v_exp_f32 v4, v20
    v_exp_f32 v5, v21
    v_add_f32 v12, v12, v6
    v_add_f32 v13, v13, v7
    v_mfma_f32_32x32x16_bf16 v[32:47], v[148:151], v[116:119], v[32:47]
    v_cvt_pk_bf16_f32 v50, v4, v5
    v_mfma_f32_32x32x16_bf16 v[32:47], v[152:155], v[120:123], v[32:47]
    v_exp_f32 v6, v22
    v_exp_f32 v7, v23
    v_add_f32 v12, v12, v4
    v_add_f32 v13, v13, v5
    v_mfma_f32_32x32x16_bf16 v[32:47], v[156:159], v[124:127], v[32:47]
    v_cvt_pk_bf16_f32 v51, v6, v7
    v_mfma_f32_32x32x16_bf16 a[192:207], v[160:163], v[56:59], a[192:207]
    v_exp_f32 v4, v24
    v_exp_f32 v5, v25
    v_add_f32 v12, v12, v6
    v_add_f32 v13, v13, v7
    v_mfma_f32_32x32x16_bf16 a[208:223], v[164:167], v[56:59], a[208:223]
    v_cvt_pk_bf16_f32 v52, v4, v5
    ds_read_b128 v[160:163], v1 offset:49152
    v_mfma_f32_32x32x16_bf16 a[224:239], v[168:171], v[56:59], a[224:239]
    v_exp_f32 v6, v26
    v_exp_f32 v7, v27
    v_add_f32 v12, v12, v4
    v_add_f32 v13, v13, v5
    v_mfma_f32_32x32x16_bf16 a[240:255], v[172:175], v[56:59], a[240:255]
    v_cvt_pk_bf16_f32 v53, v6, v7
    ds_read_b128 v[164:167], v1 offset:50176
    v_mfma_f32_32x32x16_bf16 a[192:207], v[176:179], v[60:63], a[192:207]
    v_exp_f32 v4, v28
    v_exp_f32 v5, v29
    v_add_f32 v12, v12, v6
    v_add_f32 v13, v13, v7
    v_mfma_f32_32x32x16_bf16 a[208:223], v[180:183], v[60:63], a[208:223]
    v_cvt_pk_bf16_f32 v54, v4, v5
    ds_read_b128 v[168:171], v1 offset:51200
    v_mfma_f32_32x32x16_bf16 a[224:239], v[184:187], v[60:63], a[224:239]
    v_exp_f32 v6, v30
    v_exp_f32 v7, v31
    v_add_f32 v12, v12, v4
    v_add_f32 v13, v13, v5
    v_mfma_f32_32x32x16_bf16 a[240:255], v[188:191], v[60:63], a[240:255]
    v_cvt_pk_bf16_f32 v55, v6, v7
    ds_read_b128 v[172:175], v1 offset:52224
    s_waitcnt lgkmcnt(2)
    v_exp_f32 v4, v32
    v_exp_f32 v5, v33
    v_add_f32 v12, v12, v6
    v_add_f32 v13, v13, v7
    v_cvt_pk_bf16_f32 v56, v4, v5
    ds_read_b128 v[176:179], v1 offset:53248
    v_exp_f32 v6, v34
    v_exp_f32 v7, v35
    v_add_f32 v14, v14, v4
    v_add_f32 v15, v15, v5
    v_cvt_pk_bf16_f32 v57, v6, v7
    ds_read_b128 v[180:183], v1 offset:54272
    v_exp_f32 v4, v36
    v_exp_f32 v5, v37
    v_add_f32 v14, v14, v6
    v_add_f32 v15, v15, v7
    v_cvt_pk_bf16_f32 v58, v4, v5
    ds_read_b128 v[184:187], v1 offset:55296
    s_waitcnt lgkmcnt(3)
    v_exp_f32 v6, v38
    v_exp_f32 v7, v39
    v_add_f32 v14, v14, v4
    v_add_f32 v15, v15, v5
    v_cvt_pk_bf16_f32 v59, v6, v7
    ds_read_b128 v[188:191], v1 offset:56320
    v_mfma_f32_32x32x16_bf16 a[128:143], v[160:163], v[48:51], a[128:143]
    v_exp_f32 v4, v40
    v_exp_f32 v5, v41
    v_add_f32 v14, v14, v6
    v_add_f32 v15, v15, v7
    v_mfma_f32_32x32x16_bf16 a[144:159], v[164:167], v[48:51], a[144:159]
    v_cvt_pk_bf16_f32 v60, v4, v5
    v_mfma_f32_32x32x16_bf16 a[160:175], v[168:171], v[48:51], a[160:175]
    v_exp_f32 v6, v42
    v_exp_f32 v7, v43
    v_add_f32 v14, v14, v4
    v_add_f32 v15, v15, v5
    v_mfma_f32_32x32x16_bf16 a[176:191], v[172:175], v[48:51], a[176:191]
    v_cvt_pk_bf16_f32 v61, v6, v7
    s_waitcnt lgkmcnt(0)
    v_mfma_f32_32x32x16_bf16 a[128:143], v[176:179], v[52:55], a[128:143]
    v_exp_f32 v4, v44
    v_exp_f32 v5, v45
    v_add_f32 v14, v14, v6
    v_add_f32 v15, v15, v7
    v_mfma_f32_32x32x16_bf16 a[144:159], v[180:183], v[52:55], a[144:159]
    v_cvt_pk_bf16_f32 v62, v4, v5
    v_mfma_f32_32x32x16_bf16 a[160:175], v[184:187], v[52:55], a[160:175]
    v_exp_f32 v6, v46
    v_exp_f32 v7, v47
    v_add_f32 v14, v14, v4
    v_add_f32 v15, v15, v5
    v_mfma_f32_32x32x16_bf16 a[176:191], v[188:191], v[52:55], a[176:191]
    v_cvt_pk_bf16_f32 v63, v6, v7
    v_add_f32 v14, v14, v6
    v_add_f32 v15, v15, v7
    s_nop 1
    v_mfma_f32_32x32x16_bf16 a[192:207], v[160:163], v[56:59], a[192:207]
    v_mfma_f32_32x32x16_bf16 a[208:223], v[164:167], v[56:59], a[208:223]
    v_mfma_f32_32x32x16_bf16 a[224:239], v[168:171], v[56:59], a[224:239]
    v_mfma_f32_32x32x16_bf16 a[240:255], v[172:175], v[56:59], a[240:255]
    v_mfma_f32_32x32x16_bf16 a[192:207], v[176:179], v[60:63], a[192:207]
    v_mfma_f32_32x32x16_bf16 a[208:223], v[180:183], v[60:63], a[208:223]
    v_mfma_f32_32x32x16_bf16 a[224:239], v[184:187], v[60:63], a[224:239]
    v_mfma_f32_32x32x16_bf16 a[240:255], v[188:191], v[60:63], a[240:255]
    s_getpc_b64 s[74:75]
PC_100026:
    s_lshr_b32 s72, s2, 3
    s_and_b32 s72, s72, 1
    s_lshl_b32 s72, s72, 14
    s_lshl_b32 s73, s20, 12
    s_add_u32 s72, s72, s73
    v_mbcnt_lo_u32_b32 v62, -1, 0
    v_mbcnt_hi_u32_b32 v62, -1, v62
    v_lshlrev_b32 v62, 6, v62
    v_add_u32 v62, s72, v62
    v_min_u32 v62, END_100001-PC_100026, v62
    v_mov_b32 v63, s75
    v_add_co_u32 v62, vcc, s74, v62
    s_nop 1
    v_addc_co_u32 v63, vcc, 0, v63, vcc
    global_load_dword v62, v[62:63], off
    s_barrier
    v_and_b32 v2, 0x3ff, v2
    s_lshl_b32 s37, s20, 14
    v_add_u32 v3, s37, v2
    v_xor_b32 v1, 0x4000, v3
    v_lshrrev_b32 v4, 1, v2
    s_lshl_b32 s37, s20, 9
    s_add_u32 s37, s37, 131072
    v_add_u32 v4, s37, v4
    v_xor_b32 v5, 0x200, v4
    v_mov_b32 v6, v10
    v_add_f32 v7, v14, v15
    v_add_f32 v12, v12, v13
    ds_write_b64 v4, v[6:7]
    s_nop 7
    ds_write_b128 v3, a[64:67] offset:0
    v_accvgpr_read_b32 v128, a0
    v_accvgpr_read_b32 v129, a1
    v_accvgpr_read_b32 v130, a2
    v_accvgpr_read_b32 v131, a3
    ds_write_b128 v3, a[68:71] offset:1024
    v_accvgpr_read_b32 v132, a4
    v_accvgpr_read_b32 v133, a5
    v_accvgpr_read_b32 v134, a6
    v_accvgpr_read_b32 v135, a7
    ds_write_b128 v3, a[72:75] offset:2048
    v_accvgpr_read_b32 v136, a8
    v_accvgpr_read_b32 v137, a9
    v_accvgpr_read_b32 v138, a10
    v_accvgpr_read_b32 v139, a11
    ds_write_b128 v3, a[76:79] offset:3072
    v_accvgpr_read_b32 v140, a12
    v_accvgpr_read_b32 v141, a13
    v_accvgpr_read_b32 v142, a14
    v_accvgpr_read_b32 v143, a15
    ds_write_b128 v3, a[80:83] offset:4096
    v_accvgpr_read_b32 v144, a16
    v_accvgpr_read_b32 v145, a17
    v_accvgpr_read_b32 v146, a18
    v_accvgpr_read_b32 v147, a19
    ds_write_b128 v3, a[84:87] offset:5120
    v_accvgpr_read_b32 v148, a20
    v_accvgpr_read_b32 v149, a21
    v_accvgpr_read_b32 v150, a22
    v_accvgpr_read_b32 v151, a23
    ds_write_b128 v3, a[88:91] offset:6144
    v_accvgpr_read_b32 v152, a24
    v_accvgpr_read_b32 v153, a25
    v_accvgpr_read_b32 v154, a26
    v_accvgpr_read_b32 v155, a27
    ds_write_b128 v3, a[92:95] offset:7168
    v_accvgpr_read_b32 v156, a28
    v_accvgpr_read_b32 v157, a29
    v_accvgpr_read_b32 v158, a30
    v_accvgpr_read_b32 v159, a31
    ds_write_b128 v3, a[96:99] offset:8192
    v_accvgpr_read_b32 v160, a32
    v_accvgpr_read_b32 v161, a33
    v_accvgpr_read_b32 v162, a34
    v_accvgpr_read_b32 v163, a35
    ds_write_b128 v3, a[100:103] offset:9216
    v_accvgpr_read_b32 v164, a36
    v_accvgpr_read_b32 v165, a37
    v_accvgpr_read_b32 v166, a38
    v_accvgpr_read_b32 v167, a39
    ds_write_b128 v3, a[104:107] offset:10240
    v_accvgpr_read_b32 v168, a40
    v_accvgpr_read_b32 v169, a41
    v_accvgpr_read_b32 v170, a42
    v_accvgpr_read_b32 v171, a43
    ds_write_b128 v3, a[108:111] offset:11264
    v_accvgpr_read_b32 v172, a44
    v_accvgpr_read_b32 v173, a45
    v_accvgpr_read_b32 v174, a46
    v_accvgpr_read_b32 v175, a47
    ds_write_b128 v3, a[112:115] offset:12288
    v_accvgpr_read_b32 v176, a48
    v_accvgpr_read_b32 v177, a49
    v_accvgpr_read_b32 v178, a50
    v_accvgpr_read_b32 v179, a51
    ds_write_b128 v3, a[116:119] offset:13312
    v_accvgpr_read_b32 v180, a52
    v_accvgpr_read_b32 v181, a53
    v_accvgpr_read_b32 v182, a54
    v_accvgpr_read_b32 v183, a55
    ds_write_b128 v3, a[120:123] offset:14336
    v_accvgpr_read_b32 v184, a56
    v_accvgpr_read_b32 v185, a57
    v_accvgpr_read_b32 v186, a58
    v_accvgpr_read_b32 v187, a59
    ds_write_b128 v3, a[124:127] offset:15360
    v_accvgpr_read_b32 v188, a60
    v_accvgpr_read_b32 v189, a61
    v_accvgpr_read_b32 v190, a62
    v_accvgpr_read_b32 v191, a63
    v_accvgpr_read_b32 v192, a128
    v_accvgpr_read_b32 v193, a129
    v_accvgpr_read_b32 v194, a130
    v_accvgpr_read_b32 v195, a131
    v_accvgpr_read_b32 v196, a132
    v_accvgpr_read_b32 v197, a133
    v_accvgpr_read_b32 v198, a134
    v_accvgpr_read_b32 v199, a135
    v_accvgpr_read_b32 v200, a136
    v_accvgpr_read_b32 v201, a137
    v_accvgpr_read_b32 v202, a138
    v_accvgpr_read_b32 v203, a139
    v_accvgpr_read_b32 v204, a140
    v_accvgpr_read_b32 v205, a141
    v_accvgpr_read_b32 v206, a142
    v_accvgpr_read_b32 v207, a143
    v_accvgpr_read_b32 v208, a144
    v_accvgpr_read_b32 v209, a145
    v_accvgpr_read_b32 v210, a146
    v_accvgpr_read_b32 v211, a147
    v_accvgpr_read_b32 v212, a148
    v_accvgpr_read_b32 v213, a149
    v_accvgpr_read_b32 v214, a150
    v_accvgpr_read_b32 v215, a151
    v_accvgpr_read_b32 v216, a152
    v_accvgpr_read_b32 v217, a153
    v_accvgpr_read_b32 v218, a154
    v_accvgpr_read_b32 v219, a155
    v_accvgpr_read_b32 v220, a156
    v_accvgpr_read_b32 v221, a157
    v_accvgpr_read_b32 v222, a158
    v_accvgpr_read_b32 v223, a159
    v_accvgpr_read_b32 v224, a160
    v_accvgpr_read_b32 v225, a161
    v_accvgpr_read_b32 v226, a162
    v_accvgpr_read_b32 v227, a163
    v_accvgpr_read_b32 v228, a164
    v_accvgpr_read_b32 v229, a165
    v_accvgpr_read_b32 v230, a166
    v_accvgpr_read_b32 v231, a167
    v_accvgpr_read_b32 v232, a168
    v_accvgpr_read_b32 v233, a169
    v_accvgpr_read_b32 v234, a170
    v_accvgpr_read_b32 v235, a171
    v_accvgpr_read_b32 v236, a172
    v_accvgpr_read_b32 v237, a173
    v_accvgpr_read_b32 v238, a174
    v_accvgpr_read_b32 v239, a175
    v_accvgpr_read_b32 v240, a176
    v_accvgpr_read_b32 v241, a177
    v_accvgpr_read_b32 v242, a178
    v_accvgpr_read_b32 v243, a179
    v_accvgpr_read_b32 v244, a180
    v_accvgpr_read_b32 v245, a181
    v_accvgpr_read_b32 v246, a182
    v_accvgpr_read_b32 v247, a183
    v_accvgpr_read_b32 v248, a184
    v_accvgpr_read_b32 v249, a185
    v_accvgpr_read_b32 v250, a186
    v_accvgpr_read_b32 v251, a187
    v_accvgpr_read_b32 v252, a188
    v_accvgpr_read_b32 v253, a189
    v_accvgpr_read_b32 v254, a190
    v_accvgpr_read_b32 v255, a191
    v_lshrrev_b32 v11, 4, v2
    v_and_b32 v14, 15, v11
    v_lshrrev_b32 v19, 5, v11
    v_bfe_u32 v18, v11, 4, 1
    v_lshl_add_u32 v20, v19, 4, v14
    v_lshlrev_b32 v20, 4, v20
    v_lshl_add_u32 v21, v18, 17, v20
    s_lshl_b32 s37, s31, 18
    v_add_u32 v16, s37, v21
    s_lshl_b32 s37, s32, 18
    v_add_u32 v17, s37, v21
    v_and_b32 v18, 31, v11
    v_add_u32 v18, s89, v18
    v_lshrrev_b32 v19, 5, v11
    v_lshlrev_b32 v23, 7, v18
    v_lshl_add_u32 v23, v19, 6, v23
    v_lshrrev_b32 v22, 4, v18
    v_lshlrev_b32 v22, 14, v22
    v_and_b32 v18, 15, v18
    v_lshl_add_u32 v22, v18, 4, v22
    v_lshl_add_u32 v22, v19, 8, v22
    s_waitcnt lgkmcnt(0)
    s_mov_b32 s55, 0xd80000
    buffer_load_dwordx4 a[160:163], v23, s[76:79], s55 offen offset:0 sc1
    buffer_load_dwordx4 a[164:167], v23, s[76:79], s55 offen offset:16 sc1
    buffer_load_dwordx4 a[168:171], v23, s[76:79], s55 offen offset:32 sc1
    buffer_load_dwordx4 a[172:175], v23, s[76:79], s55 offen offset:48 sc1
    s_barrier
    ds_read_b64 v[6:7], v5
    ds_read_b128 v[96:99], v1 offset:0
    ds_read_b128 v[100:103], v1 offset:1024
    ds_read_b128 v[104:107], v1 offset:2048
    ds_read_b128 v[108:111], v1 offset:3072
    ds_read_b128 v[112:115], v1 offset:4096
    ds_read_b128 v[116:119], v1 offset:5120
    ds_read_b128 v[120:123], v1 offset:6144
    ds_read_b128 v[124:127], v1 offset:7168
    s_waitcnt lgkmcnt(8)
    v_add_f32 v8, v8, v6
    v_add_f32 v12, v12, v7
    v_mov_b32 v9, v8
    s_nop 1
    v_permlane32_swap_b32 v8, v9
    s_nop 1
    v_add_f32 v8, v8, v9
    v_mov_b32 v13, v12
    s_nop 1
    v_permlane32_swap_b32 v12, v13
    s_nop 1
    v_add_f32 v12, v12, v13
    v_mov_b32 v9, 0x2b800000
    v_cmp_ge_f32 vcc, v8, v9
    v_mov_b32 v9, 0x53800000
    v_cmp_le_f32 s[50:51], v8, v9
    s_nop 1
    s_and_b64 vcc, vcc, s[50:51]
    s_cmp_eq_u64 vcc, -1
    s_cselect_b32 s33, 0, 1
    v_mov_b32 v9, 0x2b800000
    v_cmp_ge_f32 vcc, v12, v9
    v_mov_b32 v9, 0x53800000
    v_cmp_le_f32 s[50:51], v12, v9
    s_nop 1
    s_and_b64 vcc, vcc, s[50:51]
    s_cmp_eq_u64 vcc, -1
    s_cselect_b32 s34, 0, 1
    v_rcp_f32 v8, v8
    v_rcp_f32 v12, v12
    s_nop 0
    v_mov_b32 v9, v8
    v_mov_b32 v13, v12
    s_waitcnt lgkmcnt(6)
    buffer_load_dwordx4 a[0:3], v22, s[76:79], s45 offen offset:0 sc1
    buffer_load_dwordx4 a[4:7], v22, s[76:79], s45 offen offset:512 sc1
    v_pk_add_f32 v[128:129], v[128:129], v[96:97]
    v_pk_add_f32 v[130:131], v[130:131], v[98:99]
    v_pk_add_f32 v[132:133], v[132:133], v[100:101]
    v_pk_add_f32 v[134:135], v[134:135], v[102:103]
    ds_read_b128 v[96:99], v1 offset:8192
    ds_read_b128 v[100:103], v1 offset:9216
    v_pk_mul_f32 v[128:129], v[128:129], v[8:9]
    v_pk_mul_f32 v[130:131], v[130:131], v[8:9]
    v_pk_mul_f32 v[132:133], v[132:133], v[8:9]
    v_pk_mul_f32 v[134:135], v[134:135], v[8:9]
    v_cvt_pk_bf16_f32 v50, v128, v129
    v_cvt_pk_bf16_f32 v51, v130, v131
    v_cvt_pk_bf16_f32 v52, v132, v133
    v_cvt_pk_bf16_f32 v53, v134, v135
    buffer_store_dwordx4 v[50:53], v16, s[16:19], s36 offen offset:0
    s_waitcnt lgkmcnt(6)
    buffer_load_dwordx4 a[8:11], v22, s[76:79], s45 offen offset:1024 sc1
    buffer_load_dwordx4 a[12:15], v22, s[76:79], s45 offen offset:1536 sc1
    v_pk_add_f32 v[136:137], v[136:137], v[104:105]
    v_pk_add_f32 v[138:139], v[138:139], v[106:107]
    v_pk_add_f32 v[140:141], v[140:141], v[108:109]
    v_pk_add_f32 v[142:143], v[142:143], v[110:111]
    ds_read_b128 v[104:107], v1 offset:10240
    ds_read_b128 v[108:111], v1 offset:11264
    v_pk_mul_f32 v[136:137], v[136:137], v[8:9]
    v_pk_mul_f32 v[138:139], v[138:139], v[8:9]
    v_pk_mul_f32 v[140:141], v[140:141], v[8:9]
    v_pk_mul_f32 v[142:143], v[142:143], v[8:9]
    v_cvt_pk_bf16_f32 v54, v136, v137
    v_cvt_pk_bf16_f32 v55, v138, v139
    v_cvt_pk_bf16_f32 v56, v140, v141
    v_cvt_pk_bf16_f32 v57, v142, v143
    buffer_store_dwordx4 v[54:57], v16, s[16:19], s36 offen offset:512
    s_waitcnt lgkmcnt(6)
    buffer_load_dwordx4 a[16:19], v22, s[76:79], s45 offen offset:2048 sc1
    buffer_load_dwordx4 a[20:23], v22, s[76:79], s45 offen offset:2560 sc1
    v_pk_add_f32 v[144:145], v[144:145], v[112:113]
    v_pk_add_f32 v[146:147], v[146:147], v[114:115]
    v_pk_add_f32 v[148:149], v[148:149], v[116:117]
    v_pk_add_f32 v[150:151], v[150:151], v[118:119]
    ds_read_b128 v[112:115], v1 offset:12288
    ds_read_b128 v[116:119], v1 offset:13312
    v_pk_mul_f32 v[144:145], v[144:145], v[8:9]
    v_pk_mul_f32 v[146:147], v[146:147], v[8:9]
    v_pk_mul_f32 v[148:149], v[148:149], v[8:9]
    v_pk_mul_f32 v[150:151], v[150:151], v[8:9]
    v_cvt_pk_bf16_f32 v50, v144, v145
    v_cvt_pk_bf16_f32 v51, v146, v147
    v_cvt_pk_bf16_f32 v52, v148, v149
    v_cvt_pk_bf16_f32 v53, v150, v151
    buffer_store_dwordx4 v[50:53], v16, s[16:19], s36 offen offset:1024
    s_waitcnt lgkmcnt(6)
    buffer_load_dwordx4 a[24:27], v22, s[76:79], s45 offen offset:3072 sc1
    buffer_load_dwordx4 a[28:31], v22, s[76:79], s45 offen offset:3584 sc1
    v_pk_add_f32 v[152:153], v[152:153], v[120:121]
    v_pk_add_f32 v[154:155], v[154:155], v[122:123]
    v_pk_add_f32 v[156:157], v[156:157], v[124:125]
    v_pk_add_f32 v[158:159], v[158:159], v[126:127]
    ds_read_b128 v[120:123], v1 offset:14336
    ds_read_b128 v[124:127], v1 offset:15360
    v_pk_mul_f32 v[152:153], v[152:153], v[8:9]
    v_pk_mul_f32 v[154:155], v[154:155], v[8:9]
    v_pk_mul_f32 v[156:157], v[156:157], v[8:9]
    v_pk_mul_f32 v[158:159], v[158:159], v[8:9]
    v_cvt_pk_bf16_f32 v54, v152, v153
    v_cvt_pk_bf16_f32 v55, v154, v155
    v_cvt_pk_bf16_f32 v56, v156, v157
    v_cvt_pk_bf16_f32 v57, v158, v159
    buffer_store_dwordx4 v[54:57], v16, s[16:19], s36 offen offset:1536
    s_waitcnt lgkmcnt(6)
    buffer_load_dwordx4 a[32:35], v22, s[76:79], s46 offen offset:0 sc1
    buffer_load_dwordx4 a[36:39], v22, s[76:79], s46 offen offset:512 sc1
    v_pk_add_f32 v[160:161], v[160:161], v[96:97]
    v_pk_add_f32 v[162:163], v[162:163], v[98:99]
    v_pk_add_f32 v[164:165], v[164:165], v[100:101]
    v_pk_add_f32 v[166:167], v[166:167], v[102:103]
    v_pk_mul_f32 v[160:161], v[160:161], v[8:9]
    v_pk_mul_f32 v[162:163], v[162:163], v[8:9]
    v_pk_mul_f32 v[164:165], v[164:165], v[8:9]
    v_pk_mul_f32 v[166:167], v[166:167], v[8:9]
    v_cvt_pk_bf16_f32 v50, v160, v161
    v_cvt_pk_bf16_f32 v51, v162, v163
    v_cvt_pk_bf16_f32 v52, v164, v165
    v_cvt_pk_bf16_f32 v53, v166, v167
    buffer_store_dwordx4 v[50:53], v16, s[16:19], s36 offen offset:2048
    s_waitcnt lgkmcnt(0)
    s_barrier
    buffer_load_dwordx4 a[40:43], v22, s[76:79], s46 offen offset:1024 sc1
    buffer_load_dwordx4 a[44:47], v22, s[76:79], s46 offen offset:1536 sc1
    v_pk_add_f32 v[168:169], v[168:169], v[104:105]
    v_pk_add_f32 v[170:171], v[170:171], v[106:107]
    v_pk_add_f32 v[172:173], v[172:173], v[108:109]
    v_pk_add_f32 v[174:175], v[174:175], v[110:111]
    ds_write_b128 v3, a[192:195] offset:0
    ds_write_b128 v3, a[196:199] offset:1024
    ds_write_b128 v3, a[200:203] offset:2048
    ds_write_b128 v3, a[204:207] offset:3072
    ds_write_b128 v3, a[208:211] offset:4096
    ds_write_b128 v3, a[212:215] offset:5120
    v_pk_mul_f32 v[168:169], v[168:169], v[8:9]
    v_pk_mul_f32 v[170:171], v[170:171], v[8:9]
    v_pk_mul_f32 v[172:173], v[172:173], v[8:9]
    v_pk_mul_f32 v[174:175], v[174:175], v[8:9]
    v_cvt_pk_bf16_f32 v54, v168, v169
    v_cvt_pk_bf16_f32 v55, v170, v171
    v_cvt_pk_bf16_f32 v56, v172, v173
    v_cvt_pk_bf16_f32 v57, v174, v175
    buffer_store_dwordx4 v[54:57], v16, s[16:19], s36 offen offset:2560
    buffer_load_dwordx4 a[48:51], v22, s[76:79], s46 offen offset:2048 sc1
    buffer_load_dwordx4 a[52:55], v22, s[76:79], s46 offen offset:2560 sc1
    v_pk_add_f32 v[176:177], v[176:177], v[112:113]
    v_pk_add_f32 v[178:179], v[178:179], v[114:115]
    v_pk_add_f32 v[180:181], v[180:181], v[116:117]
    v_pk_add_f32 v[182:183], v[182:183], v[118:119]
    ds_write_b128 v3, a[216:219] offset:6144
    ds_write_b128 v3, a[220:223] offset:7168
    ds_write_b128 v3, a[224:227] offset:8192
    ds_write_b128 v3, a[228:231] offset:9216
    ds_write_b128 v3, a[232:235] offset:10240
    v_pk_mul_f32 v[176:177], v[176:177], v[8:9]
    v_pk_mul_f32 v[178:179], v[178:179], v[8:9]
    v_pk_mul_f32 v[180:181], v[180:181], v[8:9]
    v_pk_mul_f32 v[182:183], v[182:183], v[8:9]
    v_cvt_pk_bf16_f32 v50, v176, v177
    v_cvt_pk_bf16_f32 v51, v178, v179
    v_cvt_pk_bf16_f32 v52, v180, v181
    v_cvt_pk_bf16_f32 v53, v182, v183
    buffer_store_dwordx4 v[50:53], v16, s[16:19], s36 offen offset:3072
    buffer_load_dwordx4 a[56:59], v22, s[76:79], s46 offen offset:3072 sc1
    buffer_load_dwordx4 a[60:63], v22, s[76:79], s46 offen offset:3584 sc1
    v_pk_add_f32 v[184:185], v[184:185], v[120:121]
    v_pk_add_f32 v[186:187], v[186:187], v[122:123]
    v_pk_add_f32 v[188:189], v[188:189], v[124:125]
    v_pk_add_f32 v[190:191], v[190:191], v[126:127]
    ds_write_b128 v3, a[236:239] offset:11264
    ds_write_b128 v3, a[240:243] offset:12288
    ds_write_b128 v3, a[244:247] offset:13312
    ds_write_b128 v3, a[248:251] offset:14336
    ds_write_b128 v3, a[252:255] offset:15360
    v_pk_mul_f32 v[184:185], v[184:185], v[8:9]
    v_pk_mul_f32 v[186:187], v[186:187], v[8:9]
    v_pk_mul_f32 v[188:189], v[188:189], v[8:9]
    v_pk_mul_f32 v[190:191], v[190:191], v[8:9]
    v_cvt_pk_bf16_f32 v54, v184, v185
    v_cvt_pk_bf16_f32 v55, v186, v187
    v_cvt_pk_bf16_f32 v56, v188, v189
    v_cvt_pk_bf16_f32 v57, v190, v191
    buffer_store_dwordx4 v[54:57], v16, s[16:19], s36 offen offset:3584
    s_waitcnt lgkmcnt(0)
    s_barrier
    ds_read_b128 v[96:99], v1 offset:0
    ds_read_b128 v[100:103], v1 offset:1024
    ds_read_b128 v[104:107], v1 offset:2048
    ds_read_b128 v[108:111], v1 offset:3072
    ds_read_b128 v[112:115], v1 offset:4096
    ds_read_b128 v[116:119], v1 offset:5120
    ds_read_b128 v[120:123], v1 offset:6144
    ds_read_b128 v[124:127], v1 offset:7168
    buffer_load_dwordx4 a[64:67], v22, s[76:79], s47 offen offset:0 sc1
    buffer_load_dwordx4 a[68:71], v22, s[76:79], s47 offen offset:512 sc1
    s_waitcnt lgkmcnt(6)
    v_pk_add_f32 v[192:193], v[192:193], v[96:97]
    v_pk_add_f32 v[194:195], v[194:195], v[98:99]
    v_pk_add_f32 v[196:197], v[196:197], v[100:101]
    v_pk_add_f32 v[198:199], v[198:199], v[102:103]
    ds_read_b128 v[96:99], v1 offset:8192
    ds_read_b128 v[100:103], v1 offset:9216
    v_pk_mul_f32 v[192:193], v[192:193], v[12:13]
    v_pk_mul_f32 v[194:195], v[194:195], v[12:13]
    v_pk_mul_f32 v[196:197], v[196:197], v[12:13]
    v_pk_mul_f32 v[198:199], v[198:199], v[12:13]
    v_cvt_pk_bf16_f32 v50, v192, v193
    v_cvt_pk_bf16_f32 v51, v194, v195
    v_cvt_pk_bf16_f32 v52, v196, v197
    v_cvt_pk_bf16_f32 v53, v198, v199
    buffer_store_dwordx4 v[50:53], v17, s[16:19], s36 offen offset:0
    buffer_load_dwordx4 a[72:75], v22, s[76:79], s47 offen offset:1024 sc1
    buffer_load_dwordx4 a[76:79], v22, s[76:79], s47 offen offset:1536 sc1
    s_waitcnt lgkmcnt(6)
    v_pk_add_f32 v[200:201], v[200:201], v[104:105]
    v_pk_add_f32 v[202:203], v[202:203], v[106:107]
    v_pk_add_f32 v[204:205], v[204:205], v[108:109]
    v_pk_add_f32 v[206:207], v[206:207], v[110:111]
    ds_read_b128 v[104:107], v1 offset:10240
    ds_read_b128 v[108:111], v1 offset:11264
    v_pk_mul_f32 v[200:201], v[200:201], v[12:13]
    v_pk_mul_f32 v[202:203], v[202:203], v[12:13]
    v_pk_mul_f32 v[204:205], v[204:205], v[12:13]
    v_pk_mul_f32 v[206:207], v[206:207], v[12:13]
    v_cvt_pk_bf16_f32 v54, v200, v201
    v_cvt_pk_bf16_f32 v55, v202, v203
    v_cvt_pk_bf16_f32 v56, v204, v205
    v_cvt_pk_bf16_f32 v57, v206, v207
    buffer_store_dwordx4 v[54:57], v17, s[16:19], s36 offen offset:512
    buffer_load_dwordx4 a[80:83], v22, s[76:79], s47 offen offset:2048 sc1
    buffer_load_dwordx4 a[84:87], v22, s[76:79], s47 offen offset:2560 sc1
    s_waitcnt lgkmcnt(6)
    v_pk_add_f32 v[208:209], v[208:209], v[112:113]
    v_pk_add_f32 v[210:211], v[210:211], v[114:115]
    v_pk_add_f32 v[212:213], v[212:213], v[116:117]
    v_pk_add_f32 v[214:215], v[214:215], v[118:119]
    ds_read_b128 v[112:115], v1 offset:12288
    ds_read_b128 v[116:119], v1 offset:13312
    v_pk_mul_f32 v[208:209], v[208:209], v[12:13]
    v_pk_mul_f32 v[210:211], v[210:211], v[12:13]
    v_pk_mul_f32 v[212:213], v[212:213], v[12:13]
    v_pk_mul_f32 v[214:215], v[214:215], v[12:13]
    v_cvt_pk_bf16_f32 v50, v208, v209
    v_cvt_pk_bf16_f32 v51, v210, v211
    v_cvt_pk_bf16_f32 v52, v212, v213
    v_cvt_pk_bf16_f32 v53, v214, v215
    buffer_store_dwordx4 v[50:53], v17, s[16:19], s36 offen offset:1024
    buffer_load_dwordx4 a[88:91], v22, s[76:79], s47 offen offset:3072 sc1
    buffer_load_dwordx4 a[92:95], v22, s[76:79], s47 offen offset:3584 sc1
    s_waitcnt lgkmcnt(6)
    v_pk_add_f32 v[216:217], v[216:217], v[120:121]
    v_pk_add_f32 v[218:219], v[218:219], v[122:123]
    v_pk_add_f32 v[220:221], v[220:221], v[124:125]
    v_pk_add_f32 v[222:223], v[222:223], v[126:127]
    ds_read_b128 v[120:123], v1 offset:14336
    ds_read_b128 v[124:127], v1 offset:15360
    v_pk_mul_f32 v[216:217], v[216:217], v[12:13]
    v_pk_mul_f32 v[218:219], v[218:219], v[12:13]
    v_pk_mul_f32 v[220:221], v[220:221], v[12:13]
    v_pk_mul_f32 v[222:223], v[222:223], v[12:13]
    v_cvt_pk_bf16_f32 v54, v216, v217
    v_cvt_pk_bf16_f32 v55, v218, v219
    v_cvt_pk_bf16_f32 v56, v220, v221
    v_cvt_pk_bf16_f32 v57, v222, v223
    buffer_store_dwordx4 v[54:57], v17, s[16:19], s36 offen offset:1536
    buffer_load_dwordx4 a[96:99], v22, s[76:79], s48 offen offset:0 sc1
    buffer_load_dwordx4 a[100:103], v22, s[76:79], s48 offen offset:512 sc1
    s_waitcnt lgkmcnt(6)
    v_pk_add_f32 v[224:225], v[224:225], v[96:97]
    v_pk_add_f32 v[226:227], v[226:227], v[98:99]
    v_pk_add_f32 v[228:229], v[228:229], v[100:101]
    v_pk_add_f32 v[230:231], v[230:231], v[102:103]
    v_pk_mul_f32 v[224:225], v[224:225], v[12:13]
    v_pk_mul_f32 v[226:227], v[226:227], v[12:13]
    v_pk_mul_f32 v[228:229], v[228:229], v[12:13]
    v_pk_mul_f32 v[230:231], v[230:231], v[12:13]
    v_cvt_pk_bf16_f32 v50, v224, v225
    v_cvt_pk_bf16_f32 v51, v226, v227
    v_cvt_pk_bf16_f32 v52, v228, v229
    v_cvt_pk_bf16_f32 v53, v230, v231
    buffer_store_dwordx4 v[50:53], v17, s[16:19], s36 offen offset:2048
    buffer_load_dwordx4 a[104:107], v22, s[76:79], s48 offen offset:1024 sc1
    buffer_load_dwordx4 a[108:111], v22, s[76:79], s48 offen offset:1536 sc1
    s_waitcnt lgkmcnt(4)
    v_pk_add_f32 v[232:233], v[232:233], v[104:105]
    v_pk_add_f32 v[234:235], v[234:235], v[106:107]
    v_pk_add_f32 v[236:237], v[236:237], v[108:109]
    v_pk_add_f32 v[238:239], v[238:239], v[110:111]
    v_pk_mul_f32 v[232:233], v[232:233], v[12:13]
    v_pk_mul_f32 v[234:235], v[234:235], v[12:13]
    v_pk_mul_f32 v[236:237], v[236:237], v[12:13]
    v_pk_mul_f32 v[238:239], v[238:239], v[12:13]
    v_cvt_pk_bf16_f32 v54, v232, v233
    v_cvt_pk_bf16_f32 v55, v234, v235
    v_cvt_pk_bf16_f32 v56, v236, v237
    v_cvt_pk_bf16_f32 v57, v238, v239
    buffer_store_dwordx4 v[54:57], v17, s[16:19], s36 offen offset:2560
    buffer_load_dwordx4 a[112:115], v22, s[76:79], s48 offen offset:2048 sc1
    buffer_load_dwordx4 a[116:119], v22, s[76:79], s48 offen offset:2560 sc1
    s_waitcnt lgkmcnt(2)
    v_pk_add_f32 v[240:241], v[240:241], v[112:113]
    v_pk_add_f32 v[242:243], v[242:243], v[114:115]
    v_pk_add_f32 v[244:245], v[244:245], v[116:117]
    v_pk_add_f32 v[246:247], v[246:247], v[118:119]
    v_pk_mul_f32 v[240:241], v[240:241], v[12:13]
    v_pk_mul_f32 v[242:243], v[242:243], v[12:13]
    v_pk_mul_f32 v[244:245], v[244:245], v[12:13]
    v_pk_mul_f32 v[246:247], v[246:247], v[12:13]
    v_cvt_pk_bf16_f32 v50, v240, v241
    v_cvt_pk_bf16_f32 v51, v242, v243
    v_cvt_pk_bf16_f32 v52, v244, v245
    v_cvt_pk_bf16_f32 v53, v246, v247
    buffer_store_dwordx4 v[50:53], v17, s[16:19], s36 offen offset:3072
    buffer_load_dwordx4 a[120:123], v22, s[76:79], s48 offen offset:3072 sc1
    buffer_load_dwordx4 a[124:127], v22, s[76:79], s48 offen offset:3584 sc1
    s_waitcnt lgkmcnt(0)
    v_pk_add_f32 v[248:249], v[248:249], v[120:121]
    v_pk_add_f32 v[250:251], v[250:251], v[122:123]
    v_pk_add_f32 v[252:253], v[252:253], v[124:125]
    v_pk_add_f32 v[254:255], v[254:255], v[126:127]
    v_pk_mul_f32 v[248:249], v[248:249], v[12:13]
    v_pk_mul_f32 v[250:251], v[250:251], v[12:13]
    v_pk_mul_f32 v[252:253], v[252:253], v[12:13]
    v_pk_mul_f32 v[254:255], v[254:255], v[12:13]
    v_cvt_pk_bf16_f32 v54, v248, v249
    v_cvt_pk_bf16_f32 v55, v250, v251
    v_cvt_pk_bf16_f32 v56, v252, v253
    v_cvt_pk_bf16_f32 v57, v254, v255
    buffer_store_dwordx4 v[54:57], v17, s[16:19], s36 offen offset:3584
    s_cmp_eq_u32 s34, 0
    s_cbranch_scc0 FL_100028
RL_100030:
    s_cmp_eq_u32 s33, 0
    s_cbranch_scc0 FS_100027
RS_100029:
    s_branch AE_100031
FL_100028:
    s_waitcnt vmcnt(0)
    v_and_b32 v12, 0x3ff, v2
    v_lshrrev_b32 v231, 4, v12
    v_lshrrev_b32 v10, 5, v231
    v_and_b32 v231, 31, v231
    v_lshlrev_b32 v10, 2, v10
    v_sub_u32 v231, v231, v10
    v_mov_b32 v10, 0xff800000
    v_cmp_gt_i32 vcc, 0, v231
    s_nop 1
    v_cndmask_b32 v128, 0, v10, vcc
    v_cmp_gt_i32 vcc, 1, v231
    s_nop 1
    v_cndmask_b32 v129, 0, v10, vcc
    v_cmp_gt_i32 vcc, 2, v231
    s_nop 1
    v_cndmask_b32 v130, 0, v10, vcc
    v_cmp_gt_i32 vcc, 3, v231
    s_nop 1
    v_cndmask_b32 v131, 0, v10, vcc
    v_cmp_gt_i32 vcc, 16, v231
    s_nop 1
    v_cndmask_b32 v132, 0, v10, vcc
    v_cmp_gt_i32 vcc, 17, v231
    s_nop 1
    v_cndmask_b32 v133, 0, v10, vcc
    v_cmp_gt_i32 vcc, 18, v231
    s_nop 1
    v_cndmask_b32 v134, 0, v10, vcc
    v_cmp_gt_i32 vcc, 19, v231
    s_nop 1
    v_cndmask_b32 v135, 0, v10, vcc
    v_cmp_gt_i32 vcc, 8, v231
    s_nop 1
    v_cndmask_b32 v136, 0, v10, vcc
    v_cmp_gt_i32 vcc, 9, v231
    s_nop 1
    v_cndmask_b32 v137, 0, v10, vcc
    v_cmp_gt_i32 vcc, 10, v231
    s_nop 1
    v_cndmask_b32 v138, 0, v10, vcc
    v_cmp_gt_i32 vcc, 11, v231
    s_nop 1
    v_cndmask_b32 v139, 0, v10, vcc
    v_cmp_gt_i32 vcc, 24, v231
    s_nop 1
    v_cndmask_b32 v140, 0, v10, vcc
    v_cmp_gt_i32 vcc, 25, v231
    s_nop 1
    v_cndmask_b32 v141, 0, v10, vcc
    v_cmp_gt_i32 vcc, 26, v231
    s_nop 1
    v_cndmask_b32 v142, 0, v10, vcc
    v_cmp_gt_i32 vcc, 27, v231
    s_nop 1
    v_cndmask_b32 v143, 0, v10, vcc
    v_mov_b32 v164, 0
    v_mov_b32 v165, 0
    v_mov_b32 v166, 0
    v_mov_b32 v167, 0
    v_mov_b32 v168, 0
    v_mov_b32 v169, 0
    v_mov_b32 v170, 0
    v_mov_b32 v171, 0
    v_mov_b32 v172, 0
    v_mov_b32 v173, 0
    v_mov_b32 v174, 0
    v_mov_b32 v175, 0
    v_mov_b32 v176, 0
    v_mov_b32 v177, 0
    v_mov_b32 v178, 0
    v_mov_b32 v179, 0
    v_mov_b32 v180, 0
    v_mov_b32 v181, 0
    v_mov_b32 v182, 0
    v_mov_b32 v183, 0
    v_mov_b32 v184, 0
    v_mov_b32 v185, 0
    v_mov_b32 v186, 0
    v_mov_b32 v187, 0
    v_mov_b32 v188, 0
    v_mov_b32 v189, 0
    v_mov_b32 v190, 0
    v_mov_b32 v191, 0
    v_mov_b32 v192, 0
    v_mov_b32 v193, 0
    v_mov_b32 v194, 0
    v_mov_b32 v195, 0
    v_mov_b32 v196, 0
    v_mov_b32 v197, 0
    v_mov_b32 v198, 0
    v_mov_b32 v199, 0
    v_mov_b32 v200, 0
    v_mov_b32 v201, 0
    v_mov_b32 v202, 0
    v_mov_b32 v203, 0
    v_mov_b32 v204, 0
    v_mov_b32 v205, 0
    v_mov_b32 v206, 0
    v_mov_b32 v207, 0
    v_mov_b32 v208, 0
    v_mov_b32 v209, 0
    v_mov_b32 v210, 0
    v_mov_b32 v211, 0
    v_mov_b32 v212, 0
    v_mov_b32 v213, 0
    v_mov_b32 v214, 0
    v_mov_b32 v215, 0
    v_mov_b32 v216, 0
    v_mov_b32 v217, 0
    v_mov_b32 v218, 0
    v_mov_b32 v219, 0
    v_mov_b32 v220, 0
    v_mov_b32 v221, 0
    v_mov_b32 v222, 0
    v_mov_b32 v223, 0
    v_mov_b32 v224, 0
    v_mov_b32 v225, 0
    v_mov_b32 v226, 0
    v_mov_b32 v227, 0
    v_mov_b32 v228, 0xff800000
    v_mov_b32 v229, 0
    v_add_u32 v11, 4096, v12
    s_mov_b32 s52, 0
    s_waitcnt vmcnt(0)
FP_100032:
    s_lshr_b32 s53, s52, 1
    s_lshl_b32 s53, s53, 15
    s_and_b32 s54, s52, 1
    s_lshl_b32 s54, s54, 13
    s_add_u32 s53, s53, s54
    s_add_u32 s54, s53, 16384
    buffer_load_dwordx4 a[192:195], v12, s[4:7], s53 offen offset:0
    buffer_load_dwordx4 a[196:199], v12, s[4:7], s53 offen offset:1024
    buffer_load_dwordx4 a[200:203], v12, s[4:7], s53 offen offset:2048
    buffer_load_dwordx4 a[204:207], v12, s[4:7], s53 offen offset:3072
    buffer_load_dwordx4 a[208:211], v11, s[4:7], s53 offen offset:0
    buffer_load_dwordx4 a[212:215], v11, s[4:7], s53 offen offset:1024
    buffer_load_dwordx4 a[216:219], v11, s[4:7], s53 offen offset:2048
    buffer_load_dwordx4 a[220:223], v11, s[4:7], s53 offen offset:3072
    buffer_load_dwordx4 a[224:227], v12, s[4:7], s54 offen offset:0
    buffer_load_dwordx4 a[228:231], v12, s[4:7], s54 offen offset:1024
    buffer_load_dwordx4 a[232:235], v12, s[4:7], s54 offen offset:2048
    buffer_load_dwordx4 a[236:239], v12, s[4:7], s54 offen offset:3072
    buffer_load_dwordx4 a[240:243], v11, s[4:7], s54 offen offset:0
    buffer_load_dwordx4 a[244:247], v11, s[4:7], s54 offen offset:1024
    buffer_load_dwordx4 a[248:251], v11, s[4:7], s54 offen offset:2048
    buffer_load_dwordx4 a[252:255], v11, s[4:7], s54 offen offset:3072
    s_waitcnt vmcnt(8)
    s_cmp_eq_u32 s52, s32
    s_cbranch_scc1 FD_100033
    v_mfma_f32_32x32x16_bf16 v[32:47], a[192:195], v[64:67], 0
    s_branch FN_100034
FD_100033:
    v_mfma_f32_32x32x16_bf16 v[32:47], a[192:195], v[64:67], v[128:143]
FN_100034:
    v_mfma_f32_32x32x16_bf16 v[32:47], a[196:199], v[68:71], v[32:47]
    v_mfma_f32_32x32x16_bf16 v[32:47], a[200:203], v[72:75], v[32:47]
    v_mfma_f32_32x32x16_bf16 v[32:47], a[204:207], v[76:79], v[32:47]
    v_mfma_f32_32x32x16_bf16 v[32:47], a[208:211], v[80:83], v[32:47]
    v_mfma_f32_32x32x16_bf16 v[32:47], a[212:215], v[84:87], v[32:47]
    v_mfma_f32_32x32x16_bf16 v[32:47], a[216:219], v[88:91], v[32:47]
    v_mfma_f32_32x32x16_bf16 v[32:47], a[220:223], v[92:95], v[32:47]
    s_nop 7
    s_nop 7
    v_max_f32 v231, v32, v33
    v_max3_f32 v231, v231, v34, v35
    v_max3_f32 v231, v231, v36, v37
    v_max3_f32 v231, v231, v38, v39
    v_max3_f32 v231, v231, v40, v41
    v_max3_f32 v231, v231, v42, v43
    v_max3_f32 v231, v231, v44, v45
    v_max3_f32 v231, v231, v46, v47
    v_mov_b32 v10, v231
    s_nop 1
    v_permlane32_swap_b32 v231, v10
    s_nop 1
    v_max_f32 v231, v231, v10
    v_max_f32 v231, v231, v228
    v_sub_f32 v230, v228, v231
    v_exp_f32 v230, v230
    v_mov_b32 v228, v231
    v_sub_f32 v32, v32, v228
    v_sub_f32 v33, v33, v228
    v_sub_f32 v34, v34, v228
    v_sub_f32 v35, v35, v228
    v_sub_f32 v36, v36, v228
    v_sub_f32 v37, v37, v228
    v_sub_f32 v38, v38, v228
    v_sub_f32 v39, v39, v228
    v_sub_f32 v40, v40, v228
    v_sub_f32 v41, v41, v228
    v_sub_f32 v42, v42, v228
    v_sub_f32 v43, v43, v228
    v_sub_f32 v44, v44, v228
    v_sub_f32 v45, v45, v228
    v_sub_f32 v46, v46, v228
    v_sub_f32 v47, v47, v228
    v_exp_f32 v32, v32
    v_exp_f32 v33, v33
    v_exp_f32 v34, v34
    v_exp_f32 v35, v35
    v_exp_f32 v36, v36
    v_exp_f32 v37, v37
    v_exp_f32 v38, v38
    v_exp_f32 v39, v39
    v_exp_f32 v40, v40
    v_exp_f32 v41, v41
    v_exp_f32 v42, v42
    v_exp_f32 v43, v43
    v_exp_f32 v44, v44
    v_exp_f32 v45, v45
    v_exp_f32 v46, v46
    v_exp_f32 v47, v47
    v_mul_f32 v229, v229, v230
    v_add_f32 v229, v229, v32
    v_add_f32 v229, v229, v33
    v_add_f32 v229, v229, v34
    v_add_f32 v229, v229, v35
    v_add_f32 v229, v229, v36
    v_add_f32 v229, v229, v37
    v_add_f32 v229, v229, v38
    v_add_f32 v229, v229, v39
    v_add_f32 v229, v229, v40
    v_add_f32 v229, v229, v41
    v_add_f32 v229, v229, v42
    v_add_f32 v229, v229, v43
    v_add_f32 v229, v229, v44
    v_add_f32 v229, v229, v45
    v_add_f32 v229, v229, v46
    v_add_f32 v229, v229, v47
    v_cvt_pk_bf16_f32 v48, v32, v33
    v_cvt_pk_bf16_f32 v49, v34, v35
    v_cvt_pk_bf16_f32 v50, v36, v37
    v_cvt_pk_bf16_f32 v51, v38, v39
    v_cvt_pk_bf16_f32 v52, v40, v41
    v_cvt_pk_bf16_f32 v53, v42, v43
    v_cvt_pk_bf16_f32 v54, v44, v45
    v_cvt_pk_bf16_f32 v55, v46, v47
    v_mul_f32 v164, v164, v230
    v_mul_f32 v165, v165, v230
    v_mul_f32 v166, v166, v230
    v_mul_f32 v167, v167, v230
    v_mul_f32 v168, v168, v230
    v_mul_f32 v169, v169, v230
    v_mul_f32 v170, v170, v230
    v_mul_f32 v171, v171, v230
    v_mul_f32 v172, v172, v230
    v_mul_f32 v173, v173, v230
    v_mul_f32 v174, v174, v230
    v_mul_f32 v175, v175, v230
    v_mul_f32 v176, v176, v230
    v_mul_f32 v177, v177, v230
    v_mul_f32 v178, v178, v230
    v_mul_f32 v179, v179, v230
    v_mul_f32 v180, v180, v230
    v_mul_f32 v181, v181, v230
    v_mul_f32 v182, v182, v230
    v_mul_f32 v183, v183, v230
    v_mul_f32 v184, v184, v230
    v_mul_f32 v185, v185, v230
    v_mul_f32 v186, v186, v230
    v_mul_f32 v187, v187, v230
    v_mul_f32 v188, v188, v230
    v_mul_f32 v189, v189, v230
    v_mul_f32 v190, v190, v230
    v_mul_f32 v191, v191, v230
    v_mul_f32 v192, v192, v230
    v_mul_f32 v193, v193, v230
    v_mul_f32 v194, v194, v230
    v_mul_f32 v195, v195, v230
    v_mul_f32 v196, v196, v230
    v_mul_f32 v197, v197, v230
    v_mul_f32 v198, v198, v230
    v_mul_f32 v199, v199, v230
    v_mul_f32 v200, v200, v230
    v_mul_f32 v201, v201, v230
    v_mul_f32 v202, v202, v230
    v_mul_f32 v203, v203, v230
    v_mul_f32 v204, v204, v230
    v_mul_f32 v205, v205, v230
    v_mul_f32 v206, v206, v230
    v_mul_f32 v207, v207, v230
    v_mul_f32 v208, v208, v230
    v_mul_f32 v209, v209, v230
    v_mul_f32 v210, v210, v230
    v_mul_f32 v211, v211, v230
    v_mul_f32 v212, v212, v230
    v_mul_f32 v213, v213, v230
    v_mul_f32 v214, v214, v230
    v_mul_f32 v215, v215, v230
    v_mul_f32 v216, v216, v230
    v_mul_f32 v217, v217, v230
    v_mul_f32 v218, v218, v230
    v_mul_f32 v219, v219, v230
    v_mul_f32 v220, v220, v230
    v_mul_f32 v221, v221, v230
    v_mul_f32 v222, v222, v230
    v_mul_f32 v223, v223, v230
    v_mul_f32 v224, v224, v230
    v_mul_f32 v225, v225, v230
    v_mul_f32 v226, v226, v230
    v_mul_f32 v227, v227, v230
    s_waitcnt vmcnt(0)
    s_nop 1
    v_mfma_f32_32x32x16_bf16 v[164:179], a[224:227], v[48:51], v[164:179]
    v_mfma_f32_32x32x16_bf16 v[180:195], a[228:231], v[48:51], v[180:195]
    v_mfma_f32_32x32x16_bf16 v[196:211], a[232:235], v[48:51], v[196:211]
    v_mfma_f32_32x32x16_bf16 v[212:227], a[236:239], v[48:51], v[212:227]
    v_mfma_f32_32x32x16_bf16 v[164:179], a[240:243], v[52:55], v[164:179]
    v_mfma_f32_32x32x16_bf16 v[180:195], a[244:247], v[52:55], v[180:195]
    v_mfma_f32_32x32x16_bf16 v[196:211], a[248:251], v[52:55], v[196:211]
    v_mfma_f32_32x32x16_bf16 v[212:227], a[252:255], v[52:55], v[212:227]
    s_nop 7
    s_nop 7
    s_add_u32 s52, s52, 1
    s_cmp_le_u32 s52, s32
    s_cbranch_scc1 FP_100032
    v_mov_b32 v10, v229
    s_nop 1
    v_permlane32_swap_b32 v229, v10
    s_nop 1
    v_add_f32 v229, v229, v10
    v_rcp_f32 v229, v229
    s_nop 0
    v_mul_f32 v232, v164, v229
    v_mul_f32 v233, v165, v229
    v_mul_f32 v234, v166, v229
    v_mul_f32 v235, v167, v229
    v_mul_f32 v236, v168, v229
    v_mul_f32 v237, v169, v229
    v_mul_f32 v238, v170, v229
    v_mul_f32 v239, v171, v229
    v_cvt_pk_bf16_f32 v240, v232, v233
    v_cvt_pk_bf16_f32 v241, v234, v235
    v_cvt_pk_bf16_f32 v242, v236, v237
    v_cvt_pk_bf16_f32 v243, v238, v239
    buffer_store_dwordx4 v[240:243], v17, s[16:19], s36 offen offset:0
    v_mul_f32 v244, v172, v229
    v_mul_f32 v245, v173, v229
    v_mul_f32 v246, v174, v229
    v_mul_f32 v247, v175, v229
    v_mul_f32 v248, v176, v229
    v_mul_f32 v249, v177, v229
    v_mul_f32 v250, v178, v229
    v_mul_f32 v251, v179, v229
    v_cvt_pk_bf16_f32 v252, v244, v245
    v_cvt_pk_bf16_f32 v253, v246, v247
    v_cvt_pk_bf16_f32 v254, v248, v249
    v_cvt_pk_bf16_f32 v255, v250, v251
    buffer_store_dwordx4 v[252:255], v17, s[16:19], s36 offen offset:512
    v_mul_f32 v232, v180, v229
    v_mul_f32 v233, v181, v229
    v_mul_f32 v234, v182, v229
    v_mul_f32 v235, v183, v229
    v_mul_f32 v236, v184, v229
    v_mul_f32 v237, v185, v229
    v_mul_f32 v238, v186, v229
    v_mul_f32 v239, v187, v229
    v_cvt_pk_bf16_f32 v240, v232, v233
    v_cvt_pk_bf16_f32 v241, v234, v235
    v_cvt_pk_bf16_f32 v242, v236, v237
    v_cvt_pk_bf16_f32 v243, v238, v239
    buffer_store_dwordx4 v[240:243], v17, s[16:19], s36 offen offset:1024
    v_mul_f32 v244, v188, v229
    v_mul_f32 v245, v189, v229
    v_mul_f32 v246, v190, v229
    v_mul_f32 v247, v191, v229
    v_mul_f32 v248, v192, v229
    v_mul_f32 v249, v193, v229
    v_mul_f32 v250, v194, v229
    v_mul_f32 v251, v195, v229
    v_cvt_pk_bf16_f32 v252, v244, v245
    v_cvt_pk_bf16_f32 v253, v246, v247
    v_cvt_pk_bf16_f32 v254, v248, v249
    v_cvt_pk_bf16_f32 v255, v250, v251
    buffer_store_dwordx4 v[252:255], v17, s[16:19], s36 offen offset:1536
    v_mul_f32 v232, v196, v229
    v_mul_f32 v233, v197, v229
    v_mul_f32 v234, v198, v229
    v_mul_f32 v235, v199, v229
    v_mul_f32 v236, v200, v229
    v_mul_f32 v237, v201, v229
    v_mul_f32 v238, v202, v229
    v_mul_f32 v239, v203, v229
    v_cvt_pk_bf16_f32 v240, v232, v233
    v_cvt_pk_bf16_f32 v241, v234, v235
    v_cvt_pk_bf16_f32 v242, v236, v237
    v_cvt_pk_bf16_f32 v243, v238, v239
    buffer_store_dwordx4 v[240:243], v17, s[16:19], s36 offen offset:2048
    v_mul_f32 v244, v204, v229
    v_mul_f32 v245, v205, v229
    v_mul_f32 v246, v206, v229
    v_mul_f32 v247, v207, v229
    v_mul_f32 v248, v208, v229
    v_mul_f32 v249, v209, v229
    v_mul_f32 v250, v210, v229
    v_mul_f32 v251, v211, v229
    v_cvt_pk_bf16_f32 v252, v244, v245
    v_cvt_pk_bf16_f32 v253, v246, v247
    v_cvt_pk_bf16_f32 v254, v248, v249
    v_cvt_pk_bf16_f32 v255, v250, v251
    buffer_store_dwordx4 v[252:255], v17, s[16:19], s36 offen offset:2560
    v_mul_f32 v232, v212, v229
    v_mul_f32 v233, v213, v229
    v_mul_f32 v234, v214, v229
    v_mul_f32 v235, v215, v229
    v_mul_f32 v236, v216, v229
    v_mul_f32 v237, v217, v229
    v_mul_f32 v238, v218, v229
    v_mul_f32 v239, v219, v229
    v_cvt_pk_bf16_f32 v240, v232, v233
    v_cvt_pk_bf16_f32 v241, v234, v235
    v_cvt_pk_bf16_f32 v242, v236, v237
    v_cvt_pk_bf16_f32 v243, v238, v239
    buffer_store_dwordx4 v[240:243], v17, s[16:19], s36 offen offset:3072
    v_mul_f32 v244, v220, v229
    v_mul_f32 v245, v221, v229
    v_mul_f32 v246, v222, v229
    v_mul_f32 v247, v223, v229
    v_mul_f32 v248, v224, v229
    v_mul_f32 v249, v225, v229
    v_mul_f32 v250, v226, v229
    v_mul_f32 v251, v227, v229
    v_cvt_pk_bf16_f32 v252, v244, v245
    v_cvt_pk_bf16_f32 v253, v246, v247
    v_cvt_pk_bf16_f32 v254, v248, v249
    v_cvt_pk_bf16_f32 v255, v250, v251
    buffer_store_dwordx4 v[252:255], v17, s[16:19], s36 offen offset:3584
    s_branch RL_100030
FS_100027:
    s_waitcnt vmcnt(0)
    v_and_b32 v12, 0x3ff, v2
    s_lshl_b32 s53, s2, 15
    s_lshl_b32 s54, s20, 13
    s_add_u32 s53, s53, s54
    s_add_u32 s54, s53, 4096
    buffer_load_dwordx4 v[64:67], v12, s[56:59], s53 offen offset:0 sc1
    buffer_load_dwordx4 v[68:71], v12, s[56:59], s53 offen offset:1024 sc1
    buffer_load_dwordx4 v[72:75], v12, s[56:59], s53 offen offset:2048 sc1
    buffer_load_dwordx4 v[76:79], v12, s[56:59], s53 offen offset:3072 sc1
    buffer_load_dwordx4 v[80:83], v12, s[56:59], s54 offen offset:0 sc1
    buffer_load_dwordx4 v[84:87], v12, s[56:59], s54 offen offset:1024 sc1
    buffer_load_dwordx4 v[88:91], v12, s[56:59], s54 offen offset:2048 sc1
    buffer_load_dwordx4 v[92:95], v12, s[56:59], s54 offen offset:3072 sc1
    v_lshrrev_b32 v231, 4, v12
    v_lshrrev_b32 v10, 5, v231
    v_and_b32 v231, 31, v231
    v_lshlrev_b32 v10, 2, v10
    v_sub_u32 v231, v231, v10
    v_mov_b32 v10, 0xff800000
    v_cmp_gt_i32 vcc, 0, v231
    s_nop 1
    v_cndmask_b32 v128, 0, v10, vcc
    v_cmp_gt_i32 vcc, 1, v231
    s_nop 1
    v_cndmask_b32 v129, 0, v10, vcc
    v_cmp_gt_i32 vcc, 2, v231
    s_nop 1
    v_cndmask_b32 v130, 0, v10, vcc
    v_cmp_gt_i32 vcc, 3, v231
    s_nop 1
    v_cndmask_b32 v131, 0, v10, vcc
    v_cmp_gt_i32 vcc, 16, v231
    s_nop 1
    v_cndmask_b32 v132, 0, v10, vcc
    v_cmp_gt_i32 vcc, 17, v231
    s_nop 1
    v_cndmask_b32 v133, 0, v10, vcc
    v_cmp_gt_i32 vcc, 18, v231
    s_nop 1
    v_cndmask_b32 v134, 0, v10, vcc
    v_cmp_gt_i32 vcc, 19, v231
    s_nop 1
    v_cndmask_b32 v135, 0, v10, vcc
    v_cmp_gt_i32 vcc, 8, v231
    s_nop 1
    v_cndmask_b32 v136, 0, v10, vcc
    v_cmp_gt_i32 vcc, 9, v231
    s_nop 1
    v_cndmask_b32 v137, 0, v10, vcc
    v_cmp_gt_i32 vcc, 10, v231
    s_nop 1
    v_cndmask_b32 v138, 0, v10, vcc
    v_cmp_gt_i32 vcc, 11, v231
    s_nop 1
    v_cndmask_b32 v139, 0, v10, vcc
    v_cmp_gt_i32 vcc, 24, v231
    s_nop 1
    v_cndmask_b32 v140, 0, v10, vcc
    v_cmp_gt_i32 vcc, 25, v231
    s_nop 1
    v_cndmask_b32 v141, 0, v10, vcc
    v_cmp_gt_i32 vcc, 26, v231
    s_nop 1
    v_cndmask_b32 v142, 0, v10, vcc
    v_cmp_gt_i32 vcc, 27, v231
    s_nop 1
    v_cndmask_b32 v143, 0, v10, vcc
    v_mov_b32 v164, 0
    v_mov_b32 v165, 0
    v_mov_b32 v166, 0
    v_mov_b32 v167, 0
    v_mov_b32 v168, 0
    v_mov_b32 v169, 0
    v_mov_b32 v170, 0
    v_mov_b32 v171, 0
    v_mov_b32 v172, 0
    v_mov_b32 v173, 0
    v_mov_b32 v174, 0
    v_mov_b32 v175, 0
    v_mov_b32 v176, 0
    v_mov_b32 v177, 0
    v_mov_b32 v178, 0
    v_mov_b32 v179, 0
    v_mov_b32 v180, 0
    v_mov_b32 v181, 0
    v_mov_b32 v182, 0
    v_mov_b32 v183, 0
    v_mov_b32 v184, 0
    v_mov_b32 v185, 0
    v_mov_b32 v186, 0
    v_mov_b32 v187, 0
    v_mov_b32 v188, 0
    v_mov_b32 v189, 0
    v_mov_b32 v190, 0
    v_mov_b32 v191, 0
    v_mov_b32 v192, 0
    v_mov_b32 v193, 0
    v_mov_b32 v194, 0
    v_mov_b32 v195, 0
    v_mov_b32 v196, 0
    v_mov_b32 v197, 0
    v_mov_b32 v198, 0
    v_mov_b32 v199, 0
    v_mov_b32 v200, 0
    v_mov_b32 v201, 0
    v_mov_b32 v202, 0
    v_mov_b32 v203, 0
    v_mov_b32 v204, 0
    v_mov_b32 v205, 0
    v_mov_b32 v206, 0
    v_mov_b32 v207, 0
    v_mov_b32 v208, 0
    v_mov_b32 v209, 0
    v_mov_b32 v210, 0
    v_mov_b32 v211, 0
    v_mov_b32 v212, 0
    v_mov_b32 v213, 0
    v_mov_b32 v214, 0
    v_mov_b32 v215, 0
    v_mov_b32 v216, 0
    v_mov_b32 v217, 0
    v_mov_b32 v218, 0
    v_mov_b32 v219, 0
    v_mov_b32 v220, 0
    v_mov_b32 v221, 0
    v_mov_b32 v222, 0
    v_mov_b32 v223, 0
    v_mov_b32 v224, 0
    v_mov_b32 v225, 0
    v_mov_b32 v226, 0
    v_mov_b32 v227, 0
    v_mov_b32 v228, 0xff800000
    v_mov_b32 v229, 0
    v_add_u32 v11, 4096, v12
    s_mov_b32 s52, 0
    s_waitcnt vmcnt(0)
FP_100035:
    s_lshr_b32 s53, s52, 1
    s_lshl_b32 s53, s53, 15
    s_and_b32 s54, s52, 1
    s_lshl_b32 s54, s54, 13
    s_add_u32 s53, s53, s54
    s_add_u32 s54, s53, 16384
    buffer_load_dwordx4 a[192:195], v12, s[4:7], s53 offen offset:0
    buffer_load_dwordx4 a[196:199], v12, s[4:7], s53 offen offset:1024
    buffer_load_dwordx4 a[200:203], v12, s[4:7], s53 offen offset:2048
    buffer_load_dwordx4 a[204:207], v12, s[4:7], s53 offen offset:3072
    buffer_load_dwordx4 a[208:211], v11, s[4:7], s53 offen offset:0
    buffer_load_dwordx4 a[212:215], v11, s[4:7], s53 offen offset:1024
    buffer_load_dwordx4 a[216:219], v11, s[4:7], s53 offen offset:2048
    buffer_load_dwordx4 a[220:223], v11, s[4:7], s53 offen offset:3072
    buffer_load_dwordx4 a[224:227], v12, s[4:7], s54 offen offset:0
    buffer_load_dwordx4 a[228:231], v12, s[4:7], s54 offen offset:1024
    buffer_load_dwordx4 a[232:235], v12, s[4:7], s54 offen offset:2048
    buffer_load_dwordx4 a[236:239], v12, s[4:7], s54 offen offset:3072
    buffer_load_dwordx4 a[240:243], v11, s[4:7], s54 offen offset:0
    buffer_load_dwordx4 a[244:247], v11, s[4:7], s54 offen offset:1024
    buffer_load_dwordx4 a[248:251], v11, s[4:7], s54 offen offset:2048
    buffer_load_dwordx4 a[252:255], v11, s[4:7], s54 offen offset:3072
    s_waitcnt vmcnt(8)
    s_cmp_eq_u32 s52, s31
    s_cbranch_scc1 FD_100036
    v_mfma_f32_32x32x16_bf16 v[32:47], a[192:195], v[64:67], 0
    s_branch FN_100037
FD_100036:
    v_mfma_f32_32x32x16_bf16 v[32:47], a[192:195], v[64:67], v[128:143]
FN_100037:
    v_mfma_f32_32x32x16_bf16 v[32:47], a[196:199], v[68:71], v[32:47]
    v_mfma_f32_32x32x16_bf16 v[32:47], a[200:203], v[72:75], v[32:47]
    v_mfma_f32_32x32x16_bf16 v[32:47], a[204:207], v[76:79], v[32:47]
    v_mfma_f32_32x32x16_bf16 v[32:47], a[208:211], v[80:83], v[32:47]
    v_mfma_f32_32x32x16_bf16 v[32:47], a[212:215], v[84:87], v[32:47]
    v_mfma_f32_32x32x16_bf16 v[32:47], a[216:219], v[88:91], v[32:47]
    v_mfma_f32_32x32x16_bf16 v[32:47], a[220:223], v[92:95], v[32:47]
    s_nop 7
    s_nop 7
    v_max_f32 v231, v32, v33
    v_max3_f32 v231, v231, v34, v35
    v_max3_f32 v231, v231, v36, v37
    v_max3_f32 v231, v231, v38, v39
    v_max3_f32 v231, v231, v40, v41
    v_max3_f32 v231, v231, v42, v43
    v_max3_f32 v231, v231, v44, v45
    v_max3_f32 v231, v231, v46, v47
    v_mov_b32 v10, v231
    s_nop 1
    v_permlane32_swap_b32 v231, v10
    s_nop 1
    v_max_f32 v231, v231, v10
    v_max_f32 v231, v231, v228
    v_sub_f32 v230, v228, v231
    v_exp_f32 v230, v230
    v_mov_b32 v228, v231
    v_sub_f32 v32, v32, v228
    v_sub_f32 v33, v33, v228
    v_sub_f32 v34, v34, v228
    v_sub_f32 v35, v35, v228
    v_sub_f32 v36, v36, v228
    v_sub_f32 v37, v37, v228
    v_sub_f32 v38, v38, v228
    v_sub_f32 v39, v39, v228
    v_sub_f32 v40, v40, v228
    v_sub_f32 v41, v41, v228
    v_sub_f32 v42, v42, v228
    v_sub_f32 v43, v43, v228
    v_sub_f32 v44, v44, v228
    v_sub_f32 v45, v45, v228
    v_sub_f32 v46, v46, v228
    v_sub_f32 v47, v47, v228
    v_exp_f32 v32, v32
    v_exp_f32 v33, v33
    v_exp_f32 v34, v34
    v_exp_f32 v35, v35
    v_exp_f32 v36, v36
    v_exp_f32 v37, v37
    v_exp_f32 v38, v38
    v_exp_f32 v39, v39
    v_exp_f32 v40, v40
    v_exp_f32 v41, v41
    v_exp_f32 v42, v42
    v_exp_f32 v43, v43
    v_exp_f32 v44, v44
    v_exp_f32 v45, v45
    v_exp_f32 v46, v46
    v_exp_f32 v47, v47
    v_mul_f32 v229, v229, v230
    v_add_f32 v229, v229, v32
    v_add_f32 v229, v229, v33
    v_add_f32 v229, v229, v34
    v_add_f32 v229, v229, v35
    v_add_f32 v229, v229, v36
    v_add_f32 v229, v229, v37
    v_add_f32 v229, v229, v38
    v_add_f32 v229, v229, v39
    v_add_f32 v229, v229, v40
    v_add_f32 v229, v229, v41
    v_add_f32 v229, v229, v42
    v_add_f32 v229, v229, v43
    v_add_f32 v229, v229, v44
    v_add_f32 v229, v229, v45
    v_add_f32 v229, v229, v46
    v_add_f32 v229, v229, v47
    v_cvt_pk_bf16_f32 v48, v32, v33
    v_cvt_pk_bf16_f32 v49, v34, v35
    v_cvt_pk_bf16_f32 v50, v36, v37
    v_cvt_pk_bf16_f32 v51, v38, v39
    v_cvt_pk_bf16_f32 v52, v40, v41
    v_cvt_pk_bf16_f32 v53, v42, v43
    v_cvt_pk_bf16_f32 v54, v44, v45
    v_cvt_pk_bf16_f32 v55, v46, v47
    v_mul_f32 v164, v164, v230
    v_mul_f32 v165, v165, v230
    v_mul_f32 v166, v166, v230
    v_mul_f32 v167, v167, v230
    v_mul_f32 v168, v168, v230
    v_mul_f32 v169, v169, v230
    v_mul_f32 v170, v170, v230
    v_mul_f32 v171, v171, v230
    v_mul_f32 v172, v172, v230
    v_mul_f32 v173, v173, v230
    v_mul_f32 v174, v174, v230
    v_mul_f32 v175, v175, v230
    v_mul_f32 v176, v176, v230
    v_mul_f32 v177, v177, v230
    v_mul_f32 v178, v178, v230
    v_mul_f32 v179, v179, v230
    v_mul_f32 v180, v180, v230
    v_mul_f32 v181, v181, v230
    v_mul_f32 v182, v182, v230
    v_mul_f32 v183, v183, v230
    v_mul_f32 v184, v184, v230
    v_mul_f32 v185, v185, v230
    v_mul_f32 v186, v186, v230
    v_mul_f32 v187, v187, v230
    v_mul_f32 v188, v188, v230
    v_mul_f32 v189, v189, v230
    v_mul_f32 v190, v190, v230
    v_mul_f32 v191, v191, v230
    v_mul_f32 v192, v192, v230
    v_mul_f32 v193, v193, v230
    v_mul_f32 v194, v194, v230
    v_mul_f32 v195, v195, v230
    v_mul_f32 v196, v196, v230
    v_mul_f32 v197, v197, v230
    v_mul_f32 v198, v198, v230
    v_mul_f32 v199, v199, v230
    v_mul_f32 v200, v200, v230
    v_mul_f32 v201, v201, v230
    v_mul_f32 v202, v202, v230
    v_mul_f32 v203, v203, v230
    v_mul_f32 v204, v204, v230
    v_mul_f32 v205, v205, v230
    v_mul_f32 v206, v206, v230
    v_mul_f32 v207, v207, v230
    v_mul_f32 v208, v208, v230
    v_mul_f32 v209, v209, v230
    v_mul_f32 v210, v210, v230
    v_mul_f32 v211, v211, v230
    v_mul_f32 v212, v212, v230
    v_mul_f32 v213, v213, v230
    v_mul_f32 v214, v214, v230
    v_mul_f32 v215, v215, v230
    v_mul_f32 v216, v216, v230
    v_mul_f32 v217, v217, v230
    v_mul_f32 v218, v218, v230
    v_mul_f32 v219, v219, v230
    v_mul_f32 v220, v220, v230
    v_mul_f32 v221, v221, v230
    v_mul_f32 v222, v222, v230
    v_mul_f32 v223, v223, v230
    v_mul_f32 v224, v224, v230
    v_mul_f32 v225, v225, v230
    v_mul_f32 v226, v226, v230
    v_mul_f32 v227, v227, v230
    s_waitcnt vmcnt(0)
    s_nop 1
    v_mfma_f32_32x32x16_bf16 v[164:179], a[224:227], v[48:51], v[164:179]
    v_mfma_f32_32x32x16_bf16 v[180:195], a[228:231], v[48:51], v[180:195]
    v_mfma_f32_32x32x16_bf16 v[196:211], a[232:235], v[48:51], v[196:211]
    v_mfma_f32_32x32x16_bf16 v[212:227], a[236:239], v[48:51], v[212:227]
    v_mfma_f32_32x32x16_bf16 v[164:179], a[240:243], v[52:55], v[164:179]
    v_mfma_f32_32x32x16_bf16 v[180:195], a[244:247], v[52:55], v[180:195]
    v_mfma_f32_32x32x16_bf16 v[196:211], a[248:251], v[52:55], v[196:211]
    v_mfma_f32_32x32x16_bf16 v[212:227], a[252:255], v[52:55], v[212:227]
    s_nop 7
    s_nop 7
    s_add_u32 s52, s52, 1
    s_cmp_le_u32 s52, s31
    s_cbranch_scc1 FP_100035
    v_mov_b32 v10, v229
    s_nop 1
    v_permlane32_swap_b32 v229, v10
    s_nop 1
    v_add_f32 v229, v229, v10
    v_rcp_f32 v229, v229
    s_nop 0
    v_mul_f32 v232, v164, v229
    v_mul_f32 v233, v165, v229
    v_mul_f32 v234, v166, v229
    v_mul_f32 v235, v167, v229
    v_mul_f32 v236, v168, v229
    v_mul_f32 v237, v169, v229
    v_mul_f32 v238, v170, v229
    v_mul_f32 v239, v171, v229
    v_cvt_pk_bf16_f32 v240, v232, v233
    v_cvt_pk_bf16_f32 v241, v234, v235
    v_cvt_pk_bf16_f32 v242, v236, v237
    v_cvt_pk_bf16_f32 v243, v238, v239
    buffer_store_dwordx4 v[240:243], v16, s[16:19], s36 offen offset:0
    v_mul_f32 v244, v172, v229
    v_mul_f32 v245, v173, v229
    v_mul_f32 v246, v174, v229
    v_mul_f32 v247, v175, v229
    v_mul_f32 v248, v176, v229
    v_mul_f32 v249, v177, v229
    v_mul_f32 v250, v178, v229
    v_mul_f32 v251, v179, v229
    v_cvt_pk_bf16_f32 v252, v244, v245
    v_cvt_pk_bf16_f32 v253, v246, v247
    v_cvt_pk_bf16_f32 v254, v248, v249
    v_cvt_pk_bf16_f32 v255, v250, v251
    buffer_store_dwordx4 v[252:255], v16, s[16:19], s36 offen offset:512
    v_mul_f32 v232, v180, v229
    v_mul_f32 v233, v181, v229
    v_mul_f32 v234, v182, v229
    v_mul_f32 v235, v183, v229
    v_mul_f32 v236, v184, v229
    v_mul_f32 v237, v185, v229
    v_mul_f32 v238, v186, v229
    v_mul_f32 v239, v187, v229
    v_cvt_pk_bf16_f32 v240, v232, v233
    v_cvt_pk_bf16_f32 v241, v234, v235
    v_cvt_pk_bf16_f32 v242, v236, v237
    v_cvt_pk_bf16_f32 v243, v238, v239
    buffer_store_dwordx4 v[240:243], v16, s[16:19], s36 offen offset:1024
    v_mul_f32 v244, v188, v229
    v_mul_f32 v245, v189, v229
    v_mul_f32 v246, v190, v229
    v_mul_f32 v247, v191, v229
    v_mul_f32 v248, v192, v229
    v_mul_f32 v249, v193, v229
    v_mul_f32 v250, v194, v229
    v_mul_f32 v251, v195, v229
    v_cvt_pk_bf16_f32 v252, v244, v245
    v_cvt_pk_bf16_f32 v253, v246, v247
    v_cvt_pk_bf16_f32 v254, v248, v249
    v_cvt_pk_bf16_f32 v255, v250, v251
    buffer_store_dwordx4 v[252:255], v16, s[16:19], s36 offen offset:1536
    v_mul_f32 v232, v196, v229
    v_mul_f32 v233, v197, v229
    v_mul_f32 v234, v198, v229
    v_mul_f32 v235, v199, v229
    v_mul_f32 v236, v200, v229
    v_mul_f32 v237, v201, v229
    v_mul_f32 v238, v202, v229
    v_mul_f32 v239, v203, v229
    v_cvt_pk_bf16_f32 v240, v232, v233
    v_cvt_pk_bf16_f32 v241, v234, v235
    v_cvt_pk_bf16_f32 v242, v236, v237
    v_cvt_pk_bf16_f32 v243, v238, v239
    buffer_store_dwordx4 v[240:243], v16, s[16:19], s36 offen offset:2048
    v_mul_f32 v244, v204, v229
    v_mul_f32 v245, v205, v229
    v_mul_f32 v246, v206, v229
    v_mul_f32 v247, v207, v229
    v_mul_f32 v248, v208, v229
    v_mul_f32 v249, v209, v229
    v_mul_f32 v250, v210, v229
    v_mul_f32 v251, v211, v229
    v_cvt_pk_bf16_f32 v252, v244, v245
    v_cvt_pk_bf16_f32 v253, v246, v247
    v_cvt_pk_bf16_f32 v254, v248, v249
    v_cvt_pk_bf16_f32 v255, v250, v251
    buffer_store_dwordx4 v[252:255], v16, s[16:19], s36 offen offset:2560
    v_mul_f32 v232, v212, v229
    v_mul_f32 v233, v213, v229
    v_mul_f32 v234, v214, v229
    v_mul_f32 v235, v215, v229
    v_mul_f32 v236, v216, v229
    v_mul_f32 v237, v217, v229
    v_mul_f32 v238, v218, v229
    v_mul_f32 v239, v219, v229
    v_cvt_pk_bf16_f32 v240, v232, v233
    v_cvt_pk_bf16_f32 v241, v234, v235
    v_cvt_pk_bf16_f32 v242, v236, v237
    v_cvt_pk_bf16_f32 v243, v238, v239
    buffer_store_dwordx4 v[240:243], v16, s[16:19], s36 offen offset:3072
    v_mul_f32 v244, v220, v229
    v_mul_f32 v245, v221, v229
    v_mul_f32 v246, v222, v229
    v_mul_f32 v247, v223, v229
    v_mul_f32 v248, v224, v229
    v_mul_f32 v249, v225, v229
    v_mul_f32 v250, v226, v229
    v_mul_f32 v251, v227, v229
    v_cvt_pk_bf16_f32 v252, v244, v245
    v_cvt_pk_bf16_f32 v253, v246, v247
    v_cvt_pk_bf16_f32 v254, v248, v249
    v_cvt_pk_bf16_f32 v255, v250, v251
    buffer_store_dwordx4 v[252:255], v16, s[16:19], s36 offen offset:3584
    s_branch RS_100029
AE_100031:
    s_cmp_ge_u32 s2, 224
    s_cbranch_scc1 G3X_100038
    v_mbcnt_lo_u32_b32 v11, -1, 0
    v_mbcnt_hi_u32_b32 v11, -1, v11
    v_and_b32 v12, 15, v11
    v_lshrrev_b32 v13, 4, v11
    v_lshrrev_b32 v9, 5, v11
    v_lshrrev_b32 v14, 2, v12
    v_lshl_add_u32 v15, v9, 3, v14
    v_lshlrev_b32 v15, 8, v15
    v_and_b32 v16, 1, v13
    v_lshl_add_u32 v15, v16, 5, v15
    v_and_b32 v16, 3, v12
    v_lshl_add_u32 v15, v16, 3, v15
    v_add_u32 v15, 65536, v15
    s_add_u32 s31, s20, 0
    s_and_b32 s31, s31, 3
    v_xor_b32 v16, s31, v14
    v_lshl_add_u32 v24, v16, 6, v15
    s_add_u32 s32, s20, 1
    s_and_b32 s32, s32, 3
    v_xor_b32 v16, s32, v14
    v_lshl_add_u32 v25, v16, 6, v15
    s_add_u32 s33, s20, 2
    s_and_b32 s33, s33, 3
    v_xor_b32 v16, s33, v14
    v_lshl_add_u32 v26, v16, 6, v15
    s_add_u32 s34, s20, 3
    s_and_b32 s34, s34, 3
    v_xor_b32 v16, s34, v14
    v_lshl_add_u32 v27, v16, 6, v15
    v_mov_b32 v28, 0x3f803f80
    v_mov_b32 v29, 0x3f803f80
    v_mov_b32 v30, 0x3f803f80
    v_mov_b32 v31, 0x3f803f80
    v_and_b32 v16, 31, v11
    v_add_u32 v16, s89, v16
    v_lshrrev_b32 v17, 4, v16
    v_mul_u32_u24 v17, 57344, v17
    v_and_b32 v16, 15, v16
    v_lshl_add_u32 v17, v16, 4, v17
    v_lshl_add_u32 v2, v9, 8, v17
    s_waitcnt vmcnt(43)
    s_barrier
    ds_read_b64_tr_b16 a[176:177], v24 offset:0
    ds_read_b64_tr_b16 a[178:179], v24 offset:1024
    ds_read_b64_tr_b16 a[180:181], v25 offset:0
    ds_read_b64_tr_b16 a[182:183], v25 offset:1024
    ds_read_b64_tr_b16 a[184:185], v24 offset:4096
    ds_read_b64_tr_b16 a[186:187], v24 offset:5120
    ds_read_b64_tr_b16 a[188:189], v25 offset:4096
    ds_read_b64_tr_b16 a[190:191], v25 offset:5120
    ds_read_b64_tr_b16 a[192:193], v24 offset:8192
    ds_read_b64_tr_b16 a[194:195], v24 offset:9216
    ds_read_b64_tr_b16 a[196:197], v25 offset:8192
    ds_read_b64_tr_b16 a[198:199], v25 offset:9216
    ds_read_b64_tr_b16 a[200:201], v24 offset:12288
    ds_read_b64_tr_b16 a[202:203], v24 offset:13312
    ds_read_b64_tr_b16 a[204:205], v25 offset:12288
    ds_read_b64_tr_b16 a[206:207], v25 offset:13312
    s_waitcnt lgkmcnt(12)
    s_waitcnt vmcnt(37)
    s_barrier
    v_mfma_f32_32x32x16_bf16 v[128:143], a[176:179], a[0:3], 0
    ds_read_b64_tr_b16 a[208:209], v24 offset:16384
    ds_read_b64_tr_b16 a[210:211], v24 offset:17408
    s_add_u32 m0, s30, 0
    s_mov_b32 s49, 1146880
    buffer_load_dwordx4 v0, s[80:83], s49 offen lds
    v_mfma_f32_32x32x16_bf16 v[144:159], a[180:183], a[0:3], 0
    ds_read_b64_tr_b16 a[212:213], v25 offset:16384
    ds_read_b64_tr_b16 a[214:215], v25 offset:17408
    s_add_u32 m0, s30, 1024
    s_mov_b32 s49, 1161216
    buffer_load_dwordx4 v0, s[80:83], s49 offen lds
    v_mfma_f32_32x32x16_bf16 v[192:207], a[176:179], v[28:31], 0
    s_waitcnt lgkmcnt(12)
    v_mfma_f32_32x32x16_bf16 v[128:143], a[184:187], a[4:7], v[128:143]
    ds_read_b64_tr_b16 a[216:217], v24 offset:20480
    ds_read_b64_tr_b16 a[218:219], v24 offset:21504
    s_add_u32 m0, s30, 2048
    s_mov_b32 s49, 1175552
    buffer_load_dwordx4 v0, s[80:83], s49 offen lds
    v_mov_b32 v54, 0xc0135761
    v_mov_b32 v55, 0xc0135761
    v_mfma_f32_32x32x16_bf16 v[144:159], a[188:191], a[4:7], v[144:159]
    ds_read_b64_tr_b16 a[220:221], v25 offset:20480
    ds_read_b64_tr_b16 a[222:223], v25 offset:21504
    s_add_u32 m0, s30, 3072
    s_mov_b32 s49, 1189888
    buffer_load_dwordx4 v0, s[80:83], s49 offen lds
    v_mov_b32 v56, 0xbdd2d3e8
    v_mov_b32 v57, 0xbdd2d3e8
    v_mfma_f32_32x32x16_bf16 v[192:207], a[184:187], v[28:31], v[192:207]
    s_lshl_b32 s55, s20, 7
    s_add_u32 s55, s55, 131072
    s_waitcnt lgkmcnt(12)
    v_mfma_f32_32x32x16_bf16 v[128:143], a[192:195], a[8:11], v[128:143]
    ds_read_b64_tr_b16 a[224:225], v24 offset:24576
    ds_read_b64_tr_b16 a[226:227], v24 offset:25600
    s_add_u32 m0, s30, 16384
    s_mov_b32 s49, 1376256
    buffer_load_dwordx4 v0, s[80:83], s49 offen lds
    v_lshlrev_b32 v16, 6, v9
    v_add_u32 v17, s55, v16
    v_mfma_f32_32x32x16_bf16 v[144:159], a[196:199], a[8:11], v[144:159]
    ds_read_b64_tr_b16 a[228:229], v25 offset:24576
    ds_read_b64_tr_b16 a[230:231], v25 offset:25600
    s_add_u32 m0, s30, 17408
    s_mov_b32 s49, 1390592
    buffer_load_dwordx4 v0, s[80:83], s49 offen lds
    s_lshl_b32 s55, s32, 7
    s_add_u32 s55, s55, 131072
    v_mfma_f32_32x32x16_bf16 v[192:207], a[192:195], v[28:31], v[192:207]
    v_add_u32 v18, s55, v16
    s_lshl_b32 s55, s33, 7
    s_waitcnt lgkmcnt(12)
    v_mfma_f32_32x32x16_bf16 v[128:143], a[200:203], a[12:15], v[128:143]
    ds_read_b64_tr_b16 a[232:233], v24 offset:28672
    ds_read_b64_tr_b16 a[234:235], v24 offset:29696
    s_add_u32 m0, s30, 18432
    s_mov_b32 s49, 1404928
    buffer_load_dwordx4 v0, s[80:83], s49 offen lds
    s_add_u32 s55, s55, 131072
    v_add_u32 v19, s55, v16
    v_mfma_f32_32x32x16_bf16 v[144:159], a[204:207], a[12:15], v[144:159]
    ds_read_b64_tr_b16 a[236:237], v25 offset:28672
    ds_read_b64_tr_b16 a[238:239], v25 offset:29696
    s_add_u32 m0, s30, 19456
    s_mov_b32 s49, 1419264
    buffer_load_dwordx4 v0, s[80:83], s49 offen lds
    s_lshl_b32 s55, s34, 7
    s_add_u32 s55, s55, 131072
    v_mfma_f32_32x32x16_bf16 v[192:207], a[200:203], v[28:31], v[192:207]
    v_add_u32 v20, s55, v16
    s_add_u32 s31, s31, s90
    s_waitcnt lgkmcnt(12)
    s_waitcnt vmcnt(39)
    s_barrier
    v_mfma_f32_32x32x16_bf16 v[128:143], a[208:211], a[16:19], v[128:143]
    ds_read_b64_tr_b16 a[240:241], v24 offset:32768
    ds_read_b64_tr_b16 a[242:243], v24 offset:33792
    s_add_u32 m0, s30, 32768
    s_mov_b32 s49, 1605632
    buffer_load_dwordx4 v0, s[80:83], s49 offen lds
    s_lshl_b32 s31, s31, 10
    s_add_u32 s31, s31, 0x400000
    v_mfma_f32_32x32x16_bf16 v[144:159], a[212:215], a[16:19], v[144:159]
    ds_read_b64_tr_b16 a[244:245], v25 offset:32768
    ds_read_b64_tr_b16 a[246:247], v25 offset:33792
    s_add_u32 m0, s30, 33792
    s_mov_b32 s49, 1619968
    buffer_load_dwordx4 v0, s[80:83], s49 offen lds
    s_add_u32 s32, s32, s90
    s_lshl_b32 s32, s32, 10
    v_mfma_f32_32x32x16_bf16 v[192:207], a[208:211], v[28:31], v[192:207]
    s_add_u32 s32, s32, 0x400000
    s_add_u32 s33, s33, s90
    s_waitcnt lgkmcnt(12)
    v_mfma_f32_32x32x16_bf16 v[128:143], a[216:219], a[20:23], v[128:143]
    ds_read_b64_tr_b16 a[248:249], v24 offset:36864
    ds_read_b64_tr_b16 a[250:251], v24 offset:37888
    s_add_u32 m0, s30, 34816
    s_mov_b32 s49, 1634304
    buffer_load_dwordx4 v0, s[80:83], s49 offen lds
    s_lshl_b32 s33, s33, 10
    s_add_u32 s33, s33, 0x400000
    v_mfma_f32_32x32x16_bf16 v[144:159], a[220:223], a[20:23], v[144:159]
    ds_read_b64_tr_b16 a[252:253], v25 offset:36864
    ds_read_b64_tr_b16 a[254:255], v25 offset:37888
    s_add_u32 m0, s30, 35840
    s_mov_b32 s49, 1648640
    buffer_load_dwordx4 v0, s[80:83], s49 offen lds
    s_add_u32 s34, s34, s90
    s_lshl_b32 s34, s34, 10
    v_mfma_f32_32x32x16_bf16 v[192:207], a[216:219], v[28:31], v[192:207]
    s_add_u32 s34, s34, 0x400000
    v_accvgpr_read_b32 v32, a160
    s_waitcnt lgkmcnt(12)
    v_mfma_f32_32x32x16_bf16 v[128:143], a[224:227], a[24:27], v[128:143]
    ds_read_b64_tr_b16 a[176:177], v24 offset:40960
    ds_read_b64_tr_b16 a[178:179], v24 offset:41984
    v_accvgpr_read_b32 v33, a161
    v_accvgpr_read_b32 v34, a162
    v_mfma_f32_32x32x16_bf16 v[144:159], a[228:231], a[24:27], v[144:159]
    ds_read_b64_tr_b16 a[180:181], v25 offset:40960
    ds_read_b64_tr_b16 a[182:183], v25 offset:41984
    v_accvgpr_read_b32 v35, a163
    v_accvgpr_read_b32 v36, a164
    v_mfma_f32_32x32x16_bf16 v[192:207], a[224:227], v[28:31], v[192:207]
    v_accvgpr_read_b32 v37, a165
    v_accvgpr_read_b32 v38, a166
    s_waitcnt lgkmcnt(12)
    v_mfma_f32_32x32x16_bf16 v[128:143], a[232:235], a[28:31], v[128:143]
    ds_read_b64_tr_b16 a[184:185], v24 offset:45056
    ds_read_b64_tr_b16 a[186:187], v24 offset:46080
    v_accvgpr_read_b32 v39, a167
    v_accvgpr_read_b32 v40, a168
    v_mfma_f32_32x32x16_bf16 v[144:159], a[236:239], a[28:31], v[144:159]
    ds_read_b64_tr_b16 a[188:189], v25 offset:45056
    ds_read_b64_tr_b16 a[190:191], v25 offset:46080
    v_accvgpr_read_b32 v41, a169
    v_accvgpr_read_b32 v42, a170
    v_mfma_f32_32x32x16_bf16 v[192:207], a[232:235], v[28:31], v[192:207]
    v_accvgpr_read_b32 v43, a171
    v_accvgpr_read_b32 v44, a172
    s_waitcnt lgkmcnt(12)
    s_waitcnt vmcnt(37)
    s_barrier
    v_add_u32 v24, 65536, v24
    v_add_u32 v25, 65536, v25
    v_mfma_f32_32x32x16_bf16 v[128:143], a[240:243], a[32:35], v[128:143]
    ds_read_b64_tr_b16 a[192:193], v24 offset:2048
    ds_read_b64_tr_b16 a[194:195], v24 offset:3072
    v_accvgpr_read_b32 v45, a173
    v_accvgpr_read_b32 v46, a174
    v_mfma_f32_32x32x16_bf16 v[144:159], a[244:247], a[32:35], v[144:159]
    ds_read_b64_tr_b16 a[196:197], v25 offset:2048
    ds_read_b64_tr_b16 a[198:199], v25 offset:3072
    v_accvgpr_read_b32 v47, a175
    v_add_f32 v48, v32, v34
    v_mfma_f32_32x32x16_bf16 v[192:207], a[240:243], v[28:31], v[192:207]
    v_add_f32 v48, v48, v36
    v_add_f32 v48, v48, v38
    s_waitcnt lgkmcnt(12)
    v_mfma_f32_32x32x16_bf16 v[128:143], a[248:251], a[36:39], v[128:143]
    ds_read_b64_tr_b16 a[200:201], v24 offset:6144
    ds_read_b64_tr_b16 a[202:203], v24 offset:7168
    v_add_f32 v48, v48, v40
    v_add_f32 v48, v48, v42
    v_mfma_f32_32x32x16_bf16 v[144:159], a[252:255], a[36:39], v[144:159]
    ds_read_b64_tr_b16 a[204:205], v25 offset:6144
    ds_read_b64_tr_b16 a[206:207], v25 offset:7168
    v_add_f32 v48, v48, v44
    v_add_f32 v48, v48, v46
    v_mfma_f32_32x32x16_bf16 v[192:207], a[248:251], v[28:31], v[192:207]
    v_mov_b32 v50, v48
    s_nop 1
    s_waitcnt lgkmcnt(12)
    v_mfma_f32_32x32x16_bf16 v[128:143], a[176:179], a[40:43], v[128:143]
    ds_read_b64_tr_b16 a[208:209], v24 offset:10240
    ds_read_b64_tr_b16 a[210:211], v24 offset:11264
    v_permlane32_swap_b32 v48, v50
    s_nop 1
    v_mfma_f32_32x32x16_bf16 v[144:159], a[180:183], a[40:43], v[144:159]
    ds_read_b64_tr_b16 a[212:213], v25 offset:10240
    ds_read_b64_tr_b16 a[214:215], v25 offset:11264
    v_add_f32 v48, v48, v50
    v_mul_f32 v48, 0x3d800000, v48
    v_mfma_f32_32x32x16_bf16 v[192:207], a[176:179], v[28:31], v[192:207]
    v_sub_f32 v32, v32, v48
    v_sub_f32 v34, v34, v48
    s_waitcnt lgkmcnt(12)
    v_mfma_f32_32x32x16_bf16 v[128:143], a[184:187], a[44:47], v[128:143]
    ds_read_b64_tr_b16 a[216:217], v24 offset:14336
    ds_read_b64_tr_b16 a[218:219], v24 offset:15360
    v_sub_f32 v36, v36, v48
    v_sub_f32 v38, v38, v48
    v_mfma_f32_32x32x16_bf16 v[144:159], a[188:191], a[44:47], v[144:159]
    ds_read_b64_tr_b16 a[220:221], v25 offset:14336
    ds_read_b64_tr_b16 a[222:223], v25 offset:15360
    v_sub_f32 v40, v40, v48
    v_sub_f32 v42, v42, v48
    v_mfma_f32_32x32x16_bf16 v[192:207], a[184:187], v[28:31], v[192:207]
    v_sub_f32 v44, v44, v48
    v_sub_f32 v46, v46, v48
    s_waitcnt lgkmcnt(12)
    s_waitcnt vmcnt(31)
    s_barrier
    v_subrev_u32 v24, 65536, v24
    v_subrev_u32 v25, 65536, v25
    v_mfma_f32_32x32x16_bf16 v[128:143], a[192:195], a[48:51], v[128:143]
    ds_read_b64_tr_b16 a[224:225], v24 offset:49152
    ds_read_b64_tr_b16 a[226:227], v24 offset:50176
    v_mul_f32 v49, v32, v32
    v_fma_f32 v49, v34, v34, v49
    v_mfma_f32_32x32x16_bf16 v[144:159], a[196:199], a[48:51], v[144:159]
    ds_read_b64_tr_b16 a[228:229], v25 offset:49152
    ds_read_b64_tr_b16 a[230:231], v25 offset:50176
    v_fma_f32 v49, v36, v36, v49
    v_fma_f32 v49, v38, v38, v49
    v_mfma_f32_32x32x16_bf16 v[192:207], a[192:195], v[28:31], v[192:207]
    v_fma_f32 v49, v40, v40, v49
    v_fma_f32 v49, v42, v42, v49
    s_waitcnt lgkmcnt(12)
    v_mfma_f32_32x32x16_bf16 v[128:143], a[200:203], a[52:55], v[128:143]
    ds_read_b64_tr_b16 a[232:233], v24 offset:53248
    ds_read_b64_tr_b16 a[234:235], v24 offset:54272
    v_fma_f32 v49, v44, v44, v49
    v_fma_f32 v49, v46, v46, v49
    v_mfma_f32_32x32x16_bf16 v[144:159], a[204:207], a[52:55], v[144:159]
    ds_read_b64_tr_b16 a[236:237], v25 offset:53248
    ds_read_b64_tr_b16 a[238:239], v25 offset:54272
    v_add_f32 v51, v33, v35
    v_add_f32 v51, v51, v37
    v_mfma_f32_32x32x16_bf16 v[192:207], a[200:203], v[28:31], v[192:207]
    v_add_f32 v51, v51, v39
    v_add_f32 v51, v51, v41
    s_waitcnt lgkmcnt(12)
    v_mfma_f32_32x32x16_bf16 v[128:143], a[208:211], a[56:59], v[128:143]
    ds_read_b64_tr_b16 a[240:241], v24 offset:57344
    ds_read_b64_tr_b16 a[242:243], v24 offset:58368
    v_add_f32 v51, v51, v43
    v_add_f32 v51, v51, v45
    v_mfma_f32_32x32x16_bf16 v[144:159], a[212:215], a[56:59], v[144:159]
    ds_read_b64_tr_b16 a[244:245], v25 offset:57344
    ds_read_b64_tr_b16 a[246:247], v25 offset:58368
    v_add_f32 v51, v51, v47
    v_mov_b32 v52, 0x42000000
    v_mfma_f32_32x32x16_bf16 v[192:207], a[208:211], v[28:31], v[192:207]
    v_fma_f32 v49, v49, v52, v51
    v_mov_b32 v50, v49
    s_waitcnt lgkmcnt(12)
    v_mfma_f32_32x32x16_bf16 v[128:143], a[216:219], a[60:63], v[128:143]
    ds_read_b64_tr_b16 a[248:249], v24 offset:61440
    ds_read_b64_tr_b16 a[250:251], v24 offset:62464
    s_nop 1
    v_permlane32_swap_b32 v49, v50
    v_mfma_f32_32x32x16_bf16 v[144:159], a[220:223], a[60:63], v[144:159]
    ds_read_b64_tr_b16 a[252:253], v25 offset:61440
    ds_read_b64_tr_b16 a[254:255], v25 offset:62464
    s_nop 1
    v_add_f32 v49, v49, v50
    v_mfma_f32_32x32x16_bf16 v[192:207], a[216:219], v[28:31], v[192:207]
    v_mov_b32 v50, 0x3727c5ac
    v_fmac_f32 v50, 0x3b000000, v49
    s_waitcnt lgkmcnt(12)
    s_waitcnt vmcnt(8)
    s_barrier
    v_subrev_u32 v24, 65536, v24
    v_subrev_u32 v25, 65536, v25
    v_mfma_f32_32x32x16_bf16 v[128:143], a[224:227], a[64:67], v[128:143]
    ds_read_b64_tr_b16 a[176:177], v24 offset:0
    ds_read_b64_tr_b16 a[178:179], v24 offset:1024
    v_rsq_f32 v50, v50
    s_nop 0
    v_mfma_f32_32x32x16_bf16 v[144:159], a[228:231], a[64:67], v[144:159]
    ds_read_b64_tr_b16 a[180:181], v25 offset:0
    ds_read_b64_tr_b16 a[182:183], v25 offset:1024
    v_mov_b32 v51, v50
    v_sub_f32 v52, 0, v48
    v_mfma_f32_32x32x16_bf16 v[192:207], a[224:227], v[28:31], v[192:207]
    v_mov_b32 v53, v52
    s_waitcnt lgkmcnt(12)
    v_mfma_f32_32x32x16_bf16 v[128:143], a[232:235], a[68:71], v[128:143]
    ds_read_b64_tr_b16 a[184:185], v24 offset:4096
    ds_read_b64_tr_b16 a[186:187], v24 offset:5120
    v_mfma_f32_32x32x16_bf16 v[144:159], a[236:239], a[68:71], v[144:159]
    ds_read_b64_tr_b16 a[188:189], v25 offset:4096
    ds_read_b64_tr_b16 a[190:191], v25 offset:5120
    v_mfma_f32_32x32x16_bf16 v[192:207], a[232:235], v[28:31], v[192:207]
    s_waitcnt lgkmcnt(12)
    v_mfma_f32_32x32x16_bf16 v[128:143], a[240:243], a[72:75], v[128:143]
    ds_read_b64_tr_b16 a[192:193], v24 offset:8192
    ds_read_b64_tr_b16 a[194:195], v24 offset:9216
    v_mfma_f32_32x32x16_bf16 v[144:159], a[244:247], a[72:75], v[144:159]
    ds_read_b64_tr_b16 a[196:197], v25 offset:8192
    ds_read_b64_tr_b16 a[198:199], v25 offset:9216
    v_mfma_f32_32x32x16_bf16 v[192:207], a[240:243], v[28:31], v[192:207]
    s_waitcnt lgkmcnt(12)
    v_mfma_f32_32x32x16_bf16 v[128:143], a[248:251], a[76:79], v[128:143]
    ds_read_b64_tr_b16 a[200:201], v24 offset:12288
    ds_read_b64_tr_b16 a[202:203], v24 offset:13312
    v_mfma_f32_32x32x16_bf16 v[144:159], a[252:255], a[76:79], v[144:159]
    ds_read_b64_tr_b16 a[204:205], v25 offset:12288
    ds_read_b64_tr_b16 a[206:207], v25 offset:13312
    v_mfma_f32_32x32x16_bf16 v[192:207], a[248:251], v[28:31], v[192:207]
    s_waitcnt lgkmcnt(12)
    s_waitcnt vmcnt(4)
    s_barrier
    v_mfma_f32_32x32x16_bf16 v[128:143], a[176:179], a[80:83], v[128:143]
    ds_read_b64_tr_b16 a[208:209], v24 offset:16384
    ds_read_b64_tr_b16 a[210:211], v24 offset:17408
    v_mfma_f32_32x32x16_bf16 v[144:159], a[180:183], a[80:83], v[144:159]
    ds_read_b64_tr_b16 a[212:213], v25 offset:16384
    ds_read_b64_tr_b16 a[214:215], v25 offset:17408
    v_mfma_f32_32x32x16_bf16 v[192:207], a[176:179], v[28:31], v[192:207]
    s_waitcnt lgkmcnt(12)
    v_mfma_f32_32x32x16_bf16 v[128:143], a[184:187], a[84:87], v[128:143]
    ds_read_b64_tr_b16 a[216:217], v24 offset:20480
    ds_read_b64_tr_b16 a[218:219], v24 offset:21504
    v_mfma_f32_32x32x16_bf16 v[144:159], a[188:191], a[84:87], v[144:159]
    ds_read_b64_tr_b16 a[220:221], v25 offset:20480
    ds_read_b64_tr_b16 a[222:223], v25 offset:21504
    v_mfma_f32_32x32x16_bf16 v[192:207], a[184:187], v[28:31], v[192:207]
    s_waitcnt lgkmcnt(12)
    v_mfma_f32_32x32x16_bf16 v[128:143], a[192:195], a[88:91], v[128:143]
    ds_read_b64_tr_b16 a[224:225], v24 offset:24576
    ds_read_b64_tr_b16 a[226:227], v24 offset:25600
    v_mfma_f32_32x32x16_bf16 v[144:159], a[196:199], a[88:91], v[144:159]
    ds_read_b64_tr_b16 a[228:229], v25 offset:24576
    ds_read_b64_tr_b16 a[230:231], v25 offset:25600
    v_mfma_f32_32x32x16_bf16 v[192:207], a[192:195], v[28:31], v[192:207]
    s_waitcnt lgkmcnt(12)
    v_mfma_f32_32x32x16_bf16 v[128:143], a[200:203], a[92:95], v[128:143]
    ds_read_b64_tr_b16 a[232:233], v24 offset:28672
    ds_read_b64_tr_b16 a[234:235], v24 offset:29696
    v_mfma_f32_32x32x16_bf16 v[144:159], a[204:207], a[92:95], v[144:159]
    ds_read_b64_tr_b16 a[236:237], v25 offset:28672
    ds_read_b64_tr_b16 a[238:239], v25 offset:29696
    v_mfma_f32_32x32x16_bf16 v[192:207], a[200:203], v[28:31], v[192:207]
    s_waitcnt lgkmcnt(12)
    s_waitcnt vmcnt(0)
    s_barrier
    v_mfma_f32_32x32x16_bf16 v[128:143], a[208:211], a[96:99], v[128:143]
    ds_read_b64_tr_b16 a[240:241], v24 offset:32768
    ds_read_b64_tr_b16 a[242:243], v24 offset:33792
    v_mfma_f32_32x32x16_bf16 v[144:159], a[212:215], a[96:99], v[144:159]
    ds_read_b64_tr_b16 a[244:245], v25 offset:32768
    ds_read_b64_tr_b16 a[246:247], v25 offset:33792
    v_mfma_f32_32x32x16_bf16 v[192:207], a[208:211], v[28:31], v[192:207]
    s_waitcnt lgkmcnt(12)
    v_mfma_f32_32x32x16_bf16 v[128:143], a[216:219], a[100:103], v[128:143]
    ds_read_b64_tr_b16 a[248:249], v24 offset:36864
    ds_read_b64_tr_b16 a[250:251], v24 offset:37888
    v_mfma_f32_32x32x16_bf16 v[144:159], a[220:223], a[100:103], v[144:159]
    ds_read_b64_tr_b16 a[252:253], v25 offset:36864
    ds_read_b64_tr_b16 a[254:255], v25 offset:37888
    v_mfma_f32_32x32x16_bf16 v[192:207], a[216:219], v[28:31], v[192:207]
    s_waitcnt lgkmcnt(12)
    v_mfma_f32_32x32x16_bf16 v[128:143], a[224:227], a[104:107], v[128:143]
    ds_read_b64_tr_b16 a[176:177], v24 offset:40960
    ds_read_b64_tr_b16 a[178:179], v24 offset:41984
    v_mfma_f32_32x32x16_bf16 v[144:159], a[228:231], a[104:107], v[144:159]
    ds_read_b64_tr_b16 a[180:181], v25 offset:40960
    ds_read_b64_tr_b16 a[182:183], v25 offset:41984
    v_mfma_f32_32x32x16_bf16 v[192:207], a[224:227], v[28:31], v[192:207]
    s_waitcnt lgkmcnt(12)
    v_mfma_f32_32x32x16_bf16 v[128:143], a[232:235], a[108:111], v[128:143]
    ds_read_b64_tr_b16 a[184:185], v24 offset:45056
    ds_read_b64_tr_b16 a[186:187], v24 offset:46080
    v_mfma_f32_32x32x16_bf16 v[144:159], a[236:239], a[108:111], v[144:159]
    ds_read_b64_tr_b16 a[188:189], v25 offset:45056
    ds_read_b64_tr_b16 a[190:191], v25 offset:46080
    v_mfma_f32_32x32x16_bf16 v[192:207], a[232:235], v[28:31], v[192:207]
    s_waitcnt lgkmcnt(12)
    v_mfma_f32_32x32x16_bf16 v[128:143], a[240:243], a[112:115], v[128:143]
    v_mfma_f32_32x32x16_bf16 v[144:159], a[244:247], a[112:115], v[144:159]
    v_mfma_f32_32x32x16_bf16 v[192:207], a[240:243], v[28:31], v[192:207]
    s_waitcnt lgkmcnt(8)
    v_mfma_f32_32x32x16_bf16 v[128:143], a[248:251], a[116:119], v[128:143]
    v_mfma_f32_32x32x16_bf16 v[144:159], a[252:255], a[116:119], v[144:159]
    v_mfma_f32_32x32x16_bf16 v[192:207], a[248:251], v[28:31], v[192:207]
    s_waitcnt lgkmcnt(4)
    v_mfma_f32_32x32x16_bf16 v[128:143], a[176:179], a[120:123], v[128:143]
    v_mfma_f32_32x32x16_bf16 v[144:159], a[180:183], a[120:123], v[144:159]
    v_mfma_f32_32x32x16_bf16 v[192:207], a[176:179], v[28:31], v[192:207]
    s_waitcnt lgkmcnt(0)
    v_mfma_f32_32x32x16_bf16 v[128:143], a[184:187], a[124:127], v[128:143]
    v_mfma_f32_32x32x16_bf16 v[144:159], a[188:191], a[124:127], v[144:159]
    v_mfma_f32_32x32x16_bf16 v[192:207], a[184:187], v[28:31], v[192:207]
    s_nop 7
    s_nop 7
    s_mov_b32 exec_lo, 1
    s_mov_b32 exec_hi, 1
    ds_write_b128 v17, v[192:195] offset:0
    ds_write_b128 v17, v[196:199] offset:16
    ds_write_b128 v17, v[200:203] offset:32
    ds_write_b128 v17, v[204:207] offset:48
    s_mov_b64 exec, -1
    s_waitcnt lgkmcnt(0)
    s_barrier
    ds_read_b128 v[208:211], v18 offset:0
    ds_read_b128 v[212:215], v18 offset:16
    ds_read_b128 v[216:219], v18 offset:32
    ds_read_b128 v[220:223], v18 offset:48
    ds_read_b128 v[224:227], v19 offset:0
    ds_read_b128 v[228:231], v19 offset:16
    ds_read_b128 v[232:235], v19 offset:32
    ds_read_b128 v[236:239], v19 offset:48
    ds_read_b128 v[240:243], v20 offset:0
    ds_read_b128 v[244:247], v20 offset:16
    ds_read_b128 v[248:251], v20 offset:32
    ds_read_b128 v[252:255], v20 offset:48
    s_waitcnt lgkmcnt(0)
    ds_read_b64_tr_b16 a[176:177], v26 offset:0
    ds_read_b64_tr_b16 a[178:179], v26 offset:1024
    ds_read_b64_tr_b16 a[180:181], v27 offset:0
    ds_read_b64_tr_b16 a[182:183], v27 offset:1024
    ds_read_b64_tr_b16 a[184:185], v26 offset:4096
    ds_read_b64_tr_b16 a[186:187], v26 offset:5120
    ds_read_b64_tr_b16 a[188:189], v27 offset:4096
    ds_read_b64_tr_b16 a[190:191], v27 offset:5120
    ds_read_b64_tr_b16 a[192:193], v26 offset:8192
    ds_read_b64_tr_b16 a[194:195], v26 offset:9216
    ds_read_b64_tr_b16 a[196:197], v27 offset:8192
    ds_read_b64_tr_b16 a[198:199], v27 offset:9216
    ds_read_b64_tr_b16 a[200:201], v26 offset:12288
    ds_read_b64_tr_b16 a[202:203], v26 offset:13312
    ds_read_b64_tr_b16 a[204:205], v27 offset:12288
    ds_read_b64_tr_b16 a[206:207], v27 offset:13312
    s_waitcnt lgkmcnt(12)
    v_mfma_f32_32x32x16_bf16 v[160:175], a[176:179], a[0:3], 0
    ds_read_b64_tr_b16 a[208:209], v26 offset:16384
    ds_read_b64_tr_b16 a[210:211], v26 offset:17408
    v_mfma_f32_32x32x16_bf16 v[176:191], a[180:183], a[0:3], 0
    ds_read_b64_tr_b16 a[212:213], v27 offset:16384
    ds_read_b64_tr_b16 a[214:215], v27 offset:17408
    s_waitcnt lgkmcnt(12)
    v_mfma_f32_32x32x16_bf16 v[160:175], a[184:187], a[4:7], v[160:175]
    ds_read_b64_tr_b16 a[216:217], v26 offset:20480
    ds_read_b64_tr_b16 a[218:219], v26 offset:21504
    v_fma_f32 v128, v192, v52, v128
    v_mul_f32 v128, v128, v50
    v_mul_f32 v64, v128, v128
    v_fma_f32 v64, v64, v56, v54
    v_mul_f32 v64, v64, v128
    v_mfma_f32_32x32x16_bf16 v[176:191], a[188:191], a[4:7], v[176:191]
    ds_read_b64_tr_b16 a[220:221], v27 offset:20480
    ds_read_b64_tr_b16 a[222:223], v27 offset:21504
    v_exp_f32 v64, v64
    v_fma_f32 v129, v193, v52, v129
    v_mul_f32 v129, v129, v50
    v_mul_f32 v65, v129, v129
    v_add_f32 v64, 1.0, v64
    s_waitcnt lgkmcnt(12)
    v_mfma_f32_32x32x16_bf16 v[160:175], a[192:195], a[8:11], v[160:175]
    ds_read_b64_tr_b16 a[224:225], v26 offset:24576
    ds_read_b64_tr_b16 a[226:227], v26 offset:25600
    v_fma_f32 v65, v65, v56, v54
    v_mul_f32 v65, v65, v129
    v_rcp_f32 v64, v64
    v_exp_f32 v65, v65
    v_fma_f32 v130, v194, v52, v130
    v_mfma_f32_32x32x16_bf16 v[176:191], a[196:199], a[8:11], v[176:191]
    ds_read_b64_tr_b16 a[228:229], v27 offset:24576
    ds_read_b64_tr_b16 a[230:231], v27 offset:25600
    v_mul_f32 v130, v130, v50
    v_mul_f32 v66, v130, v130
    v_add_f32 v65, 1.0, v65
    v_fma_f32 v66, v66, v56, v54
    v_mul_f32 v66, v66, v130
    s_waitcnt lgkmcnt(12)
    v_mfma_f32_32x32x16_bf16 v[160:175], a[200:203], a[12:15], v[160:175]
    ds_read_b64_tr_b16 a[232:233], v26 offset:28672
    ds_read_b64_tr_b16 a[234:235], v26 offset:29696
    v_rcp_f32 v65, v65
    v_mul_f32 v128, v128, v64
    v_exp_f32 v66, v66
    v_fma_f32 v131, v195, v52, v131
    v_mul_f32 v131, v131, v50
    v_mfma_f32_32x32x16_bf16 v[176:191], a[204:207], a[12:15], v[176:191]
    ds_read_b64_tr_b16 a[236:237], v27 offset:28672
    ds_read_b64_tr_b16 a[238:239], v27 offset:29696
    v_mul_f32 v67, v131, v131
    v_add_f32 v66, 1.0, v66
    v_fma_f32 v67, v67, v56, v54
    v_mul_f32 v67, v67, v131
    v_rcp_f32 v66, v66
    s_waitcnt lgkmcnt(12)
    v_mfma_f32_32x32x16_bf16 v[160:175], a[208:211], a[16:19], v[160:175]
    ds_read_b64_tr_b16 a[240:241], v26 offset:32768
    ds_read_b64_tr_b16 a[242:243], v26 offset:33792
    v_mul_f32 v129, v129, v65
    v_cvt_pk_bf16_f32 v32, v128, v129
    v_exp_f32 v67, v67
    v_fma_f32 v132, v196, v52, v132
    v_mul_f32 v132, v132, v50
    v_mfma_f32_32x32x16_bf16 v[176:191], a[212:215], a[16:19], v[176:191]
    ds_read_b64_tr_b16 a[244:245], v27 offset:32768
    ds_read_b64_tr_b16 a[246:247], v27 offset:33792
    v_mul_f32 v68, v132, v132
    v_add_f32 v67, 1.0, v67
    v_fma_f32 v68, v68, v56, v54
    v_mul_f32 v68, v68, v132
    v_rcp_f32 v67, v67
    s_waitcnt lgkmcnt(12)
    v_mfma_f32_32x32x16_bf16 v[160:175], a[216:219], a[20:23], v[160:175]
    ds_read_b64_tr_b16 a[248:249], v26 offset:36864
    ds_read_b64_tr_b16 a[250:251], v26 offset:37888
    v_mul_f32 v130, v130, v66
    v_exp_f32 v68, v68
    v_fma_f32 v133, v197, v52, v133
    v_mul_f32 v133, v133, v50
    v_mul_f32 v69, v133, v133
    v_mfma_f32_32x32x16_bf16 v[176:191], a[220:223], a[20:23], v[176:191]
    ds_read_b64_tr_b16 a[252:253], v27 offset:36864
    ds_read_b64_tr_b16 a[254:255], v27 offset:37888
    v_add_f32 v68, 1.0, v68
    v_fma_f32 v69, v69, v56, v54
    v_mul_f32 v69, v69, v133
    v_rcp_f32 v68, v68
    v_mul_f32 v131, v131, v67
    s_waitcnt lgkmcnt(12)
    v_mfma_f32_32x32x16_bf16 v[160:175], a[224:227], a[24:27], v[160:175]
    ds_read_b64_tr_b16 a[176:177], v26 offset:40960
    ds_read_b64_tr_b16 a[178:179], v26 offset:41984
    v_cvt_pk_bf16_f32 v33, v130, v131
    v_exp_f32 v69, v69
    v_fma_f32 v134, v198, v52, v134
    v_mul_f32 v134, v134, v50
    v_mul_f32 v70, v134, v134
    v_mfma_f32_32x32x16_bf16 v[176:191], a[228:231], a[24:27], v[176:191]
    ds_read_b64_tr_b16 a[180:181], v27 offset:40960
    ds_read_b64_tr_b16 a[182:183], v27 offset:41984
    v_add_f32 v69, 1.0, v69
    v_fma_f32 v70, v70, v56, v54
    v_mul_f32 v70, v70, v134
    v_rcp_f32 v69, v69
    v_mul_f32 v132, v132, v68
    s_waitcnt lgkmcnt(12)
    v_mfma_f32_32x32x16_bf16 v[160:175], a[232:235], a[28:31], v[160:175]
    ds_read_b64_tr_b16 a[184:185], v26 offset:45056
    ds_read_b64_tr_b16 a[186:187], v26 offset:46080
    v_exp_f32 v70, v70
    v_fma_f32 v135, v199, v52, v135
    v_mul_f32 v135, v135, v50
    v_mul_f32 v71, v135, v135
    v_add_f32 v70, 1.0, v70
    v_mfma_f32_32x32x16_bf16 v[176:191], a[236:239], a[28:31], v[176:191]
    ds_read_b64_tr_b16 a[188:189], v27 offset:45056
    ds_read_b64_tr_b16 a[190:191], v27 offset:46080
    v_fma_f32 v71, v71, v56, v54
    v_mul_f32 v71, v71, v135
    v_rcp_f32 v70, v70
    v_mul_f32 v133, v133, v69
    v_cvt_pk_bf16_f32 v34, v132, v133
    s_waitcnt lgkmcnt(12)
    v_add_u32 v26, 65536, v26
    v_add_u32 v27, 65536, v27
    v_mfma_f32_32x32x16_bf16 v[160:175], a[240:243], a[32:35], v[160:175]
    ds_read_b64_tr_b16 a[192:193], v26 offset:2048
    ds_read_b64_tr_b16 a[194:195], v26 offset:3072
    v_exp_f32 v71, v71
    v_fma_f32 v136, v200, v52, v136
    v_mul_f32 v136, v136, v50
    v_mul_f32 v72, v136, v136
    v_add_f32 v71, 1.0, v71
    v_mfma_f32_32x32x16_bf16 v[176:191], a[244:247], a[32:35], v[176:191]
    ds_read_b64_tr_b16 a[196:197], v27 offset:2048
    ds_read_b64_tr_b16 a[198:199], v27 offset:3072
    v_fma_f32 v72, v72, v56, v54
    v_mul_f32 v72, v72, v136
    v_rcp_f32 v71, v71
    v_mul_f32 v134, v134, v70
    v_exp_f32 v72, v72
    s_waitcnt lgkmcnt(12)
    v_mfma_f32_32x32x16_bf16 v[160:175], a[248:251], a[36:39], v[160:175]
    ds_read_b64_tr_b16 a[200:201], v26 offset:6144
    ds_read_b64_tr_b16 a[202:203], v26 offset:7168
    v_fma_f32 v137, v201, v52, v137
    v_mul_f32 v137, v137, v50
    v_mul_f32 v73, v137, v137
    v_add_f32 v72, 1.0, v72
    v_fma_f32 v73, v73, v56, v54
    v_mfma_f32_32x32x16_bf16 v[176:191], a[252:255], a[36:39], v[176:191]
    ds_read_b64_tr_b16 a[204:205], v27 offset:6144
    ds_read_b64_tr_b16 a[206:207], v27 offset:7168
    v_mul_f32 v73, v73, v137
    v_rcp_f32 v72, v72
    v_mul_f32 v135, v135, v71
    v_cvt_pk_bf16_f32 v35, v134, v135
    v_exp_f32 v73, v73
    s_waitcnt lgkmcnt(12)
    v_mfma_f32_32x32x16_bf16 v[160:175], a[176:179], a[40:43], v[160:175]
    ds_read_b64_tr_b16 a[208:209], v26 offset:10240
    ds_read_b64_tr_b16 a[210:211], v26 offset:11264
    v_fma_f32 v138, v202, v52, v138
    v_mul_f32 v138, v138, v50
    v_mul_f32 v74, v138, v138
    v_add_f32 v73, 1.0, v73
    v_fma_f32 v74, v74, v56, v54
    v_mfma_f32_32x32x16_bf16 v[176:191], a[180:183], a[40:43], v[176:191]
    ds_read_b64_tr_b16 a[212:213], v27 offset:10240
    ds_read_b64_tr_b16 a[214:215], v27 offset:11264
    v_mul_f32 v74, v74, v138
    v_rcp_f32 v73, v73
    v_mul_f32 v136, v136, v72
    v_exp_f32 v74, v74
    v_fma_f32 v139, v203, v52, v139
    s_waitcnt lgkmcnt(12)
    v_mfma_f32_32x32x16_bf16 v[160:175], a[184:187], a[44:47], v[160:175]
    ds_read_b64_tr_b16 a[216:217], v26 offset:14336
    ds_read_b64_tr_b16 a[218:219], v26 offset:15360
    v_mul_f32 v139, v139, v50
    v_mul_f32 v75, v139, v139
    v_add_f32 v74, 1.0, v74
    v_fma_f32 v75, v75, v56, v54
    v_mul_f32 v75, v75, v139
    v_mfma_f32_32x32x16_bf16 v[176:191], a[188:191], a[44:47], v[176:191]
    ds_read_b64_tr_b16 a[220:221], v27 offset:14336
    ds_read_b64_tr_b16 a[222:223], v27 offset:15360
    v_rcp_f32 v74, v74
    v_mul_f32 v137, v137, v73
    v_cvt_pk_bf16_f32 v36, v136, v137
    v_exp_f32 v75, v75
    v_fma_f32 v140, v204, v52, v140
    s_waitcnt lgkmcnt(12)
    v_subrev_u32 v26, 65536, v26
    v_subrev_u32 v27, 65536, v27
    v_mfma_f32_32x32x16_bf16 v[160:175], a[192:195], a[48:51], v[160:175]
    ds_read_b64_tr_b16 a[224:225], v26 offset:49152
    ds_read_b64_tr_b16 a[226:227], v26 offset:50176
    v_mul_f32 v140, v140, v50
    v_mul_f32 v76, v140, v140
    v_add_f32 v75, 1.0, v75
    v_fma_f32 v76, v76, v56, v54
    v_mul_f32 v76, v76, v140
    v_mfma_f32_32x32x16_bf16 v[176:191], a[196:199], a[48:51], v[176:191]
    ds_read_b64_tr_b16 a[228:229], v27 offset:49152
    ds_read_b64_tr_b16 a[230:231], v27 offset:50176
    v_rcp_f32 v75, v75
    v_mul_f32 v138, v138, v74
    v_exp_f32 v76, v76
    v_fma_f32 v141, v205, v52, v141
    v_mul_f32 v141, v141, v50
    s_waitcnt lgkmcnt(12)
    v_mfma_f32_32x32x16_bf16 v[160:175], a[200:203], a[52:55], v[160:175]
    ds_read_b64_tr_b16 a[232:233], v26 offset:53248
    ds_read_b64_tr_b16 a[234:235], v26 offset:54272
    v_mul_f32 v77, v141, v141
    v_add_f32 v76, 1.0, v76
    v_fma_f32 v77, v77, v56, v54
    v_mul_f32 v77, v77, v141
    v_rcp_f32 v76, v76
    v_mfma_f32_32x32x16_bf16 v[176:191], a[204:207], a[52:55], v[176:191]
    ds_read_b64_tr_b16 a[236:237], v27 offset:53248
    ds_read_b64_tr_b16 a[238:239], v27 offset:54272
    v_mul_f32 v139, v139, v75
    v_cvt_pk_bf16_f32 v37, v138, v139
    v_exp_f32 v77, v77
    v_fma_f32 v142, v206, v52, v142
    v_mul_f32 v142, v142, v50
    s_waitcnt lgkmcnt(12)
    v_mfma_f32_32x32x16_bf16 v[160:175], a[208:211], a[56:59], v[160:175]
    ds_read_b64_tr_b16 a[240:241], v26 offset:57344
    ds_read_b64_tr_b16 a[242:243], v26 offset:58368
    v_mul_f32 v78, v142, v142
    v_add_f32 v77, 1.0, v77
    v_fma_f32 v78, v78, v56, v54
    v_mul_f32 v78, v78, v142
    v_rcp_f32 v77, v77
    v_mfma_f32_32x32x16_bf16 v[176:191], a[212:215], a[56:59], v[176:191]
    ds_read_b64_tr_b16 a[244:245], v27 offset:57344
    ds_read_b64_tr_b16 a[246:247], v27 offset:58368
    v_mul_f32 v140, v140, v76
    v_exp_f32 v78, v78
    v_fma_f32 v143, v207, v52, v143
    v_mul_f32 v143, v143, v50
    v_mul_f32 v79, v143, v143
    s_waitcnt lgkmcnt(12)
    v_mfma_f32_32x32x16_bf16 v[160:175], a[216:219], a[60:63], v[160:175]
    ds_read_b64_tr_b16 a[248:249], v26 offset:61440
    ds_read_b64_tr_b16 a[250:251], v26 offset:62464
    v_add_f32 v78, 1.0, v78
    v_fma_f32 v79, v79, v56, v54
    v_mul_f32 v79, v79, v143
    v_rcp_f32 v78, v78
    v_mul_f32 v141, v141, v77
    v_mfma_f32_32x32x16_bf16 v[176:191], a[220:223], a[60:63], v[176:191]
    ds_read_b64_tr_b16 a[252:253], v27 offset:61440
    ds_read_b64_tr_b16 a[254:255], v27 offset:62464
    v_cvt_pk_bf16_f32 v38, v140, v141
    v_exp_f32 v79, v79
    s_nop 0
    v_add_f32 v79, 1.0, v79
    v_rcp_f32 v79, v79
    s_waitcnt lgkmcnt(12)
    v_subrev_u32 v26, 65536, v26
    v_subrev_u32 v27, 65536, v27
    v_mfma_f32_32x32x16_bf16 v[160:175], a[224:227], a[64:67], v[160:175]
    ds_read_b64_tr_b16 a[176:177], v26 offset:0
    ds_read_b64_tr_b16 a[178:179], v26 offset:1024
    v_mul_f32 v142, v142, v78
    v_mul_f32 v143, v143, v79
    v_cvt_pk_bf16_f32 v39, v142, v143
    buffer_store_dwordx4 v[32:35], v2, s[76:79], s31 offen
    buffer_store_dwordx4 v[36:39], v2, s[76:79], s31 offen offset:512
    v_mfma_f32_32x32x16_bf16 v[176:191], a[228:231], a[64:67], v[176:191]
    ds_read_b64_tr_b16 a[180:181], v27 offset:0
    ds_read_b64_tr_b16 a[182:183], v27 offset:1024
    v_fma_f32 v144, v208, v52, v144
    v_mul_f32 v144, v144, v50
    v_mul_f32 v64, v144, v144
    v_fma_f32 v64, v64, v56, v54
    v_mul_f32 v64, v64, v144
    s_waitcnt lgkmcnt(12)
    v_mfma_f32_32x32x16_bf16 v[160:175], a[232:235], a[68:71], v[160:175]
    ds_read_b64_tr_b16 a[184:185], v26 offset:4096
    ds_read_b64_tr_b16 a[186:187], v26 offset:5120
    v_exp_f32 v64, v64
    v_fma_f32 v145, v209, v52, v145
    v_mul_f32 v145, v145, v50
    v_mul_f32 v65, v145, v145
    v_add_f32 v64, 1.0, v64
    v_mfma_f32_32x32x16_bf16 v[176:191], a[236:239], a[68:71], v[176:191]
    ds_read_b64_tr_b16 a[188:189], v27 offset:4096
    ds_read_b64_tr_b16 a[190:191], v27 offset:5120
    v_fma_f32 v65, v65, v56, v54
    v_mul_f32 v65, v65, v145
    v_rcp_f32 v64, v64
    v_exp_f32 v65, v65
    v_fma_f32 v146, v210, v52, v146
    s_waitcnt lgkmcnt(12)
    v_mfma_f32_32x32x16_bf16 v[160:175], a[240:243], a[72:75], v[160:175]
    ds_read_b64_tr_b16 a[192:193], v26 offset:8192
    ds_read_b64_tr_b16 a[194:195], v26 offset:9216
    v_mul_f32 v146, v146, v50
    v_mul_f32 v66, v146, v146
    v_add_f32 v65, 1.0, v65
    v_fma_f32 v66, v66, v56, v54
    v_mul_f32 v66, v66, v146
    v_mfma_f32_32x32x16_bf16 v[176:191], a[244:247], a[72:75], v[176:191]
    ds_read_b64_tr_b16 a[196:197], v27 offset:8192
    ds_read_b64_tr_b16 a[198:199], v27 offset:9216
    v_rcp_f32 v65, v65
    v_mul_f32 v144, v144, v64
    v_exp_f32 v66, v66
    v_fma_f32 v147, v211, v52, v147
    v_mul_f32 v147, v147, v50
    s_waitcnt lgkmcnt(12)
    v_mfma_f32_32x32x16_bf16 v[160:175], a[248:251], a[76:79], v[160:175]
    ds_read_b64_tr_b16 a[200:201], v26 offset:12288
    ds_read_b64_tr_b16 a[202:203], v26 offset:13312
    v_mul_f32 v67, v147, v147
    v_add_f32 v66, 1.0, v66
    v_fma_f32 v67, v67, v56, v54
    v_mul_f32 v67, v67, v147
    v_rcp_f32 v66, v66
    v_mfma_f32_32x32x16_bf16 v[176:191], a[252:255], a[76:79], v[176:191]
    ds_read_b64_tr_b16 a[204:205], v27 offset:12288
    ds_read_b64_tr_b16 a[206:207], v27 offset:13312
    v_mul_f32 v145, v145, v65
    v_cvt_pk_bf16_f32 v40, v144, v145
    v_exp_f32 v67, v67
    v_fma_f32 v148, v212, v52, v148
    v_mul_f32 v148, v148, v50
    s_waitcnt lgkmcnt(12)
    v_mfma_f32_32x32x16_bf16 v[160:175], a[176:179], a[80:83], v[160:175]
    ds_read_b64_tr_b16 a[208:209], v26 offset:16384
    ds_read_b64_tr_b16 a[210:211], v26 offset:17408
    v_mul_f32 v68, v148, v148
    v_add_f32 v67, 1.0, v67
    v_fma_f32 v68, v68, v56, v54
    v_mul_f32 v68, v68, v148
    v_rcp_f32 v67, v67
    v_mfma_f32_32x32x16_bf16 v[176:191], a[180:183], a[80:83], v[176:191]
    ds_read_b64_tr_b16 a[212:213], v27 offset:16384
    ds_read_b64_tr_b16 a[214:215], v27 offset:17408
    v_mul_f32 v146, v146, v66
    v_exp_f32 v68, v68
    v_fma_f32 v149, v213, v52, v149
    v_mul_f32 v149, v149, v50
    v_mul_f32 v69, v149, v149
    s_waitcnt lgkmcnt(12)
    v_mfma_f32_32x32x16_bf16 v[160:175], a[184:187], a[84:87], v[160:175]
    ds_read_b64_tr_b16 a[216:217], v26 offset:20480
    ds_read_b64_tr_b16 a[218:219], v26 offset:21504
    v_add_f32 v68, 1.0, v68
    v_fma_f32 v69, v69, v56, v54
    v_mul_f32 v69, v69, v149
    v_rcp_f32 v68, v68
    v_mul_f32 v147, v147, v67
    v_mfma_f32_32x32x16_bf16 v[176:191], a[188:191], a[84:87], v[176:191]
    ds_read_b64_tr_b16 a[220:221], v27 offset:20480
    ds_read_b64_tr_b16 a[222:223], v27 offset:21504
    v_cvt_pk_bf16_f32 v41, v146, v147
    v_exp_f32 v69, v69
    v_fma_f32 v150, v214, v52, v150
    v_mul_f32 v150, v150, v50
    v_mul_f32 v70, v150, v150
    s_waitcnt lgkmcnt(12)
    v_mfma_f32_32x32x16_bf16 v[160:175], a[192:195], a[88:91], v[160:175]
    ds_read_b64_tr_b16 a[224:225], v26 offset:24576
    ds_read_b64_tr_b16 a[226:227], v26 offset:25600
    v_add_f32 v69, 1.0, v69
    v_fma_f32 v70, v70, v56, v54
    v_mul_f32 v70, v70, v150
    v_rcp_f32 v69, v69
    v_mul_f32 v148, v148, v68
    v_mfma_f32_32x32x16_bf16 v[176:191], a[196:199], a[88:91], v[176:191]
    ds_read_b64_tr_b16 a[228:229], v27 offset:24576
    ds_read_b64_tr_b16 a[230:231], v27 offset:25600
    v_exp_f32 v70, v70
    v_fma_f32 v151, v215, v52, v151
    v_mul_f32 v151, v151, v50
    v_mul_f32 v71, v151, v151
    v_add_f32 v70, 1.0, v70
    s_waitcnt lgkmcnt(12)
    v_mfma_f32_32x32x16_bf16 v[160:175], a[200:203], a[92:95], v[160:175]
    ds_read_b64_tr_b16 a[232:233], v26 offset:28672
    ds_read_b64_tr_b16 a[234:235], v26 offset:29696
    v_fma_f32 v71, v71, v56, v54
    v_mul_f32 v71, v71, v151
    v_rcp_f32 v70, v70
    v_mul_f32 v149, v149, v69
    v_cvt_pk_bf16_f32 v42, v148, v149
    v_mfma_f32_32x32x16_bf16 v[176:191], a[204:207], a[92:95], v[176:191]
    ds_read_b64_tr_b16 a[236:237], v27 offset:28672
    ds_read_b64_tr_b16 a[238:239], v27 offset:29696
    v_exp_f32 v71, v71
    v_fma_f32 v152, v216, v52, v152
    v_mul_f32 v152, v152, v50
    v_mul_f32 v72, v152, v152
    v_add_f32 v71, 1.0, v71
    s_waitcnt lgkmcnt(12)
    v_mfma_f32_32x32x16_bf16 v[160:175], a[208:211], a[96:99], v[160:175]
    ds_read_b64_tr_b16 a[240:241], v26 offset:32768
    ds_read_b64_tr_b16 a[242:243], v26 offset:33792
    v_fma_f32 v72, v72, v56, v54
    v_mul_f32 v72, v72, v152
    v_rcp_f32 v71, v71
    v_mul_f32 v150, v150, v70
    v_exp_f32 v72, v72
    v_mfma_f32_32x32x16_bf16 v[176:191], a[212:215], a[96:99], v[176:191]
    ds_read_b64_tr_b16 a[244:245], v27 offset:32768
    ds_read_b64_tr_b16 a[246:247], v27 offset:33792
    v_fma_f32 v153, v217, v52, v153
    v_mul_f32 v153, v153, v50
    v_mul_f32 v73, v153, v153
    v_add_f32 v72, 1.0, v72
    v_fma_f32 v73, v73, v56, v54
    s_waitcnt lgkmcnt(12)
    v_mfma_f32_32x32x16_bf16 v[160:175], a[216:219], a[100:103], v[160:175]
    ds_read_b64_tr_b16 a[248:249], v26 offset:36864
    ds_read_b64_tr_b16 a[250:251], v26 offset:37888
    v_mul_f32 v73, v73, v153
    v_rcp_f32 v72, v72
    v_mul_f32 v151, v151, v71
    v_cvt_pk_bf16_f32 v43, v150, v151
    v_exp_f32 v73, v73
    v_mfma_f32_32x32x16_bf16 v[176:191], a[220:223], a[100:103], v[176:191]
    ds_read_b64_tr_b16 a[252:253], v27 offset:36864
    ds_read_b64_tr_b16 a[254:255], v27 offset:37888
    v_fma_f32 v154, v218, v52, v154
    v_mul_f32 v154, v154, v50
    v_mul_f32 v74, v154, v154
    v_add_f32 v73, 1.0, v73
    v_fma_f32 v74, v74, v56, v54
    s_waitcnt lgkmcnt(12)
    v_mfma_f32_32x32x16_bf16 v[160:175], a[224:227], a[104:107], v[160:175]
    ds_read_b64_tr_b16 a[176:177], v26 offset:40960
    ds_read_b64_tr_b16 a[178:179], v26 offset:41984
    v_mul_f32 v74, v74, v154
    v_rcp_f32 v73, v73
    v_mul_f32 v152, v152, v72
    v_exp_f32 v74, v74
    v_fma_f32 v155, v219, v52, v155
    v_mfma_f32_32x32x16_bf16 v[176:191], a[228:231], a[104:107], v[176:191]
    ds_read_b64_tr_b16 a[180:181], v27 offset:40960
    ds_read_b64_tr_b16 a[182:183], v27 offset:41984
    v_mul_f32 v155, v155, v50
    v_mul_f32 v75, v155, v155
    v_add_f32 v74, 1.0, v74
    v_fma_f32 v75, v75, v56, v54
    v_mul_f32 v75, v75, v155
    s_waitcnt lgkmcnt(12)
    v_mfma_f32_32x32x16_bf16 v[160:175], a[232:235], a[108:111], v[160:175]
    ds_read_b64_tr_b16 a[184:185], v26 offset:45056
    ds_read_b64_tr_b16 a[186:187], v26 offset:46080
    v_rcp_f32 v74, v74
    v_mul_f32 v153, v153, v73
    v_cvt_pk_bf16_f32 v44, v152, v153
    v_exp_f32 v75, v75
    v_fma_f32 v156, v220, v52, v156
    v_mfma_f32_32x32x16_bf16 v[176:191], a[236:239], a[108:111], v[176:191]
    ds_read_b64_tr_b16 a[188:189], v27 offset:45056
    ds_read_b64_tr_b16 a[190:191], v27 offset:46080
    v_mul_f32 v156, v156, v50
    v_mul_f32 v76, v156, v156
    v_add_f32 v75, 1.0, v75
    v_fma_f32 v76, v76, v56, v54
    v_mul_f32 v76, v76, v156
    s_waitcnt lgkmcnt(12)
    v_mfma_f32_32x32x16_bf16 v[160:175], a[240:243], a[112:115], v[160:175]
    v_rcp_f32 v75, v75
    v_mul_f32 v154, v154, v74
    v_exp_f32 v76, v76
    v_fma_f32 v157, v221, v52, v157
    v_mul_f32 v157, v157, v50
    v_mfma_f32_32x32x16_bf16 v[176:191], a[244:247], a[112:115], v[176:191]
    v_mul_f32 v77, v157, v157
    v_add_f32 v76, 1.0, v76
    v_fma_f32 v77, v77, v56, v54
    v_mul_f32 v77, v77, v157
    v_rcp_f32 v76, v76
    s_waitcnt lgkmcnt(8)
    v_mfma_f32_32x32x16_bf16 v[160:175], a[248:251], a[116:119], v[160:175]
    v_mul_f32 v155, v155, v75
    v_cvt_pk_bf16_f32 v45, v154, v155
    v_exp_f32 v77, v77
    v_fma_f32 v158, v222, v52, v158
    v_mul_f32 v158, v158, v50
    v_mfma_f32_32x32x16_bf16 v[176:191], a[252:255], a[116:119], v[176:191]
    v_mul_f32 v78, v158, v158
    v_add_f32 v77, 1.0, v77
    v_fma_f32 v78, v78, v56, v54
    v_mul_f32 v78, v78, v158
    v_rcp_f32 v77, v77
    s_waitcnt lgkmcnt(4)
    v_mfma_f32_32x32x16_bf16 v[160:175], a[176:179], a[120:123], v[160:175]
    v_mul_f32 v156, v156, v76
    v_exp_f32 v78, v78
    v_fma_f32 v159, v223, v52, v159
    v_mul_f32 v159, v159, v50
    v_mul_f32 v79, v159, v159
    v_mfma_f32_32x32x16_bf16 v[176:191], a[180:183], a[120:123], v[176:191]
    v_add_f32 v78, 1.0, v78
    v_fma_f32 v79, v79, v56, v54
    v_mul_f32 v79, v79, v159
    v_rcp_f32 v78, v78
    v_mul_f32 v157, v157, v77
    s_waitcnt lgkmcnt(0)
    v_mfma_f32_32x32x16_bf16 v[160:175], a[184:187], a[124:127], v[160:175]
    v_cvt_pk_bf16_f32 v46, v156, v157
    v_exp_f32 v79, v79
    s_nop 0
    v_add_f32 v79, 1.0, v79
    v_rcp_f32 v79, v79
    v_mfma_f32_32x32x16_bf16 v[176:191], a[188:191], a[124:127], v[176:191]
    v_mul_f32 v158, v158, v78
    v_mul_f32 v159, v159, v79
    v_cvt_pk_bf16_f32 v47, v158, v159
    buffer_store_dwordx4 v[40:43], v2, s[76:79], s32 offen
    buffer_store_dwordx4 v[44:47], v2, s[76:79], s32 offen offset:512
    s_nop 7
    s_nop 7
    v_pk_fma_f32 v[160:161], v[224:225], v[52:53], v[160:161]
    v_pk_fma_f32 v[162:163], v[226:227], v[52:53], v[162:163]
    v_pk_fma_f32 v[164:165], v[228:229], v[52:53], v[164:165]
    v_pk_fma_f32 v[166:167], v[230:231], v[52:53], v[166:167]
    v_pk_fma_f32 v[168:169], v[232:233], v[52:53], v[168:169]
    v_pk_fma_f32 v[170:171], v[234:235], v[52:53], v[170:171]
    v_pk_fma_f32 v[172:173], v[236:237], v[52:53], v[172:173]
    v_pk_fma_f32 v[174:175], v[238:239], v[52:53], v[174:175]
    v_pk_mul_f32 v[160:161], v[160:161], v[50:51]
    v_pk_mul_f32 v[162:163], v[162:163], v[50:51]
    v_pk_mul_f32 v[164:165], v[164:165], v[50:51]
    v_pk_mul_f32 v[166:167], v[166:167], v[50:51]
    v_pk_mul_f32 v[168:169], v[168:169], v[50:51]
    v_pk_mul_f32 v[170:171], v[170:171], v[50:51]
    v_pk_mul_f32 v[172:173], v[172:173], v[50:51]
    v_pk_mul_f32 v[174:175], v[174:175], v[50:51]
    v_pk_mul_f32 v[64:65], v[160:161], v[160:161]
    v_pk_mul_f32 v[66:67], v[162:163], v[162:163]
    v_pk_mul_f32 v[68:69], v[164:165], v[164:165]
    v_pk_mul_f32 v[70:71], v[166:167], v[166:167]
    v_pk_mul_f32 v[72:73], v[168:169], v[168:169]
    v_pk_mul_f32 v[74:75], v[170:171], v[170:171]
    v_pk_mul_f32 v[76:77], v[172:173], v[172:173]
    v_pk_mul_f32 v[78:79], v[174:175], v[174:175]
    v_pk_fma_f32 v[64:65], v[64:65], v[56:57], v[54:55]
    v_pk_fma_f32 v[66:67], v[66:67], v[56:57], v[54:55]
    v_pk_fma_f32 v[68:69], v[68:69], v[56:57], v[54:55]
    v_pk_fma_f32 v[70:71], v[70:71], v[56:57], v[54:55]
    v_pk_fma_f32 v[72:73], v[72:73], v[56:57], v[54:55]
    v_pk_fma_f32 v[74:75], v[74:75], v[56:57], v[54:55]
    v_pk_fma_f32 v[76:77], v[76:77], v[56:57], v[54:55]
    v_pk_fma_f32 v[78:79], v[78:79], v[56:57], v[54:55]
    v_pk_mul_f32 v[64:65], v[64:65], v[160:161]
    v_pk_mul_f32 v[66:67], v[66:67], v[162:163]
    v_pk_mul_f32 v[68:69], v[68:69], v[164:165]
    v_pk_mul_f32 v[70:71], v[70:71], v[166:167]
    v_pk_mul_f32 v[72:73], v[72:73], v[168:169]
    v_pk_mul_f32 v[74:75], v[74:75], v[170:171]
    v_pk_mul_f32 v[76:77], v[76:77], v[172:173]
    v_pk_mul_f32 v[78:79], v[78:79], v[174:175]
    v_exp_f32 v64, v64
    v_exp_f32 v65, v65
    v_exp_f32 v66, v66
    v_exp_f32 v67, v67
    v_exp_f32 v68, v68
    v_exp_f32 v69, v69
    v_exp_f32 v70, v70
    v_exp_f32 v71, v71
    v_exp_f32 v72, v72
    v_exp_f32 v73, v73
    v_exp_f32 v74, v74
    v_exp_f32 v75, v75
    v_exp_f32 v76, v76
    v_exp_f32 v77, v77
    v_exp_f32 v78, v78
    v_exp_f32 v79, v79
    s_nop 0
    v_add_f32 v64, 1.0, v64
    v_add_f32 v65, 1.0, v65
    v_add_f32 v66, 1.0, v66
    v_add_f32 v67, 1.0, v67
    v_add_f32 v68, 1.0, v68
    v_add_f32 v69, 1.0, v69
    v_add_f32 v70, 1.0, v70
    v_add_f32 v71, 1.0, v71
    v_add_f32 v72, 1.0, v72
    v_add_f32 v73, 1.0, v73
    v_add_f32 v74, 1.0, v74
    v_add_f32 v75, 1.0, v75
    v_add_f32 v76, 1.0, v76
    v_add_f32 v77, 1.0, v77
    v_add_f32 v78, 1.0, v78
    v_add_f32 v79, 1.0, v79
    v_rcp_f32 v64, v64
    v_rcp_f32 v65, v65
    v_rcp_f32 v66, v66
    v_rcp_f32 v67, v67
    v_rcp_f32 v68, v68
    v_rcp_f32 v69, v69
    v_rcp_f32 v70, v70
    v_rcp_f32 v71, v71
    v_rcp_f32 v72, v72
    v_rcp_f32 v73, v73
    v_rcp_f32 v74, v74
    v_rcp_f32 v75, v75
    v_rcp_f32 v76, v76
    v_rcp_f32 v77, v77
    v_rcp_f32 v78, v78
    v_rcp_f32 v79, v79
    s_nop 0
    v_pk_mul_f32 v[160:161], v[160:161], v[64:65]
    v_pk_mul_f32 v[162:163], v[162:163], v[66:67]
    v_pk_mul_f32 v[164:165], v[164:165], v[68:69]
    v_pk_mul_f32 v[166:167], v[166:167], v[70:71]
    v_pk_mul_f32 v[168:169], v[168:169], v[72:73]
    v_pk_mul_f32 v[170:171], v[170:171], v[74:75]
    v_pk_mul_f32 v[172:173], v[172:173], v[76:77]
    v_pk_mul_f32 v[174:175], v[174:175], v[78:79]
    v_cvt_pk_bf16_f32 v32, v160, v161
    v_cvt_pk_bf16_f32 v33, v162, v163
    v_cvt_pk_bf16_f32 v34, v164, v165
    v_cvt_pk_bf16_f32 v35, v166, v167
    v_cvt_pk_bf16_f32 v36, v168, v169
    v_cvt_pk_bf16_f32 v37, v170, v171
    v_cvt_pk_bf16_f32 v38, v172, v173
    v_cvt_pk_bf16_f32 v39, v174, v175
    buffer_store_dwordx4 v[32:35], v2, s[76:79], s33 offen
    buffer_store_dwordx4 v[36:39], v2, s[76:79], s33 offen offset:512
    v_pk_fma_f32 v[176:177], v[240:241], v[52:53], v[176:177]
    v_pk_fma_f32 v[178:179], v[242:243], v[52:53], v[178:179]
    v_pk_fma_f32 v[180:181], v[244:245], v[52:53], v[180:181]
    v_pk_fma_f32 v[182:183], v[246:247], v[52:53], v[182:183]
    v_pk_fma_f32 v[184:185], v[248:249], v[52:53], v[184:185]
    v_pk_fma_f32 v[186:187], v[250:251], v[52:53], v[186:187]
    v_pk_fma_f32 v[188:189], v[252:253], v[52:53], v[188:189]
    v_pk_fma_f32 v[190:191], v[254:255], v[52:53], v[190:191]
    v_pk_mul_f32 v[176:177], v[176:177], v[50:51]
    v_pk_mul_f32 v[178:179], v[178:179], v[50:51]
    v_pk_mul_f32 v[180:181], v[180:181], v[50:51]
    v_pk_mul_f32 v[182:183], v[182:183], v[50:51]
    v_pk_mul_f32 v[184:185], v[184:185], v[50:51]
    v_pk_mul_f32 v[186:187], v[186:187], v[50:51]
    v_pk_mul_f32 v[188:189], v[188:189], v[50:51]
    v_pk_mul_f32 v[190:191], v[190:191], v[50:51]
    v_pk_mul_f32 v[64:65], v[176:177], v[176:177]
    v_pk_mul_f32 v[66:67], v[178:179], v[178:179]
    v_pk_mul_f32 v[68:69], v[180:181], v[180:181]
    v_pk_mul_f32 v[70:71], v[182:183], v[182:183]
    v_pk_mul_f32 v[72:73], v[184:185], v[184:185]
    v_pk_mul_f32 v[74:75], v[186:187], v[186:187]
    v_pk_mul_f32 v[76:77], v[188:189], v[188:189]
    v_pk_mul_f32 v[78:79], v[190:191], v[190:191]
    v_pk_fma_f32 v[64:65], v[64:65], v[56:57], v[54:55]
    v_pk_fma_f32 v[66:67], v[66:67], v[56:57], v[54:55]
    v_pk_fma_f32 v[68:69], v[68:69], v[56:57], v[54:55]
    v_pk_fma_f32 v[70:71], v[70:71], v[56:57], v[54:55]
    v_pk_fma_f32 v[72:73], v[72:73], v[56:57], v[54:55]
    v_pk_fma_f32 v[74:75], v[74:75], v[56:57], v[54:55]
    v_pk_fma_f32 v[76:77], v[76:77], v[56:57], v[54:55]
    v_pk_fma_f32 v[78:79], v[78:79], v[56:57], v[54:55]
    v_pk_mul_f32 v[64:65], v[64:65], v[176:177]
    v_pk_mul_f32 v[66:67], v[66:67], v[178:179]
    v_pk_mul_f32 v[68:69], v[68:69], v[180:181]
    v_pk_mul_f32 v[70:71], v[70:71], v[182:183]
    v_pk_mul_f32 v[72:73], v[72:73], v[184:185]
    v_pk_mul_f32 v[74:75], v[74:75], v[186:187]
    v_pk_mul_f32 v[76:77], v[76:77], v[188:189]
    v_pk_mul_f32 v[78:79], v[78:79], v[190:191]
    v_exp_f32 v64, v64
    v_exp_f32 v65, v65
    v_exp_f32 v66, v66
    v_exp_f32 v67, v67
    v_exp_f32 v68, v68
    v_exp_f32 v69, v69
    v_exp_f32 v70, v70
    v_exp_f32 v71, v71
    v_exp_f32 v72, v72
    v_exp_f32 v73, v73
    v_exp_f32 v74, v74
    v_exp_f32 v75, v75
    v_exp_f32 v76, v76
    v_exp_f32 v77, v77
    v_exp_f32 v78, v78
    v_exp_f32 v79, v79
    s_nop 0
    v_add_f32 v64, 1.0, v64
    v_add_f32 v65, 1.0, v65
    v_add_f32 v66, 1.0, v66
    v_add_f32 v67, 1.0, v67
    v_add_f32 v68, 1.0, v68
    v_add_f32 v69, 1.0, v69
    v_add_f32 v70, 1.0, v70
    v_add_f32 v71, 1.0, v71
    v_add_f32 v72, 1.0, v72
    v_add_f32 v73, 1.0, v73
    v_add_f32 v74, 1.0, v74
    v_add_f32 v75, 1.0, v75
    v_add_f32 v76, 1.0, v76
    v_add_f32 v77, 1.0, v77
    v_add_f32 v78, 1.0, v78
    v_add_f32 v79, 1.0, v79
    v_rcp_f32 v64, v64
    v_rcp_f32 v65, v65
    v_rcp_f32 v66, v66
    v_rcp_f32 v67, v67
    v_rcp_f32 v68, v68
    v_rcp_f32 v69, v69
    v_rcp_f32 v70, v70
    v_rcp_f32 v71, v71
    v_rcp_f32 v72, v72
    v_rcp_f32 v73, v73
    v_rcp_f32 v74, v74
    v_rcp_f32 v75, v75
    v_rcp_f32 v76, v76
    v_rcp_f32 v77, v77
    v_rcp_f32 v78, v78
    v_rcp_f32 v79, v79
    s_nop 0
    v_pk_mul_f32 v[176:177], v[176:177], v[64:65]
    v_pk_mul_f32 v[178:179], v[178:179], v[66:67]
    v_pk_mul_f32 v[180:181], v[180:181], v[68:69]
    v_pk_mul_f32 v[182:183], v[182:183], v[70:71]
    v_pk_mul_f32 v[184:185], v[184:185], v[72:73]
    v_pk_mul_f32 v[186:187], v[186:187], v[74:75]
    v_pk_mul_f32 v[188:189], v[188:189], v[76:77]
    v_pk_mul_f32 v[190:191], v[190:191], v[78:79]
    v_cvt_pk_bf16_f32 v40, v176, v177
    v_cvt_pk_bf16_f32 v41, v178, v179
    v_cvt_pk_bf16_f32 v42, v180, v181
    v_cvt_pk_bf16_f32 v43, v182, v183
    v_cvt_pk_bf16_f32 v44, v184, v185
    v_cvt_pk_bf16_f32 v45, v186, v187
    v_cvt_pk_bf16_f32 v46, v188, v189
    v_cvt_pk_bf16_f32 v47, v190, v191
    buffer_store_dwordx4 v[40:43], v2, s[76:79], s34 offen
    buffer_store_dwordx4 v[44:47], v2, s[76:79], s34 offen offset:512
    s_branch G3E_100039
GSPIN_100016:
    s_mov_b32 s38, 65536
GSP_100018:
    s_sleep 8
    buffer_load_dword v57, v56, s[84:87], 0 offen sc1
    s_waitcnt vmcnt(0)
    v_and_b32 v57, 0xffff, v57
    v_cmp_eq_u32 vcc, 0x808, v57
    s_cmp_eq_u64 vcc, -1
    s_cbranch_scc1 GOK_100017
    s_sub_u32 s38, s38, 1
    s_cmp_lg_u32 s38, 0
    s_cbranch_scc1 GSP_100018
    s_branch GOK_100017
G3SPIN_100023:
    s_mov_b32 s50, 65536
G3SP_100025:
    s_and_b32 s49, s88, 0xfffffff0
    buffer_load_dword v9, off, s[84:87], s49 sc1
    buffer_load_dword v11, off, s[84:87], s49 offset:8 sc1
    s_waitcnt vmcnt(0)
    v_readfirstlane_b32 s49, v9
    v_readfirstlane_b32 s55, v11
    s_min_u32 s49, s49, s55
    s_cmp_ge_u32 s49, 8
    s_cbranch_scc1 G3OK_100024
    s_sleep 8
    s_sub_u32 s50, s50, 1
    s_cmp_lg_u32 s50, 0
    s_cbranch_scc1 G3SP_100025
    s_branch G3OK_100024
G3E_100039:
    s_branch FILLX_100040
G3X_100038:
    s_load_dwordx2 s[8:9], s[0:1], 104
    v_mbcnt_lo_u32_b32 v1, -1, 0
    v_mbcnt_hi_u32_b32 v1, -1, v1
    v_lshlrev_b32 v1, 4, v1
    s_sub_u32 s10, s2, 224
    s_lshl_b32 s10, s10, 2
    s_add_u32 s10, s10, s20
    s_mul_i32 s12, s10, 81920
    v_mov_b32 v4, -1
    v_mov_b32 v5, -1
    v_mov_b32 v6, -1
    v_mov_b32 v7, -1
    s_mov_b32 s13, 20
    s_waitcnt lgkmcnt(0)
    s_add_u32 s4, s8, 0x8000000
    s_addc_u32 s5, s9, 0
    s_mov_b32 s6, 0xa00000
    s_mov_b32 s7, 0x00020000
FILL_100041:
    buffer_store_dwordx4 v[4:7], v1, s[4:7], s12 offen offset:0 sc1
    buffer_store_dwordx4 v[4:7], v1, s[4:7], s12 offen offset:1024 sc1
    buffer_store_dwordx4 v[4:7], v1, s[4:7], s12 offen offset:2048 sc1
    buffer_store_dwordx4 v[4:7], v1, s[4:7], s12 offen offset:3072 sc1
    s_add_u32 s12, s12, 4096
    s_sub_u32 s13, s13, 1
    s_cmp_lg_u32 s13, 0
    s_cbranch_scc1 FILL_100041
FILLX_100040:
    s_waitcnt vmcnt(0)
END_100001:
    s_endpgm
.globl fin_kernel
.p2align 8
.type fin_kernel,@function
fin_kernel:
    s_cmp_ge_u32 s2, 256
    s_cbranch_scc1 END_200001
    s_getpc_b64 s[62:63]
PC_200002:
    s_lshr_b32 s3, s2, 3
    s_and_b32 s3, s3, 3
    s_lshl_b32 s3, s3, 14
    v_lshlrev_b32 v255, 6, v0
    v_add_u32 v255, s3, v255
    v_min_u32 v255, END_200001-PC_200002, v255
    v_mov_b32 v253, s63
    v_add_co_u32 v252, vcc, s62, v255
    s_nop 1
    v_addc_co_u32 v253, vcc, 0, v253, vcc
    global_load_dword v254, v[252:253], off
    s_load_dwordx2 s[40:41], s[0:1], 40
    s_load_dwordx2 s[42:43], s[0:1], 104
    s_load_dwordx2 s[44:45], s[0:1], 80
    s_load_dwordx2 s[46:47], s[0:1], 0
    s_load_dwordx2 s[48:49], s[0:1], 88
    v_lshrrev_b32 v10, 6, v0
    v_and_b32 v11, 63, v0
    v_readfirstlane_b32 s24, v10
    s_and_b32 s31, s2, 3
    s_lshr_b32 s25, s2, 2
    s_and_b32 s25, s25, 1
    s_lshl_b32 s25, s25, 3
    s_lshr_b32 s27, s2, 5
    s_add_u32 s25, s25, s27
    s_lshr_b32 s26, s2, 3
    s_and_b32 s26, s26, 3
    v_and_b32 v12, 15, v11
    v_lshrrev_b32 v13, 5, v11
    v_lshlrev_b32 v14, 8, v13
    v_lshl_add_u32 v14, v12, 4, v14
    v_bfe_u32 v15, v11, 4, 1
    s_lshl_b32 s27, s25, 3
    s_lshl_b32 s32, s24, 1
    s_add_u32 s27, s27, s32
    v_add_u32 v15, s27, v15
    v_lshl_add_u32 v2, v15, 17, v14
    s_mov_b32 s32, 57344
    v_mul_lo_u32 v4, v15, s32
    v_add_u32 v4, v4, v14
    v_lshl_add_u32 v5, v15, 14, v14
    s_cmp_ge_u32 s31, 2
    s_cselect_b64 vcc, -1, 0
    v_cndmask_b32 v6, v2, v4, vcc
    v_lshrrev_b32 v14, 3, v11
    v_lshlrev_b32 v14, 10, v14
    v_bfe_u32 v15, v11, 4, 1
    v_lshlrev_b32 v15, 2, v15
    v_and_b32 v16, 7, v11
    v_xor_b32 v15, v15, v16
    v_lshl_add_u32 v16, v15, 4, v14
    s_and_b32 s32, s24, 1
    s_lshr_b32 s33, s24, 1
    s_lshl_b32 s34, s32, 7
    s_lshl_b32 s27, s33, 14
    s_add_u32 s27, s27, s34
    v_add_u32 v16, s27, v16
    v_add_u32 v17, 7168, v16
    s_lshl_b32 s30, s32, 12
    s_lshl_b32 s33, s33, 11
    s_add_u32 s30, s30, s33
    s_waitcnt lgkmcnt(0)
    s_lshl_b32 s27, s26, 8
    s_add_u32 s4, s40, s27
    s_addc_u32 s5, s41, 0
    s_sub_u32 s6, 0x400000, s27
    s_mov_b32 s7, 0x00020000
    s_add_u32 s12, s44, s27
    s_addc_u32 s13, s45, 0
    s_sub_u32 s14, 1835008, s27
    s_mov_b32 s15, 0x00020000
    s_add_u32 s8, s42, 0x2000000
    s_addc_u32 s9, s43, 0
    s_mov_b32 s10, 0x1000000
    s_mov_b32 s11, 0x00020000
    s_add_u32 s16, s42, 0x3600000
    s_addc_u32 s17, s43, 0
    s_mov_b32 s18, 0x700000
    s_mov_b32 s19, 0x00020000
    s_mul_i32 s27, s31, 46
    s_cmp_eq_u32 s31, 2
    s_cselect_b32 s27, 0, s27
    s_cmp_eq_u32 s31, 3
    s_cselect_b32 s27, 10, s27
    s_cmp_ge_u32 s31, 2
    s_mov_b32 s32, s4
    s_cselect_b32 s4, s12, s4
    s_cselect_b32 s12, s32, s12
    s_mov_b32 s32, s5
    s_cselect_b32 s5, s13, s5
    s_cselect_b32 s13, s32, s13
    s_mov_b32 s32, s6
    s_cselect_b32 s6, s14, s6
    s_cselect_b32 s14, s32, s14
    s_mov_b32 s32, s7
    s_cselect_b32 s7, s15, s7
    s_cselect_b32 s15, s32, s15
    s_mov_b32 s32, s8
    s_cselect_b32 s8, s16, s8
    s_cselect_b32 s16, s32, s16
    s_mov_b32 s32, s9
    s_cselect_b32 s9, s17, s9
    s_cselect_b32 s17, s32, s17
    s_mov_b32 s32, s10
    s_cselect_b32 s10, s18, s10
    s_cselect_b32 s18, s32, s18
    s_mov_b32 s32, s11
    s_cselect_b32 s11, s19, s11
    s_cselect_b32 s19, s32, s19
    s_lshl_b32 s28, s27, 15
    s_lshl_b32 s29, s27, 10
    s_add_u32 m0, s30, 0
    buffer_load_dwordx4 a[0:3], v6, s[8:11], s29 offen offset:0
    buffer_load_dwordx4 v16, s[4:7], s28 offen lds
    buffer_load_dwordx4 a[4:7], v6, s[8:11], s29 offen offset:512
    buffer_load_dwordx4 v17, s[4:7], s28 offen offset:1024 lds
    s_add_u32 s28, s28, 32768
    s_add_u32 m0, s30, 8192
    buffer_load_dwordx4 a[8:11], v6, s[8:11], s29 offen offset:1024
    buffer_load_dwordx4 v16, s[4:7], s28 offen lds
    buffer_load_dwordx4 a[12:15], v6, s[8:11], s29 offen offset:1536
    buffer_load_dwordx4 v17, s[4:7], s28 offen offset:1024 lds
    s_add_u32 s28, s28, 32768
    s_add_u32 s29, s29, 2048
    s_add_u32 m0, s30, 16384
    buffer_load_dwordx4 a[16:19], v6, s[8:11], s29 offen offset:0
    buffer_load_dwordx4 v16, s[4:7], s28 offen lds
    buffer_load_dwordx4 a[20:23], v6, s[8:11], s29 offen offset:512
    buffer_load_dwordx4 v17, s[4:7], s28 offen offset:1024 lds
    s_add_u32 s28, s28, 32768
    s_add_u32 m0, s30, 24576
    buffer_load_dwordx4 a[24:27], v6, s[8:11], s29 offen offset:1024
    buffer_load_dwordx4 v16, s[4:7], s28 offen lds
    buffer_load_dwordx4 a[28:31], v6, s[8:11], s29 offen offset:1536
    buffer_load_dwordx4 v17, s[4:7], s28 offen offset:1024 lds
    s_add_u32 s28, s28, 32768
    s_add_u32 s29, s29, 2048
    s_add_u32 m0, s30, 32768
    buffer_load_dwordx4 a[32:35], v6, s[8:11], s29 offen offset:0
    buffer_load_dwordx4 v16, s[4:7], s28 offen lds
    buffer_load_dwordx4 a[36:39], v6, s[8:11], s29 offen offset:512
    buffer_load_dwordx4 v17, s[4:7], s28 offen offset:1024 lds
    s_add_u32 s28, s28, 32768
    s_add_u32 m0, s30, 40960
    buffer_load_dwordx4 a[40:43], v6, s[8:11], s29 offen offset:1024
    buffer_load_dwordx4 v16, s[4:7], s28 offen lds
    buffer_load_dwordx4 a[44:47], v6, s[8:11], s29 offen offset:1536
    buffer_load_dwordx4 v17, s[4:7], s28 offen offset:1024 lds
    s_add_u32 s28, s28, 32768
    s_add_u32 s29, s29, 2048
    v_lshrrev_b32 v15, 4, v11
    v_lshrrev_b32 v20, 1, v15
    v_lshlrev_b32 v20, 2, v20
    v_lshrrev_b32 v21, 2, v12
    v_add_u32 v20, v20, v21
    v_and_b32 v15, 1, v15
    v_lshlrev_b32 v15, 1, v15
    v_and_b32 v21, 1, v12
    v_add_u32 v15, v15, v21
    v_bfe_u32 v21, v12, 3, 1
    v_lshlrev_b32 v21, 2, v21
    v_xor_b32 v15, v15, v21
    v_lshlrev_b32 v15, 4, v15
    v_lshl_add_u32 v8, v20, 7, v15
    v_bfe_u32 v21, v12, 1, 1
    v_lshl_add_u32 v8, v21, 3, v8
    s_add_u32 s32, s31, 0
    s_and_b32 s33, s32, 1
    s_lshl_b32 s33, s33, 6
    s_lshr_b32 s32, s32, 1
    s_and_b32 s32, s32, 1
    s_lshl_b32 s32, s32, 12
    v_xor_b32 v24, s33, v8
    v_add_u32 v24, s32, v24
    v_add_u32 v28, 0x10000, v24
    s_add_u32 s32, s31, 1
    s_and_b32 s33, s32, 1
    s_lshl_b32 s33, s33, 6
    s_lshr_b32 s32, s32, 1
    s_and_b32 s32, s32, 1
    s_lshl_b32 s32, s32, 12
    v_xor_b32 v25, s33, v8
    v_add_u32 v25, s32, v25
    v_add_u32 v29, 0x10000, v25
    s_add_u32 s32, s31, 2
    s_and_b32 s33, s32, 1
    s_lshl_b32 s33, s33, 6
    s_lshr_b32 s32, s32, 1
    s_and_b32 s32, s32, 1
    s_lshl_b32 s32, s32, 12
    v_xor_b32 v26, s33, v8
    v_add_u32 v26, s32, v26
    v_add_u32 v30, 0x10000, v26
    s_add_u32 s32, s31, 3
    s_and_b32 s33, s32, 1
    s_lshl_b32 s33, s33, 6
    s_lshr_b32 s32, s32, 1
    s_and_b32 s32, s32, 1
    s_lshl_b32 s32, s32, 12
    v_xor_b32 v27, s33, v8
    v_add_u32 v27, s32, v27
    v_add_u32 v31, 0x10000, v27
    s_add_u32 s20, s42, 0x3400000
    s_addc_u32 s21, s43, 0
    s_mov_b32 s22, 0x200000
    s_mov_b32 s23, 0x00020000
    s_add_u32 s52, s42, 0x8000000
    s_addc_u32 s53, s43, 0
    s_mov_b32 s54, 0x1400000
    s_mov_b32 s55, 0x00020000
    s_mov_b32 s76, s46
    s_mov_b32 s77, s47
    s_mov_b32 s78, 0x200000
    s_mov_b32 s79, 0x00020000
    s_lshl_b32 s60, s26, 2
    s_add_u32 s60, s60, s31
    s_lshl_b32 s61, s60, 6
    s_lshl_b32 s60, s60, 10
    s_lshl_b32 s32, s25, 7
    s_lshl_b32 s33, s24, 5
    s_add_u32 s32, s32, s33
    v_and_b32 v20, 31, v11
    v_add_u32 v20, s32, v20
    v_lshlrev_b32 v23, 10, v20
    v_lshl_add_u32 v23, v13, 4, v23
    s_lshl_b32 s32, s25, 2
    s_add_u32 s32, s32, s26
    s_mul_i32 s35, s32, 163840
    s_lshl_b32 s33, s24, 11
    v_lshlrev_b32 v22, 4, v11
    v_add_u32 v22, s33, v22
    v_mov_b32 v128, 0
    v_mov_b32 v129, 0
    v_mov_b32 v130, 0
    v_mov_b32 v131, 0
    v_mov_b32 v132, 0
    v_mov_b32 v133, 0
    v_mov_b32 v134, 0
    v_mov_b32 v135, 0
    v_mov_b32 v136, 0
    v_mov_b32 v137, 0
    v_mov_b32 v138, 0
    v_mov_b32 v139, 0
    v_mov_b32 v140, 0
    v_mov_b32 v141, 0
    v_mov_b32 v142, 0
    v_mov_b32 v143, 0
    s_cmp_ge_u32 s31, 2
    s_cselect_b32 s37, 1, 0
    s_add_u32 s37, s37, s31
    s_waitcnt vmcnt(16)
    s_barrier
    ds_read_b64_tr_b16 a[128:129], v24 offset:0
    ds_read_b64_tr_b16 a[130:131], v24 offset:1024
    ds_read_b64_tr_b16 a[132:133], v25 offset:0
    ds_read_b64_tr_b16 a[134:135], v25 offset:1024
    ds_read_b64_tr_b16 a[136:137], v26 offset:0
    ds_read_b64_tr_b16 a[138:139], v26 offset:1024
    ds_read_b64_tr_b16 a[140:141], v27 offset:0
    ds_read_b64_tr_b16 a[142:143], v27 offset:1024
    ds_read_b64_tr_b16 a[144:145], v24 offset:2048
    ds_read_b64_tr_b16 a[146:147], v24 offset:3072
    ds_read_b64_tr_b16 a[148:149], v25 offset:2048
    ds_read_b64_tr_b16 a[150:151], v25 offset:3072
    ds_read_b64_tr_b16 a[152:153], v26 offset:2048
    ds_read_b64_tr_b16 a[154:155], v26 offset:3072
    ds_read_b64_tr_b16 a[156:157], v27 offset:2048
    ds_read_b64_tr_b16 a[158:159], v27 offset:3072
    ds_read_b64_tr_b16 a[160:161], v24 offset:8192
    ds_read_b64_tr_b16 a[162:163], v24 offset:9216
    ds_read_b64_tr_b16 a[164:165], v25 offset:8192
    ds_read_b64_tr_b16 a[166:167], v25 offset:9216
    ds_read_b64_tr_b16 a[168:169], v26 offset:8192
    ds_read_b64_tr_b16 a[170:171], v26 offset:9216
    ds_read_b64_tr_b16 a[172:173], v27 offset:8192
    ds_read_b64_tr_b16 a[174:175], v27 offset:9216
    ds_read_b64_tr_b16 a[176:177], v24 offset:10240
    ds_read_b64_tr_b16 a[178:179], v24 offset:11264
    ds_read_b64_tr_b16 a[180:181], v25 offset:10240
    ds_read_b64_tr_b16 a[182:183], v25 offset:11264
    ds_read_b64_tr_b16 a[184:185], v26 offset:10240
    ds_read_b64_tr_b16 a[186:187], v26 offset:11264
    ds_read_b64_tr_b16 a[188:189], v27 offset:10240
    ds_read_b64_tr_b16 a[190:191], v27 offset:11264
    s_waitcnt vmcnt(8) lgkmcnt(0)
    s_barrier
    v_mfma_f32_32x32x16_bf16 v[64:79], a[128:131], a[0:3], 0
    ds_read_b64_tr_b16 a[192:193], v24 offset:16384
    ds_read_b64_tr_b16 a[194:195], v24 offset:17408
    s_add_u32 m0, s30, 49152
    buffer_load_dwordx4 a[48:51], v6, s[8:11], s29 offen offset:0
    v_mfma_f32_32x32x16_bf16 v[80:95], a[132:135], a[0:3], 0
    ds_read_b64_tr_b16 a[196:197], v25 offset:16384
    ds_read_b64_tr_b16 a[198:199], v25 offset:17408
    buffer_load_dwordx4 v16, s[4:7], s28 offen lds
    buffer_load_dwordx4 a[52:55], v6, s[8:11], s29 offen offset:512
    v_mfma_f32_32x32x16_bf16 v[96:111], a[136:139], a[0:3], 0
    ds_read_b64_tr_b16 a[200:201], v26 offset:16384
    ds_read_b64_tr_b16 a[202:203], v26 offset:17408
    buffer_load_dwordx4 v17, s[4:7], s28 offen offset:1024 lds
    v_mfma_f32_32x32x16_bf16 v[112:127], a[140:143], a[0:3], 0
    ds_read_b64_tr_b16 a[204:205], v27 offset:16384
    ds_read_b64_tr_b16 a[206:207], v27 offset:17408
    s_add_u32 s28, s28, 32768
    s_add_u32 m0, s30, 57344
    v_mfma_f32_32x32x16_bf16 v[64:79], a[144:147], a[4:7], v[64:79]
    ds_read_b64_tr_b16 a[208:209], v24 offset:18432
    ds_read_b64_tr_b16 a[210:211], v24 offset:19456
    buffer_load_dwordx4 a[56:59], v6, s[8:11], s29 offen offset:1024
    buffer_load_dwordx4 v16, s[4:7], s28 offen lds
    v_mfma_f32_32x32x16_bf16 v[80:95], a[148:151], a[4:7], v[80:95]
    ds_read_b64_tr_b16 a[212:213], v25 offset:18432
    ds_read_b64_tr_b16 a[214:215], v25 offset:19456
    buffer_load_dwordx4 a[60:63], v6, s[8:11], s29 offen offset:1536
    v_mfma_f32_32x32x16_bf16 v[96:111], a[152:155], a[4:7], v[96:111]
    ds_read_b64_tr_b16 a[216:217], v26 offset:18432
    ds_read_b64_tr_b16 a[218:219], v26 offset:19456
    buffer_load_dwordx4 v17, s[4:7], s28 offen offset:1024 lds
    s_add_u32 s28, s28, 32768
    v_mfma_f32_32x32x16_bf16 v[112:127], a[156:159], a[4:7], v[112:127]
    ds_read_b64_tr_b16 a[220:221], v27 offset:18432
    ds_read_b64_tr_b16 a[222:223], v27 offset:19456
    s_add_u32 s29, s29, 2048
    v_mfma_f32_32x32x16_bf16 v[64:79], a[160:163], a[8:11], v[64:79]
    ds_read_b64_tr_b16 a[224:225], v24 offset:24576
    ds_read_b64_tr_b16 a[226:227], v24 offset:25600
    s_add_u32 m0, s30, 65536
    buffer_load_dwordx4 a[64:67], v6, s[8:11], s29 offen offset:0
    v_mfma_f32_32x32x16_bf16 v[80:95], a[164:167], a[8:11], v[80:95]
    ds_read_b64_tr_b16 a[228:229], v25 offset:24576
    ds_read_b64_tr_b16 a[230:231], v25 offset:25600
    buffer_load_dwordx4 v16, s[4:7], s28 offen lds
    buffer_load_dwordx4 a[68:71], v6, s[8:11], s29 offen offset:512
    v_mfma_f32_32x32x16_bf16 v[96:111], a[168:171], a[8:11], v[96:111]
    ds_read_b64_tr_b16 a[232:233], v26 offset:24576
    ds_read_b64_tr_b16 a[234:235], v26 offset:25600
    buffer_load_dwordx4 v17, s[4:7], s28 offen offset:1024 lds
    v_mfma_f32_32x32x16_bf16 v[112:127], a[172:175], a[8:11], v[112:127]
    ds_read_b64_tr_b16 a[236:237], v27 offset:24576
    ds_read_b64_tr_b16 a[238:239], v27 offset:25600
    s_add_u32 s28, s28, 32768
    s_add_u32 m0, s30, 73728
    v_mfma_f32_32x32x16_bf16 v[64:79], a[176:179], a[12:15], v[64:79]
    ds_read_b64_tr_b16 a[240:241], v24 offset:26624
    ds_read_b64_tr_b16 a[242:243], v24 offset:27648
    buffer_load_dwordx4 a[72:75], v6, s[8:11], s29 offen offset:1024
    buffer_load_dwordx4 v16, s[4:7], s28 offen lds
    v_mfma_f32_32x32x16_bf16 v[80:95], a[180:183], a[12:15], v[80:95]
    ds_read_b64_tr_b16 a[244:245], v25 offset:26624
    ds_read_b64_tr_b16 a[246:247], v25 offset:27648
    buffer_load_dwordx4 a[76:79], v6, s[8:11], s29 offen offset:1536
    v_mfma_f32_32x32x16_bf16 v[96:111], a[184:187], a[12:15], v[96:111]
    ds_read_b64_tr_b16 a[248:249], v26 offset:26624
    ds_read_b64_tr_b16 a[250:251], v26 offset:27648
    buffer_load_dwordx4 v17, s[4:7], s28 offen offset:1024 lds
    s_add_u32 s28, s28, 32768
    v_mfma_f32_32x32x16_bf16 v[112:127], a[188:191], a[12:15], v[112:127]
    ds_read_b64_tr_b16 a[252:253], v27 offset:26624
    ds_read_b64_tr_b16 a[254:255], v27 offset:27648
    s_add_u32 s29, s29, 2048
    s_waitcnt vmcnt(16) lgkmcnt(0)
    s_barrier
    v_mfma_f32_32x32x16_bf16 v[64:79], a[192:195], a[16:19], v[64:79]
    ds_read_b64_tr_b16 a[128:129], v24 offset:32768
    ds_read_b64_tr_b16 a[130:131], v24 offset:33792
    s_cmp_eq_u32 s31, 2
    s_cselect_b32 s4, s12, s4
    v_mfma_f32_32x32x16_bf16 v[80:95], a[196:199], a[16:19], v[80:95]
    ds_read_b64_tr_b16 a[132:133], v25 offset:32768
    ds_read_b64_tr_b16 a[134:135], v25 offset:33792
    s_cselect_b32 s5, s13, s5
    s_cselect_b32 s6, s14, s6
    v_mfma_f32_32x32x16_bf16 v[96:111], a[200:203], a[16:19], v[96:111]
    ds_read_b64_tr_b16 a[136:137], v26 offset:32768
    ds_read_b64_tr_b16 a[138:139], v26 offset:33792
    s_cselect_b32 s7, s15, s7
    s_cselect_b32 s8, s16, s8
    v_mfma_f32_32x32x16_bf16 v[112:127], a[204:207], a[16:19], v[112:127]
    ds_read_b64_tr_b16 a[140:141], v27 offset:32768
    ds_read_b64_tr_b16 a[142:143], v27 offset:33792
    s_cselect_b32 s9, s17, s9
    v_mfma_f32_32x32x16_bf16 v[64:79], a[208:211], a[20:23], v[64:79]
    ds_read_b64_tr_b16 a[144:145], v24 offset:34816
    ds_read_b64_tr_b16 a[146:147], v24 offset:35840
    s_cselect_b32 s10, s18, s10
    s_cselect_b32 s11, s19, s11
    v_mfma_f32_32x32x16_bf16 v[80:95], a[212:215], a[20:23], v[80:95]
    ds_read_b64_tr_b16 a[148:149], v25 offset:34816
    ds_read_b64_tr_b16 a[150:151], v25 offset:35840
    s_cselect_b32 s28, 3014656, s28
    s_cselect_b32 s29, 94208, s29
    v_mfma_f32_32x32x16_bf16 v[96:111], a[216:219], a[20:23], v[96:111]
    ds_read_b64_tr_b16 a[152:153], v26 offset:34816
    ds_read_b64_tr_b16 a[154:155], v26 offset:35840
    s_cselect_b64 vcc, -1, 0
    v_mfma_f32_32x32x16_bf16 v[112:127], a[220:223], a[20:23], v[112:127]
    ds_read_b64_tr_b16 a[156:157], v27 offset:34816
    ds_read_b64_tr_b16 a[158:159], v27 offset:35840
    v_cndmask_b32 v6, v6, v2, vcc
    s_nop 4
    v_mfma_f32_32x32x16_bf16 v[64:79], a[224:227], a[24:27], v[64:79]
    ds_read_b64_tr_b16 a[160:161], v24 offset:40960
    ds_read_b64_tr_b16 a[162:163], v24 offset:41984
    s_add_u32 m0, s30, 81920
    buffer_load_dwordx4 a[80:83], v6, s[8:11], s29 offen offset:0
    v_mfma_f32_32x32x16_bf16 v[80:95], a[228:231], a[24:27], v[80:95]
    ds_read_b64_tr_b16 a[164:165], v25 offset:40960
    ds_read_b64_tr_b16 a[166:167], v25 offset:41984
    buffer_load_dwordx4 v16, s[4:7], s28 offen lds
    v_mfma_f32_32x32x16_bf16 v[96:111], a[232:235], a[24:27], v[96:111]
    ds_read_b64_tr_b16 a[168:169], v26 offset:40960
    ds_read_b64_tr_b16 a[170:171], v26 offset:41984
    buffer_load_dwordx4 a[84:87], v6, s[8:11], s29 offen offset:512
    buffer_load_dwordx4 v17, s[4:7], s28 offen offset:1024 lds
    v_mfma_f32_32x32x16_bf16 v[112:127], a[236:239], a[24:27], v[112:127]
    ds_read_b64_tr_b16 a[172:173], v27 offset:40960
    ds_read_b64_tr_b16 a[174:175], v27 offset:41984
    s_add_u32 s28, s28, 32768
    s_add_u32 m0, s30, 90112
    v_mfma_f32_32x32x16_bf16 v[64:79], a[240:243], a[28:31], v[64:79]
    ds_read_b64_tr_b16 a[176:177], v24 offset:43008
    ds_read_b64_tr_b16 a[178:179], v24 offset:44032
    buffer_load_dwordx4 a[88:91], v6, s[8:11], s29 offen offset:1024
    v_mfma_f32_32x32x16_bf16 v[80:95], a[244:247], a[28:31], v[80:95]
    ds_read_b64_tr_b16 a[180:181], v25 offset:43008
    ds_read_b64_tr_b16 a[182:183], v25 offset:44032
    buffer_load_dwordx4 v16, s[4:7], s28 offen lds
    buffer_load_dwordx4 a[92:95], v6, s[8:11], s29 offen offset:1536
    v_mfma_f32_32x32x16_bf16 v[96:111], a[248:251], a[28:31], v[96:111]
    ds_read_b64_tr_b16 a[184:185], v26 offset:43008
    ds_read_b64_tr_b16 a[186:187], v26 offset:44032
    buffer_load_dwordx4 v17, s[4:7], s28 offen offset:1024 lds
    s_add_u32 s28, s28, 32768
    v_mfma_f32_32x32x16_bf16 v[112:127], a[252:255], a[28:31], v[112:127]
    ds_read_b64_tr_b16 a[188:189], v27 offset:43008
    ds_read_b64_tr_b16 a[190:191], v27 offset:44032
    s_add_u32 s29, s29, 2048
    s_waitcnt vmcnt(16) lgkmcnt(0)
    s_barrier
    v_mfma_f32_32x32x16_bf16 v[64:79], a[128:131], a[32:35], v[64:79]
    ds_read_b64_tr_b16 a[192:193], v24 offset:49152
    ds_read_b64_tr_b16 a[194:195], v24 offset:50176
    s_add_u32 m0, s30, 98304
    v_mfma_f32_32x32x16_bf16 v[80:95], a[132:135], a[32:35], v[80:95]
    ds_read_b64_tr_b16 a[196:197], v25 offset:49152
    ds_read_b64_tr_b16 a[198:199], v25 offset:50176
    buffer_load_dwordx4 a[96:99], v6, s[8:11], s29 offen offset:0
    v_mfma_f32_32x32x16_bf16 v[96:111], a[136:139], a[32:35], v[96:111]
    ds_read_b64_tr_b16 a[200:201], v26 offset:49152
    ds_read_b64_tr_b16 a[202:203], v26 offset:50176
    buffer_load_dwordx4 v16, s[4:7], s28 offen lds
    v_mfma_f32_32x32x16_bf16 v[112:127], a[140:143], a[32:35], v[112:127]
    ds_read_b64_tr_b16 a[204:205], v27 offset:49152
    ds_read_b64_tr_b16 a[206:207], v27 offset:50176
    buffer_load_dwordx4 a[100:103], v6, s[8:11], s29 offen offset:512
    v_mfma_f32_32x32x16_bf16 v[64:79], a[144:147], a[36:39], v[64:79]
    ds_read_b64_tr_b16 a[208:209], v24 offset:51200
    ds_read_b64_tr_b16 a[210:211], v24 offset:52224
    buffer_load_dwordx4 v17, s[4:7], s28 offen offset:1024 lds
    v_mfma_f32_32x32x16_bf16 v[80:95], a[148:151], a[36:39], v[80:95]
    ds_read_b64_tr_b16 a[212:213], v25 offset:51200
    ds_read_b64_tr_b16 a[214:215], v25 offset:52224
    v_mfma_f32_32x32x16_bf16 v[96:111], a[152:155], a[36:39], v[96:111]
    ds_read_b64_tr_b16 a[216:217], v26 offset:51200
    ds_read_b64_tr_b16 a[218:219], v26 offset:52224
    s_add_u32 s28, s28, 32768
    v_mfma_f32_32x32x16_bf16 v[112:127], a[156:159], a[36:39], v[112:127]
    ds_read_b64_tr_b16 a[220:221], v27 offset:51200
    ds_read_b64_tr_b16 a[222:223], v27 offset:52224
    s_add_u32 m0, s30, 106496
    v_mfma_f32_32x32x16_bf16 v[64:79], a[160:163], a[40:43], v[64:79]
    ds_read_b64_tr_b16 a[224:225], v24 offset:57344
    ds_read_b64_tr_b16 a[226:227], v24 offset:58368
    buffer_load_dwordx4 a[104:107], v6, s[8:11], s29 offen offset:1024
    v_mfma_f32_32x32x16_bf16 v[80:95], a[164:167], a[40:43], v[80:95]
    ds_read_b64_tr_b16 a[228:229], v25 offset:57344
    ds_read_b64_tr_b16 a[230:231], v25 offset:58368
    buffer_load_dwordx4 v16, s[4:7], s28 offen lds
    v_mfma_f32_32x32x16_bf16 v[96:111], a[168:171], a[40:43], v[96:111]
    ds_read_b64_tr_b16 a[232:233], v26 offset:57344
    ds_read_b64_tr_b16 a[234:235], v26 offset:58368
    v_mfma_f32_32x32x16_bf16 v[112:127], a[172:175], a[40:43], v[112:127]
    ds_read_b64_tr_b16 a[236:237], v27 offset:57344
    ds_read_b64_tr_b16 a[238:239], v27 offset:58368
    buffer_load_dwordx4 a[108:111], v6, s[8:11], s29 offen offset:1536
    v_mfma_f32_32x32x16_bf16 v[64:79], a[176:179], a[44:47], v[64:79]
    ds_read_b64_tr_b16 a[240:241], v24 offset:59392
    ds_read_b64_tr_b16 a[242:243], v24 offset:60416
    buffer_load_dwordx4 v17, s[4:7], s28 offen offset:1024 lds
    v_mfma_f32_32x32x16_bf16 v[80:95], a[180:183], a[44:47], v[80:95]
    ds_read_b64_tr_b16 a[244:245], v25 offset:59392
    ds_read_b64_tr_b16 a[246:247], v25 offset:60416
    s_add_u32 s28, s28, 32768
    v_mfma_f32_32x32x16_bf16 v[96:111], a[184:187], a[44:47], v[96:111]
    ds_read_b64_tr_b16 a[248:249], v26 offset:59392
    ds_read_b64_tr_b16 a[250:251], v26 offset:60416
    s_add_u32 s29, s29, 2048
    v_mfma_f32_32x32x16_bf16 v[112:127], a[188:191], a[44:47], v[112:127]
    ds_read_b64_tr_b16 a[252:253], v27 offset:59392
    ds_read_b64_tr_b16 a[254:255], v27 offset:60416
    s_waitcnt vmcnt(16) lgkmcnt(0)
    s_barrier
    v_mfma_f32_32x32x16_bf16 v[64:79], a[192:195], a[48:51], v[64:79]
    ds_read_b64_tr_b16 a[128:129], v28 offset:0
    ds_read_b64_tr_b16 a[130:131], v28 offset:1024
    s_add_u32 m0, s30, 114688
    v_mfma_f32_32x32x16_bf16 v[80:95], a[196:199], a[48:51], v[80:95]
    ds_read_b64_tr_b16 a[132:133], v29 offset:0
    ds_read_b64_tr_b16 a[134:135], v29 offset:1024
    buffer_load_dwordx4 a[112:115], v6, s[8:11], s29 offen offset:0
    v_mfma_f32_32x32x16_bf16 v[96:111], a[200:203], a[48:51], v[96:111]
    ds_read_b64_tr_b16 a[136:137], v30 offset:0
    ds_read_b64_tr_b16 a[138:139], v30 offset:1024
    buffer_load_dwordx4 v16, s[4:7], s28 offen lds
    v_mfma_f32_32x32x16_bf16 v[112:127], a[204:207], a[48:51], v[112:127]
    ds_read_b64_tr_b16 a[140:141], v31 offset:0
    ds_read_b64_tr_b16 a[142:143], v31 offset:1024
    buffer_load_dwordx4 a[116:119], v6, s[8:11], s29 offen offset:512
    v_mfma_f32_32x32x16_bf16 v[64:79], a[208:211], a[52:55], v[64:79]
    ds_read_b64_tr_b16 a[144:145], v28 offset:2048
    ds_read_b64_tr_b16 a[146:147], v28 offset:3072
    buffer_load_dwordx4 v17, s[4:7], s28 offen offset:1024 lds
    v_mfma_f32_32x32x16_bf16 v[80:95], a[212:215], a[52:55], v[80:95]
    ds_read_b64_tr_b16 a[148:149], v29 offset:2048
    ds_read_b64_tr_b16 a[150:151], v29 offset:3072
    v_mfma_f32_32x32x16_bf16 v[96:111], a[216:219], a[52:55], v[96:111]
    ds_read_b64_tr_b16 a[152:153], v30 offset:2048
    ds_read_b64_tr_b16 a[154:155], v30 offset:3072
    s_add_u32 s28, s28, 32768
    v_mfma_f32_32x32x16_bf16 v[112:127], a[220:223], a[52:55], v[112:127]
    ds_read_b64_tr_b16 a[156:157], v31 offset:2048
    ds_read_b64_tr_b16 a[158:159], v31 offset:3072
    s_add_u32 m0, s30, 122880
    v_mfma_f32_32x32x16_bf16 v[64:79], a[224:227], a[56:59], v[64:79]
    ds_read_b64_tr_b16 a[160:161], v28 offset:8192
    ds_read_b64_tr_b16 a[162:163], v28 offset:9216
    buffer_load_dwordx4 a[120:123], v6, s[8:11], s29 offen offset:1024
    v_mfma_f32_32x32x16_bf16 v[80:95], a[228:231], a[56:59], v[80:95]
    ds_read_b64_tr_b16 a[164:165], v29 offset:8192
    ds_read_b64_tr_b16 a[166:167], v29 offset:9216
    buffer_load_dwordx4 v16, s[4:7], s28 offen lds
    v_mfma_f32_32x32x16_bf16 v[96:111], a[232:235], a[56:59], v[96:111]
    ds_read_b64_tr_b16 a[168:169], v30 offset:8192
    ds_read_b64_tr_b16 a[170:171], v30 offset:9216
    v_mfma_f32_32x32x16_bf16 v[112:127], a[236:239], a[56:59], v[112:127]
    ds_read_b64_tr_b16 a[172:173], v31 offset:8192
    ds_read_b64_tr_b16 a[174:175], v31 offset:9216
    buffer_load_dwordx4 a[124:127], v6, s[8:11], s29 offen offset:1536
    v_mfma_f32_32x32x16_bf16 v[64:79], a[240:243], a[60:63], v[64:79]
    ds_read_b64_tr_b16 a[176:177], v28 offset:10240
    ds_read_b64_tr_b16 a[178:179], v28 offset:11264
    buffer_load_dwordx4 v17, s[4:7], s28 offen offset:1024 lds
    v_mfma_f32_32x32x16_bf16 v[80:95], a[244:247], a[60:63], v[80:95]
    ds_read_b64_tr_b16 a[180:181], v29 offset:10240
    ds_read_b64_tr_b16 a[182:183], v29 offset:11264
    s_add_u32 s28, s28, 32768
    v_mfma_f32_32x32x16_bf16 v[96:111], a[248:251], a[60:63], v[96:111]
    ds_read_b64_tr_b16 a[184:185], v30 offset:10240
    ds_read_b64_tr_b16 a[186:187], v30 offset:11264
    s_add_u32 s29, s29, 2048
    v_mfma_f32_32x32x16_bf16 v[112:127], a[252:255], a[60:63], v[112:127]
    ds_read_b64_tr_b16 a[188:189], v31 offset:10240
    ds_read_b64_tr_b16 a[190:191], v31 offset:11264
    s_waitcnt vmcnt(16) lgkmcnt(0)
    s_barrier
    v_mfma_f32_32x32x16_bf16 v[64:79], a[128:131], a[64:67], v[64:79]
    ds_read_b64_tr_b16 a[192:193], v28 offset:16384
    ds_read_b64_tr_b16 a[194:195], v28 offset:17408
    s_add_u32 m0, s30, 0
    v_mfma_f32_32x32x16_bf16 v[80:95], a[132:135], a[64:67], v[80:95]
    ds_read_b64_tr_b16 a[196:197], v29 offset:16384
    ds_read_b64_tr_b16 a[198:199], v29 offset:17408
    buffer_load_dwordx4 a[0:3], v6, s[8:11], s29 offen offset:0
    v_mfma_f32_32x32x16_bf16 v[96:111], a[136:139], a[64:67], v[96:111]
    ds_read_b64_tr_b16 a[200:201], v30 offset:16384
    ds_read_b64_tr_b16 a[202:203], v30 offset:17408
    buffer_load_dwordx4 v16, s[4:7], s28 offen lds
    v_mfma_f32_32x32x16_bf16 v[112:127], a[140:143], a[64:67], v[112:127]
    ds_read_b64_tr_b16 a[204:205], v31 offset:16384
    ds_read_b64_tr_b16 a[206:207], v31 offset:17408
    buffer_load_dwordx4 a[4:7], v6, s[8:11], s29 offen offset:512
    v_mfma_f32_32x32x16_bf16 v[64:79], a[144:147], a[68:71], v[64:79]
    ds_read_b64_tr_b16 a[208:209], v28 offset:18432
    ds_read_b64_tr_b16 a[210:211], v28 offset:19456
    buffer_load_dwordx4 v17, s[4:7], s28 offen offset:1024 lds
    v_mfma_f32_32x32x16_bf16 v[80:95], a[148:151], a[68:71], v[80:95]
    ds_read_b64_tr_b16 a[212:213], v29 offset:18432
    ds_read_b64_tr_b16 a[214:215], v29 offset:19456
    v_mfma_f32_32x32x16_bf16 v[96:111], a[152:155], a[68:71], v[96:111]
    ds_read_b64_tr_b16 a[216:217], v30 offset:18432
    ds_read_b64_tr_b16 a[218:219], v30 offset:19456
    s_add_u32 s28, s28, 32768
    v_mfma_f32_32x32x16_bf16 v[112:127], a[156:159], a[68:71], v[112:127]
    ds_read_b64_tr_b16 a[220:221], v31 offset:18432
    ds_read_b64_tr_b16 a[222:223], v31 offset:19456
    s_add_u32 m0, s30, 8192
    v_mfma_f32_32x32x16_bf16 v[64:79], a[160:163], a[72:75], v[64:79]
    ds_read_b64_tr_b16 a[224:225], v28 offset:24576
    ds_read_b64_tr_b16 a[226:227], v28 offset:25600
    buffer_load_dwordx4 a[8:11], v6, s[8:11], s29 offen offset:1024
    v_mfma_f32_32x32x16_bf16 v[80:95], a[164:167], a[72:75], v[80:95]
    ds_read_b64_tr_b16 a[228:229], v29 offset:24576
    ds_read_b64_tr_b16 a[230:231], v29 offset:25600
    buffer_load_dwordx4 v16, s[4:7], s28 offen lds
    v_mfma_f32_32x32x16_bf16 v[96:111], a[168:171], a[72:75], v[96:111]
    ds_read_b64_tr_b16 a[232:233], v30 offset:24576
    ds_read_b64_tr_b16 a[234:235], v30 offset:25600
    v_mfma_f32_32x32x16_bf16 v[112:127], a[172:175], a[72:75], v[112:127]
    ds_read_b64_tr_b16 a[236:237], v31 offset:24576
    ds_read_b64_tr_b16 a[238:239], v31 offset:25600
    buffer_load_dwordx4 a[12:15], v6, s[8:11], s29 offen offset:1536
    v_mfma_f32_32x32x16_bf16 v[64:79], a[176:179], a[76:79], v[64:79]
    ds_read_b64_tr_b16 a[240:241], v28 offset:26624
    ds_read_b64_tr_b16 a[242:243], v28 offset:27648
    buffer_load_dwordx4 v17, s[4:7], s28 offen offset:1024 lds
    v_mfma_f32_32x32x16_bf16 v[80:95], a[180:183], a[76:79], v[80:95]
    ds_read_b64_tr_b16 a[244:245], v29 offset:26624
    ds_read_b64_tr_b16 a[246:247], v29 offset:27648
    s_add_u32 s28, s28, 32768
    v_mfma_f32_32x32x16_bf16 v[96:111], a[184:187], a[76:79], v[96:111]
    ds_read_b64_tr_b16 a[248:249], v30 offset:26624
    ds_read_b64_tr_b16 a[250:251], v30 offset:27648
    s_add_u32 s29, s29, 2048
    v_mfma_f32_32x32x16_bf16 v[112:127], a[188:191], a[76:79], v[112:127]
    ds_read_b64_tr_b16 a[252:253], v31 offset:26624
    ds_read_b64_tr_b16 a[254:255], v31 offset:27648
    s_waitcnt vmcnt(16) lgkmcnt(0)
    s_barrier
    s_cmp_eq_u32 s31, 2
    s_cbranch_scc0 SR_200003
    s_nop 7
    s_nop 7
    v_cvt_pk_bf16_f32 v208, v80, v81
    v_cvt_pk_bf16_f32 v209, v82, v83
    v_cvt_pk_bf16_f32 v210, v84, v85
    v_cvt_pk_bf16_f32 v211, v86, v87
    v_cvt_pk_bf16_f32 v212, v88, v89
    v_cvt_pk_bf16_f32 v213, v90, v91
    v_cvt_pk_bf16_f32 v214, v92, v93
    v_cvt_pk_bf16_f32 v215, v94, v95
    s_add_u32 s32, s31, 1
    s_and_b32 s32, s32, 3
    s_mul_i32 s32, s32, 5
    s_add_u32 s32, s32, s37
    s_lshl_b32 s32, s32, 13
    s_add_u32 s32, s32, s35
    buffer_store_dwordx4 v[208:211], v22, s[52:55], s32 offen offset:0 sc1
    buffer_store_dwordx4 v[212:215], v22, s[52:55], s32 offen offset:1024 sc1
    v_cvt_pk_bf16_f32 v216, v96, v97
    v_cvt_pk_bf16_f32 v217, v98, v99
    v_cvt_pk_bf16_f32 v218, v100, v101
    v_cvt_pk_bf16_f32 v219, v102, v103
    v_cvt_pk_bf16_f32 v220, v104, v105
    v_cvt_pk_bf16_f32 v221, v106, v107
    v_cvt_pk_bf16_f32 v222, v108, v109
    v_cvt_pk_bf16_f32 v223, v110, v111
    s_add_u32 s32, s31, 2
    s_and_b32 s32, s32, 3
    s_mul_i32 s32, s32, 5
    s_add_u32 s32, s32, s37
    s_lshl_b32 s32, s32, 13
    s_add_u32 s32, s32, s35
    buffer_store_dwordx4 v[216:219], v22, s[52:55], s32 offen offset:0 sc1
    buffer_store_dwordx4 v[220:223], v22, s[52:55], s32 offen offset:1024 sc1
    v_cvt_pk_bf16_f32 v224, v112, v113
    v_cvt_pk_bf16_f32 v225, v114, v115
    v_cvt_pk_bf16_f32 v226, v116, v117
    v_cvt_pk_bf16_f32 v227, v118, v119
    v_cvt_pk_bf16_f32 v228, v120, v121
    v_cvt_pk_bf16_f32 v229, v122, v123
    v_cvt_pk_bf16_f32 v230, v124, v125
    v_cvt_pk_bf16_f32 v231, v126, v127
    s_add_u32 s32, s31, 3
    s_and_b32 s32, s32, 3
    s_mul_i32 s32, s32, 5
    s_add_u32 s32, s32, s37
    s_lshl_b32 s32, s32, 13
    s_add_u32 s32, s32, s35
    buffer_store_dwordx4 v[224:227], v22, s[52:55], s32 offen offset:0 sc1
    buffer_store_dwordx4 v[228:231], v22, s[52:55], s32 offen offset:1024 sc1
    s_mov_b32 s37, 2
    v_mov_b32 v128, v64
    v_mov_b32 v129, v65
    v_mov_b32 v130, v66
    v_mov_b32 v131, v67
    v_mov_b32 v132, v68
    v_mov_b32 v133, v69
    v_mov_b32 v134, v70
    v_mov_b32 v135, v71
    v_mov_b32 v136, v72
    v_mov_b32 v137, v73
    v_mov_b32 v138, v74
    v_mov_b32 v139, v75
    v_mov_b32 v140, v76
    v_mov_b32 v141, v77
    v_mov_b32 v142, v78
    v_mov_b32 v143, v79
    v_mov_b32 v64, 0
    v_mov_b32 v65, 0
    v_mov_b32 v66, 0
    v_mov_b32 v67, 0
    v_mov_b32 v68, 0
    v_mov_b32 v69, 0
    v_mov_b32 v70, 0
    v_mov_b32 v71, 0
    v_mov_b32 v72, 0
    v_mov_b32 v73, 0
    v_mov_b32 v74, 0
    v_mov_b32 v75, 0
    v_mov_b32 v76, 0
    v_mov_b32 v77, 0
    v_mov_b32 v78, 0
    v_mov_b32 v79, 0
    v_mov_b32 v80, 0
    v_mov_b32 v81, 0
    v_mov_b32 v82, 0
    v_mov_b32 v83, 0
    v_mov_b32 v84, 0
    v_mov_b32 v85, 0
    v_mov_b32 v86, 0
    v_mov_b32 v87, 0
    v_mov_b32 v88, 0
    v_mov_b32 v89, 0
    v_mov_b32 v90, 0
    v_mov_b32 v91, 0
    v_mov_b32 v92, 0
    v_mov_b32 v93, 0
    v_mov_b32 v94, 0
    v_mov_b32 v95, 0
    v_mov_b32 v96, 0
    v_mov_b32 v97, 0
    v_mov_b32 v98, 0
    v_mov_b32 v99, 0
    v_mov_b32 v100, 0
    v_mov_b32 v101, 0
    v_mov_b32 v102, 0
    v_mov_b32 v103, 0
    v_mov_b32 v104, 0
    v_mov_b32 v105, 0
    v_mov_b32 v106, 0
    v_mov_b32 v107, 0
    v_mov_b32 v108, 0
    v_mov_b32 v109, 0
    v_mov_b32 v110, 0
    v_mov_b32 v111, 0
    v_mov_b32 v112, 0
    v_mov_b32 v113, 0
    v_mov_b32 v114, 0
    v_mov_b32 v115, 0
    v_mov_b32 v116, 0
    v_mov_b32 v117, 0
    v_mov_b32 v118, 0
    v_mov_b32 v119, 0
    v_mov_b32 v120, 0
    v_mov_b32 v121, 0
    v_mov_b32 v122, 0
    v_mov_b32 v123, 0
    v_mov_b32 v124, 0
    v_mov_b32 v125, 0
    v_mov_b32 v126, 0
    v_mov_b32 v127, 0
    s_nop 1
SR_200003:
    v_mfma_f32_32x32x16_bf16 v[64:79], a[192:195], a[80:83], v[64:79]
    ds_read_b64_tr_b16 a[128:129], v28 offset:32768
    ds_read_b64_tr_b16 a[130:131], v28 offset:33792
    s_add_u32 m0, s30, 16384
    v_mfma_f32_32x32x16_bf16 v[80:95], a[196:199], a[80:83], v[80:95]
    ds_read_b64_tr_b16 a[132:133], v29 offset:32768
    ds_read_b64_tr_b16 a[134:135], v29 offset:33792
    buffer_load_dwordx4 a[16:19], v6, s[8:11], s29 offen offset:0
    v_mfma_f32_32x32x16_bf16 v[96:111], a[200:203], a[80:83], v[96:111]
    ds_read_b64_tr_b16 a[136:137], v30 offset:32768
    ds_read_b64_tr_b16 a[138:139], v30 offset:33792
    buffer_load_dwordx4 v16, s[4:7], s28 offen lds
    v_mfma_f32_32x32x16_bf16 v[112:127], a[204:207], a[80:83], v[112:127]
    ds_read_b64_tr_b16 a[140:141], v31 offset:32768
    ds_read_b64_tr_b16 a[142:143], v31 offset:33792
    buffer_load_dwordx4 a[20:23], v6, s[8:11], s29 offen offset:512
    v_mfma_f32_32x32x16_bf16 v[64:79], a[208:211], a[84:87], v[64:79]
    ds_read_b64_tr_b16 a[144:145], v28 offset:34816
    ds_read_b64_tr_b16 a[146:147], v28 offset:35840
    buffer_load_dwordx4 v17, s[4:7], s28 offen offset:1024 lds
    v_mfma_f32_32x32x16_bf16 v[80:95], a[212:215], a[84:87], v[80:95]
    ds_read_b64_tr_b16 a[148:149], v29 offset:34816
    ds_read_b64_tr_b16 a[150:151], v29 offset:35840
    v_mfma_f32_32x32x16_bf16 v[96:111], a[216:219], a[84:87], v[96:111]
    ds_read_b64_tr_b16 a[152:153], v30 offset:34816
    ds_read_b64_tr_b16 a[154:155], v30 offset:35840
    s_add_u32 s28, s28, 32768
    v_mfma_f32_32x32x16_bf16 v[112:127], a[220:223], a[84:87], v[112:127]
    ds_read_b64_tr_b16 a[156:157], v31 offset:34816
    ds_read_b64_tr_b16 a[158:159], v31 offset:35840
    s_add_u32 m0, s30, 24576
    v_mfma_f32_32x32x16_bf16 v[64:79], a[224:227], a[88:91], v[64:79]
    ds_read_b64_tr_b16 a[160:161], v28 offset:40960
    ds_read_b64_tr_b16 a[162:163], v28 offset:41984
    buffer_load_dwordx4 a[24:27], v6, s[8:11], s29 offen offset:1024
    v_mfma_f32_32x32x16_bf16 v[80:95], a[228:231], a[88:91], v[80:95]
    ds_read_b64_tr_b16 a[164:165], v29 offset:40960
    ds_read_b64_tr_b16 a[166:167], v29 offset:41984
    buffer_load_dwordx4 v16, s[4:7], s28 offen lds
    v_mfma_f32_32x32x16_bf16 v[96:111], a[232:235], a[88:91], v[96:111]
    ds_read_b64_tr_b16 a[168:169], v30 offset:40960
    ds_read_b64_tr_b16 a[170:171], v30 offset:41984
    v_mfma_f32_32x32x16_bf16 v[112:127], a[236:239], a[88:91], v[112:127]
    ds_read_b64_tr_b16 a[172:173], v31 offset:40960
    ds_read_b64_tr_b16 a[174:175], v31 offset:41984
    buffer_load_dwordx4 a[28:31], v6, s[8:11], s29 offen offset:1536
    v_mfma_f32_32x32x16_bf16 v[64:79], a[240:243], a[92:95], v[64:79]
    ds_read_b64_tr_b16 a[176:177], v28 offset:43008
    ds_read_b64_tr_b16 a[178:179], v28 offset:44032
    buffer_load_dwordx4 v17, s[4:7], s28 offen offset:1024 lds
    v_mfma_f32_32x32x16_bf16 v[80:95], a[244:247], a[92:95], v[80:95]
    ds_read_b64_tr_b16 a[180:181], v29 offset:43008
    ds_read_b64_tr_b16 a[182:183], v29 offset:44032
    s_add_u32 s28, s28, 32768
    v_mfma_f32_32x32x16_bf16 v[96:111], a[248:251], a[92:95], v[96:111]
    ds_read_b64_tr_b16 a[184:185], v30 offset:43008
    ds_read_b64_tr_b16 a[186:187], v30 offset:44032
    s_add_u32 s29, s29, 2048
    v_mfma_f32_32x32x16_bf16 v[112:127], a[252:255], a[92:95], v[112:127]
    ds_read_b64_tr_b16 a[188:189], v31 offset:43008
    ds_read_b64_tr_b16 a[190:191], v31 offset:44032
    s_cmp_eq_u32 s31, 2
    s_cbranch_scc1 WA_200004
    s_waitcnt vmcnt(16) lgkmcnt(0)
    s_branch WB_200005
WA_200004:
    s_waitcnt vmcnt(22) lgkmcnt(0)
WB_200005:
    s_barrier
    v_mfma_f32_32x32x16_bf16 v[64:79], a[128:131], a[96:99], v[64:79]
    ds_read_b64_tr_b16 a[192:193], v28 offset:49152
    ds_read_b64_tr_b16 a[194:195], v28 offset:50176
    s_add_u32 m0, s30, 32768
    v_mfma_f32_32x32x16_bf16 v[80:95], a[132:135], a[96:99], v[80:95]
    ds_read_b64_tr_b16 a[196:197], v29 offset:49152
    ds_read_b64_tr_b16 a[198:199], v29 offset:50176
    buffer_load_dwordx4 a[32:35], v6, s[8:11], s29 offen offset:0
    v_mfma_f32_32x32x16_bf16 v[96:111], a[136:139], a[96:99], v[96:111]
    ds_read_b64_tr_b16 a[200:201], v30 offset:49152
    ds_read_b64_tr_b16 a[202:203], v30 offset:50176
    buffer_load_dwordx4 v16, s[4:7], s28 offen lds
    v_mfma_f32_32x32x16_bf16 v[112:127], a[140:143], a[96:99], v[112:127]
    ds_read_b64_tr_b16 a[204:205], v31 offset:49152
    ds_read_b64_tr_b16 a[206:207], v31 offset:50176
    buffer_load_dwordx4 a[36:39], v6, s[8:11], s29 offen offset:512
    v_mfma_f32_32x32x16_bf16 v[64:79], a[144:147], a[100:103], v[64:79]
    ds_read_b64_tr_b16 a[208:209], v28 offset:51200
    ds_read_b64_tr_b16 a[210:211], v28 offset:52224
    buffer_load_dwordx4 v17, s[4:7], s28 offen offset:1024 lds
    v_mfma_f32_32x32x16_bf16 v[80:95], a[148:151], a[100:103], v[80:95]
    ds_read_b64_tr_b16 a[212:213], v29 offset:51200
    ds_read_b64_tr_b16 a[214:215], v29 offset:52224
    v_mfma_f32_32x32x16_bf16 v[96:111], a[152:155], a[100:103], v[96:111]
    ds_read_b64_tr_b16 a[216:217], v30 offset:51200
    ds_read_b64_tr_b16 a[218:219], v30 offset:52224
    s_add_u32 s28, s28, 32768
    v_mfma_f32_32x32x16_bf16 v[112:127], a[156:159], a[100:103], v[112:127]
    ds_read_b64_tr_b16 a[220:221], v31 offset:51200
    ds_read_b64_tr_b16 a[222:223], v31 offset:52224
    s_add_u32 m0, s30, 40960
    v_mfma_f32_32x32x16_bf16 v[64:79], a[160:163], a[104:107], v[64:79]
    ds_read_b64_tr_b16 a[224:225], v28 offset:57344
    ds_read_b64_tr_b16 a[226:227], v28 offset:58368
    buffer_load_dwordx4 a[40:43], v6, s[8:11], s29 offen offset:1024
    v_mfma_f32_32x32x16_bf16 v[80:95], a[164:167], a[104:107], v[80:95]
    ds_read_b64_tr_b16 a[228:229], v29 offset:57344
    ds_read_b64_tr_b16 a[230:231], v29 offset:58368
    buffer_load_dwordx4 v16, s[4:7], s28 offen lds
    v_mfma_f32_32x32x16_bf16 v[96:111], a[168:171], a[104:107], v[96:111]
    ds_read_b64_tr_b16 a[232:233], v30 offset:57344
    ds_read_b64_tr_b16 a[234:235], v30 offset:58368
    v_mfma_f32_32x32x16_bf16 v[112:127], a[172:175], a[104:107], v[112:127]
    ds_read_b64_tr_b16 a[236:237], v31 offset:57344
    ds_read_b64_tr_b16 a[238:239], v31 offset:58368
    buffer_load_dwordx4 a[44:47], v6, s[8:11], s29 offen offset:1536
    v_mfma_f32_32x32x16_bf16 v[64:79], a[176:179], a[108:111], v[64:79]
    ds_read_b64_tr_b16 a[240:241], v28 offset:59392
    ds_read_b64_tr_b16 a[242:243], v28 offset:60416
    buffer_load_dwordx4 v17, s[4:7], s28 offen offset:1024 lds
    v_mfma_f32_32x32x16_bf16 v[80:95], a[180:183], a[108:111], v[80:95]
    ds_read_b64_tr_b16 a[244:245], v29 offset:59392
    ds_read_b64_tr_b16 a[246:247], v29 offset:60416
    s_add_u32 s28, s28, 32768
    v_mfma_f32_32x32x16_bf16 v[96:111], a[184:187], a[108:111], v[96:111]
    ds_read_b64_tr_b16 a[248:249], v30 offset:59392
    ds_read_b64_tr_b16 a[250:251], v30 offset:60416
    s_add_u32 s29, s29, 2048
    v_mfma_f32_32x32x16_bf16 v[112:127], a[188:191], a[108:111], v[112:127]
    ds_read_b64_tr_b16 a[252:253], v31 offset:59392
    ds_read_b64_tr_b16 a[254:255], v31 offset:60416
    s_cmp_eq_u32 s31, 2
    s_cbranch_scc1 WA_200006
    s_waitcnt vmcnt(16) lgkmcnt(0)
    s_branch WB_200007
WA_200006:
    s_waitcnt vmcnt(22) lgkmcnt(0)
WB_200007:
    s_barrier
    v_mfma_f32_32x32x16_bf16 v[64:79], a[192:195], a[112:115], v[64:79]
    ds_read_b64_tr_b16 a[128:129], v24 offset:0
    ds_read_b64_tr_b16 a[130:131], v24 offset:1024
    s_add_u32 m0, s30, 49152
    v_mfma_f32_32x32x16_bf16 v[80:95], a[196:199], a[112:115], v[80:95]
    ds_read_b64_tr_b16 a[132:133], v25 offset:0
    ds_read_b64_tr_b16 a[134:135], v25 offset:1024
    buffer_load_dwordx4 a[48:51], v6, s[8:11], s29 offen offset:0
    v_mfma_f32_32x32x16_bf16 v[96:111], a[200:203], a[112:115], v[96:111]
    ds_read_b64_tr_b16 a[136:137], v26 offset:0
    ds_read_b64_tr_b16 a[138:139], v26 offset:1024
    buffer_load_dwordx4 v16, s[4:7], s28 offen lds
    v_mfma_f32_32x32x16_bf16 v[112:127], a[204:207], a[112:115], v[112:127]
    ds_read_b64_tr_b16 a[140:141], v27 offset:0
    ds_read_b64_tr_b16 a[142:143], v27 offset:1024
    buffer_load_dwordx4 a[52:55], v6, s[8:11], s29 offen offset:512
    v_mfma_f32_32x32x16_bf16 v[64:79], a[208:211], a[116:119], v[64:79]
    ds_read_b64_tr_b16 a[144:145], v24 offset:2048
    ds_read_b64_tr_b16 a[146:147], v24 offset:3072
    buffer_load_dwordx4 v17, s[4:7], s28 offen offset:1024 lds
    v_mfma_f32_32x32x16_bf16 v[80:95], a[212:215], a[116:119], v[80:95]
    ds_read_b64_tr_b16 a[148:149], v25 offset:2048
    ds_read_b64_tr_b16 a[150:151], v25 offset:3072
    v_mfma_f32_32x32x16_bf16 v[96:111], a[216:219], a[116:119], v[96:111]
    ds_read_b64_tr_b16 a[152:153], v26 offset:2048
    ds_read_b64_tr_b16 a[154:155], v26 offset:3072
    s_add_u32 s28, s28, 32768
    v_mfma_f32_32x32x16_bf16 v[112:127], a[220:223], a[116:119], v[112:127]
    ds_read_b64_tr_b16 a[156:157], v27 offset:2048
    ds_read_b64_tr_b16 a[158:159], v27 offset:3072
    s_add_u32 m0, s30, 57344
    v_mfma_f32_32x32x16_bf16 v[64:79], a[224:227], a[120:123], v[64:79]
    ds_read_b64_tr_b16 a[160:161], v24 offset:8192
    ds_read_b64_tr_b16 a[162:163], v24 offset:9216
    buffer_load_dwordx4 a[56:59], v6, s[8:11], s29 offen offset:1024
    v_mfma_f32_32x32x16_bf16 v[80:95], a[228:231], a[120:123], v[80:95]
    ds_read_b64_tr_b16 a[164:165], v25 offset:8192
    ds_read_b64_tr_b16 a[166:167], v25 offset:9216
    buffer_load_dwordx4 v16, s[4:7], s28 offen lds
    v_mfma_f32_32x32x16_bf16 v[96:111], a[232:235], a[120:123], v[96:111]
    ds_read_b64_tr_b16 a[168:169], v26 offset:8192
    ds_read_b64_tr_b16 a[170:171], v26 offset:9216
    v_mfma_f32_32x32x16_bf16 v[112:127], a[236:239], a[120:123], v[112:127]
    ds_read_b64_tr_b16 a[172:173], v27 offset:8192
    ds_read_b64_tr_b16 a[174:175], v27 offset:9216
    buffer_load_dwordx4 a[60:63], v6, s[8:11], s29 offen offset:1536
    v_mfma_f32_32x32x16_bf16 v[64:79], a[240:243], a[124:127], v[64:79]
    ds_read_b64_tr_b16 a[176:177], v24 offset:10240
    ds_read_b64_tr_b16 a[178:179], v24 offset:11264
    buffer_load_dwordx4 v17, s[4:7], s28 offen offset:1024 lds
    v_mfma_f32_32x32x16_bf16 v[80:95], a[244:247], a[124:127], v[80:95]
    ds_read_b64_tr_b16 a[180:181], v25 offset:10240
    ds_read_b64_tr_b16 a[182:183], v25 offset:11264
    s_add_u32 s28, s28, 32768
    v_mfma_f32_32x32x16_bf16 v[96:111], a[248:251], a[124:127], v[96:111]
    ds_read_b64_tr_b16 a[184:185], v26 offset:10240
    ds_read_b64_tr_b16 a[186:187], v26 offset:11264
    s_add_u32 s29, s29, 2048
    v_mfma_f32_32x32x16_bf16 v[112:127], a[252:255], a[124:127], v[112:127]
    ds_read_b64_tr_b16 a[188:189], v27 offset:10240
    ds_read_b64_tr_b16 a[190:191], v27 offset:11264
    s_waitcnt vmcnt(16) lgkmcnt(0)
    s_barrier
    v_mfma_f32_32x32x16_bf16 v[64:79], a[128:131], a[0:3], v[64:79]
    buffer_load_dwordx4 v[32:35], v5, s[20:23], s60 offen
    buffer_load_dwordx4 v[36:39], v5, s[20:23], s60 offen offset:512
    buffer_load_dwordx4 v[40:43], v23, s[76:79], s61 offen
    buffer_load_dwordx4 v[44:47], v23, s[76:79], s61 offen offset:32
    ds_read_b64_tr_b16 a[192:193], v24 offset:16384
    ds_read_b64_tr_b16 a[194:195], v24 offset:17408
    s_add_u32 m0, s30, 65536
    v_mfma_f32_32x32x16_bf16 v[80:95], a[132:135], a[0:3], v[80:95]
    ds_read_b64_tr_b16 a[196:197], v25 offset:16384
    ds_read_b64_tr_b16 a[198:199], v25 offset:17408
    buffer_load_dwordx4 a[64:67], v6, s[8:11], s29 offen offset:0
    v_mfma_f32_32x32x16_bf16 v[96:111], a[136:139], a[0:3], v[96:111]
    ds_read_b64_tr_b16 a[200:201], v26 offset:16384
    ds_read_b64_tr_b16 a[202:203], v26 offset:17408
    buffer_load_dwordx4 v16, s[4:7], s28 offen lds
    v_mfma_f32_32x32x16_bf16 v[112:127], a[140:143], a[0:3], v[112:127]
    ds_read_b64_tr_b16 a[204:205], v27 offset:16384
    ds_read_b64_tr_b16 a[206:207], v27 offset:17408
    buffer_load_dwordx4 a[68:71], v6, s[8:11], s29 offen offset:512
    v_mfma_f32_32x32x16_bf16 v[64:79], a[144:147], a[4:7], v[64:79]
    ds_read_b64_tr_b16 a[208:209], v24 offset:18432
    ds_read_b64_tr_b16 a[210:211], v24 offset:19456
    buffer_load_dwordx4 v17, s[4:7], s28 offen offset:1024 lds
    v_mfma_f32_32x32x16_bf16 v[80:95], a[148:151], a[4:7], v[80:95]
    ds_read_b64_tr_b16 a[212:213], v25 offset:18432
    ds_read_b64_tr_b16 a[214:215], v25 offset:19456
    v_mfma_f32_32x32x16_bf16 v[96:111], a[152:155], a[4:7], v[96:111]
    ds_read_b64_tr_b16 a[216:217], v26 offset:18432
    ds_read_b64_tr_b16 a[218:219], v26 offset:19456
    s_add_u32 s28, s28, 32768
    v_mfma_f32_32x32x16_bf16 v[112:127], a[156:159], a[4:7], v[112:127]
    ds_read_b64_tr_b16 a[220:221], v27 offset:18432
    ds_read_b64_tr_b16 a[222:223], v27 offset:19456
    s_add_u32 m0, s30, 73728
    v_mfma_f32_32x32x16_bf16 v[64:79], a[160:163], a[8:11], v[64:79]
    ds_read_b64_tr_b16 a[224:225], v24 offset:24576
    ds_read_b64_tr_b16 a[226:227], v24 offset:25600
    buffer_load_dwordx4 a[72:75], v6, s[8:11], s29 offen offset:1024
    v_mfma_f32_32x32x16_bf16 v[80:95], a[164:167], a[8:11], v[80:95]
    ds_read_b64_tr_b16 a[228:229], v25 offset:24576
    ds_read_b64_tr_b16 a[230:231], v25 offset:25600
    buffer_load_dwordx4 v16, s[4:7], s28 offen lds
    v_mfma_f32_32x32x16_bf16 v[96:111], a[168:171], a[8:11], v[96:111]
    ds_read_b64_tr_b16 a[232:233], v26 offset:24576
    ds_read_b64_tr_b16 a[234:235], v26 offset:25600
    v_mfma_f32_32x32x16_bf16 v[112:127], a[172:175], a[8:11], v[112:127]
    ds_read_b64_tr_b16 a[236:237], v27 offset:24576
    ds_read_b64_tr_b16 a[238:239], v27 offset:25600
    buffer_load_dwordx4 a[76:79], v6, s[8:11], s29 offen offset:1536
    v_mfma_f32_32x32x16_bf16 v[64:79], a[176:179], a[12:15], v[64:79]
    ds_read_b64_tr_b16 a[240:241], v24 offset:26624
    ds_read_b64_tr_b16 a[242:243], v24 offset:27648
    buffer_load_dwordx4 v17, s[4:7], s28 offen offset:1024 lds
    v_mfma_f32_32x32x16_bf16 v[80:95], a[180:183], a[12:15], v[80:95]
    ds_read_b64_tr_b16 a[244:245], v25 offset:26624
    ds_read_b64_tr_b16 a[246:247], v25 offset:27648
    s_add_u32 s28, s28, 32768
    v_mfma_f32_32x32x16_bf16 v[96:111], a[184:187], a[12:15], v[96:111]
    ds_read_b64_tr_b16 a[248:249], v26 offset:26624
    ds_read_b64_tr_b16 a[250:251], v26 offset:27648
    s_add_u32 s29, s29, 2048
    v_mfma_f32_32x32x16_bf16 v[112:127], a[188:191], a[12:15], v[112:127]
    ds_read_b64_tr_b16 a[252:253], v27 offset:26624
    ds_read_b64_tr_b16 a[254:255], v27 offset:27648
    s_waitcnt vmcnt(16) lgkmcnt(0)
    s_barrier
    v_mfma_f32_32x32x16_bf16 v[64:79], a[192:195], a[16:19], v[64:79]
    ds_read_b64_tr_b16 a[128:129], v24 offset:32768
    ds_read_b64_tr_b16 a[130:131], v24 offset:33792
    s_add_u32 m0, s30, 81920
    v_mfma_f32_32x32x16_bf16 v[80:95], a[196:199], a[16:19], v[80:95]
    ds_read_b64_tr_b16 a[132:133], v25 offset:32768
    ds_read_b64_tr_b16 a[134:135], v25 offset:33792
    buffer_load_dwordx4 a[80:83], v6, s[8:11], s29 offen offset:0
    v_mfma_f32_32x32x16_bf16 v[96:111], a[200:203], a[16:19], v[96:111]
    ds_read_b64_tr_b16 a[136:137], v26 offset:32768
    ds_read_b64_tr_b16 a[138:139], v26 offset:33792
    buffer_load_dwordx4 v16, s[4:7], s28 offen lds
    v_mfma_f32_32x32x16_bf16 v[112:127], a[204:207], a[16:19], v[112:127]
    ds_read_b64_tr_b16 a[140:141], v27 offset:32768
    ds_read_b64_tr_b16 a[142:143], v27 offset:33792
    buffer_load_dwordx4 a[84:87], v6, s[8:11], s29 offen offset:512
    v_mfma_f32_32x32x16_bf16 v[64:79], a[208:211], a[20:23], v[64:79]
    ds_read_b64_tr_b16 a[144:145], v24 offset:34816
    ds_read_b64_tr_b16 a[146:147], v24 offset:35840
    buffer_load_dwordx4 v17, s[4:7], s28 offen offset:1024 lds
    v_mfma_f32_32x32x16_bf16 v[80:95], a[212:215], a[20:23], v[80:95]
    ds_read_b64_tr_b16 a[148:149], v25 offset:34816
    ds_read_b64_tr_b16 a[150:151], v25 offset:35840
    v_mfma_f32_32x32x16_bf16 v[96:111], a[216:219], a[20:23], v[96:111]
    ds_read_b64_tr_b16 a[152:153], v26 offset:34816
    ds_read_b64_tr_b16 a[154:155], v26 offset:35840
    s_add_u32 s28, s28, 32768
    v_mfma_f32_32x32x16_bf16 v[112:127], a[220:223], a[20:23], v[112:127]
    ds_read_b64_tr_b16 a[156:157], v27 offset:34816
    ds_read_b64_tr_b16 a[158:159], v27 offset:35840
    s_add_u32 m0, s30, 90112
    v_mfma_f32_32x32x16_bf16 v[64:79], a[224:227], a[24:27], v[64:79]
    ds_read_b64_tr_b16 a[160:161], v24 offset:40960
    ds_read_b64_tr_b16 a[162:163], v24 offset:41984
    buffer_load_dwordx4 a[88:91], v6, s[8:11], s29 offen offset:1024
    v_mfma_f32_32x32x16_bf16 v[80:95], a[228:231], a[24:27], v[80:95]
    ds_read_b64_tr_b16 a[164:165], v25 offset:40960
    ds_read_b64_tr_b16 a[166:167], v25 offset:41984
    buffer_load_dwordx4 v16, s[4:7], s28 offen lds
    v_mfma_f32_32x32x16_bf16 v[96:111], a[232:235], a[24:27], v[96:111]
    ds_read_b64_tr_b16 a[168:169], v26 offset:40960
    ds_read_b64_tr_b16 a[170:171], v26 offset:41984
    v_mfma_f32_32x32x16_bf16 v[112:127], a[236:239], a[24:27], v[112:127]
    ds_read_b64_tr_b16 a[172:173], v27 offset:40960
    ds_read_b64_tr_b16 a[174:175], v27 offset:41984
    buffer_load_dwordx4 a[92:95], v6, s[8:11], s29 offen offset:1536
    v_mfma_f32_32x32x16_bf16 v[64:79], a[240:243], a[28:31], v[64:79]
    ds_read_b64_tr_b16 a[176:177], v24 offset:43008
    ds_read_b64_tr_b16 a[178:179], v24 offset:44032
    buffer_load_dwordx4 v17, s[4:7], s28 offen offset:1024 lds
    v_mfma_f32_32x32x16_bf16 v[80:95], a[244:247], a[28:31], v[80:95]
    ds_read_b64_tr_b16 a[180:181], v25 offset:43008
    ds_read_b64_tr_b16 a[182:183], v25 offset:44032
    s_add_u32 s28, s28, 32768
    v_mfma_f32_32x32x16_bf16 v[96:111], a[248:251], a[28:31], v[96:111]
    ds_read_b64_tr_b16 a[184:185], v26 offset:43008
    ds_read_b64_tr_b16 a[186:187], v26 offset:44032
    s_add_u32 s29, s29, 2048
    v_mfma_f32_32x32x16_bf16 v[112:127], a[252:255], a[28:31], v[112:127]
    ds_read_b64_tr_b16 a[188:189], v27 offset:43008
    ds_read_b64_tr_b16 a[190:191], v27 offset:44032
    s_waitcnt vmcnt(16) lgkmcnt(0)
    s_barrier
    v_mfma_f32_32x32x16_bf16 v[64:79], a[128:131], a[32:35], v[64:79]
    ds_read_b64_tr_b16 a[192:193], v24 offset:49152
    ds_read_b64_tr_b16 a[194:195], v24 offset:50176
    s_add_u32 m0, s30, 98304
    v_mfma_f32_32x32x16_bf16 v[80:95], a[132:135], a[32:35], v[80:95]
    ds_read_b64_tr_b16 a[196:197], v25 offset:49152
    ds_read_b64_tr_b16 a[198:199], v25 offset:50176
    buffer_load_dwordx4 a[96:99], v6, s[8:11], s29 offen offset:0
    v_mfma_f32_32x32x16_bf16 v[96:111], a[136:139], a[32:35], v[96:111]
    ds_read_b64_tr_b16 a[200:201], v26 offset:49152
    ds_read_b64_tr_b16 a[202:203], v26 offset:50176
    buffer_load_dwordx4 v16, s[4:7], s28 offen lds
    v_mfma_f32_32x32x16_bf16 v[112:127], a[140:143], a[32:35], v[112:127]
    ds_read_b64_tr_b16 a[204:205], v27 offset:49152
    ds_read_b64_tr_b16 a[206:207], v27 offset:50176
    buffer_load_dwordx4 a[100:103], v6, s[8:11], s29 offen offset:512
    v_mfma_f32_32x32x16_bf16 v[64:79], a[144:147], a[36:39], v[64:79]
    ds_read_b64_tr_b16 a[208:209], v24 offset:51200
    ds_read_b64_tr_b16 a[210:211], v24 offset:52224
    buffer_load_dwordx4 v17, s[4:7], s28 offen offset:1024 lds
    v_mfma_f32_32x32x16_bf16 v[80:95], a[148:151], a[36:39], v[80:95]
    ds_read_b64_tr_b16 a[212:213], v25 offset:51200
    ds_read_b64_tr_b16 a[214:215], v25 offset:52224
    v_mfma_f32_32x32x16_bf16 v[96:111], a[152:155], a[36:39], v[96:111]
    ds_read_b64_tr_b16 a[216:217], v26 offset:51200
    ds_read_b64_tr_b16 a[218:219], v26 offset:52224
    s_add_u32 s28, s28, 32768
    v_mfma_f32_32x32x16_bf16 v[112:127], a[156:159], a[36:39], v[112:127]
    ds_read_b64_tr_b16 a[220:221], v27 offset:51200
    ds_read_b64_tr_b16 a[222:223], v27 offset:52224
    s_add_u32 m0, s30, 106496
    v_mfma_f32_32x32x16_bf16 v[64:79], a[160:163], a[40:43], v[64:79]
    ds_read_b64_tr_b16 a[224:225], v24 offset:57344
    ds_read_b64_tr_b16 a[226:227], v24 offset:58368
    buffer_load_dwordx4 a[104:107], v6, s[8:11], s29 offen offset:1024
    v_mfma_f32_32x32x16_bf16 v[80:95], a[164:167], a[40:43], v[80:95]
    ds_read_b64_tr_b16 a[228:229], v25 offset:57344
    ds_read_b64_tr_b16 a[230:231], v25 offset:58368
    buffer_load_dwordx4 v16, s[4:7], s28 offen lds
    v_mfma_f32_32x32x16_bf16 v[96:111], a[168:171], a[40:43], v[96:111]
    ds_read_b64_tr_b16 a[232:233], v26 offset:57344
    ds_read_b64_tr_b16 a[234:235], v26 offset:58368
    v_mfma_f32_32x32x16_bf16 v[112:127], a[172:175], a[40:43], v[112:127]
    ds_read_b64_tr_b16 a[236:237], v27 offset:57344
    ds_read_b64_tr_b16 a[238:239], v27 offset:58368
    buffer_load_dwordx4 a[108:111], v6, s[8:11], s29 offen offset:1536
    v_mfma_f32_32x32x16_bf16 v[64:79], a[176:179], a[44:47], v[64:79]
    ds_read_b64_tr_b16 a[240:241], v24 offset:59392
    ds_read_b64_tr_b16 a[242:243], v24 offset:60416
    buffer_load_dwordx4 v17, s[4:7], s28 offen offset:1024 lds
    v_mfma_f32_32x32x16_bf16 v[80:95], a[180:183], a[44:47], v[80:95]
    ds_read_b64_tr_b16 a[244:245], v25 offset:59392
    ds_read_b64_tr_b16 a[246:247], v25 offset:60416
    s_add_u32 s28, s28, 32768
    v_mfma_f32_32x32x16_bf16 v[96:111], a[184:187], a[44:47], v[96:111]
    ds_read_b64_tr_b16 a[248:249], v26 offset:59392
    ds_read_b64_tr_b16 a[250:251], v26 offset:60416
    s_add_u32 s29, s29, 2048
    v_mfma_f32_32x32x16_bf16 v[112:127], a[188:191], a[44:47], v[112:127]
    ds_read_b64_tr_b16 a[252:253], v27 offset:59392
    ds_read_b64_tr_b16 a[254:255], v27 offset:60416
    s_waitcnt vmcnt(16) lgkmcnt(0)
    s_barrier
    v_mfma_f32_32x32x16_bf16 v[64:79], a[192:195], a[48:51], v[64:79]
    ds_read_b64_tr_b16 a[128:129], v28 offset:0
    ds_read_b64_tr_b16 a[130:131], v28 offset:1024
    s_add_u32 m0, s30, 114688
    v_mfma_f32_32x32x16_bf16 v[80:95], a[196:199], a[48:51], v[80:95]
    ds_read_b64_tr_b16 a[132:133], v29 offset:0
    ds_read_b64_tr_b16 a[134:135], v29 offset:1024
    buffer_load_dwordx4 a[112:115], v6, s[8:11], s29 offen offset:0
    v_mfma_f32_32x32x16_bf16 v[96:111], a[200:203], a[48:51], v[96:111]
    ds_read_b64_tr_b16 a[136:137], v30 offset:0
    ds_read_b64_tr_b16 a[138:139], v30 offset:1024
    buffer_load_dwordx4 v16, s[4:7], s28 offen lds
    v_mfma_f32_32x32x16_bf16 v[112:127], a[204:207], a[48:51], v[112:127]
    ds_read_b64_tr_b16 a[140:141], v31 offset:0
    ds_read_b64_tr_b16 a[142:143], v31 offset:1024
    buffer_load_dwordx4 a[116:119], v6, s[8:11], s29 offen offset:512
    v_mfma_f32_32x32x16_bf16 v[64:79], a[208:211], a[52:55], v[64:79]
    ds_read_b64_tr_b16 a[144:145], v28 offset:2048
    ds_read_b64_tr_b16 a[146:147], v28 offset:3072
    buffer_load_dwordx4 v17, s[4:7], s28 offen offset:1024 lds
    v_mfma_f32_32x32x16_bf16 v[80:95], a[212:215], a[52:55], v[80:95]
    ds_read_b64_tr_b16 a[148:149], v29 offset:2048
    ds_read_b64_tr_b16 a[150:151], v29 offset:3072
    v_mfma_f32_32x32x16_bf16 v[96:111], a[216:219], a[52:55], v[96:111]
    ds_read_b64_tr_b16 a[152:153], v30 offset:2048
    ds_read_b64_tr_b16 a[154:155], v30 offset:3072
    s_add_u32 s28, s28, 32768
    v_mfma_f32_32x32x16_bf16 v[112:127], a[220:223], a[52:55], v[112:127]
    ds_read_b64_tr_b16 a[156:157], v31 offset:2048
    ds_read_b64_tr_b16 a[158:159], v31 offset:3072
    s_add_u32 m0, s30, 122880
    v_mfma_f32_32x32x16_bf16 v[64:79], a[224:227], a[56:59], v[64:79]
    ds_read_b64_tr_b16 a[160:161], v28 offset:8192
    ds_read_b64_tr_b16 a[162:163], v28 offset:9216
    buffer_load_dwordx4 a[120:123], v6, s[8:11], s29 offen offset:1024
    v_mfma_f32_32x32x16_bf16 v[80:95], a[228:231], a[56:59], v[80:95]
    ds_read_b64_tr_b16 a[164:165], v29 offset:8192
    ds_read_b64_tr_b16 a[166:167], v29 offset:9216
    buffer_load_dwordx4 v16, s[4:7], s28 offen lds
    v_mfma_f32_32x32x16_bf16 v[96:111], a[232:235], a[56:59], v[96:111]
    ds_read_b64_tr_b16 a[168:169], v30 offset:8192
    ds_read_b64_tr_b16 a[170:171], v30 offset:9216
    v_mfma_f32_32x32x16_bf16 v[112:127], a[236:239], a[56:59], v[112:127]
    ds_read_b64_tr_b16 a[172:173], v31 offset:8192
    ds_read_b64_tr_b16 a[174:175], v31 offset:9216
    buffer_load_dwordx4 a[124:127], v6, s[8:11], s29 offen offset:1536
    v_mfma_f32_32x32x16_bf16 v[64:79], a[240:243], a[60:63], v[64:79]
    ds_read_b64_tr_b16 a[176:177], v28 offset:10240
    ds_read_b64_tr_b16 a[178:179], v28 offset:11264
    buffer_load_dwordx4 v17, s[4:7], s28 offen offset:1024 lds
    v_mfma_f32_32x32x16_bf16 v[80:95], a[244:247], a[60:63], v[80:95]
    ds_read_b64_tr_b16 a[180:181], v29 offset:10240
    ds_read_b64_tr_b16 a[182:183], v29 offset:11264
    s_add_u32 s28, s28, 32768
    v_mfma_f32_32x32x16_bf16 v[96:111], a[248:251], a[60:63], v[96:111]
    ds_read_b64_tr_b16 a[184:185], v30 offset:10240
    ds_read_b64_tr_b16 a[186:187], v30 offset:11264
    s_add_u32 s29, s29, 2048
    v_mfma_f32_32x32x16_bf16 v[112:127], a[252:255], a[60:63], v[112:127]
    ds_read_b64_tr_b16 a[188:189], v31 offset:10240
    ds_read_b64_tr_b16 a[190:191], v31 offset:11264
    s_waitcnt vmcnt(16) lgkmcnt(0)
    s_barrier
    v_mfma_f32_32x32x16_bf16 v[64:79], a[128:131], a[64:67], v[64:79]
    ds_read_b64_tr_b16 a[192:193], v28 offset:16384
    ds_read_b64_tr_b16 a[194:195], v28 offset:17408
    s_add_u32 m0, s30, 0
    v_mfma_f32_32x32x16_bf16 v[80:95], a[132:135], a[64:67], v[80:95]
    ds_read_b64_tr_b16 a[196:197], v29 offset:16384
    ds_read_b64_tr_b16 a[198:199], v29 offset:17408
    buffer_load_dwordx4 a[0:3], v6, s[8:11], s29 offen offset:0
    v_mfma_f32_32x32x16_bf16 v[96:111], a[136:139], a[64:67], v[96:111]
    ds_read_b64_tr_b16 a[200:201], v30 offset:16384
    ds_read_b64_tr_b16 a[202:203], v30 offset:17408
    buffer_load_dwordx4 v16, s[4:7], s28 offen lds
    v_mfma_f32_32x32x16_bf16 v[112:127], a[140:143], a[64:67], v[112:127]
    ds_read_b64_tr_b16 a[204:205], v31 offset:16384
    ds_read_b64_tr_b16 a[206:207], v31 offset:17408
    buffer_load_dwordx4 a[4:7], v6, s[8:11], s29 offen offset:512
    v_mfma_f32_32x32x16_bf16 v[64:79], a[144:147], a[68:71], v[64:79]
    ds_read_b64_tr_b16 a[208:209], v28 offset:18432
    ds_read_b64_tr_b16 a[210:211], v28 offset:19456
    buffer_load_dwordx4 v17, s[4:7], s28 offen offset:1024 lds
    v_mfma_f32_32x32x16_bf16 v[80:95], a[148:151], a[68:71], v[80:95]
    ds_read_b64_tr_b16 a[212:213], v29 offset:18432
    ds_read_b64_tr_b16 a[214:215], v29 offset:19456
    v_mfma_f32_32x32x16_bf16 v[96:111], a[152:155], a[68:71], v[96:111]
    ds_read_b64_tr_b16 a[216:217], v30 offset:18432
    ds_read_b64_tr_b16 a[218:219], v30 offset:19456
    s_add_u32 s28, s28, 32768
    v_mfma_f32_32x32x16_bf16 v[112:127], a[156:159], a[68:71], v[112:127]
    ds_read_b64_tr_b16 a[220:221], v31 offset:18432
    ds_read_b64_tr_b16 a[222:223], v31 offset:19456
    s_add_u32 m0, s30, 8192
    v_mfma_f32_32x32x16_bf16 v[64:79], a[160:163], a[72:75], v[64:79]
    ds_read_b64_tr_b16 a[224:225], v28 offset:24576
    ds_read_b64_tr_b16 a[226:227], v28 offset:25600
    buffer_load_dwordx4 a[8:11], v6, s[8:11], s29 offen offset:1024
    v_mfma_f32_32x32x16_bf16 v[80:95], a[164:167], a[72:75], v[80:95]
    ds_read_b64_tr_b16 a[228:229], v29 offset:24576
    ds_read_b64_tr_b16 a[230:231], v29 offset:25600
    buffer_load_dwordx4 v16, s[4:7], s28 offen lds
    v_mfma_f32_32x32x16_bf16 v[96:111], a[168:171], a[72:75], v[96:111]
    ds_read_b64_tr_b16 a[232:233], v30 offset:24576
    ds_read_b64_tr_b16 a[234:235], v30 offset:25600
    v_mfma_f32_32x32x16_bf16 v[112:127], a[172:175], a[72:75], v[112:127]
    ds_read_b64_tr_b16 a[236:237], v31 offset:24576
    ds_read_b64_tr_b16 a[238:239], v31 offset:25600
    buffer_load_dwordx4 a[12:15], v6, s[8:11], s29 offen offset:1536
    v_mfma_f32_32x32x16_bf16 v[64:79], a[176:179], a[76:79], v[64:79]
    ds_read_b64_tr_b16 a[240:241], v28 offset:26624
    ds_read_b64_tr_b16 a[242:243], v28 offset:27648
    buffer_load_dwordx4 v17, s[4:7], s28 offen offset:1024 lds
    v_mfma_f32_32x32x16_bf16 v[80:95], a[180:183], a[76:79], v[80:95]
    ds_read_b64_tr_b16 a[244:245], v29 offset:26624
    ds_read_b64_tr_b16 a[246:247], v29 offset:27648
    s_add_u32 s28, s28, 32768
    v_mfma_f32_32x32x16_bf16 v[96:111], a[184:187], a[76:79], v[96:111]
    ds_read_b64_tr_b16 a[248:249], v30 offset:26624
    ds_read_b64_tr_b16 a[250:251], v30 offset:27648
    s_add_u32 s29, s29, 2048
    v_mfma_f32_32x32x16_bf16 v[112:127], a[188:191], a[76:79], v[112:127]
    ds_read_b64_tr_b16 a[252:253], v31 offset:26624
    ds_read_b64_tr_b16 a[254:255], v31 offset:27648
    s_waitcnt vmcnt(16) lgkmcnt(0)
    s_barrier
    v_mfma_f32_32x32x16_bf16 v[64:79], a[192:195], a[80:83], v[64:79]
    ds_read_b64_tr_b16 a[128:129], v28 offset:32768
    ds_read_b64_tr_b16 a[130:131], v28 offset:33792
    s_add_u32 m0, s30, 16384
    v_mfma_f32_32x32x16_bf16 v[80:95], a[196:199], a[80:83], v[80:95]
    ds_read_b64_tr_b16 a[132:133], v29 offset:32768
    ds_read_b64_tr_b16 a[134:135], v29 offset:33792
    buffer_load_dwordx4 a[16:19], v6, s[8:11], s29 offen offset:0
    v_mfma_f32_32x32x16_bf16 v[96:111], a[200:203], a[80:83], v[96:111]
    ds_read_b64_tr_b16 a[136:137], v30 offset:32768
    ds_read_b64_tr_b16 a[138:139], v30 offset:33792
    buffer_load_dwordx4 v16, s[4:7], s28 offen lds
    v_mfma_f32_32x32x16_bf16 v[112:127], a[204:207], a[80:83], v[112:127]
    ds_read_b64_tr_b16 a[140:141], v31 offset:32768
    ds_read_b64_tr_b16 a[142:143], v31 offset:33792
    buffer_load_dwordx4 a[20:23], v6, s[8:11], s29 offen offset:512
    v_mfma_f32_32x32x16_bf16 v[64:79], a[208:211], a[84:87], v[64:79]
    ds_read_b64_tr_b16 a[144:145], v28 offset:34816
    ds_read_b64_tr_b16 a[146:147], v28 offset:35840
    buffer_load_dwordx4 v17, s[4:7], s28 offen offset:1024 lds
    v_mfma_f32_32x32x16_bf16 v[80:95], a[212:215], a[84:87], v[80:95]
    ds_read_b64_tr_b16 a[148:149], v29 offset:34816
    ds_read_b64_tr_b16 a[150:151], v29 offset:35840
    v_mfma_f32_32x32x16_bf16 v[96:111], a[216:219], a[84:87], v[96:111]
    ds_read_b64_tr_b16 a[152:153], v30 offset:34816
    ds_read_b64_tr_b16 a[154:155], v30 offset:35840
    s_add_u32 s28, s28, 32768
    v_mfma_f32_32x32x16_bf16 v[112:127], a[220:223], a[84:87], v[112:127]
    ds_read_b64_tr_b16 a[156:157], v31 offset:34816
    ds_read_b64_tr_b16 a[158:159], v31 offset:35840
    s_add_u32 m0, s30, 24576
    v_mfma_f32_32x32x16_bf16 v[64:79], a[224:227], a[88:91], v[64:79]
    ds_read_b64_tr_b16 a[160:161], v28 offset:40960
    ds_read_b64_tr_b16 a[162:163], v28 offset:41984
    buffer_load_dwordx4 a[24:27], v6, s[8:11], s29 offen offset:1024
    v_mfma_f32_32x32x16_bf16 v[80:95], a[228:231], a[88:91], v[80:95]
    ds_read_b64_tr_b16 a[164:165], v29 offset:40960
    ds_read_b64_tr_b16 a[166:167], v29 offset:41984
    buffer_load_dwordx4 v16, s[4:7], s28 offen lds
    v_mfma_f32_32x32x16_bf16 v[96:111], a[232:235], a[88:91], v[96:111]
    ds_read_b64_tr_b16 a[168:169], v30 offset:40960
    ds_read_b64_tr_b16 a[170:171], v30 offset:41984
    v_mfma_f32_32x32x16_bf16 v[112:127], a[236:239], a[88:91], v[112:127]
    ds_read_b64_tr_b16 a[172:173], v31 offset:40960
    ds_read_b64_tr_b16 a[174:175], v31 offset:41984
    buffer_load_dwordx4 a[28:31], v6, s[8:11], s29 offen offset:1536
    v_mfma_f32_32x32x16_bf16 v[64:79], a[240:243], a[92:95], v[64:79]
    ds_read_b64_tr_b16 a[176:177], v28 offset:43008
    ds_read_b64_tr_b16 a[178:179], v28 offset:44032
    buffer_load_dwordx4 v17, s[4:7], s28 offen offset:1024 lds
    v_mfma_f32_32x32x16_bf16 v[80:95], a[244:247], a[92:95], v[80:95]
    ds_read_b64_tr_b16 a[180:181], v29 offset:43008
    ds_read_b64_tr_b16 a[182:183], v29 offset:44032
    s_add_u32 s28, s28, 32768
    v_mfma_f32_32x32x16_bf16 v[96:111], a[248:251], a[92:95], v[96:111]
    ds_read_b64_tr_b16 a[184:185], v30 offset:43008
    ds_read_b64_tr_b16 a[186:187], v30 offset:44032
    s_add_u32 s29, s29, 2048
    v_mfma_f32_32x32x16_bf16 v[112:127], a[252:255], a[92:95], v[112:127]
    ds_read_b64_tr_b16 a[188:189], v31 offset:43008
    ds_read_b64_tr_b16 a[190:191], v31 offset:44032
    s_waitcnt vmcnt(16) lgkmcnt(0)
    s_barrier
    v_mfma_f32_32x32x16_bf16 v[64:79], a[128:131], a[96:99], v[64:79]
    ds_read_b64_tr_b16 a[192:193], v28 offset:49152
    ds_read_b64_tr_b16 a[194:195], v28 offset:50176
    s_add_u32 m0, s30, 32768
    v_mfma_f32_32x32x16_bf16 v[80:95], a[132:135], a[96:99], v[80:95]
    ds_read_b64_tr_b16 a[196:197], v29 offset:49152
    ds_read_b64_tr_b16 a[198:199], v29 offset:50176
    buffer_load_dwordx4 a[32:35], v6, s[8:11], s29 offen offset:0
    v_mfma_f32_32x32x16_bf16 v[96:111], a[136:139], a[96:99], v[96:111]
    ds_read_b64_tr_b16 a[200:201], v30 offset:49152
    ds_read_b64_tr_b16 a[202:203], v30 offset:50176
    buffer_load_dwordx4 v16, s[4:7], s28 offen lds
    v_mfma_f32_32x32x16_bf16 v[112:127], a[140:143], a[96:99], v[112:127]
    ds_read_b64_tr_b16 a[204:205], v31 offset:49152
    ds_read_b64_tr_b16 a[206:207], v31 offset:50176
    buffer_load_dwordx4 a[36:39], v6, s[8:11], s29 offen offset:512
    v_mfma_f32_32x32x16_bf16 v[64:79], a[144:147], a[100:103], v[64:79]
    ds_read_b64_tr_b16 a[208:209], v28 offset:51200
    ds_read_b64_tr_b16 a[210:211], v28 offset:52224
    buffer_load_dwordx4 v17, s[4:7], s28 offen offset:1024 lds
    v_mfma_f32_32x32x16_bf16 v[80:95], a[148:151], a[100:103], v[80:95]
    ds_read_b64_tr_b16 a[212:213], v29 offset:51200
    ds_read_b64_tr_b16 a[214:215], v29 offset:52224
    v_mfma_f32_32x32x16_bf16 v[96:111], a[152:155], a[100:103], v[96:111]
    ds_read_b64_tr_b16 a[216:217], v30 offset:51200
    ds_read_b64_tr_b16 a[218:219], v30 offset:52224
    s_add_u32 s28, s28, 32768
    v_mfma_f32_32x32x16_bf16 v[112:127], a[156:159], a[100:103], v[112:127]
    ds_read_b64_tr_b16 a[220:221], v31 offset:51200
    ds_read_b64_tr_b16 a[222:223], v31 offset:52224
    s_add_u32 m0, s30, 40960
    v_mfma_f32_32x32x16_bf16 v[64:79], a[160:163], a[104:107], v[64:79]
    ds_read_b64_tr_b16 a[224:225], v28 offset:57344
    ds_read_b64_tr_b16 a[226:227], v28 offset:58368
    buffer_load_dwordx4 a[40:43], v6, s[8:11], s29 offen offset:1024
    v_mfma_f32_32x32x16_bf16 v[80:95], a[164:167], a[104:107], v[80:95]
    ds_read_b64_tr_b16 a[228:229], v29 offset:57344
    ds_read_b64_tr_b16 a[230:231], v29 offset:58368
    buffer_load_dwordx4 v16, s[4:7], s28 offen lds
    v_mfma_f32_32x32x16_bf16 v[96:111], a[168:171], a[104:107], v[96:111]
    ds_read_b64_tr_b16 a[232:233], v30 offset:57344
    ds_read_b64_tr_b16 a[234:235], v30 offset:58368
    v_mfma_f32_32x32x16_bf16 v[112:127], a[172:175], a[104:107], v[112:127]
    ds_read_b64_tr_b16 a[236:237], v31 offset:57344
    ds_read_b64_tr_b16 a[238:239], v31 offset:58368
    buffer_load_dwordx4 a[44:47], v6, s[8:11], s29 offen offset:1536
    v_mfma_f32_32x32x16_bf16 v[64:79], a[176:179], a[108:111], v[64:79]
    ds_read_b64_tr_b16 a[240:241], v28 offset:59392
    ds_read_b64_tr_b16 a[242:243], v28 offset:60416
    buffer_load_dwordx4 v17, s[4:7], s28 offen offset:1024 lds
    v_mfma_f32_32x32x16_bf16 v[80:95], a[180:183], a[108:111], v[80:95]
    ds_read_b64_tr_b16 a[244:245], v29 offset:59392
    ds_read_b64_tr_b16 a[246:247], v29 offset:60416
    s_add_u32 s28, s28, 32768
    v_mfma_f32_32x32x16_bf16 v[96:111], a[184:187], a[108:111], v[96:111]
    ds_read_b64_tr_b16 a[248:249], v30 offset:59392
    ds_read_b64_tr_b16 a[250:251], v30 offset:60416
    s_add_u32 s29, s29, 2048
    v_mfma_f32_32x32x16_bf16 v[112:127], a[188:191], a[108:111], v[112:127]
    ds_read_b64_tr_b16 a[252:253], v31 offset:59392
    ds_read_b64_tr_b16 a[254:255], v31 offset:60416
    s_waitcnt vmcnt(16) lgkmcnt(0)
    s_barrier
    v_mfma_f32_32x32x16_bf16 v[64:79], a[192:195], a[112:115], v[64:79]
    ds_read_b64_tr_b16 a[128:129], v24 offset:0
    ds_read_b64_tr_b16 a[130:131], v24 offset:1024
    s_add_u32 m0, s30, 49152
    v_mfma_f32_32x32x16_bf16 v[80:95], a[196:199], a[112:115], v[80:95]
    ds_read_b64_tr_b16 a[132:133], v25 offset:0
    ds_read_b64_tr_b16 a[134:135], v25 offset:1024
    buffer_load_dwordx4 a[48:51], v6, s[8:11], s29 offen offset:0
    v_mfma_f32_32x32x16_bf16 v[96:111], a[200:203], a[112:115], v[96:111]
    ds_read_b64_tr_b16 a[136:137], v26 offset:0
    ds_read_b64_tr_b16 a[138:139], v26 offset:1024
    buffer_load_dwordx4 v16, s[4:7], s28 offen lds
    v_mfma_f32_32x32x16_bf16 v[112:127], a[204:207], a[112:115], v[112:127]
    ds_read_b64_tr_b16 a[140:141], v27 offset:0
    ds_read_b64_tr_b16 a[142:143], v27 offset:1024
    buffer_load_dwordx4 a[52:55], v6, s[8:11], s29 offen offset:512
    v_mfma_f32_32x32x16_bf16 v[64:79], a[208:211], a[116:119], v[64:79]
    ds_read_b64_tr_b16 a[144:145], v24 offset:2048
    ds_read_b64_tr_b16 a[146:147], v24 offset:3072
    buffer_load_dwordx4 v17, s[4:7], s28 offen offset:1024 lds
    v_mfma_f32_32x32x16_bf16 v[80:95], a[212:215], a[116:119], v[80:95]
    ds_read_b64_tr_b16 a[148:149], v25 offset:2048
    ds_read_b64_tr_b16 a[150:151], v25 offset:3072
    v_mfma_f32_32x32x16_bf16 v[96:111], a[216:219], a[116:119], v[96:111]
    ds_read_b64_tr_b16 a[152:153], v26 offset:2048
    ds_read_b64_tr_b16 a[154:155], v26 offset:3072
    s_add_u32 s28, s28, 32768
    v_mfma_f32_32x32x16_bf16 v[112:127], a[220:223], a[116:119], v[112:127]
    ds_read_b64_tr_b16 a[156:157], v27 offset:2048
    ds_read_b64_tr_b16 a[158:159], v27 offset:3072
    s_add_u32 m0, s30, 57344
    v_mfma_f32_32x32x16_bf16 v[64:79], a[224:227], a[120:123], v[64:79]
    ds_read_b64_tr_b16 a[160:161], v24 offset:8192
    ds_read_b64_tr_b16 a[162:163], v24 offset:9216
    buffer_load_dwordx4 a[56:59], v6, s[8:11], s29 offen offset:1024
    v_mfma_f32_32x32x16_bf16 v[80:95], a[228:231], a[120:123], v[80:95]
    ds_read_b64_tr_b16 a[164:165], v25 offset:8192
    ds_read_b64_tr_b16 a[166:167], v25 offset:9216
    buffer_load_dwordx4 v16, s[4:7], s28 offen lds
    v_mfma_f32_32x32x16_bf16 v[96:111], a[232:235], a[120:123], v[96:111]
    ds_read_b64_tr_b16 a[168:169], v26 offset:8192
    ds_read_b64_tr_b16 a[170:171], v26 offset:9216
    v_mfma_f32_32x32x16_bf16 v[112:127], a[236:239], a[120:123], v[112:127]
    ds_read_b64_tr_b16 a[172:173], v27 offset:8192
    ds_read_b64_tr_b16 a[174:175], v27 offset:9216
    buffer_load_dwordx4 a[60:63], v6, s[8:11], s29 offen offset:1536
    v_mfma_f32_32x32x16_bf16 v[64:79], a[240:243], a[124:127], v[64:79]
    ds_read_b64_tr_b16 a[176:177], v24 offset:10240
    ds_read_b64_tr_b16 a[178:179], v24 offset:11264
    buffer_load_dwordx4 v17, s[4:7], s28 offen offset:1024 lds
    v_mfma_f32_32x32x16_bf16 v[80:95], a[244:247], a[124:127], v[80:95]
    ds_read_b64_tr_b16 a[180:181], v25 offset:10240
    ds_read_b64_tr_b16 a[182:183], v25 offset:11264
    s_add_u32 s28, s28, 32768
    v_mfma_f32_32x32x16_bf16 v[96:111], a[248:251], a[124:127], v[96:111]
    ds_read_b64_tr_b16 a[184:185], v26 offset:10240
    ds_read_b64_tr_b16 a[186:187], v26 offset:11264
    s_add_u32 s29, s29, 2048
    v_mfma_f32_32x32x16_bf16 v[112:127], a[252:255], a[124:127], v[112:127]
    ds_read_b64_tr_b16 a[188:189], v27 offset:10240
    ds_read_b64_tr_b16 a[190:191], v27 offset:11264
    s_waitcnt vmcnt(16) lgkmcnt(0)
    s_barrier
    v_mfma_f32_32x32x16_bf16 v[64:79], a[128:131], a[0:3], v[64:79]
    ds_read_b64_tr_b16 a[192:193], v24 offset:16384
    ds_read_b64_tr_b16 a[194:195], v24 offset:17408
    s_add_u32 m0, s30, 65536
    v_mfma_f32_32x32x16_bf16 v[80:95], a[132:135], a[0:3], v[80:95]
    ds_read_b64_tr_b16 a[196:197], v25 offset:16384
    ds_read_b64_tr_b16 a[198:199], v25 offset:17408
    buffer_load_dwordx4 a[64:67], v6, s[8:11], s29 offen offset:0
    v_mfma_f32_32x32x16_bf16 v[96:111], a[136:139], a[0:3], v[96:111]
    ds_read_b64_tr_b16 a[200:201], v26 offset:16384
    ds_read_b64_tr_b16 a[202:203], v26 offset:17408
    buffer_load_dwordx4 v16, s[4:7], s28 offen lds
    v_mfma_f32_32x32x16_bf16 v[112:127], a[140:143], a[0:3], v[112:127]
    ds_read_b64_tr_b16 a[204:205], v27 offset:16384
    ds_read_b64_tr_b16 a[206:207], v27 offset:17408
    buffer_load_dwordx4 a[68:71], v6, s[8:11], s29 offen offset:512
    v_mfma_f32_32x32x16_bf16 v[64:79], a[144:147], a[4:7], v[64:79]
    ds_read_b64_tr_b16 a[208:209], v24 offset:18432
    ds_read_b64_tr_b16 a[210:211], v24 offset:19456
    buffer_load_dwordx4 v17, s[4:7], s28 offen offset:1024 lds
    v_mfma_f32_32x32x16_bf16 v[80:95], a[148:151], a[4:7], v[80:95]
    ds_read_b64_tr_b16 a[212:213], v25 offset:18432
    ds_read_b64_tr_b16 a[214:215], v25 offset:19456
    v_mfma_f32_32x32x16_bf16 v[96:111], a[152:155], a[4:7], v[96:111]
    ds_read_b64_tr_b16 a[216:217], v26 offset:18432
    ds_read_b64_tr_b16 a[218:219], v26 offset:19456
    s_add_u32 s28, s28, 32768
    v_mfma_f32_32x32x16_bf16 v[112:127], a[156:159], a[4:7], v[112:127]
    ds_read_b64_tr_b16 a[220:221], v27 offset:18432
    ds_read_b64_tr_b16 a[222:223], v27 offset:19456
    s_add_u32 m0, s30, 73728
    v_mfma_f32_32x32x16_bf16 v[64:79], a[160:163], a[8:11], v[64:79]
    ds_read_b64_tr_b16 a[224:225], v24 offset:24576
    ds_read_b64_tr_b16 a[226:227], v24 offset:25600
    buffer_load_dwordx4 a[72:75], v6, s[8:11], s29 offen offset:1024
    v_mfma_f32_32x32x16_bf16 v[80:95], a[164:167], a[8:11], v[80:95]
    ds_read_b64_tr_b16 a[228:229], v25 offset:24576
    ds_read_b64_tr_b16 a[230:231], v25 offset:25600
    buffer_load_dwordx4 v16, s[4:7], s28 offen lds
    v_mfma_f32_32x32x16_bf16 v[96:111], a[168:171], a[8:11], v[96:111]
    ds_read_b64_tr_b16 a[232:233], v26 offset:24576
    ds_read_b64_tr_b16 a[234:235], v26 offset:25600
    v_mfma_f32_32x32x16_bf16 v[112:127], a[172:175], a[8:11], v[112:127]
    ds_read_b64_tr_b16 a[236:237], v27 offset:24576
    ds_read_b64_tr_b16 a[238:239], v27 offset:25600
    buffer_load_dwordx4 a[76:79], v6, s[8:11], s29 offen offset:1536
    v_mfma_f32_32x32x16_bf16 v[64:79], a[176:179], a[12:15], v[64:79]
    ds_read_b64_tr_b16 a[240:241], v24 offset:26624
    ds_read_b64_tr_b16 a[242:243], v24 offset:27648
    buffer_load_dwordx4 v17, s[4:7], s28 offen offset:1024 lds
    v_mfma_f32_32x32x16_bf16 v[80:95], a[180:183], a[12:15], v[80:95]
    ds_read_b64_tr_b16 a[244:245], v25 offset:26624
    ds_read_b64_tr_b16 a[246:247], v25 offset:27648
    s_add_u32 s28, s28, 32768
    v_mfma_f32_32x32x16_bf16 v[96:111], a[184:187], a[12:15], v[96:111]
    ds_read_b64_tr_b16 a[248:249], v26 offset:26624
    ds_read_b64_tr_b16 a[250:251], v26 offset:27648
    s_add_u32 s29, s29, 2048
    v_mfma_f32_32x32x16_bf16 v[112:127], a[188:191], a[12:15], v[112:127]
    ds_read_b64_tr_b16 a[252:253], v27 offset:26624
    ds_read_b64_tr_b16 a[254:255], v27 offset:27648
    s_waitcnt vmcnt(16) lgkmcnt(0)
    s_barrier
    v_mfma_f32_32x32x16_bf16 v[64:79], a[192:195], a[16:19], v[64:79]
    ds_read_b64_tr_b16 a[128:129], v24 offset:32768
    ds_read_b64_tr_b16 a[130:131], v24 offset:33792
    s_add_u32 m0, s30, 81920
    v_mfma_f32_32x32x16_bf16 v[80:95], a[196:199], a[16:19], v[80:95]
    ds_read_b64_tr_b16 a[132:133], v25 offset:32768
    ds_read_b64_tr_b16 a[134:135], v25 offset:33792
    buffer_load_dwordx4 a[80:83], v6, s[8:11], s29 offen offset:0
    v_mfma_f32_32x32x16_bf16 v[96:111], a[200:203], a[16:19], v[96:111]
    ds_read_b64_tr_b16 a[136:137], v26 offset:32768
    ds_read_b64_tr_b16 a[138:139], v26 offset:33792
    buffer_load_dwordx4 v16, s[4:7], s28 offen lds
    v_mfma_f32_32x32x16_bf16 v[112:127], a[204:207], a[16:19], v[112:127]
    ds_read_b64_tr_b16 a[140:141], v27 offset:32768
    ds_read_b64_tr_b16 a[142:143], v27 offset:33792
    buffer_load_dwordx4 a[84:87], v6, s[8:11], s29 offen offset:512
    v_mfma_f32_32x32x16_bf16 v[64:79], a[208:211], a[20:23], v[64:79]
    ds_read_b64_tr_b16 a[144:145], v24 offset:34816
    ds_read_b64_tr_b16 a[146:147], v24 offset:35840
    buffer_load_dwordx4 v17, s[4:7], s28 offen offset:1024 lds
    v_mfma_f32_32x32x16_bf16 v[80:95], a[212:215], a[20:23], v[80:95]
    ds_read_b64_tr_b16 a[148:149], v25 offset:34816
    ds_read_b64_tr_b16 a[150:151], v25 offset:35840
    v_mfma_f32_32x32x16_bf16 v[96:111], a[216:219], a[20:23], v[96:111]
    ds_read_b64_tr_b16 a[152:153], v26 offset:34816
    ds_read_b64_tr_b16 a[154:155], v26 offset:35840
    s_add_u32 s28, s28, 32768
    v_mfma_f32_32x32x16_bf16 v[112:127], a[220:223], a[20:23], v[112:127]
    ds_read_b64_tr_b16 a[156:157], v27 offset:34816
    ds_read_b64_tr_b16 a[158:159], v27 offset:35840
    s_add_u32 m0, s30, 90112
    v_mfma_f32_32x32x16_bf16 v[64:79], a[224:227], a[24:27], v[64:79]
    ds_read_b64_tr_b16 a[160:161], v24 offset:40960
    ds_read_b64_tr_b16 a[162:163], v24 offset:41984
    buffer_load_dwordx4 a[88:91], v6, s[8:11], s29 offen offset:1024
    v_mfma_f32_32x32x16_bf16 v[80:95], a[228:231], a[24:27], v[80:95]
    ds_read_b64_tr_b16 a[164:165], v25 offset:40960
    ds_read_b64_tr_b16 a[166:167], v25 offset:41984
    buffer_load_dwordx4 v16, s[4:7], s28 offen lds
    v_mfma_f32_32x32x16_bf16 v[96:111], a[232:235], a[24:27], v[96:111]
    ds_read_b64_tr_b16 a[168:169], v26 offset:40960
    ds_read_b64_tr_b16 a[170:171], v26 offset:41984
    v_mfma_f32_32x32x16_bf16 v[112:127], a[236:239], a[24:27], v[112:127]
    ds_read_b64_tr_b16 a[172:173], v27 offset:40960
    ds_read_b64_tr_b16 a[174:175], v27 offset:41984
    buffer_load_dwordx4 a[92:95], v6, s[8:11], s29 offen offset:1536
    v_mfma_f32_32x32x16_bf16 v[64:79], a[240:243], a[28:31], v[64:79]
    ds_read_b64_tr_b16 a[176:177], v24 offset:43008
    ds_read_b64_tr_b16 a[178:179], v24 offset:44032
    buffer_load_dwordx4 v17, s[4:7], s28 offen offset:1024 lds
    v_mfma_f32_32x32x16_bf16 v[80:95], a[244:247], a[28:31], v[80:95]
    ds_read_b64_tr_b16 a[180:181], v25 offset:43008
    ds_read_b64_tr_b16 a[182:183], v25 offset:44032
    s_add_u32 s28, s28, 32768
    v_mfma_f32_32x32x16_bf16 v[96:111], a[248:251], a[28:31], v[96:111]
    ds_read_b64_tr_b16 a[184:185], v26 offset:43008
    ds_read_b64_tr_b16 a[186:187], v26 offset:44032
    s_add_u32 s29, s29, 2048
    v_mfma_f32_32x32x16_bf16 v[112:127], a[252:255], a[28:31], v[112:127]
    ds_read_b64_tr_b16 a[188:189], v27 offset:43008
    ds_read_b64_tr_b16 a[190:191], v27 offset:44032
    s_waitcnt vmcnt(16) lgkmcnt(0)
    s_barrier
    v_mfma_f32_32x32x16_bf16 v[64:79], a[128:131], a[32:35], v[64:79]
    ds_read_b64_tr_b16 a[192:193], v24 offset:49152
    ds_read_b64_tr_b16 a[194:195], v24 offset:50176
    s_add_u32 m0, s30, 98304
    v_mfma_f32_32x32x16_bf16 v[80:95], a[132:135], a[32:35], v[80:95]
    ds_read_b64_tr_b16 a[196:197], v25 offset:49152
    ds_read_b64_tr_b16 a[198:199], v25 offset:50176
    buffer_load_dwordx4 a[96:99], v6, s[8:11], s29 offen offset:0
    v_mfma_f32_32x32x16_bf16 v[96:111], a[136:139], a[32:35], v[96:111]
    ds_read_b64_tr_b16 a[200:201], v26 offset:49152
    ds_read_b64_tr_b16 a[202:203], v26 offset:50176
    buffer_load_dwordx4 v16, s[4:7], s28 offen lds
    v_mfma_f32_32x32x16_bf16 v[112:127], a[140:143], a[32:35], v[112:127]
    ds_read_b64_tr_b16 a[204:205], v27 offset:49152
    ds_read_b64_tr_b16 a[206:207], v27 offset:50176
    buffer_load_dwordx4 a[100:103], v6, s[8:11], s29 offen offset:512
    v_mfma_f32_32x32x16_bf16 v[64:79], a[144:147], a[36:39], v[64:79]
    ds_read_b64_tr_b16 a[208:209], v24 offset:51200
    ds_read_b64_tr_b16 a[210:211], v24 offset:52224
    buffer_load_dwordx4 v17, s[4:7], s28 offen offset:1024 lds
    v_mfma_f32_32x32x16_bf16 v[80:95], a[148:151], a[36:39], v[80:95]
    ds_read_b64_tr_b16 a[212:213], v25 offset:51200
    ds_read_b64_tr_b16 a[214:215], v25 offset:52224
    v_mfma_f32_32x32x16_bf16 v[96:111], a[152:155], a[36:39], v[96:111]
    ds_read_b64_tr_b16 a[216:217], v26 offset:51200
    ds_read_b64_tr_b16 a[218:219], v26 offset:52224
    s_add_u32 s28, s28, 32768
    v_mfma_f32_32x32x16_bf16 v[112:127], a[156:159], a[36:39], v[112:127]
    ds_read_b64_tr_b16 a[220:221], v27 offset:51200
    ds_read_b64_tr_b16 a[222:223], v27 offset:52224
    s_add_u32 m0, s30, 106496
    v_mfma_f32_32x32x16_bf16 v[64:79], a[160:163], a[40:43], v[64:79]
    ds_read_b64_tr_b16 a[224:225], v24 offset:57344
    ds_read_b64_tr_b16 a[226:227], v24 offset:58368
    buffer_load_dwordx4 a[104:107], v6, s[8:11], s29 offen offset:1024
    v_mfma_f32_32x32x16_bf16 v[80:95], a[164:167], a[40:43], v[80:95]
    ds_read_b64_tr_b16 a[228:229], v25 offset:57344
    ds_read_b64_tr_b16 a[230:231], v25 offset:58368
    buffer_load_dwordx4 v16, s[4:7], s28 offen lds
    v_mfma_f32_32x32x16_bf16 v[96:111], a[168:171], a[40:43], v[96:111]
    ds_read_b64_tr_b16 a[232:233], v26 offset:57344
    ds_read_b64_tr_b16 a[234:235], v26 offset:58368
    v_mfma_f32_32x32x16_bf16 v[112:127], a[172:175], a[40:43], v[112:127]
    ds_read_b64_tr_b16 a[236:237], v27 offset:57344
    ds_read_b64_tr_b16 a[238:239], v27 offset:58368
    buffer_load_dwordx4 a[108:111], v6, s[8:11], s29 offen offset:1536
    v_mfma_f32_32x32x16_bf16 v[64:79], a[176:179], a[44:47], v[64:79]
    ds_read_b64_tr_b16 a[240:241], v24 offset:59392
    ds_read_b64_tr_b16 a[242:243], v24 offset:60416
    buffer_load_dwordx4 v17, s[4:7], s28 offen offset:1024 lds
    v_mfma_f32_32x32x16_bf16 v[80:95], a[180:183], a[44:47], v[80:95]
    ds_read_b64_tr_b16 a[244:245], v25 offset:59392
    ds_read_b64_tr_b16 a[246:247], v25 offset:60416
    s_add_u32 s28, s28, 32768
    v_mfma_f32_32x32x16_bf16 v[96:111], a[184:187], a[44:47], v[96:111]
    ds_read_b64_tr_b16 a[248:249], v26 offset:59392
    ds_read_b64_tr_b16 a[250:251], v26 offset:60416
    s_add_u32 s29, s29, 2048
    v_mfma_f32_32x32x16_bf16 v[112:127], a[188:191], a[44:47], v[112:127]
    ds_read_b64_tr_b16 a[252:253], v27 offset:59392
    ds_read_b64_tr_b16 a[254:255], v27 offset:60416
    s_waitcnt vmcnt(16) lgkmcnt(0)
    s_barrier
    v_mfma_f32_32x32x16_bf16 v[64:79], a[192:195], a[48:51], v[64:79]
    ds_read_b64_tr_b16 a[128:129], v28 offset:0
    ds_read_b64_tr_b16 a[130:131], v28 offset:1024
    v_mfma_f32_32x32x16_bf16 v[80:95], a[196:199], a[48:51], v[80:95]
    ds_read_b64_tr_b16 a[132:133], v29 offset:0
    ds_read_b64_tr_b16 a[134:135], v29 offset:1024
    v_mfma_f32_32x32x16_bf16 v[96:111], a[200:203], a[48:51], v[96:111]
    ds_read_b64_tr_b16 a[136:137], v30 offset:0
    ds_read_b64_tr_b16 a[138:139], v30 offset:1024
    v_mfma_f32_32x32x16_bf16 v[112:127], a[204:207], a[48:51], v[112:127]
    ds_read_b64_tr_b16 a[140:141], v31 offset:0
    ds_read_b64_tr_b16 a[142:143], v31 offset:1024
    v_mfma_f32_32x32x16_bf16 v[64:79], a[208:211], a[52:55], v[64:79]
    ds_read_b64_tr_b16 a[144:145], v28 offset:2048
    ds_read_b64_tr_b16 a[146:147], v28 offset:3072
    v_mfma_f32_32x32x16_bf16 v[80:95], a[212:215], a[52:55], v[80:95]
    ds_read_b64_tr_b16 a[148:149], v29 offset:2048
    ds_read_b64_tr_b16 a[150:151], v29 offset:3072
    v_mfma_f32_32x32x16_bf16 v[96:111], a[216:219], a[52:55], v[96:111]
    ds_read_b64_tr_b16 a[152:153], v30 offset:2048
    ds_read_b64_tr_b16 a[154:155], v30 offset:3072
    v_mfma_f32_32x32x16_bf16 v[112:127], a[220:223], a[52:55], v[112:127]
    ds_read_b64_tr_b16 a[156:157], v31 offset:2048
    ds_read_b64_tr_b16 a[158:159], v31 offset:3072
    v_mfma_f32_32x32x16_bf16 v[64:79], a[224:227], a[56:59], v[64:79]
    ds_read_b64_tr_b16 a[160:161], v28 offset:8192
    ds_read_b64_tr_b16 a[162:163], v28 offset:9216
    v_mfma_f32_32x32x16_bf16 v[80:95], a[228:231], a[56:59], v[80:95]
    ds_read_b64_tr_b16 a[164:165], v29 offset:8192
    ds_read_b64_tr_b16 a[166:167], v29 offset:9216
    v_mfma_f32_32x32x16_bf16 v[96:111], a[232:235], a[56:59], v[96:111]
    ds_read_b64_tr_b16 a[168:169], v30 offset:8192
    ds_read_b64_tr_b16 a[170:171], v30 offset:9216
    v_mfma_f32_32x32x16_bf16 v[112:127], a[236:239], a[56:59], v[112:127]
    ds_read_b64_tr_b16 a[172:173], v31 offset:8192
    ds_read_b64_tr_b16 a[174:175], v31 offset:9216
    v_mfma_f32_32x32x16_bf16 v[64:79], a[240:243], a[60:63], v[64:79]
    ds_read_b64_tr_b16 a[176:177], v28 offset:10240
    ds_read_b64_tr_b16 a[178:179], v28 offset:11264
    v_mfma_f32_32x32x16_bf16 v[80:95], a[244:247], a[60:63], v[80:95]
    ds_read_b64_tr_b16 a[180:181], v29 offset:10240
    ds_read_b64_tr_b16 a[182:183], v29 offset:11264
    v_mfma_f32_32x32x16_bf16 v[96:111], a[248:251], a[60:63], v[96:111]
    ds_read_b64_tr_b16 a[184:185], v30 offset:10240
    ds_read_b64_tr_b16 a[186:187], v30 offset:11264
    v_mfma_f32_32x32x16_bf16 v[112:127], a[252:255], a[60:63], v[112:127]
    ds_read_b64_tr_b16 a[188:189], v31 offset:10240
    ds_read_b64_tr_b16 a[190:191], v31 offset:11264
    s_waitcnt vmcnt(8) lgkmcnt(0)
    s_barrier
    v_mfma_f32_32x32x16_bf16 v[64:79], a[128:131], a[64:67], v[64:79]
    ds_read_b64_tr_b16 a[192:193], v28 offset:16384
    ds_read_b64_tr_b16 a[194:195], v28 offset:17408
    v_mfma_f32_32x32x16_bf16 v[80:95], a[132:135], a[64:67], v[80:95]
    ds_read_b64_tr_b16 a[196:197], v29 offset:16384
    ds_read_b64_tr_b16 a[198:199], v29 offset:17408
    v_mfma_f32_32x32x16_bf16 v[96:111], a[136:139], a[64:67], v[96:111]
    ds_read_b64_tr_b16 a[200:201], v30 offset:16384
    ds_read_b64_tr_b16 a[202:203], v30 offset:17408
    v_mfma_f32_32x32x16_bf16 v[112:127], a[140:143], a[64:67], v[112:127]
    ds_read_b64_tr_b16 a[204:205], v31 offset:16384
    ds_read_b64_tr_b16 a[206:207], v31 offset:17408
    v_mfma_f32_32x32x16_bf16 v[64:79], a[144:147], a[68:71], v[64:79]
    ds_read_b64_tr_b16 a[208:209], v28 offset:18432
    ds_read_b64_tr_b16 a[210:211], v28 offset:19456
    v_mfma_f32_32x32x16_bf16 v[80:95], a[148:151], a[68:71], v[80:95]
    ds_read_b64_tr_b16 a[212:213], v29 offset:18432
    ds_read_b64_tr_b16 a[214:215], v29 offset:19456
    v_mfma_f32_32x32x16_bf16 v[96:111], a[152:155], a[68:71], v[96:111]
    ds_read_b64_tr_b16 a[216:217], v30 offset:18432
    ds_read_b64_tr_b16 a[218:219], v30 offset:19456
    v_mfma_f32_32x32x16_bf16 v[112:127], a[156:159], a[68:71], v[112:127]
    ds_read_b64_tr_b16 a[220:221], v31 offset:18432
    ds_read_b64_tr_b16 a[222:223], v31 offset:19456
    v_mfma_f32_32x32x16_bf16 v[64:79], a[160:163], a[72:75], v[64:79]
    ds_read_b64_tr_b16 a[224:225], v28 offset:24576
    ds_read_b64_tr_b16 a[226:227], v28 offset:25600
    v_mfma_f32_32x32x16_bf16 v[80:95], a[164:167], a[72:75], v[80:95]
    ds_read_b64_tr_b16 a[228:229], v29 offset:24576
    ds_read_b64_tr_b16 a[230:231], v29 offset:25600
    v_mfma_f32_32x32x16_bf16 v[96:111], a[168:171], a[72:75], v[96:111]
    ds_read_b64_tr_b16 a[232:233], v30 offset:24576
    ds_read_b64_tr_b16 a[234:235], v30 offset:25600
    v_mfma_f32_32x32x16_bf16 v[112:127], a[172:175], a[72:75], v[112:127]
    ds_read_b64_tr_b16 a[236:237], v31 offset:24576
    ds_read_b64_tr_b16 a[238:239], v31 offset:25600
    v_mfma_f32_32x32x16_bf16 v[64:79], a[176:179], a[76:79], v[64:79]
    ds_read_b64_tr_b16 a[240:241], v28 offset:26624
    ds_read_b64_tr_b16 a[242:243], v28 offset:27648
    v_mfma_f32_32x32x16_bf16 v[80:95], a[180:183], a[76:79], v[80:95]
    ds_read_b64_tr_b16 a[244:245], v29 offset:26624
    ds_read_b64_tr_b16 a[246:247], v29 offset:27648
    v_mfma_f32_32x32x16_bf16 v[96:111], a[184:187], a[76:79], v[96:111]
    ds_read_b64_tr_b16 a[248:249], v30 offset:26624
    ds_read_b64_tr_b16 a[250:251], v30 offset:27648
    v_mfma_f32_32x32x16_bf16 v[112:127], a[188:191], a[76:79], v[112:127]
    ds_read_b64_tr_b16 a[252:253], v31 offset:26624
    ds_read_b64_tr_b16 a[254:255], v31 offset:27648
    s_waitcnt vmcnt(0) lgkmcnt(0)
    s_barrier
    v_mfma_f32_32x32x16_bf16 v[64:79], a[192:195], a[80:83], v[64:79]
    ds_read_b64_tr_b16 a[128:129], v28 offset:32768
    ds_read_b64_tr_b16 a[130:131], v28 offset:33792
    v_mfma_f32_32x32x16_bf16 v[80:95], a[196:199], a[80:83], v[80:95]
    ds_read_b64_tr_b16 a[132:133], v29 offset:32768
    ds_read_b64_tr_b16 a[134:135], v29 offset:33792
    v_mfma_f32_32x32x16_bf16 v[96:111], a[200:203], a[80:83], v[96:111]
    ds_read_b64_tr_b16 a[136:137], v30 offset:32768
    ds_read_b64_tr_b16 a[138:139], v30 offset:33792
    v_mfma_f32_32x32x16_bf16 v[112:127], a[204:207], a[80:83], v[112:127]
    ds_read_b64_tr_b16 a[140:141], v31 offset:32768
    ds_read_b64_tr_b16 a[142:143], v31 offset:33792
    v_mfma_f32_32x32x16_bf16 v[64:79], a[208:211], a[84:87], v[64:79]
    ds_read_b64_tr_b16 a[144:145], v28 offset:34816
    ds_read_b64_tr_b16 a[146:147], v28 offset:35840
    v_mfma_f32_32x32x16_bf16 v[80:95], a[212:215], a[84:87], v[80:95]
    ds_read_b64_tr_b16 a[148:149], v29 offset:34816
    ds_read_b64_tr_b16 a[150:151], v29 offset:35840
    v_mfma_f32_32x32x16_bf16 v[96:111], a[216:219], a[84:87], v[96:111]
    ds_read_b64_tr_b16 a[152:153], v30 offset:34816
    ds_read_b64_tr_b16 a[154:155], v30 offset:35840
    v_mfma_f32_32x32x16_bf16 v[112:127], a[220:223], a[84:87], v[112:127]
    ds_read_b64_tr_b16 a[156:157], v31 offset:34816
    ds_read_b64_tr_b16 a[158:159], v31 offset:35840
    v_mfma_f32_32x32x16_bf16 v[64:79], a[224:227], a[88:91], v[64:79]
    ds_read_b64_tr_b16 a[160:161], v28 offset:40960
    ds_read_b64_tr_b16 a[162:163], v28 offset:41984
    v_mfma_f32_32x32x16_bf16 v[80:95], a[228:231], a[88:91], v[80:95]
    ds_read_b64_tr_b16 a[164:165], v29 offset:40960
    ds_read_b64_tr_b16 a[166:167], v29 offset:41984
    v_mfma_f32_32x32x16_bf16 v[96:111], a[232:235], a[88:91], v[96:111]
    ds_read_b64_tr_b16 a[168:169], v30 offset:40960
    ds_read_b64_tr_b16 a[170:171], v30 offset:41984
    v_mfma_f32_32x32x16_bf16 v[112:127], a[236:239], a[88:91], v[112:127]
    ds_read_b64_tr_b16 a[172:173], v31 offset:40960
    ds_read_b64_tr_b16 a[174:175], v31 offset:41984
    v_mfma_f32_32x32x16_bf16 v[64:79], a[240:243], a[92:95], v[64:79]
    ds_read_b64_tr_b16 a[176:177], v28 offset:43008
    ds_read_b64_tr_b16 a[178:179], v28 offset:44032
    v_mfma_f32_32x32x16_bf16 v[80:95], a[244:247], a[92:95], v[80:95]
    ds_read_b64_tr_b16 a[180:181], v29 offset:43008
    ds_read_b64_tr_b16 a[182:183], v29 offset:44032
    v_mfma_f32_32x32x16_bf16 v[96:111], a[248:251], a[92:95], v[96:111]
    ds_read_b64_tr_b16 a[184:185], v30 offset:43008
    ds_read_b64_tr_b16 a[186:187], v30 offset:44032
    v_mfma_f32_32x32x16_bf16 v[112:127], a[252:255], a[92:95], v[112:127]
    ds_read_b64_tr_b16 a[188:189], v31 offset:43008
    ds_read_b64_tr_b16 a[190:191], v31 offset:44032
    s_waitcnt lgkmcnt(0)
    v_mfma_f32_32x32x16_bf16 v[64:79], a[128:131], a[96:99], v[64:79]
    v_mfma_f32_32x32x16_bf16 v[80:95], a[132:135], a[96:99], v[80:95]
    v_mfma_f32_32x32x16_bf16 v[96:111], a[136:139], a[96:99], v[96:111]
    v_mfma_f32_32x32x16_bf16 v[112:127], a[140:143], a[96:99], v[112:127]
    v_mfma_f32_32x32x16_bf16 v[64:79], a[144:147], a[100:103], v[64:79]
    v_mfma_f32_32x32x16_bf16 v[80:95], a[148:151], a[100:103], v[80:95]
    v_mfma_f32_32x32x16_bf16 v[96:111], a[152:155], a[100:103], v[96:111]
    v_mfma_f32_32x32x16_bf16 v[112:127], a[156:159], a[100:103], v[112:127]
    v_mfma_f32_32x32x16_bf16 v[64:79], a[160:163], a[104:107], v[64:79]
    v_mfma_f32_32x32x16_bf16 v[80:95], a[164:167], a[104:107], v[80:95]
    v_mfma_f32_32x32x16_bf16 v[96:111], a[168:171], a[104:107], v[96:111]
    v_mfma_f32_32x32x16_bf16 v[112:127], a[172:175], a[104:107], v[112:127]
    v_mfma_f32_32x32x16_bf16 v[64:79], a[176:179], a[108:111], v[64:79]
    v_mfma_f32_32x32x16_bf16 v[80:95], a[180:183], a[108:111], v[80:95]
    v_mfma_f32_32x32x16_bf16 v[96:111], a[184:187], a[108:111], v[96:111]
    v_mfma_f32_32x32x16_bf16 v[112:127], a[188:191], a[108:111], v[112:127]
    s_nop 7
    s_nop 7
    v_cvt_pk_bf16_f32 v208, v80, v81
    v_cvt_pk_bf16_f32 v209, v82, v83
    v_cvt_pk_bf16_f32 v210, v84, v85
    v_cvt_pk_bf16_f32 v211, v86, v87
    v_cvt_pk_bf16_f32 v212, v88, v89
    v_cvt_pk_bf16_f32 v213, v90, v91
    v_cvt_pk_bf16_f32 v214, v92, v93
    v_cvt_pk_bf16_f32 v215, v94, v95
    s_add_u32 s32, s31, 1
    s_and_b32 s32, s32, 3
    s_mul_i32 s32, s32, 5
    s_add_u32 s32, s32, s37
    s_lshl_b32 s32, s32, 13
    s_add_u32 s32, s32, s35
    buffer_store_dwordx4 v[208:211], v22, s[52:55], s32 offen offset:0 sc1
    buffer_store_dwordx4 v[212:215], v22, s[52:55], s32 offen offset:1024 sc1
    v_cvt_pk_bf16_f32 v216, v96, v97
    v_cvt_pk_bf16_f32 v217, v98, v99
    v_cvt_pk_bf16_f32 v218, v100, v101
    v_cvt_pk_bf16_f32 v219, v102, v103
    v_cvt_pk_bf16_f32 v220, v104, v105
    v_cvt_pk_bf16_f32 v221, v106, v107
    v_cvt_pk_bf16_f32 v222, v108, v109
    v_cvt_pk_bf16_f32 v223, v110, v111
    s_add_u32 s32, s31, 2
    s_and_b32 s32, s32, 3
    s_mul_i32 s32, s32, 5
    s_add_u32 s32, s32, s37
    s_lshl_b32 s32, s32, 13
    s_add_u32 s32, s32, s35
    buffer_store_dwordx4 v[216:219], v22, s[52:55], s32 offen offset:0 sc1
    buffer_store_dwordx4 v[220:223], v22, s[52:55], s32 offen offset:1024 sc1
    v_cvt_pk_bf16_f32 v224, v112, v113
    v_cvt_pk_bf16_f32 v225, v114, v115
    v_cvt_pk_bf16_f32 v226, v116, v117
    v_cvt_pk_bf16_f32 v227, v118, v119
    v_cvt_pk_bf16_f32 v228, v120, v121
    v_cvt_pk_bf16_f32 v229, v122, v123
    v_cvt_pk_bf16_f32 v230, v124, v125
    v_cvt_pk_bf16_f32 v231, v126, v127
    s_add_u32 s32, s31, 3
    s_and_b32 s32, s32, 3
    s_mul_i32 s32, s32, 5
    s_add_u32 s32, s32, s37
    s_lshl_b32 s32, s32, 13
    s_add_u32 s32, s32, s35
    buffer_store_dwordx4 v[224:227], v22, s[52:55], s32 offen offset:0 sc1
    buffer_store_dwordx4 v[228:231], v22, s[52:55], s32 offen offset:1024 sc1
    s_mov_b32 s12, s48
    s_mov_b32 s13, s49
    s_mov_b32 s14, 0x200000
    s_mov_b32 s15, 0x00020000
    s_mul_i32 s32, s31, 5
    s_lshl_b32 s32, s32, 13
    s_add_u32 s32, s32, s35
    s_cmp_eq_u32 s31, 0
    s_cselect_b32 s4, 1, 0
    s_cmp_lt_u32 s31, 2
    s_cselect_b32 s5, 2, 1
    s_cmp_eq_u32 s31, 3
    s_cselect_b32 s6, 2, 3
    s_cselect_b32 s7, 3, 4
    s_cmp_eq_u32 s31, 2
    s_cselect_b32 s6, 4, s6
    s_lshl_b32 s4, s4, 13
    s_add_u32 s4, s4, s32
    s_lshl_b32 s5, s5, 13
    s_add_u32 s5, s5, s32
    s_lshl_b32 s6, s6, 13
    s_add_u32 s6, s6, s32
    s_lshl_b32 s7, s7, 13
    s_add_u32 s7, s7, s32
    v_lshlrev_b32 v176, 16, v32
    v_and_b32 v177, 0xffff0000, v32
    v_lshlrev_b32 v178, 16, v33
    v_and_b32 v179, 0xffff0000, v33
    v_lshlrev_b32 v180, 16, v34
    v_and_b32 v181, 0xffff0000, v34
    v_lshlrev_b32 v182, 16, v35
    v_and_b32 v183, 0xffff0000, v35
    v_lshlrev_b32 v184, 16, v36
    v_and_b32 v185, 0xffff0000, v36
    v_lshlrev_b32 v186, 16, v37
    v_and_b32 v187, 0xffff0000, v37
    v_lshlrev_b32 v188, 16, v38
    v_and_b32 v189, 0xffff0000, v38
    v_lshlrev_b32 v190, 16, v39
    v_and_b32 v191, 0xffff0000, v39
    v_lshlrev_b32 v192, 16, v40
    v_and_b32 v193, 0xffff0000, v40
    v_lshlrev_b32 v194, 16, v41
    v_and_b32 v195, 0xffff0000, v41
    v_lshlrev_b32 v196, 16, v42
    v_and_b32 v197, 0xffff0000, v42
    v_lshlrev_b32 v198, 16, v43
    v_and_b32 v199, 0xffff0000, v43
    v_lshlrev_b32 v200, 16, v44
    v_and_b32 v201, 0xffff0000, v44
    v_lshlrev_b32 v202, 16, v45
    v_and_b32 v203, 0xffff0000, v45
    v_lshlrev_b32 v204, 16, v46
    v_and_b32 v205, 0xffff0000, v46
    v_lshlrev_b32 v206, 16, v47
    v_and_b32 v207, 0xffff0000, v47
    s_cmp_eq_u32 s31, 2
    s_cbranch_scc0 K1_200008
    v_add_f32 v176, v176, v128
    v_add_f32 v177, v177, v129
    v_add_f32 v178, v178, v130
    v_add_f32 v179, v179, v131
    v_add_f32 v180, v180, v132
    v_add_f32 v181, v181, v133
    v_add_f32 v182, v182, v134
    v_add_f32 v183, v183, v135
    v_add_f32 v184, v184, v136
    v_add_f32 v185, v185, v137
    v_add_f32 v186, v186, v138
    v_add_f32 v187, v187, v139
    v_add_f32 v188, v188, v140
    v_add_f32 v189, v189, v141
    v_add_f32 v190, v190, v142
    v_add_f32 v191, v191, v143
K1_200008:
    s_cmp_eq_u32 s31, 3
    s_cbranch_scc1 K2_200009
    v_mov_b32 v128, v64
    v_mov_b32 v129, v65
    v_mov_b32 v130, v66
    v_mov_b32 v131, v67
    v_mov_b32 v132, v68
    v_mov_b32 v133, v69
    v_mov_b32 v134, v70
    v_mov_b32 v135, v71
    v_mov_b32 v136, v72
    v_mov_b32 v137, v73
    v_mov_b32 v138, v74
    v_mov_b32 v139, v75
    v_mov_b32 v140, v76
    v_mov_b32 v141, v77
    v_mov_b32 v142, v78
    v_mov_b32 v143, v79
    s_branch KJ_200010
K2_200009:
    v_add_f32 v176, v176, v64
    v_add_f32 v177, v177, v65
    v_add_f32 v178, v178, v66
    v_add_f32 v179, v179, v67
    v_add_f32 v180, v180, v68
    v_add_f32 v181, v181, v69
    v_add_f32 v182, v182, v70
    v_add_f32 v183, v183, v71
    v_add_f32 v184, v184, v72
    v_add_f32 v185, v185, v73
    v_add_f32 v186, v186, v74
    v_add_f32 v187, v187, v75
    v_add_f32 v188, v188, v76
    v_add_f32 v189, v189, v77
    v_add_f32 v190, v190, v78
    v_add_f32 v191, v191, v79
KJ_200010:
    v_mov_b32 v28, 0x3f80
    v_mov_b32 v29, 0x3f800000
    s_waitcnt vmcnt(0)
    s_mov_b32 s34, 16384
FP_200011:
    buffer_load_dwordx4 v[144:147], v22, s[52:55], s4 offen offset:0 sc1
    buffer_load_dwordx4 v[148:151], v22, s[52:55], s4 offen offset:1024 sc1
    buffer_load_dwordx4 v[152:155], v22, s[52:55], s5 offen offset:0 sc1
    buffer_load_dwordx4 v[156:159], v22, s[52:55], s5 offen offset:1024 sc1
    buffer_load_dwordx4 v[160:163], v22, s[52:55], s6 offen offset:0 sc1
    buffer_load_dwordx4 v[164:167], v22, s[52:55], s6 offen offset:1024 sc1
    buffer_load_dwordx4 v[168:171], v22, s[52:55], s7 offen offset:0 sc1
    buffer_load_dwordx4 v[172:175], v22, s[52:55], s7 offen offset:1024 sc1
    s_waitcnt vmcnt(0)
    v_max3_u32 v80, v144, v145, v146
    v_max3_u32 v81, v147, v148, v149
    v_max3_u32 v82, v150, v151, v152
    v_max3_u32 v83, v153, v154, v155
    v_max3_u32 v84, v156, v157, v158
    v_max3_u32 v85, v159, v160, v161
    v_max3_u32 v86, v162, v163, v164
    v_max3_u32 v87, v165, v166, v167
    v_max3_u32 v88, v168, v169, v170
    v_max3_u32 v89, v171, v172, v173
    v_max3_u32 v80, v80, v174, v175
    v_max3_u32 v81, v81, v82, v83
    v_max3_u32 v84, v84, v85, v86
    v_max3_u32 v87, v87, v88, v89
    v_max3_u32 v80, v80, v81, v84
    v_max_u32 v80, v80, v87
    v_cmp_eq_u32 vcc, -1, v80
    s_nop 1
    s_cbranch_vccz FOK_200012
    s_sub_u32 s34, s34, 1
    s_cmp_lg_u32 s34, 0
    s_cbranch_scc1 FP_200011
FOK_200012:
    v_dot2c_f32_bf16 v128, v144, v28
    v_dot2c_f32_bf16 v129, v144, v29
    v_dot2c_f32_bf16 v130, v145, v28
    v_dot2c_f32_bf16 v131, v145, v29
    v_dot2c_f32_bf16 v132, v146, v28
    v_dot2c_f32_bf16 v133, v146, v29
    v_dot2c_f32_bf16 v134, v147, v28
    v_dot2c_f32_bf16 v135, v147, v29
    v_dot2c_f32_bf16 v136, v148, v28
    v_dot2c_f32_bf16 v137, v148, v29
    v_dot2c_f32_bf16 v138, v149, v28
    v_dot2c_f32_bf16 v139, v149, v29
    v_dot2c_f32_bf16 v140, v150, v28
    v_dot2c_f32_bf16 v141, v150, v29
    v_dot2c_f32_bf16 v142, v151, v28
    v_dot2c_f32_bf16 v143, v151, v29
    v_dot2c_f32_bf16 v128, v152, v28
    v_dot2c_f32_bf16 v129, v152, v29
    v_dot2c_f32_bf16 v130, v153, v28
    v_dot2c_f32_bf16 v131, v153, v29
    v_dot2c_f32_bf16 v132, v154, v28
    v_dot2c_f32_bf16 v133, v154, v29
    v_dot2c_f32_bf16 v134, v155, v28
    v_dot2c_f32_bf16 v135, v155, v29
    v_dot2c_f32_bf16 v136, v156, v28
    v_dot2c_f32_bf16 v137, v156, v29
    v_dot2c_f32_bf16 v138, v157, v28
    v_dot2c_f32_bf16 v139, v157, v29
    v_dot2c_f32_bf16 v140, v158, v28
    v_dot2c_f32_bf16 v141, v158, v29
    v_dot2c_f32_bf16 v142, v159, v28
    v_dot2c_f32_bf16 v143, v159, v29
    v_dot2c_f32_bf16 v176, v168, v28
    v_dot2c_f32_bf16 v177, v168, v29
    v_dot2c_f32_bf16 v178, v169, v28
    v_dot2c_f32_bf16 v179, v169, v29
    v_dot2c_f32_bf16 v180, v170, v28
    v_dot2c_f32_bf16 v181, v170, v29
    v_dot2c_f32_bf16 v182, v171, v28
    v_dot2c_f32_bf16 v183, v171, v29
    v_dot2c_f32_bf16 v184, v172, v28
    v_dot2c_f32_bf16 v185, v172, v29
    v_dot2c_f32_bf16 v186, v173, v28
    v_dot2c_f32_bf16 v187, v173, v29
    v_dot2c_f32_bf16 v188, v174, v28
    v_dot2c_f32_bf16 v189, v174, v29
    v_dot2c_f32_bf16 v190, v175, v28
    v_dot2c_f32_bf16 v191, v175, v29
    s_cmp_ge_u32 s31, 2
    s_cbranch_scc1 K3_200013
    v_dot2c_f32_bf16 v176, v160, v28
    v_dot2c_f32_bf16 v177, v160, v29
    v_dot2c_f32_bf16 v178, v161, v28
    v_dot2c_f32_bf16 v179, v161, v29
    v_dot2c_f32_bf16 v180, v162, v28
    v_dot2c_f32_bf16 v181, v162, v29
    v_dot2c_f32_bf16 v182, v163, v28
    v_dot2c_f32_bf16 v183, v163, v29
    v_dot2c_f32_bf16 v184, v164, v28
    v_dot2c_f32_bf16 v185, v164, v29
    v_dot2c_f32_bf16 v186, v165, v28
    v_dot2c_f32_bf16 v187, v165, v29
    v_dot2c_f32_bf16 v188, v166, v28
    v_dot2c_f32_bf16 v189, v166, v29
    v_dot2c_f32_bf16 v190, v167, v28
    v_dot2c_f32_bf16 v191, v167, v29
    s_branch KK_200014
K3_200013:
    s_cmp_eq_u32 s31, 3
    s_cbranch_scc0 KK_200014
    v_dot2c_f32_bf16 v128, v160, v28
    v_dot2c_f32_bf16 v129, v160, v29
    v_dot2c_f32_bf16 v130, v161, v28
    v_dot2c_f32_bf16 v131, v161, v29
    v_dot2c_f32_bf16 v132, v162, v28
    v_dot2c_f32_bf16 v133, v162, v29
    v_dot2c_f32_bf16 v134, v163, v28
    v_dot2c_f32_bf16 v135, v163, v29
    v_dot2c_f32_bf16 v136, v164, v28
    v_dot2c_f32_bf16 v137, v164, v29
    v_dot2c_f32_bf16 v138, v165, v28
    v_dot2c_f32_bf16 v139, v165, v29
    v_dot2c_f32_bf16 v140, v166, v28
    v_dot2c_f32_bf16 v141, v166, v29
    v_dot2c_f32_bf16 v142, v167, v28
    v_dot2c_f32_bf16 v143, v167, v29
KK_200014:
    s_nop 1
    v_mov_b32 v30, 0xbfb8aa3b
    v_mul_f32 v80, v30, v176
    v_mul_f32 v81, v30, v177
    v_mul_f32 v82, v30, v178
    v_mul_f32 v83, v30, v179
    v_mul_f32 v84, v30, v180
    v_mul_f32 v85, v30, v181
    v_mul_f32 v86, v30, v182
    v_mul_f32 v87, v30, v183
    v_mul_f32 v88, v30, v184
    v_mul_f32 v89, v30, v185
    v_mul_f32 v90, v30, v186
    v_mul_f32 v91, v30, v187
    v_mul_f32 v92, v30, v188
    v_mul_f32 v93, v30, v189
    v_mul_f32 v94, v30, v190
    v_mul_f32 v95, v30, v191
    v_exp_f32 v80, v80
    v_exp_f32 v81, v81
    v_exp_f32 v82, v82
    v_exp_f32 v83, v83
    v_exp_f32 v84, v84
    v_exp_f32 v85, v85
    v_exp_f32 v86, v86
    v_exp_f32 v87, v87
    v_exp_f32 v88, v88
    v_exp_f32 v89, v89
    v_exp_f32 v90, v90
    v_exp_f32 v91, v91
    v_exp_f32 v92, v92
    v_exp_f32 v93, v93
    v_exp_f32 v94, v94
    v_exp_f32 v95, v95
    s_nop 0
    v_add_f32 v80, 1.0, v80
    v_add_f32 v81, 1.0, v81
    v_add_f32 v82, 1.0, v82
    v_add_f32 v83, 1.0, v83
    v_add_f32 v84, 1.0, v84
    v_add_f32 v85, 1.0, v85
    v_add_f32 v86, 1.0, v86
    v_add_f32 v87, 1.0, v87
    v_add_f32 v88, 1.0, v88
    v_add_f32 v89, 1.0, v89
    v_add_f32 v90, 1.0, v90
    v_add_f32 v91, 1.0, v91
    v_add_f32 v92, 1.0, v92
    v_add_f32 v93, 1.0, v93
    v_add_f32 v94, 1.0, v94
    v_add_f32 v95, 1.0, v95
    v_rcp_f32 v80, v80
    v_rcp_f32 v81, v81
    v_rcp_f32 v82, v82
    v_rcp_f32 v83, v83
    v_rcp_f32 v84, v84
    v_rcp_f32 v85, v85
    v_rcp_f32 v86, v86
    v_rcp_f32 v87, v87
    v_rcp_f32 v88, v88
    v_rcp_f32 v89, v89
    v_rcp_f32 v90, v90
    v_rcp_f32 v91, v91
    v_rcp_f32 v92, v92
    v_rcp_f32 v93, v93
    v_rcp_f32 v94, v94
    v_rcp_f32 v95, v95
    s_nop 0
    v_mul_f32 v176, v176, v80
    v_mul_f32 v177, v177, v81
    v_mul_f32 v178, v178, v82
    v_mul_f32 v179, v179, v83
    v_mul_f32 v180, v180, v84
    v_mul_f32 v181, v181, v85
    v_mul_f32 v182, v182, v86
    v_mul_f32 v183, v183, v87
    v_mul_f32 v184, v184, v88
    v_mul_f32 v185, v185, v89
    v_mul_f32 v186, v186, v90
    v_mul_f32 v187, v187, v91
    v_mul_f32 v188, v188, v92
    v_mul_f32 v189, v189, v93
    v_mul_f32 v190, v190, v94
    v_mul_f32 v191, v191, v95
    v_fma_f32 v128, v128, v176, v192
    v_fma_f32 v129, v129, v177, v193
    v_fma_f32 v130, v130, v178, v194
    v_fma_f32 v131, v131, v179, v195
    v_fma_f32 v132, v132, v180, v196
    v_fma_f32 v133, v133, v181, v197
    v_fma_f32 v134, v134, v182, v198
    v_fma_f32 v135, v135, v183, v199
    v_fma_f32 v136, v136, v184, v200
    v_fma_f32 v137, v137, v185, v201
    v_fma_f32 v138, v138, v186, v202
    v_fma_f32 v139, v139, v187, v203
    v_fma_f32 v140, v140, v188, v204
    v_fma_f32 v141, v141, v189, v205
    v_fma_f32 v142, v142, v190, v206
    v_fma_f32 v143, v143, v191, v207
    v_cvt_pk_bf16_f32 v48, v128, v129
    v_cvt_pk_bf16_f32 v49, v130, v131
    v_cvt_pk_bf16_f32 v50, v132, v133
    v_cvt_pk_bf16_f32 v51, v134, v135
    v_cvt_pk_bf16_f32 v52, v136, v137
    v_cvt_pk_bf16_f32 v53, v138, v139
    v_cvt_pk_bf16_f32 v54, v140, v141
    v_cvt_pk_bf16_f32 v55, v142, v143
    buffer_store_dwordx4 v[48:51], v23, s[12:15], s61 offen
    buffer_store_dwordx4 v[52:55], v23, s[12:15], s61 offen offset:32
    s_waitcnt vmcnt(0)
END_200001:
    s_endpgm
.section .rodata,"a"
.p2align 6
.amdhsa_kernel main_kernel
  .amdhsa_next_free_vgpr 512
  .amdhsa_next_free_sgpr 102
  .amdhsa_accum_offset 256
  .amdhsa_group_segment_fixed_size 0
  .amdhsa_kernarg_size 112
  .amdhsa_user_sgpr_count 2
  .amdhsa_user_sgpr_kernarg_segment_ptr 1
  .amdhsa_system_sgpr_workgroup_id_x 1
.end_amdhsa_kernel
.p2align 6
.amdhsa_kernel fin_kernel
  .amdhsa_next_free_vgpr 512
  .amdhsa_next_free_sgpr 102
  .amdhsa_accum_offset 256
  .amdhsa_group_segment_fixed_size 0
  .amdhsa_kernarg_size 112
  .amdhsa_user_sgpr_count 2
  .amdhsa_user_sgpr_kernarg_segment_ptr 1
  .amdhsa_system_sgpr_workgroup_id_x 1
.end_amdhsa_kernel
```
